```python
import torch

def _softmax(x, axis=-1):
    return torch.softmax(x, dim=axis)
def _gelu(x):
    return torch.nn.functional.gelu(x, approximate="tanh")
def _silu(x):
    return torch.nn.functional.silu(x)
def _sigmoid(x):
    return torch.sigmoid(x)
def _layernorm(x, axis=-1, eps=1e-5):
    m = x.mean(dim=axis, keepdim=True)
    v = x.var(dim=axis, keepdim=True, unbiased=False)
    return (x - m) / torch.sqrt(v + eps)
def _scatter_add(tgt, idx, src, axis=0):
    return tgt.clone().index_add_(axis, idx, src)
def _segment_sum(src, seg, n):
    out = torch.zeros((n,) + src.shape[1:], dtype=src.dtype)
    return out.index_add_(0, seg, src)
def _pad(x, pw):
    flat = tuple(v for pair in reversed(pw) for v in pair)
    return torch.nn.functional.pad(x, flat)

kernel_name = 'parallel_sum__softmax_full_mha__mixer_s_mlp__prompt'

def setup_inputs():

    _w = (lambda a: (lambda t: t.to(torch.bfloat16) if t.is_floating_point() else t)(torch.as_tensor(a)))
    def _A_setup():
        B, S, D = 1, 2048, 576
        return {
            "x": _w((lambda *s: torch.randn(*s, dtype=torch.bfloat16) * 0.05)(B, S, D)),
            "wqkv": _w((lambda *s: torch.randn(*s, dtype=torch.bfloat16) * 0.1)(D, 3 * D)),
            "wo": _w((lambda *s: torch.randn(*s, dtype=torch.bfloat16) * 0.05)(D, D)),
        }
    _A_in = _A_setup()

    def _B_setup():
        B, S, D, F = 1, 2048, 576, 4608
        return {
            "x":  _w((lambda *s: torch.randn(*s, dtype=torch.bfloat16) * 0.05)(B, S, D)),
            "w1": _w((lambda *s: torch.randn(*s, dtype=torch.bfloat16) * 3.2)(D, D) * (D ** -0.5)),
            "w2": _w((lambda *s: torch.randn(*s, dtype=torch.bfloat16) * 3.2)(D, D) * (D ** -0.5)),
            "w3": _w((lambda *s: torch.randn(*s, dtype=torch.bfloat16) * 3.2)(D, F) * (D ** -0.5)),
            "w4": _w((lambda *s: torch.randn(*s, dtype=torch.bfloat16) * 3.2)(F, D) * (F ** -0.5)),
        }
    _B_in = _B_setup()

    return {
        "A_x": _A_in["x"],
        "A_wqkv": _A_in["wqkv"],
        "A_wo": _A_in["wo"],
        "B_x": _B_in["x"],
        "B_w1": _B_in["w1"],
        "B_w2": _B_in["w2"],
        "B_w3": _B_in["w3"],
        "B_w4": _B_in["w4"],
    }

def reference(A_x, A_wqkv, A_wo, B_x, B_w1, B_w2, B_w3, B_w4):
    def _A_ref(x, wqkv, wo):
        B, S, D = x.shape
        H = 32; Dh = D // H
        qkv = (lambda x, *d: x.permute(*d))((x @ wqkv).reshape(B, S, 3, H, Dh), 2, 0, 3, 1, 4)
        q, k, v = qkv[0], qkv[1], qkv[2]
        scale = Dh ** -0.5
        scores = torch.einsum("bhqd,bhkd->bhqk", q, k) * scale
        p = _softmax(scores, axis=-1)
        o = torch.einsum("bhqk,bhkd->bhqd", p, v)
        return (lambda x, *d: x.permute(*d))(o, 0, 2, 1, 3).reshape(B, S, D) @ wo

    def _B_ref(x, w1, w2, w3, w4):
        B, S, D = x.shape
        h = _gelu(_layernorm(x, axis=-1) @ w1)
        c = D // 4
        g0 = _pad(h[:, :, 0*c:1*c], ((0, 0), (1, 0), (0, 0)))[:, :S, :]
        g1 = _pad(h[:, :, 1*c:2*c], ((0, 0), (0, 1), (0, 0)))[:, 1:, :]
        g2 = _pad(h[:, :, 2*c:3*c], ((0, 0), (2, 0), (0, 0)))[:, :S, :]
        g3 = _pad(h[:, :, 3*c:   ], ((0, 0), (0, 2), (0, 0)))[:, 2:, :]
        hs = torch.concatenate([g0, g1, g2, g3], axis=-1) @ w2
        x1 = x + hs
        h2 = _gelu(_layernorm(x1, axis=-1) @ w3) @ w4
        return x1 + h2

    x = A_x
    xn = _layernorm(x, axis=-1)
    return x + _A_ref(xn, A_wqkv, A_wo) + _B_ref(xn, B_w1, B_w2, B_w3, B_w4)
```

```asm
; @launch kernel=parallel_sum__softmax_full_mha__mixer_s_mlp__prompt_kernel grid=(256,1,1) block=(256,1,1) lds=147968
.amdgcn_target "amdgcn-amd-amdhsa--gfx950"
.text
.globl parallel_sum__softmax_full_mha__mixer_s_mlp__prompt_kernel
.p2align 8
.type parallel_sum__softmax_full_mha__mixer_s_mlp__prompt_kernel,@function
parallel_sum__softmax_full_mha__mixer_s_mlp__prompt_kernel:
 s_cmp_ge_u32 s2, 256
 s_cbranch_scc1 L1_end
 s_load_dwordx4 s[4:7], s[0:1], 0
 s_load_dwordx4 s[52:55], s[0:1], 32
 s_load_dwordx4 s[56:59], s[0:1], 72
 s_load_dwordx4 s[96:99], s[0:1], 48
 s_load_dwordx2 s[48:49], s[0:1], 16
 v_lshlrev_b32 v253, 4, v0
 s_getpc_b64 s[100:101]
L_pc_k1a:
 s_add_u32 s100, s100, L1_pf0-L_pc_k1a
 s_addc_u32 s101, s101, 0
 global_load_dwordx4 v[248:251], v253, s[100:101]
 s_add_u32 s100, s100, 4096
 s_addc_u32 s101, s101, 0
 global_load_dwordx4 v[248:251], v253, s[100:101]
L1_pf0:
 s_lshr_b32 s3, s2, 3
 s_and_b32 s24, s2, 7
 s_lshr_b32 s26, s24, 1
 s_lshl_b32 s26, s26, 2
 s_and_b32 s21, s3, 3
 s_add_u32 s26, s26, s21
 s_lshr_b32 s3, s3, 2
 s_and_b32 s24, s24, 1
 s_lshl_b32 s24, s24, 3
 s_add_u32 s3, s3, s24
 s_lshl_b32 s3, s3, 2
 s_mov_b32 s32, 0xa9873210
 s_mov_b32 s33, 0xfedcb654
 s_mov_b32 s34, 0x32107654
 s_mov_b32 s35, 0x87654210
 s_lshr_b64 s[32:33], s[32:33], s3
 s_lshr_b64 s[34:35], s[34:35], s3
 s_and_b32 s27, s32, 15
 s_and_b32 s28, s34, 15
 s_sub_u32 s25, s27, 7
 s_min_u32 s27, s27, 7
 v_lshrrev_b32 v1, 6, v0
 v_and_b32 v255, 63, v0
 v_readfirstlane_b32 s29, v1
 s_cmp_ge_u32 s26, 9
 s_cselect_b32 s3, 9, 0
 s_sub_u32 s91, s26, s3
 s_add_u32 s28, s28, s91
 s_cmp_ge_u32 s28, 9
 s_cselect_b32 s3, 9, 0
 s_sub_u32 s28, s28, s3
 v_lshrrev_b32 v1, 3, v255
 v_mul_u32_u24 v144, 1152, v1
 v_lshrrev_b32 v1, 4, v255
 v_and_b32 v2, 7, v255
 v_xor_b32 v1, v1, v2
 v_xor_b32 v2, 4, v1
 v_lshl_add_u32 v145, v2, 4, v144
 v_add_u32 v145, 8192, v145
 v_lshl_add_u32 v144, v1, 4, v144
 s_lshl_b32 s24, s26, 2
 s_add_u32 s24, s24, s29
 s_mul_i32 s23, s24, 36864
 s_lshl_b32 s30, s29, 11
 s_add_u32 s3, s28, 0
 s_cmp_ge_u32 s3, 9
 s_cselect_b32 s41, 9, 0
 s_sub_u32 s41, s3, s41
 s_lshl_b32 s3, s41, 7
 s_add_u32 s32, s3, s23
 s_waitcnt lgkmcnt(0)
 s_mov_b32 s8, s4
 s_and_b32 s9, s5, 0xffff
 s_mov_b32 s10, 0x240000
 s_mov_b32 s11, 0x20000
 s_mov_b32 s100, s48
 s_mov_b32 s101, s49
 s_add_u32 m0, s30, 0
 s_add_u32 s20, s32, 0
 buffer_load_dwordx4 v144, s[8:11], s20 offen lds
 buffer_load_dwordx4 v145, s[8:11], s20 offen offset:1024 lds
 s_add_u32 m0, s30, 8192
 s_add_u32 s20, s32, 18432
 buffer_load_dwordx4 v144, s[8:11], s20 offen lds
 buffer_load_dwordx4 v145, s[8:11], s20 offen offset:1024 lds
 s_add_u32 s3, s28, 1
 s_cmp_ge_u32 s3, 9
 s_cselect_b32 s42, 9, 0
 s_sub_u32 s42, s3, s42
 s_lshl_b32 s3, s42, 7
 s_add_u32 s33, s3, s23
 s_add_u32 m0, s30, 16384
 s_add_u32 s20, s33, 0
 buffer_load_dwordx4 v144, s[8:11], s20 offen lds
 buffer_load_dwordx4 v145, s[8:11], s20 offen offset:1024 lds
 s_add_u32 m0, s30, 24576
 s_add_u32 s20, s33, 18432
 buffer_load_dwordx4 v144, s[8:11], s20 offen lds
 buffer_load_dwordx4 v145, s[8:11], s20 offen offset:1024 lds
 s_add_u32 s3, s28, 2
 s_cmp_ge_u32 s3, 9
 s_cselect_b32 s43, 9, 0
 s_sub_u32 s43, s3, s43
 s_lshl_b32 s3, s43, 7
 s_add_u32 s34, s3, s23
 s_add_u32 m0, s30, 32768
 s_add_u32 s20, s34, 0
 buffer_load_dwordx4 v144, s[8:11], s20 offen lds
 buffer_load_dwordx4 v145, s[8:11], s20 offen offset:1024 lds
 s_add_u32 m0, s30, 40960
 s_add_u32 s20, s34, 18432
 buffer_load_dwordx4 v144, s[8:11], s20 offen lds
 buffer_load_dwordx4 v145, s[8:11], s20 offen offset:1024 lds
 s_add_u32 s3, s28, 3
 s_cmp_ge_u32 s3, 9
 s_cselect_b32 s44, 9, 0
 s_sub_u32 s44, s3, s44
 s_lshl_b32 s3, s44, 7
 s_add_u32 s35, s3, s23
 s_add_u32 s3, s28, 4
 s_cmp_ge_u32 s3, 9
 s_cselect_b32 s45, 9, 0
 s_sub_u32 s45, s3, s45
 s_lshl_b32 s3, s45, 7
 s_add_u32 s36, s3, s23
 s_add_u32 s3, s28, 5
 s_cmp_ge_u32 s3, 9
 s_cselect_b32 s46, 9, 0
 s_sub_u32 s46, s3, s46
 s_lshl_b32 s3, s46, 7
 s_add_u32 s37, s3, s23
 s_add_u32 s3, s28, 6
 s_cmp_ge_u32 s3, 9
 s_cselect_b32 s47, 9, 0
 s_sub_u32 s47, s3, s47
 s_lshl_b32 s3, s47, 7
 s_add_u32 s38, s3, s23
 s_add_u32 s3, s28, 7
 s_cmp_ge_u32 s3, 9
 s_cselect_b32 s48, 9, 0
 s_sub_u32 s48, s3, s48
 s_lshl_b32 s3, s48, 7
 s_add_u32 s39, s3, s23
 s_add_u32 s3, s28, 8
 s_cmp_ge_u32 s3, 9
 s_cselect_b32 s49, 9, 0
 s_sub_u32 s49, s3, s49
 s_lshl_b32 s3, s49, 7
 s_add_u32 s40, s3, s23
 s_mov_b32 s16, s58
 s_and_b32 s17, s59, 0xffff
 s_mov_b32 s18, 0x2447200
 s_mov_b32 s19, 0x20000
 s_mov_b32 s60, s54
 s_and_b32 s61, s55, 0xffff
 s_mov_b32 s62, 0xa2000
 s_mov_b32 s63, 0x20000
 s_and_b32 s57, s57, 0xffff
 s_movk_i32 s58, 256
 s_mov_b32 s59, 0x20000
 s_mov_b32 s14, 1990656
 s_movk_i32 s31, 3456
 s_lshl_b32 s3, s27, 9
 s_lshl_b32 s25, s25, 7
 s_cmp_eq_u32 s27, 7
 s_cselect_b32 s12, s52, s6
 s_cselect_b32 s13, s53, s7
 s_cselect_b32 s14, 663552, s14
 s_cselect_b32 s31, 1152, s31
 s_cselect_b32 s3, s25, s3
 s_and_b32 s13, s13, 0xffff
 s_mov_b32 s15, 0x20000
 s_lshl_b32 s4, s31, 6
 s_mul_i32 s41, s41, s4
 s_add_u32 s41, s41, s3
 s_mul_i32 s42, s42, s4
 s_add_u32 s42, s42, s3
 s_mul_i32 s43, s43, s4
 s_add_u32 s43, s43, s3
 s_mul_i32 s44, s44, s4
 s_add_u32 s44, s44, s3
 s_mul_i32 s45, s45, s4
 s_add_u32 s45, s45, s3
 s_mul_i32 s46, s46, s4
 s_add_u32 s46, s46, s3
 s_mul_i32 s47, s47, s4
 s_add_u32 s47, s47, s3
 s_mul_i32 s48, s48, s4
 s_add_u32 s48, s48, s3
 s_mul_i32 s49, s49, s4
 s_add_u32 s49, s49, s3
 s_lshl_b32 s23, s29, 4
 v_lshrrev_b32 v1, 3, v255
 v_add_u32 v1, s23, v1
 v_mul_lo_u32 v238, v1, s31
 v_bfe_u32 v1, v255, 4, 1
 v_lshlrev_b32 v1, 2, v1
 v_and_b32 v239, 7, v255
 v_xor_b32 v1, v1, v239
 v_lshl_add_u32 v238, v1, 4, v238
 s_lshl_b32 s3, s31, 3
 s_sub_u32 s3, s3, 1024
 v_add_u32 v239, s3, v238
 v_bfe_u32 v1, v255, 2, 2
 v_lshrrev_b32 v2, 5, v255
 v_lshl_add_u32 v2, v2, 3, v1
 v_lshlrev_b32 v232, 7, v2
 v_lshrrev_b32 v1, 1, v1
 v_lshl_add_u32 v232, v1, 6, v232
 v_bfe_u32 v1, v255, 4, 1
 v_lshl_add_u32 v232, v1, 5, v232
 v_and_b32 v1, 3, v255
 v_lshl_add_u32 v232, v1, 3, v232
 v_xor_b32 v233, 64, v232
 v_add_u32 v234, 49152, v232
 v_add_u32 v235, 49152, v233
 v_add_u32 v236, 98304, v232
 v_add_u32 v237, 98304, v233
 v_and_b32 v1, 31, v255
 v_lshrrev_b32 v244, 5, v255
 v_lshrrev_b32 v2, 4, v1
 v_lshlrev_b32 v2, 13, v2
 v_add_u32 v2, s30, v2
 v_and_b32 v3, 15, v1
 v_lshl_add_u32 v2, v3, 7, v2
 v_bfe_u32 v3, v1, 1, 3
 v_xor_b32 v3, v3, v244
 v_xor_b32 v4, 0, v3
 v_lshl_add_u32 v146, v4, 4, v2
 v_xor_b32 v4, 2, v3
 v_lshl_add_u32 v147, v4, 4, v2
 v_xor_b32 v4, 4, v3
 v_lshl_add_u32 v148, v4, 4, v2
 v_xor_b32 v4, 6, v3
 v_lshl_add_u32 v149, v4, 4, v2
 s_xor_b32 s3, s27, 6
 s_or_b32 s3, s3, s26
 s_or_b32 s3, s3, s29
 s_cmp_lg_u32 s3, 0
 s_cbranch_scc1 L1_nz
 v_mov_b32 v176, 0
 v_lshlrev_b32 v177, 7, v255
 s_mov_b32 s3, 19128832
 buffer_store_dword v176, v177, s[16:19], s3 offen sc1
 s_add_u32 s3, s3, 8192
 buffer_store_dword v176, v177, s[16:19], s3 offen sc1
 s_add_u32 s3, s3, 8192
 buffer_store_dword v176, v177, s[16:19], s3 offen sc1
 s_add_u32 s3, s3, 8192
 s_waitcnt vmcnt(0)
 v_mov_b32 v177, 1
 buffer_store_dword v177, v176, s[56:59], 0 offen sc1
L1_nz:
 v_lshlrev_b32 v254, 4, v255
 v_lshlrev_b32 v243, 4, v1
 s_lshl_b32 s3, s29, 7
 s_add_u32 s3, s3, 147456
 v_lshl_add_u32 v246, v1, 2, s3
 v_lshl_add_u32 v247, v244, 4, s3
 s_mov_b32 s22, 0x3f803f80
 s_mov_b32 s50, 0x00003f80
 s_mov_b32 s51, 0x3f800000
 v_mov_b32 v152, 0
 v_mov_b32 v153, 0
 v_mov_b32 v154, 0
 v_mov_b32 v155, 0
 s_waitcnt vmcnt(8)
 ds_read_b128 v[0:3], v146 offset:0
 ds_read_b128 v[4:7], v147 offset:0
 ds_read_b128 v[8:11], v148 offset:0
 ds_read_b128 v[12:15], v149 offset:0
 s_add_u32 m0, s30, 49152
 s_add_u32 s20, s35, 0
 buffer_load_dwordx4 v144, s[8:11], s20 offen lds
 buffer_load_dwordx4 v145, s[8:11], s20 offen offset:1024 lds
 s_add_u32 m0, s30, 57344
 s_add_u32 s20, s35, 18432
 buffer_load_dwordx4 v144, s[8:11], s20 offen lds
 buffer_load_dwordx4 v145, s[8:11], s20 offen offset:1024 lds
 s_cmp_lg_u32 s91, 0
 s_cbranch_scc1 L1_nc0
 ds_read_b128 v[192:195], v146 offset:0
 ds_read_b128 v[196:199], v147 offset:0
 ds_read_b128 v[200:203], v148 offset:0
 ds_read_b128 v[204:207], v149 offset:0
L1_nc0:
 s_waitcnt lgkmcnt(0)
 s_waitcnt vmcnt(8)
 ds_read_b128 v[16:19], v146 offset:16384
 ds_read_b128 v[20:23], v147 offset:16384
 ds_read_b128 v[24:27], v148 offset:16384
 ds_read_b128 v[28:31], v149 offset:16384
 s_add_u32 m0, s30, 65536
 s_add_u32 s20, s36, 0
 buffer_load_dwordx4 v144, s[8:11], s20 offen lds
 buffer_load_dwordx4 v145, s[8:11], s20 offen offset:1024 lds
 s_add_u32 m0, s30, 73728
 s_add_u32 s20, s36, 18432
 buffer_load_dwordx4 v144, s[8:11], s20 offen lds
 buffer_load_dwordx4 v145, s[8:11], s20 offen offset:1024 lds
 v_dot2_f32_bf16 v152, v0, s22, v152
 v_dot2_f32_bf16 v154, v0, v0, v154
 v_dot2_f32_bf16 v153, v1, s22, v153
 v_dot2_f32_bf16 v155, v1, v1, v155
 v_dot2_f32_bf16 v152, v2, s22, v152
 v_dot2_f32_bf16 v154, v2, v2, v154
 v_dot2_f32_bf16 v153, v3, s22, v153
 v_dot2_f32_bf16 v155, v3, v3, v155
 v_dot2_f32_bf16 v152, v4, s22, v152
 v_dot2_f32_bf16 v154, v4, v4, v154
 v_dot2_f32_bf16 v153, v5, s22, v153
 v_dot2_f32_bf16 v155, v5, v5, v155
 v_dot2_f32_bf16 v152, v6, s22, v152
 v_dot2_f32_bf16 v154, v6, v6, v154
 v_dot2_f32_bf16 v153, v7, s22, v153
 v_dot2_f32_bf16 v155, v7, v7, v155
 v_dot2_f32_bf16 v152, v8, s22, v152
 v_dot2_f32_bf16 v154, v8, v8, v154
 v_dot2_f32_bf16 v153, v9, s22, v153
 v_dot2_f32_bf16 v155, v9, v9, v155
 v_dot2_f32_bf16 v152, v10, s22, v152
 v_dot2_f32_bf16 v154, v10, v10, v154
 v_dot2_f32_bf16 v153, v11, s22, v153
 v_dot2_f32_bf16 v155, v11, v11, v155
 v_dot2_f32_bf16 v152, v12, s22, v152
 v_dot2_f32_bf16 v154, v12, v12, v154
 v_dot2_f32_bf16 v153, v13, s22, v153
 v_dot2_f32_bf16 v155, v13, v13, v155
 v_dot2_f32_bf16 v152, v14, s22, v152
 v_dot2_f32_bf16 v154, v14, v14, v154
 v_dot2_f32_bf16 v153, v15, s22, v153
 v_dot2_f32_bf16 v155, v15, v15, v155
 s_cmp_lg_u32 s91, 8
 s_cbranch_scc1 L1_nc1
 ds_read_b128 v[192:195], v146 offset:16384
 ds_read_b128 v[196:199], v147 offset:16384
 ds_read_b128 v[200:203], v148 offset:16384
 ds_read_b128 v[204:207], v149 offset:16384
L1_nc1:
 s_waitcnt lgkmcnt(0)
 s_waitcnt vmcnt(8)
 ds_read_b128 v[32:35], v146 offset:32768
 ds_read_b128 v[36:39], v147 offset:32768
 ds_read_b128 v[40:43], v148 offset:32768
 ds_read_b128 v[44:47], v149 offset:32768
 s_add_u32 m0, s30, 81920
 s_add_u32 s20, s37, 0
 buffer_load_dwordx4 v144, s[8:11], s20 offen lds
 buffer_load_dwordx4 v145, s[8:11], s20 offen offset:1024 lds
 s_add_u32 m0, s30, 90112
 s_add_u32 s20, s37, 18432
 buffer_load_dwordx4 v144, s[8:11], s20 offen lds
 buffer_load_dwordx4 v145, s[8:11], s20 offen offset:1024 lds
 v_dot2_f32_bf16 v152, v16, s22, v152
 v_dot2_f32_bf16 v154, v16, v16, v154
 v_dot2_f32_bf16 v153, v17, s22, v153
 v_dot2_f32_bf16 v155, v17, v17, v155
 v_dot2_f32_bf16 v152, v18, s22, v152
 v_dot2_f32_bf16 v154, v18, v18, v154
 v_dot2_f32_bf16 v153, v19, s22, v153
 v_dot2_f32_bf16 v155, v19, v19, v155
 v_dot2_f32_bf16 v152, v20, s22, v152
 v_dot2_f32_bf16 v154, v20, v20, v154
 v_dot2_f32_bf16 v153, v21, s22, v153
 v_dot2_f32_bf16 v155, v21, v21, v155
 v_dot2_f32_bf16 v152, v22, s22, v152
 v_dot2_f32_bf16 v154, v22, v22, v154
 v_dot2_f32_bf16 v153, v23, s22, v153
 v_dot2_f32_bf16 v155, v23, v23, v155
 v_dot2_f32_bf16 v152, v24, s22, v152
 v_dot2_f32_bf16 v154, v24, v24, v154
 v_dot2_f32_bf16 v153, v25, s22, v153
 v_dot2_f32_bf16 v155, v25, v25, v155
 v_dot2_f32_bf16 v152, v26, s22, v152
 v_dot2_f32_bf16 v154, v26, v26, v154
 v_dot2_f32_bf16 v153, v27, s22, v153
 v_dot2_f32_bf16 v155, v27, v27, v155
 v_dot2_f32_bf16 v152, v28, s22, v152
 v_dot2_f32_bf16 v154, v28, v28, v154
 v_dot2_f32_bf16 v153, v29, s22, v153
 v_dot2_f32_bf16 v155, v29, v29, v155
 v_dot2_f32_bf16 v152, v30, s22, v152
 v_dot2_f32_bf16 v154, v30, v30, v154
 v_dot2_f32_bf16 v153, v31, s22, v153
 v_dot2_f32_bf16 v155, v31, v31, v155
 s_cmp_lg_u32 s91, 7
 s_cbranch_scc1 L1_nc2
 ds_read_b128 v[192:195], v146 offset:32768
 ds_read_b128 v[196:199], v147 offset:32768
 ds_read_b128 v[200:203], v148 offset:32768
 ds_read_b128 v[204:207], v149 offset:32768
L1_nc2:
 s_waitcnt lgkmcnt(0)
 s_waitcnt vmcnt(8)
 ds_read_b128 v[48:51], v146 offset:49152
 ds_read_b128 v[52:55], v147 offset:49152
 ds_read_b128 v[56:59], v148 offset:49152
 ds_read_b128 v[60:63], v149 offset:49152
 s_add_u32 m0, s30, 98304
 s_add_u32 s20, s38, 0
 buffer_load_dwordx4 v144, s[8:11], s20 offen lds
 buffer_load_dwordx4 v145, s[8:11], s20 offen offset:1024 lds
 s_add_u32 m0, s30, 106496
 s_add_u32 s20, s38, 18432
 buffer_load_dwordx4 v144, s[8:11], s20 offen lds
 buffer_load_dwordx4 v145, s[8:11], s20 offen offset:1024 lds
 v_dot2_f32_bf16 v152, v32, s22, v152
 v_dot2_f32_bf16 v154, v32, v32, v154
 v_dot2_f32_bf16 v153, v33, s22, v153
 v_dot2_f32_bf16 v155, v33, v33, v155
 v_dot2_f32_bf16 v152, v34, s22, v152
 v_dot2_f32_bf16 v154, v34, v34, v154
 v_dot2_f32_bf16 v153, v35, s22, v153
 v_dot2_f32_bf16 v155, v35, v35, v155
 v_dot2_f32_bf16 v152, v36, s22, v152
 v_dot2_f32_bf16 v154, v36, v36, v154
 v_dot2_f32_bf16 v153, v37, s22, v153
 v_dot2_f32_bf16 v155, v37, v37, v155
 v_dot2_f32_bf16 v152, v38, s22, v152
 v_dot2_f32_bf16 v154, v38, v38, v154
 v_dot2_f32_bf16 v153, v39, s22, v153
 v_dot2_f32_bf16 v155, v39, v39, v155
 v_dot2_f32_bf16 v152, v40, s22, v152
 v_dot2_f32_bf16 v154, v40, v40, v154
 v_dot2_f32_bf16 v153, v41, s22, v153
 v_dot2_f32_bf16 v155, v41, v41, v155
 v_dot2_f32_bf16 v152, v42, s22, v152
 v_dot2_f32_bf16 v154, v42, v42, v154
 v_dot2_f32_bf16 v153, v43, s22, v153
 v_dot2_f32_bf16 v155, v43, v43, v155
 v_dot2_f32_bf16 v152, v44, s22, v152
 v_dot2_f32_bf16 v154, v44, v44, v154
 v_dot2_f32_bf16 v153, v45, s22, v153
 v_dot2_f32_bf16 v155, v45, v45, v155
 v_dot2_f32_bf16 v152, v46, s22, v152
 v_dot2_f32_bf16 v154, v46, v46, v154
 v_dot2_f32_bf16 v153, v47, s22, v153
 v_dot2_f32_bf16 v155, v47, v47, v155
 s_cmp_lg_u32 s91, 6
 s_cbranch_scc1 L1_nc3
 ds_read_b128 v[192:195], v146 offset:49152
 ds_read_b128 v[196:199], v147 offset:49152
 ds_read_b128 v[200:203], v148 offset:49152
 ds_read_b128 v[204:207], v149 offset:49152
L1_nc3:
 s_waitcnt lgkmcnt(0)
 v_add_u32 v146, 0x10000, v146
 v_add_u32 v147, 0x10000, v147
 v_add_u32 v148, 0x10000, v148
 v_add_u32 v149, 0x10000, v149
 s_waitcnt vmcnt(8)
 ds_read_b128 v[64:67], v146 offset:0
 ds_read_b128 v[68:71], v147 offset:0
 ds_read_b128 v[72:75], v148 offset:0
 ds_read_b128 v[76:79], v149 offset:0
 s_add_u32 m0, s30, 114688
 s_add_u32 s20, s39, 0
 buffer_load_dwordx4 v144, s[8:11], s20 offen lds
 buffer_load_dwordx4 v145, s[8:11], s20 offen offset:1024 lds
 s_add_u32 m0, s30, 122880
 s_add_u32 s20, s39, 18432
 buffer_load_dwordx4 v144, s[8:11], s20 offen lds
 buffer_load_dwordx4 v145, s[8:11], s20 offen offset:1024 lds
 v_dot2_f32_bf16 v152, v48, s22, v152
 v_dot2_f32_bf16 v154, v48, v48, v154
 v_dot2_f32_bf16 v153, v49, s22, v153
 v_dot2_f32_bf16 v155, v49, v49, v155
 v_dot2_f32_bf16 v152, v50, s22, v152
 v_dot2_f32_bf16 v154, v50, v50, v154
 v_dot2_f32_bf16 v153, v51, s22, v153
 v_dot2_f32_bf16 v155, v51, v51, v155
 v_dot2_f32_bf16 v152, v52, s22, v152
 v_dot2_f32_bf16 v154, v52, v52, v154
 v_dot2_f32_bf16 v153, v53, s22, v153
 v_dot2_f32_bf16 v155, v53, v53, v155
 v_dot2_f32_bf16 v152, v54, s22, v152
 v_dot2_f32_bf16 v154, v54, v54, v154
 v_dot2_f32_bf16 v153, v55, s22, v153
 v_dot2_f32_bf16 v155, v55, v55, v155
 v_dot2_f32_bf16 v152, v56, s22, v152
 v_dot2_f32_bf16 v154, v56, v56, v154
 v_dot2_f32_bf16 v153, v57, s22, v153
 v_dot2_f32_bf16 v155, v57, v57, v155
 v_dot2_f32_bf16 v152, v58, s22, v152
 v_dot2_f32_bf16 v154, v58, v58, v154
 v_dot2_f32_bf16 v153, v59, s22, v153
 v_dot2_f32_bf16 v155, v59, v59, v155
 v_dot2_f32_bf16 v152, v60, s22, v152
 v_dot2_f32_bf16 v154, v60, v60, v154
 v_dot2_f32_bf16 v153, v61, s22, v153
 v_dot2_f32_bf16 v155, v61, v61, v155
 v_dot2_f32_bf16 v152, v62, s22, v152
 v_dot2_f32_bf16 v154, v62, v62, v154
 v_dot2_f32_bf16 v153, v63, s22, v153
 v_dot2_f32_bf16 v155, v63, v63, v155
 s_cmp_lg_u32 s91, 5
 s_cbranch_scc1 L1_nc4
 ds_read_b128 v[192:195], v146 offset:0
 ds_read_b128 v[196:199], v147 offset:0
 ds_read_b128 v[200:203], v148 offset:0
 ds_read_b128 v[204:207], v149 offset:0
L1_nc4:
 s_waitcnt lgkmcnt(0)
 s_waitcnt vmcnt(8)
 ds_read_b128 v[80:83], v146 offset:16384
 ds_read_b128 v[84:87], v147 offset:16384
 ds_read_b128 v[88:91], v148 offset:16384
 ds_read_b128 v[92:95], v149 offset:16384
 s_add_u32 m0, s30, 131072
 s_add_u32 s20, s40, 0
 buffer_load_dwordx4 v144, s[8:11], s20 offen lds
 buffer_load_dwordx4 v145, s[8:11], s20 offen offset:1024 lds
 s_add_u32 m0, s30, 139264
 s_add_u32 s20, s40, 18432
 buffer_load_dwordx4 v144, s[8:11], s20 offen lds
 buffer_load_dwordx4 v145, s[8:11], s20 offen offset:1024 lds
 v_dot2_f32_bf16 v152, v64, s22, v152
 v_dot2_f32_bf16 v154, v64, v64, v154
 v_dot2_f32_bf16 v153, v65, s22, v153
 v_dot2_f32_bf16 v155, v65, v65, v155
 v_dot2_f32_bf16 v152, v66, s22, v152
 v_dot2_f32_bf16 v154, v66, v66, v154
 v_dot2_f32_bf16 v153, v67, s22, v153
 v_dot2_f32_bf16 v155, v67, v67, v155
 v_dot2_f32_bf16 v152, v68, s22, v152
 v_dot2_f32_bf16 v154, v68, v68, v154
 v_dot2_f32_bf16 v153, v69, s22, v153
 v_dot2_f32_bf16 v155, v69, v69, v155
 v_dot2_f32_bf16 v152, v70, s22, v152
 v_dot2_f32_bf16 v154, v70, v70, v154
 v_dot2_f32_bf16 v153, v71, s22, v153
 v_dot2_f32_bf16 v155, v71, v71, v155
 v_dot2_f32_bf16 v152, v72, s22, v152
 v_dot2_f32_bf16 v154, v72, v72, v154
 v_dot2_f32_bf16 v153, v73, s22, v153
 v_dot2_f32_bf16 v155, v73, v73, v155
 v_dot2_f32_bf16 v152, v74, s22, v152
 v_dot2_f32_bf16 v154, v74, v74, v154
 v_dot2_f32_bf16 v153, v75, s22, v153
 v_dot2_f32_bf16 v155, v75, v75, v155
 v_dot2_f32_bf16 v152, v76, s22, v152
 v_dot2_f32_bf16 v154, v76, v76, v154
 v_dot2_f32_bf16 v153, v77, s22, v153
 v_dot2_f32_bf16 v155, v77, v77, v155
 v_dot2_f32_bf16 v152, v78, s22, v152
 v_dot2_f32_bf16 v154, v78, v78, v154
 v_dot2_f32_bf16 v153, v79, s22, v153
 v_dot2_f32_bf16 v155, v79, v79, v155
 s_cmp_lg_u32 s91, 4
 s_cbranch_scc1 L1_nc5
 ds_read_b128 v[192:195], v146 offset:16384
 ds_read_b128 v[196:199], v147 offset:16384
 ds_read_b128 v[200:203], v148 offset:16384
 ds_read_b128 v[204:207], v149 offset:16384
L1_nc5:
 s_waitcnt lgkmcnt(0)
 s_waitcnt vmcnt(8)
 ds_read_b128 v[96:99], v146 offset:32768
 ds_read_b128 v[100:103], v147 offset:32768
 ds_read_b128 v[104:107], v148 offset:32768
 ds_read_b128 v[108:111], v149 offset:32768
 v_dot2_f32_bf16 v152, v80, s22, v152
 v_dot2_f32_bf16 v154, v80, v80, v154
 v_dot2_f32_bf16 v153, v81, s22, v153
 v_dot2_f32_bf16 v155, v81, v81, v155
 v_dot2_f32_bf16 v152, v82, s22, v152
 v_dot2_f32_bf16 v154, v82, v82, v154
 v_dot2_f32_bf16 v153, v83, s22, v153
 v_dot2_f32_bf16 v155, v83, v83, v155
 v_dot2_f32_bf16 v152, v84, s22, v152
 v_dot2_f32_bf16 v154, v84, v84, v154
 v_dot2_f32_bf16 v153, v85, s22, v153
 v_dot2_f32_bf16 v155, v85, v85, v155
 v_dot2_f32_bf16 v152, v86, s22, v152
 v_dot2_f32_bf16 v154, v86, v86, v154
 v_dot2_f32_bf16 v153, v87, s22, v153
 v_dot2_f32_bf16 v155, v87, v87, v155
 v_dot2_f32_bf16 v152, v88, s22, v152
 v_dot2_f32_bf16 v154, v88, v88, v154
 v_dot2_f32_bf16 v153, v89, s22, v153
 v_dot2_f32_bf16 v155, v89, v89, v155
 v_dot2_f32_bf16 v152, v90, s22, v152
 v_dot2_f32_bf16 v154, v90, v90, v154
 v_dot2_f32_bf16 v153, v91, s22, v153
 v_dot2_f32_bf16 v155, v91, v91, v155
 v_dot2_f32_bf16 v152, v92, s22, v152
 v_dot2_f32_bf16 v154, v92, v92, v154
 v_dot2_f32_bf16 v153, v93, s22, v153
 v_dot2_f32_bf16 v155, v93, v93, v155
 v_dot2_f32_bf16 v152, v94, s22, v152
 v_dot2_f32_bf16 v154, v94, v94, v154
 v_dot2_f32_bf16 v153, v95, s22, v153
 v_dot2_f32_bf16 v155, v95, v95, v155
 s_cmp_lg_u32 s91, 3
 s_cbranch_scc1 L1_nc6
 ds_read_b128 v[192:195], v146 offset:32768
 ds_read_b128 v[196:199], v147 offset:32768
 ds_read_b128 v[200:203], v148 offset:32768
 ds_read_b128 v[204:207], v149 offset:32768
L1_nc6:
 s_waitcnt lgkmcnt(0)
 s_waitcnt vmcnt(4)
 ds_read_b128 v[112:115], v146 offset:49152
 ds_read_b128 v[116:119], v147 offset:49152
 ds_read_b128 v[120:123], v148 offset:49152
 ds_read_b128 v[124:127], v149 offset:49152
 v_dot2_f32_bf16 v152, v96, s22, v152
 v_dot2_f32_bf16 v154, v96, v96, v154
 v_dot2_f32_bf16 v153, v97, s22, v153
 v_dot2_f32_bf16 v155, v97, v97, v155
 v_dot2_f32_bf16 v152, v98, s22, v152
 v_dot2_f32_bf16 v154, v98, v98, v154
 v_dot2_f32_bf16 v153, v99, s22, v153
 v_dot2_f32_bf16 v155, v99, v99, v155
 v_dot2_f32_bf16 v152, v100, s22, v152
 v_dot2_f32_bf16 v154, v100, v100, v154
 v_dot2_f32_bf16 v153, v101, s22, v153
 v_dot2_f32_bf16 v155, v101, v101, v155
 v_dot2_f32_bf16 v152, v102, s22, v152
 v_dot2_f32_bf16 v154, v102, v102, v154
 v_dot2_f32_bf16 v153, v103, s22, v153
 v_dot2_f32_bf16 v155, v103, v103, v155
 v_dot2_f32_bf16 v152, v104, s22, v152
 v_dot2_f32_bf16 v154, v104, v104, v154
 v_dot2_f32_bf16 v153, v105, s22, v153
 v_dot2_f32_bf16 v155, v105, v105, v155
 v_dot2_f32_bf16 v152, v106, s22, v152
 v_dot2_f32_bf16 v154, v106, v106, v154
 v_dot2_f32_bf16 v153, v107, s22, v153
 v_dot2_f32_bf16 v155, v107, v107, v155
 v_dot2_f32_bf16 v152, v108, s22, v152
 v_dot2_f32_bf16 v154, v108, v108, v154
 v_dot2_f32_bf16 v153, v109, s22, v153
 v_dot2_f32_bf16 v155, v109, v109, v155
 v_dot2_f32_bf16 v152, v110, s22, v152
 v_dot2_f32_bf16 v154, v110, v110, v154
 v_dot2_f32_bf16 v153, v111, s22, v153
 v_dot2_f32_bf16 v155, v111, v111, v155
 s_cmp_lg_u32 s91, 2
 s_cbranch_scc1 L1_nc7
 ds_read_b128 v[192:195], v146 offset:49152
 ds_read_b128 v[196:199], v147 offset:49152
 ds_read_b128 v[200:203], v148 offset:49152
 ds_read_b128 v[204:207], v149 offset:49152
L1_nc7:
 s_waitcnt lgkmcnt(0)
 v_add_u32 v146, 0x10000, v146
 v_add_u32 v147, 0x10000, v147
 v_add_u32 v148, 0x10000, v148
 v_add_u32 v149, 0x10000, v149
 s_waitcnt vmcnt(0)
 ds_read_b128 v[128:131], v146 offset:0
 ds_read_b128 v[132:135], v147 offset:0
 ds_read_b128 v[136:139], v148 offset:0
 ds_read_b128 v[140:143], v149 offset:0
 v_dot2_f32_bf16 v152, v112, s22, v152
 v_dot2_f32_bf16 v154, v112, v112, v154
 v_dot2_f32_bf16 v153, v113, s22, v153
 v_dot2_f32_bf16 v155, v113, v113, v155
 v_dot2_f32_bf16 v152, v114, s22, v152
 v_dot2_f32_bf16 v154, v114, v114, v154
 v_dot2_f32_bf16 v153, v115, s22, v153
 v_dot2_f32_bf16 v155, v115, v115, v155
 v_dot2_f32_bf16 v152, v116, s22, v152
 v_dot2_f32_bf16 v154, v116, v116, v154
 v_dot2_f32_bf16 v153, v117, s22, v153
 v_dot2_f32_bf16 v155, v117, v117, v155
 v_dot2_f32_bf16 v152, v118, s22, v152
 v_dot2_f32_bf16 v154, v118, v118, v154
 v_dot2_f32_bf16 v153, v119, s22, v153
 v_dot2_f32_bf16 v155, v119, v119, v155
 v_dot2_f32_bf16 v152, v120, s22, v152
 v_dot2_f32_bf16 v154, v120, v120, v154
 v_dot2_f32_bf16 v153, v121, s22, v153
 v_dot2_f32_bf16 v155, v121, v121, v155
 v_dot2_f32_bf16 v152, v122, s22, v152
 v_dot2_f32_bf16 v154, v122, v122, v154
 v_dot2_f32_bf16 v153, v123, s22, v153
 v_dot2_f32_bf16 v155, v123, v123, v155
 v_dot2_f32_bf16 v152, v124, s22, v152
 v_dot2_f32_bf16 v154, v124, v124, v154
 v_dot2_f32_bf16 v153, v125, s22, v153
 v_dot2_f32_bf16 v155, v125, v125, v155
 v_dot2_f32_bf16 v152, v126, s22, v152
 v_dot2_f32_bf16 v154, v126, v126, v154
 v_dot2_f32_bf16 v153, v127, s22, v153
 v_dot2_f32_bf16 v155, v127, v127, v155
 s_cmp_lg_u32 s91, 1
 s_cbranch_scc1 L1_nc8
 ds_read_b128 v[192:195], v146 offset:0
 ds_read_b128 v[196:199], v147 offset:0
 ds_read_b128 v[200:203], v148 offset:0
 ds_read_b128 v[204:207], v149 offset:0
L1_nc8:
 s_waitcnt lgkmcnt(0)
 s_add_u32 m0, s30, 0
 s_add_u32 s21, s41, 0
 buffer_load_dwordx4 v238, s[12:15], s21 offen lds
 buffer_load_dwordx4 v239, s[12:15], s21 offen offset:1024 lds
 v_dot2_f32_bf16 v152, v128, s22, v152
 v_dot2_f32_bf16 v154, v128, v128, v154
 v_dot2_f32_bf16 v153, v129, s22, v153
 v_dot2_f32_bf16 v155, v129, v129, v155
 v_dot2_f32_bf16 v152, v130, s22, v152
 v_dot2_f32_bf16 v154, v130, v130, v154
 v_dot2_f32_bf16 v153, v131, s22, v153
 v_dot2_f32_bf16 v155, v131, v131, v155
 v_dot2_f32_bf16 v152, v132, s22, v152
 v_dot2_f32_bf16 v154, v132, v132, v154
 v_dot2_f32_bf16 v153, v133, s22, v153
 v_dot2_f32_bf16 v155, v133, v133, v155
 v_dot2_f32_bf16 v152, v134, s22, v152
 v_dot2_f32_bf16 v154, v134, v134, v154
 v_dot2_f32_bf16 v153, v135, s22, v153
 v_dot2_f32_bf16 v155, v135, v135, v155
 v_dot2_f32_bf16 v152, v136, s22, v152
 v_dot2_f32_bf16 v154, v136, v136, v154
 v_dot2_f32_bf16 v153, v137, s22, v153
 v_dot2_f32_bf16 v155, v137, v137, v155
 v_dot2_f32_bf16 v152, v138, s22, v152
 v_dot2_f32_bf16 v154, v138, v138, v154
 v_dot2_f32_bf16 v153, v139, s22, v153
 v_dot2_f32_bf16 v155, v139, v139, v155
 v_dot2_f32_bf16 v152, v140, s22, v152
 v_dot2_f32_bf16 v154, v140, v140, v154
 v_dot2_f32_bf16 v153, v141, s22, v153
 v_dot2_f32_bf16 v155, v141, v141, v155
 v_dot2_f32_bf16 v152, v142, s22, v152
 v_dot2_f32_bf16 v154, v142, v142, v154
 v_dot2_f32_bf16 v153, v143, s22, v153
 v_dot2_f32_bf16 v155, v143, v143, v155
 s_add_u32 m0, s30, 8192
 s_add_u32 s21, s42, 0
 buffer_load_dwordx4 v238, s[12:15], s21 offen lds
 buffer_load_dwordx4 v239, s[12:15], s21 offen offset:1024 lds
 s_nop 2
 v_add_f32 v152, v152, v153
 v_add_f32 v154, v154, v155
 v_mov_b32 v153, v152
 v_mov_b32 v155, v154
 s_nop 1
 v_permlane32_swap_b32 v152, v153
 v_permlane32_swap_b32 v154, v155
 v_add_f32 v152, v152, v153
 v_add_f32 v154, v154, v155
 v_mul_f32 v240, 0xbae38e39, v152
 v_mul_f32 v154, 0x3ae38e39, v154
 v_fma_f32 v154, -v240, v240, v154
 v_max_f32 v154, 0, v154
 v_add_f32 v152, 0x3727c5ac, v154
 v_rsq_f32 v241, v152
 v_mul_f32 v152, 0x3727c5ac, v152
 v_add_f32 v152, v152, v154
 v_rsq_f32 v242, v152
 ds_write_b32 v246, v241
 s_getpc_b64 s[4:5]
L1_pcv:
 s_mov_b32 s3, L1_q-L1_pcv
 s_cmp_eq_u32 s27, 5
 s_cselect_b32 s3, L1_v4-L1_pcv, s3
 s_cmp_eq_u32 s27, 6
 s_cselect_b32 s3, L1_v3-L1_pcv, s3
 s_cmp_eq_u32 s27, 7
 s_cselect_b32 s3, L1_wm-L1_pcv, s3
 s_add_u32 s4, s4, s3
 s_addc_u32 s5, s5, 0
 s_cmp_eq_u32 s27, 7
 s_cbranch_scc1 L1_w
 s_add_u32 m0, s30, 16384
 s_add_u32 s21, s43, 0
 buffer_load_dwordx4 v238, s[12:15], s21 offen lds
 buffer_load_dwordx4 v239, s[12:15], s21 offen offset:1024 lds
 v_dot2_f32_bf16 v144, v0, s50, v240
 v_dot2_f32_bf16 v145, v0, s51, v240
 v_dot2_f32_bf16 v146, v1, s50, v240
 v_dot2_f32_bf16 v147, v1, s51, v240
 v_dot2_f32_bf16 v148, v2, s50, v240
 v_dot2_f32_bf16 v149, v2, s51, v240
 v_dot2_f32_bf16 v150, v3, s50, v240
 v_dot2_f32_bf16 v151, v3, s51, v240
 v_cvt_pk_bf16_f32 v0, v144, v145
 v_cvt_pk_bf16_f32 v1, v146, v147
 v_cvt_pk_bf16_f32 v2, v148, v149
 v_cvt_pk_bf16_f32 v3, v150, v151
 v_dot2_f32_bf16 v152, v4, s50, v240
 v_dot2_f32_bf16 v153, v4, s51, v240
 v_dot2_f32_bf16 v154, v5, s50, v240
 v_dot2_f32_bf16 v155, v5, s51, v240
 v_dot2_f32_bf16 v156, v6, s50, v240
 v_dot2_f32_bf16 v157, v6, s51, v240
 v_dot2_f32_bf16 v158, v7, s50, v240
 v_dot2_f32_bf16 v159, v7, s51, v240
 v_cvt_pk_bf16_f32 v4, v152, v153
 v_cvt_pk_bf16_f32 v5, v154, v155
 v_cvt_pk_bf16_f32 v6, v156, v157
 v_cvt_pk_bf16_f32 v7, v158, v159
 global_load_dwordx4 v[248:251], v253, s[4:5]
 s_add_u32 s4, s4, 4096
 s_addc_u32 s5, s5, 0
 v_dot2_f32_bf16 v144, v8, s50, v240
 v_dot2_f32_bf16 v145, v8, s51, v240
 v_dot2_f32_bf16 v146, v9, s50, v240
 v_dot2_f32_bf16 v147, v9, s51, v240
 v_dot2_f32_bf16 v148, v10, s50, v240
 v_dot2_f32_bf16 v149, v10, s51, v240
 v_dot2_f32_bf16 v150, v11, s50, v240
 v_dot2_f32_bf16 v151, v11, s51, v240
 v_cvt_pk_bf16_f32 v8, v144, v145
 v_cvt_pk_bf16_f32 v9, v146, v147
 v_cvt_pk_bf16_f32 v10, v148, v149
 v_cvt_pk_bf16_f32 v11, v150, v151
 v_dot2_f32_bf16 v152, v12, s50, v240
 v_dot2_f32_bf16 v153, v12, s51, v240
 v_dot2_f32_bf16 v154, v13, s50, v240
 v_dot2_f32_bf16 v155, v13, s51, v240
 v_dot2_f32_bf16 v156, v14, s50, v240
 v_dot2_f32_bf16 v157, v14, s51, v240
 v_dot2_f32_bf16 v158, v15, s50, v240
 v_dot2_f32_bf16 v159, v15, s51, v240
 v_cvt_pk_bf16_f32 v12, v152, v153
 v_cvt_pk_bf16_f32 v13, v154, v155
 v_cvt_pk_bf16_f32 v14, v156, v157
 v_cvt_pk_bf16_f32 v15, v158, v159
 s_add_u32 m0, s30, 24576
 s_add_u32 s21, s44, 0
 buffer_load_dwordx4 v238, s[12:15], s21 offen lds
 buffer_load_dwordx4 v239, s[12:15], s21 offen offset:1024 lds
 v_dot2_f32_bf16 v144, v16, s50, v240
 v_dot2_f32_bf16 v145, v16, s51, v240
 v_dot2_f32_bf16 v146, v17, s50, v240
 v_dot2_f32_bf16 v147, v17, s51, v240
 v_dot2_f32_bf16 v148, v18, s50, v240
 v_dot2_f32_bf16 v149, v18, s51, v240
 v_dot2_f32_bf16 v150, v19, s50, v240
 v_dot2_f32_bf16 v151, v19, s51, v240
 v_cvt_pk_bf16_f32 v16, v144, v145
 v_cvt_pk_bf16_f32 v17, v146, v147
 v_cvt_pk_bf16_f32 v18, v148, v149
 v_cvt_pk_bf16_f32 v19, v150, v151
 v_dot2_f32_bf16 v152, v20, s50, v240
 v_dot2_f32_bf16 v153, v20, s51, v240
 v_dot2_f32_bf16 v154, v21, s50, v240
 v_dot2_f32_bf16 v155, v21, s51, v240
 v_dot2_f32_bf16 v156, v22, s50, v240
 v_dot2_f32_bf16 v157, v22, s51, v240
 v_dot2_f32_bf16 v158, v23, s50, v240
 v_dot2_f32_bf16 v159, v23, s51, v240
 v_cvt_pk_bf16_f32 v20, v152, v153
 v_cvt_pk_bf16_f32 v21, v154, v155
 v_cvt_pk_bf16_f32 v22, v156, v157
 v_cvt_pk_bf16_f32 v23, v158, v159
 v_dot2_f32_bf16 v144, v24, s50, v240
 v_dot2_f32_bf16 v145, v24, s51, v240
 v_dot2_f32_bf16 v146, v25, s50, v240
 v_dot2_f32_bf16 v147, v25, s51, v240
 v_dot2_f32_bf16 v148, v26, s50, v240
 v_dot2_f32_bf16 v149, v26, s51, v240
 v_dot2_f32_bf16 v150, v27, s50, v240
 v_dot2_f32_bf16 v151, v27, s51, v240
 v_cvt_pk_bf16_f32 v24, v144, v145
 v_cvt_pk_bf16_f32 v25, v146, v147
 v_cvt_pk_bf16_f32 v26, v148, v149
 v_cvt_pk_bf16_f32 v27, v150, v151
 s_add_u32 m0, s30, 32768
 s_add_u32 s21, s45, 0
 buffer_load_dwordx4 v238, s[12:15], s21 offen lds
 buffer_load_dwordx4 v239, s[12:15], s21 offen offset:1024 lds
 v_dot2_f32_bf16 v152, v28, s50, v240
 v_dot2_f32_bf16 v153, v28, s51, v240
 v_dot2_f32_bf16 v154, v29, s50, v240
 v_dot2_f32_bf16 v155, v29, s51, v240
 v_dot2_f32_bf16 v156, v30, s50, v240
 v_dot2_f32_bf16 v157, v30, s51, v240
 v_dot2_f32_bf16 v158, v31, s50, v240
 v_dot2_f32_bf16 v159, v31, s51, v240
 v_cvt_pk_bf16_f32 v28, v152, v153
 v_cvt_pk_bf16_f32 v29, v154, v155
 v_cvt_pk_bf16_f32 v30, v156, v157
 v_cvt_pk_bf16_f32 v31, v158, v159
 v_dot2_f32_bf16 v144, v32, s50, v240
 v_dot2_f32_bf16 v145, v32, s51, v240
 v_dot2_f32_bf16 v146, v33, s50, v240
 v_dot2_f32_bf16 v147, v33, s51, v240
 v_dot2_f32_bf16 v148, v34, s50, v240
 v_dot2_f32_bf16 v149, v34, s51, v240
 v_dot2_f32_bf16 v150, v35, s50, v240
 v_dot2_f32_bf16 v151, v35, s51, v240
 v_cvt_pk_bf16_f32 v32, v144, v145
 v_cvt_pk_bf16_f32 v33, v146, v147
 v_cvt_pk_bf16_f32 v34, v148, v149
 v_cvt_pk_bf16_f32 v35, v150, v151
 s_add_u32 m0, s30, 40960
 s_add_u32 s21, s46, 0
 buffer_load_dwordx4 v238, s[12:15], s21 offen lds
 buffer_load_dwordx4 v239, s[12:15], s21 offen offset:1024 lds
 v_dot2_f32_bf16 v152, v36, s50, v240
 v_dot2_f32_bf16 v153, v36, s51, v240
 v_dot2_f32_bf16 v154, v37, s50, v240
 v_dot2_f32_bf16 v155, v37, s51, v240
 v_dot2_f32_bf16 v156, v38, s50, v240
 v_dot2_f32_bf16 v157, v38, s51, v240
 v_dot2_f32_bf16 v158, v39, s50, v240
 v_dot2_f32_bf16 v159, v39, s51, v240
 v_cvt_pk_bf16_f32 v36, v152, v153
 v_cvt_pk_bf16_f32 v37, v154, v155
 v_cvt_pk_bf16_f32 v38, v156, v157
 v_cvt_pk_bf16_f32 v39, v158, v159
 v_dot2_f32_bf16 v144, v40, s50, v240
 v_dot2_f32_bf16 v145, v40, s51, v240
 v_dot2_f32_bf16 v146, v41, s50, v240
 v_dot2_f32_bf16 v147, v41, s51, v240
 v_dot2_f32_bf16 v148, v42, s50, v240
 v_dot2_f32_bf16 v149, v42, s51, v240
 v_dot2_f32_bf16 v150, v43, s50, v240
 v_dot2_f32_bf16 v151, v43, s51, v240
 v_cvt_pk_bf16_f32 v40, v144, v145
 v_cvt_pk_bf16_f32 v41, v146, v147
 v_cvt_pk_bf16_f32 v42, v148, v149
 v_cvt_pk_bf16_f32 v43, v150, v151
 v_dot2_f32_bf16 v152, v44, s50, v240
 v_dot2_f32_bf16 v153, v44, s51, v240
 v_dot2_f32_bf16 v154, v45, s50, v240
 v_dot2_f32_bf16 v155, v45, s51, v240
 v_dot2_f32_bf16 v156, v46, s50, v240
 v_dot2_f32_bf16 v157, v46, s51, v240
 v_dot2_f32_bf16 v158, v47, s50, v240
 v_dot2_f32_bf16 v159, v47, s51, v240
 v_cvt_pk_bf16_f32 v44, v152, v153
 v_cvt_pk_bf16_f32 v45, v154, v155
 v_cvt_pk_bf16_f32 v46, v156, v157
 v_cvt_pk_bf16_f32 v47, v158, v159
 s_add_u32 m0, s30, 49152
 s_add_u32 s21, s47, 0
 buffer_load_dwordx4 v238, s[12:15], s21 offen lds
 buffer_load_dwordx4 v239, s[12:15], s21 offen offset:1024 lds
 v_dot2_f32_bf16 v144, v48, s50, v240
 v_dot2_f32_bf16 v145, v48, s51, v240
 v_dot2_f32_bf16 v146, v49, s50, v240
 v_dot2_f32_bf16 v147, v49, s51, v240
 v_dot2_f32_bf16 v148, v50, s50, v240
 v_dot2_f32_bf16 v149, v50, s51, v240
 v_dot2_f32_bf16 v150, v51, s50, v240
 v_dot2_f32_bf16 v151, v51, s51, v240
 v_cvt_pk_bf16_f32 v48, v144, v145
 v_cvt_pk_bf16_f32 v49, v146, v147
 v_cvt_pk_bf16_f32 v50, v148, v149
 v_cvt_pk_bf16_f32 v51, v150, v151
 v_dot2_f32_bf16 v152, v52, s50, v240
 v_dot2_f32_bf16 v153, v52, s51, v240
 v_dot2_f32_bf16 v154, v53, s50, v240
 v_dot2_f32_bf16 v155, v53, s51, v240
 v_dot2_f32_bf16 v156, v54, s50, v240
 v_dot2_f32_bf16 v157, v54, s51, v240
 v_dot2_f32_bf16 v158, v55, s50, v240
 v_dot2_f32_bf16 v159, v55, s51, v240
 v_cvt_pk_bf16_f32 v52, v152, v153
 v_cvt_pk_bf16_f32 v53, v154, v155
 v_cvt_pk_bf16_f32 v54, v156, v157
 v_cvt_pk_bf16_f32 v55, v158, v159
 s_add_u32 m0, s30, 57344
 s_add_u32 s21, s48, 0
 buffer_load_dwordx4 v238, s[12:15], s21 offen lds
 buffer_load_dwordx4 v239, s[12:15], s21 offen offset:1024 lds
 v_dot2_f32_bf16 v144, v56, s50, v240
 v_dot2_f32_bf16 v145, v56, s51, v240
 v_dot2_f32_bf16 v146, v57, s50, v240
 v_dot2_f32_bf16 v147, v57, s51, v240
 v_dot2_f32_bf16 v148, v58, s50, v240
 v_dot2_f32_bf16 v149, v58, s51, v240
 v_dot2_f32_bf16 v150, v59, s50, v240
 v_dot2_f32_bf16 v151, v59, s51, v240
 v_cvt_pk_bf16_f32 v56, v144, v145
 v_cvt_pk_bf16_f32 v57, v146, v147
 v_cvt_pk_bf16_f32 v58, v148, v149
 v_cvt_pk_bf16_f32 v59, v150, v151
 v_dot2_f32_bf16 v152, v60, s50, v240
 v_dot2_f32_bf16 v153, v60, s51, v240
 v_dot2_f32_bf16 v154, v61, s50, v240
 v_dot2_f32_bf16 v155, v61, s51, v240
 v_dot2_f32_bf16 v156, v62, s50, v240
 v_dot2_f32_bf16 v157, v62, s51, v240
 v_dot2_f32_bf16 v158, v63, s50, v240
 v_dot2_f32_bf16 v159, v63, s51, v240
 v_cvt_pk_bf16_f32 v60, v152, v153
 v_cvt_pk_bf16_f32 v61, v154, v155
 v_cvt_pk_bf16_f32 v62, v156, v157
 v_cvt_pk_bf16_f32 v63, v158, v159
 s_add_u32 m0, s30, 65536
 s_add_u32 s21, s49, 0
 buffer_load_dwordx4 v238, s[12:15], s21 offen lds
 buffer_load_dwordx4 v239, s[12:15], s21 offen offset:1024 lds
 v_dot2_f32_bf16 v144, v64, s50, v240
 v_dot2_f32_bf16 v145, v64, s51, v240
 v_dot2_f32_bf16 v146, v65, s50, v240
 v_dot2_f32_bf16 v147, v65, s51, v240
 v_dot2_f32_bf16 v148, v66, s50, v240
 v_dot2_f32_bf16 v149, v66, s51, v240
 v_dot2_f32_bf16 v150, v67, s50, v240
 v_dot2_f32_bf16 v151, v67, s51, v240
 v_cvt_pk_bf16_f32 v64, v144, v145
 v_cvt_pk_bf16_f32 v65, v146, v147
 v_cvt_pk_bf16_f32 v66, v148, v149
 v_cvt_pk_bf16_f32 v67, v150, v151
 v_dot2_f32_bf16 v152, v68, s50, v240
 v_dot2_f32_bf16 v153, v68, s51, v240
 v_dot2_f32_bf16 v154, v69, s50, v240
 v_dot2_f32_bf16 v155, v69, s51, v240
 v_dot2_f32_bf16 v156, v70, s50, v240
 v_dot2_f32_bf16 v157, v70, s51, v240
 v_dot2_f32_bf16 v158, v71, s50, v240
 v_dot2_f32_bf16 v159, v71, s51, v240
 v_cvt_pk_bf16_f32 v68, v152, v153
 v_cvt_pk_bf16_f32 v69, v154, v155
 v_cvt_pk_bf16_f32 v70, v156, v157
 v_cvt_pk_bf16_f32 v71, v158, v159
 v_dot2_f32_bf16 v144, v72, s50, v240
 v_dot2_f32_bf16 v145, v72, s51, v240
 v_dot2_f32_bf16 v146, v73, s50, v240
 v_dot2_f32_bf16 v147, v73, s51, v240
 v_dot2_f32_bf16 v148, v74, s50, v240
 v_dot2_f32_bf16 v149, v74, s51, v240
 v_dot2_f32_bf16 v150, v75, s50, v240
 v_dot2_f32_bf16 v151, v75, s51, v240
 v_cvt_pk_bf16_f32 v72, v144, v145
 v_cvt_pk_bf16_f32 v73, v146, v147
 v_cvt_pk_bf16_f32 v74, v148, v149
 v_cvt_pk_bf16_f32 v75, v150, v151
 global_load_dwordx4 v[248:251], v253, s[4:5]
 s_add_u32 s4, s4, 4096
 s_addc_u32 s5, s5, 0
 v_dot2_f32_bf16 v152, v76, s50, v240
 v_dot2_f32_bf16 v153, v76, s51, v240
 v_dot2_f32_bf16 v154, v77, s50, v240
 v_dot2_f32_bf16 v155, v77, s51, v240
 v_dot2_f32_bf16 v156, v78, s50, v240
 v_dot2_f32_bf16 v157, v78, s51, v240
 v_dot2_f32_bf16 v158, v79, s50, v240
 v_dot2_f32_bf16 v159, v79, s51, v240
 v_cvt_pk_bf16_f32 v76, v152, v153
 v_cvt_pk_bf16_f32 v77, v154, v155
 v_cvt_pk_bf16_f32 v78, v156, v157
 v_cvt_pk_bf16_f32 v79, v158, v159
 v_dot2_f32_bf16 v144, v80, s50, v240
 v_dot2_f32_bf16 v145, v80, s51, v240
 v_dot2_f32_bf16 v146, v81, s50, v240
 v_dot2_f32_bf16 v147, v81, s51, v240
 v_dot2_f32_bf16 v148, v82, s50, v240
 v_dot2_f32_bf16 v149, v82, s51, v240
 v_dot2_f32_bf16 v150, v83, s50, v240
 v_dot2_f32_bf16 v151, v83, s51, v240
 v_cvt_pk_bf16_f32 v80, v144, v145
 v_cvt_pk_bf16_f32 v81, v146, v147
 v_cvt_pk_bf16_f32 v82, v148, v149
 v_cvt_pk_bf16_f32 v83, v150, v151
 global_load_dwordx4 v[248:251], v253, s[4:5]
 s_add_u32 s4, s4, 4096
 s_addc_u32 s5, s5, 0
 v_dot2_f32_bf16 v152, v84, s50, v240
 v_dot2_f32_bf16 v153, v84, s51, v240
 v_dot2_f32_bf16 v154, v85, s50, v240
 v_dot2_f32_bf16 v155, v85, s51, v240
 v_dot2_f32_bf16 v156, v86, s50, v240
 v_dot2_f32_bf16 v157, v86, s51, v240
 v_dot2_f32_bf16 v158, v87, s50, v240
 v_dot2_f32_bf16 v159, v87, s51, v240
 v_cvt_pk_bf16_f32 v84, v152, v153
 v_cvt_pk_bf16_f32 v85, v154, v155
 v_cvt_pk_bf16_f32 v86, v156, v157
 v_cvt_pk_bf16_f32 v87, v158, v159
 v_dot2_f32_bf16 v144, v88, s50, v240
 v_dot2_f32_bf16 v145, v88, s51, v240
 v_dot2_f32_bf16 v146, v89, s50, v240
 v_dot2_f32_bf16 v147, v89, s51, v240
 v_dot2_f32_bf16 v148, v90, s50, v240
 v_dot2_f32_bf16 v149, v90, s51, v240
 v_dot2_f32_bf16 v150, v91, s50, v240
 v_dot2_f32_bf16 v151, v91, s51, v240
 v_cvt_pk_bf16_f32 v88, v144, v145
 v_cvt_pk_bf16_f32 v89, v146, v147
 v_cvt_pk_bf16_f32 v90, v148, v149
 v_cvt_pk_bf16_f32 v91, v150, v151
 v_dot2_f32_bf16 v152, v92, s50, v240
 v_dot2_f32_bf16 v153, v92, s51, v240
 v_dot2_f32_bf16 v154, v93, s50, v240
 v_dot2_f32_bf16 v155, v93, s51, v240
 v_dot2_f32_bf16 v156, v94, s50, v240
 v_dot2_f32_bf16 v157, v94, s51, v240
 v_dot2_f32_bf16 v158, v95, s50, v240
 v_dot2_f32_bf16 v159, v95, s51, v240
 v_cvt_pk_bf16_f32 v92, v152, v153
 v_cvt_pk_bf16_f32 v93, v154, v155
 v_cvt_pk_bf16_f32 v94, v156, v157
 v_cvt_pk_bf16_f32 v95, v158, v159
 global_load_dwordx4 v[248:251], v253, s[4:5]
 s_add_u32 s4, s4, 4096
 s_addc_u32 s5, s5, 0
 v_dot2_f32_bf16 v144, v96, s50, v240
 v_dot2_f32_bf16 v145, v96, s51, v240
 v_dot2_f32_bf16 v146, v97, s50, v240
 v_dot2_f32_bf16 v147, v97, s51, v240
 v_dot2_f32_bf16 v148, v98, s50, v240
 v_dot2_f32_bf16 v149, v98, s51, v240
 v_dot2_f32_bf16 v150, v99, s50, v240
 v_dot2_f32_bf16 v151, v99, s51, v240
 v_cvt_pk_bf16_f32 v96, v144, v145
 v_cvt_pk_bf16_f32 v97, v146, v147
 v_cvt_pk_bf16_f32 v98, v148, v149
 v_cvt_pk_bf16_f32 v99, v150, v151
 v_dot2_f32_bf16 v152, v100, s50, v240
 v_dot2_f32_bf16 v153, v100, s51, v240
 v_dot2_f32_bf16 v154, v101, s50, v240
 v_dot2_f32_bf16 v155, v101, s51, v240
 v_dot2_f32_bf16 v156, v102, s50, v240
 v_dot2_f32_bf16 v157, v102, s51, v240
 v_dot2_f32_bf16 v158, v103, s50, v240
 v_dot2_f32_bf16 v159, v103, s51, v240
 v_cvt_pk_bf16_f32 v100, v152, v153
 v_cvt_pk_bf16_f32 v101, v154, v155
 v_cvt_pk_bf16_f32 v102, v156, v157
 v_cvt_pk_bf16_f32 v103, v158, v159
 global_load_dwordx4 v[248:251], v253, s[4:5]
 s_add_u32 s4, s4, 4096
 s_addc_u32 s5, s5, 0
 v_dot2_f32_bf16 v144, v104, s50, v240
 v_dot2_f32_bf16 v145, v104, s51, v240
 v_dot2_f32_bf16 v146, v105, s50, v240
 v_dot2_f32_bf16 v147, v105, s51, v240
 v_dot2_f32_bf16 v148, v106, s50, v240
 v_dot2_f32_bf16 v149, v106, s51, v240
 v_dot2_f32_bf16 v150, v107, s50, v240
 v_dot2_f32_bf16 v151, v107, s51, v240
 v_cvt_pk_bf16_f32 v104, v144, v145
 v_cvt_pk_bf16_f32 v105, v146, v147
 v_cvt_pk_bf16_f32 v106, v148, v149
 v_cvt_pk_bf16_f32 v107, v150, v151
 v_dot2_f32_bf16 v152, v108, s50, v240
 v_dot2_f32_bf16 v153, v108, s51, v240
 v_dot2_f32_bf16 v154, v109, s50, v240
 v_dot2_f32_bf16 v155, v109, s51, v240
 v_dot2_f32_bf16 v156, v110, s50, v240
 v_dot2_f32_bf16 v157, v110, s51, v240
 v_dot2_f32_bf16 v158, v111, s50, v240
 v_dot2_f32_bf16 v159, v111, s51, v240
 v_cvt_pk_bf16_f32 v108, v152, v153
 v_cvt_pk_bf16_f32 v109, v154, v155
 v_cvt_pk_bf16_f32 v110, v156, v157
 v_cvt_pk_bf16_f32 v111, v158, v159
 s_add_u32 m0, s30, 73728
 s_add_u32 s21, s41, 128
 buffer_load_dwordx4 v238, s[12:15], s21 offen lds
 buffer_load_dwordx4 v239, s[12:15], s21 offen offset:1024 lds
 v_dot2_f32_bf16 v144, v112, s50, v240
 v_dot2_f32_bf16 v145, v112, s51, v240
 v_dot2_f32_bf16 v146, v113, s50, v240
 v_dot2_f32_bf16 v147, v113, s51, v240
 v_dot2_f32_bf16 v148, v114, s50, v240
 v_dot2_f32_bf16 v149, v114, s51, v240
 v_dot2_f32_bf16 v150, v115, s50, v240
 v_dot2_f32_bf16 v151, v115, s51, v240
 v_cvt_pk_bf16_f32 v112, v144, v145
 v_cvt_pk_bf16_f32 v113, v146, v147
 v_cvt_pk_bf16_f32 v114, v148, v149
 v_cvt_pk_bf16_f32 v115, v150, v151
 v_dot2_f32_bf16 v152, v116, s50, v240
 v_dot2_f32_bf16 v153, v116, s51, v240
 v_dot2_f32_bf16 v154, v117, s50, v240
 v_dot2_f32_bf16 v155, v117, s51, v240
 v_dot2_f32_bf16 v156, v118, s50, v240
 v_dot2_f32_bf16 v157, v118, s51, v240
 v_dot2_f32_bf16 v158, v119, s50, v240
 v_dot2_f32_bf16 v159, v119, s51, v240
 v_cvt_pk_bf16_f32 v116, v152, v153
 v_cvt_pk_bf16_f32 v117, v154, v155
 v_cvt_pk_bf16_f32 v118, v156, v157
 v_cvt_pk_bf16_f32 v119, v158, v159
 v_dot2_f32_bf16 v144, v120, s50, v240
 v_dot2_f32_bf16 v145, v120, s51, v240
 v_dot2_f32_bf16 v146, v121, s50, v240
 v_dot2_f32_bf16 v147, v121, s51, v240
 v_dot2_f32_bf16 v148, v122, s50, v240
 v_dot2_f32_bf16 v149, v122, s51, v240
 v_dot2_f32_bf16 v150, v123, s50, v240
 v_dot2_f32_bf16 v151, v123, s51, v240
 v_cvt_pk_bf16_f32 v120, v144, v145
 v_cvt_pk_bf16_f32 v121, v146, v147
 v_cvt_pk_bf16_f32 v122, v148, v149
 v_cvt_pk_bf16_f32 v123, v150, v151
 s_add_u32 m0, s30, 81920
 s_add_u32 s21, s42, 128
 buffer_load_dwordx4 v238, s[12:15], s21 offen lds
 buffer_load_dwordx4 v239, s[12:15], s21 offen offset:1024 lds
 v_dot2_f32_bf16 v152, v124, s50, v240
 v_dot2_f32_bf16 v153, v124, s51, v240
 v_dot2_f32_bf16 v154, v125, s50, v240
 v_dot2_f32_bf16 v155, v125, s51, v240
 v_dot2_f32_bf16 v156, v126, s50, v240
 v_dot2_f32_bf16 v157, v126, s51, v240
 v_dot2_f32_bf16 v158, v127, s50, v240
 v_dot2_f32_bf16 v159, v127, s51, v240
 v_cvt_pk_bf16_f32 v124, v152, v153
 v_cvt_pk_bf16_f32 v125, v154, v155
 v_cvt_pk_bf16_f32 v126, v156, v157
 v_cvt_pk_bf16_f32 v127, v158, v159
 v_dot2_f32_bf16 v144, v128, s50, v240
 v_dot2_f32_bf16 v145, v128, s51, v240
 v_dot2_f32_bf16 v146, v129, s50, v240
 v_dot2_f32_bf16 v147, v129, s51, v240
 v_dot2_f32_bf16 v148, v130, s50, v240
 v_dot2_f32_bf16 v149, v130, s51, v240
 v_dot2_f32_bf16 v150, v131, s50, v240
 v_dot2_f32_bf16 v151, v131, s51, v240
 v_cvt_pk_bf16_f32 v128, v144, v145
 v_cvt_pk_bf16_f32 v129, v146, v147
 v_cvt_pk_bf16_f32 v130, v148, v149
 v_cvt_pk_bf16_f32 v131, v150, v151
 s_add_u32 m0, s30, 90112
 s_add_u32 s21, s43, 128
 buffer_load_dwordx4 v238, s[12:15], s21 offen lds
 buffer_load_dwordx4 v239, s[12:15], s21 offen offset:1024 lds
 v_dot2_f32_bf16 v152, v132, s50, v240
 v_dot2_f32_bf16 v153, v132, s51, v240
 v_dot2_f32_bf16 v154, v133, s50, v240
 v_dot2_f32_bf16 v155, v133, s51, v240
 v_dot2_f32_bf16 v156, v134, s50, v240
 v_dot2_f32_bf16 v157, v134, s51, v240
 v_dot2_f32_bf16 v158, v135, s50, v240
 v_dot2_f32_bf16 v159, v135, s51, v240
 v_cvt_pk_bf16_f32 v132, v152, v153
 v_cvt_pk_bf16_f32 v133, v154, v155
 v_cvt_pk_bf16_f32 v134, v156, v157
 v_cvt_pk_bf16_f32 v135, v158, v159
 v_dot2_f32_bf16 v144, v136, s50, v240
 v_dot2_f32_bf16 v145, v136, s51, v240
 v_dot2_f32_bf16 v146, v137, s50, v240
 v_dot2_f32_bf16 v147, v137, s51, v240
 v_dot2_f32_bf16 v148, v138, s50, v240
 v_dot2_f32_bf16 v149, v138, s51, v240
 v_dot2_f32_bf16 v150, v139, s50, v240
 v_dot2_f32_bf16 v151, v139, s51, v240
 v_cvt_pk_bf16_f32 v136, v144, v145
 v_cvt_pk_bf16_f32 v137, v146, v147
 v_cvt_pk_bf16_f32 v138, v148, v149
 v_cvt_pk_bf16_f32 v139, v150, v151
 v_dot2_f32_bf16 v152, v140, s50, v240
 v_dot2_f32_bf16 v153, v140, s51, v240
 v_dot2_f32_bf16 v154, v141, s50, v240
 v_dot2_f32_bf16 v155, v141, s51, v240
 v_dot2_f32_bf16 v156, v142, s50, v240
 v_dot2_f32_bf16 v157, v142, s51, v240
 v_dot2_f32_bf16 v158, v143, s50, v240
 v_dot2_f32_bf16 v159, v143, s51, v240
 v_cvt_pk_bf16_f32 v140, v152, v153
 v_cvt_pk_bf16_f32 v141, v154, v155
 v_cvt_pk_bf16_f32 v142, v156, v157
 v_cvt_pk_bf16_f32 v143, v158, v159
 s_waitcnt vmcnt(23)
 s_barrier
 ds_read_b64_tr_b16 v[208:209], v232 offset:0
 ds_read_b64_tr_b16 v[210:211], v232 offset:512
 ds_read_b64_tr_b16 v[212:213], v233 offset:0
 ds_read_b64_tr_b16 v[214:215], v233 offset:512
 ds_read_b64_tr_b16 v[216:217], v232 offset:2048
 ds_read_b64_tr_b16 v[218:219], v232 offset:2560
 ds_read_b64_tr_b16 v[220:221], v233 offset:2048
 ds_read_b64_tr_b16 v[222:223], v233 offset:2560
 s_cmp_eq_u32 s27, 6
 s_cbranch_scc1 L1_v3
 s_cmp_eq_u32 s27, 5
 s_cbranch_scc1 L1_v4
L1_q:
 s_waitcnt lgkmcnt(4)
 v_mfma_f32_32x32x16_bf16 v[144:159], v[208:211], v[0:3], 0
 ds_read_b64_tr_b16 v[224:225], v232 offset:4096
 ds_read_b64_tr_b16 v[226:227], v232 offset:4608
 v_mfma_f32_32x32x16_bf16 v[160:175], v[212:215], v[0:3], 0
 ds_read_b64_tr_b16 v[228:229], v233 offset:4096
 ds_read_b64_tr_b16 v[230:231], v233 offset:4608
 s_waitcnt lgkmcnt(4)
 v_mfma_f32_32x32x16_bf16 v[144:159], v[216:219], v[4:7], v[144:159]
 ds_read_b64_tr_b16 v[208:209], v232 offset:6144
 ds_read_b64_tr_b16 v[210:211], v232 offset:6656
 v_mfma_f32_32x32x16_bf16 v[160:175], v[220:223], v[4:7], v[160:175]
 ds_read_b64_tr_b16 v[212:213], v233 offset:6144
 ds_read_b64_tr_b16 v[214:215], v233 offset:6656
 s_waitcnt lgkmcnt(4)
 v_mfma_f32_32x32x16_bf16 v[144:159], v[224:227], v[8:11], v[144:159]
 ds_read_b64_tr_b16 v[216:217], v232 offset:8192
 ds_read_b64_tr_b16 v[218:219], v232 offset:8704
 s_add_u32 m0, s30, 98304
 s_add_u32 s21, s44, 128
 buffer_load_dwordx4 v238, s[12:15], s21 offen lds
 v_mfma_f32_32x32x16_bf16 v[160:175], v[228:231], v[8:11], v[160:175]
 ds_read_b64_tr_b16 v[220:221], v233 offset:8192
 ds_read_b64_tr_b16 v[222:223], v233 offset:8704
 s_waitcnt lgkmcnt(4)
 v_mfma_f32_32x32x16_bf16 v[144:159], v[208:211], v[12:15], v[144:159]
 ds_read_b64_tr_b16 v[224:225], v232 offset:10240
 ds_read_b64_tr_b16 v[226:227], v232 offset:10752
 v_mfma_f32_32x32x16_bf16 v[160:175], v[212:215], v[12:15], v[160:175]
 ds_read_b64_tr_b16 v[228:229], v233 offset:10240
 ds_read_b64_tr_b16 v[230:231], v233 offset:10752
 s_waitcnt lgkmcnt(4)
 v_mfma_f32_32x32x16_bf16 v[144:159], v[216:219], v[16:19], v[144:159]
 ds_read_b64_tr_b16 v[208:209], v232 offset:12288
 ds_read_b64_tr_b16 v[210:211], v232 offset:12800
 buffer_load_dwordx4 v239, s[12:15], s21 offen offset:1024 lds
 v_mfma_f32_32x32x16_bf16 v[160:175], v[220:223], v[16:19], v[160:175]
 ds_read_b64_tr_b16 v[212:213], v233 offset:12288
 ds_read_b64_tr_b16 v[214:215], v233 offset:12800
 s_waitcnt lgkmcnt(4)
 v_mfma_f32_32x32x16_bf16 v[144:159], v[224:227], v[20:23], v[144:159]
 ds_read_b64_tr_b16 v[216:217], v232 offset:14336
 ds_read_b64_tr_b16 v[218:219], v232 offset:14848
 v_mfma_f32_32x32x16_bf16 v[160:175], v[228:231], v[20:23], v[160:175]
 ds_read_b64_tr_b16 v[220:221], v233 offset:14336
 ds_read_b64_tr_b16 v[222:223], v233 offset:14848
 s_waitcnt lgkmcnt(4)
 v_mfma_f32_32x32x16_bf16 v[144:159], v[208:211], v[24:27], v[144:159]
 ds_read_b64_tr_b16 v[224:225], v232 offset:16384
 ds_read_b64_tr_b16 v[226:227], v232 offset:16896
 s_add_u32 m0, s30, 106496
 s_add_u32 s21, s45, 128
 buffer_load_dwordx4 v238, s[12:15], s21 offen lds
 v_mfma_f32_32x32x16_bf16 v[160:175], v[212:215], v[24:27], v[160:175]
 ds_read_b64_tr_b16 v[228:229], v233 offset:16384
 ds_read_b64_tr_b16 v[230:231], v233 offset:16896
 s_waitcnt lgkmcnt(4)
 v_mfma_f32_32x32x16_bf16 v[144:159], v[216:219], v[28:31], v[144:159]
 ds_read_b64_tr_b16 v[208:209], v232 offset:18432
 ds_read_b64_tr_b16 v[210:211], v232 offset:18944
 v_mfma_f32_32x32x16_bf16 v[160:175], v[220:223], v[28:31], v[160:175]
 ds_read_b64_tr_b16 v[212:213], v233 offset:18432
 ds_read_b64_tr_b16 v[214:215], v233 offset:18944
 s_waitcnt lgkmcnt(4)
 v_mfma_f32_32x32x16_bf16 v[144:159], v[224:227], v[32:35], v[144:159]
 ds_read_b64_tr_b16 v[216:217], v232 offset:20480
 ds_read_b64_tr_b16 v[218:219], v232 offset:20992
 buffer_load_dwordx4 v239, s[12:15], s21 offen offset:1024 lds
 v_mfma_f32_32x32x16_bf16 v[160:175], v[228:231], v[32:35], v[160:175]
 ds_read_b64_tr_b16 v[220:221], v233 offset:20480
 ds_read_b64_tr_b16 v[222:223], v233 offset:20992
 s_waitcnt lgkmcnt(4)
 v_mfma_f32_32x32x16_bf16 v[144:159], v[208:211], v[36:39], v[144:159]
 ds_read_b64_tr_b16 v[224:225], v232 offset:22528
 ds_read_b64_tr_b16 v[226:227], v232 offset:23040
 v_mfma_f32_32x32x16_bf16 v[160:175], v[212:215], v[36:39], v[160:175]
 ds_read_b64_tr_b16 v[228:229], v233 offset:22528
 ds_read_b64_tr_b16 v[230:231], v233 offset:23040
 s_waitcnt vmcnt(20)
 s_barrier
 s_waitcnt lgkmcnt(4)
 v_mfma_f32_32x32x16_bf16 v[144:159], v[216:219], v[40:43], v[144:159]
 ds_read_b64_tr_b16 v[208:209], v232 offset:24576
 ds_read_b64_tr_b16 v[210:211], v232 offset:25088
 s_add_u32 m0, s30, 114688
 s_add_u32 s21, s46, 128
 buffer_load_dwordx4 v238, s[12:15], s21 offen lds
 v_mfma_f32_32x32x16_bf16 v[160:175], v[220:223], v[40:43], v[160:175]
 ds_read_b64_tr_b16 v[212:213], v233 offset:24576
 ds_read_b64_tr_b16 v[214:215], v233 offset:25088
 s_waitcnt lgkmcnt(4)
 v_mfma_f32_32x32x16_bf16 v[144:159], v[224:227], v[44:47], v[144:159]
 ds_read_b64_tr_b16 v[216:217], v232 offset:26624
 ds_read_b64_tr_b16 v[218:219], v232 offset:27136
 v_mfma_f32_32x32x16_bf16 v[160:175], v[228:231], v[44:47], v[160:175]
 ds_read_b64_tr_b16 v[220:221], v233 offset:26624
 ds_read_b64_tr_b16 v[222:223], v233 offset:27136
 s_waitcnt lgkmcnt(4)
 v_mfma_f32_32x32x16_bf16 v[144:159], v[208:211], v[48:51], v[144:159]
 ds_read_b64_tr_b16 v[224:225], v232 offset:28672
 ds_read_b64_tr_b16 v[226:227], v232 offset:29184
 buffer_load_dwordx4 v239, s[12:15], s21 offen offset:1024 lds
 s_waitcnt vmcnt(12)
 v_mfma_f32_32x32x16_bf16 v[160:175], v[212:215], v[48:51], v[160:175]
 ds_read_b64_tr_b16 v[228:229], v233 offset:28672
 ds_read_b64_tr_b16 v[230:231], v233 offset:29184
 s_waitcnt lgkmcnt(4)
 v_mfma_f32_32x32x16_bf16 v[144:159], v[216:219], v[52:55], v[144:159]
 ds_read_b64_tr_b16 v[208:209], v232 offset:30720
 ds_read_b64_tr_b16 v[210:211], v232 offset:31232
 v_mfma_f32_32x32x16_bf16 v[160:175], v[220:223], v[52:55], v[160:175]
 ds_read_b64_tr_b16 v[212:213], v233 offset:30720
 ds_read_b64_tr_b16 v[214:215], v233 offset:31232
 s_waitcnt lgkmcnt(4)
 v_mfma_f32_32x32x16_bf16 v[144:159], v[224:227], v[56:59], v[144:159]
 ds_read_b64_tr_b16 v[216:217], v232 offset:32768
 ds_read_b64_tr_b16 v[218:219], v232 offset:33280
 s_add_u32 m0, s30, 122880
 s_add_u32 s21, s47, 128
 buffer_load_dwordx4 v238, s[12:15], s21 offen lds
 v_mfma_f32_32x32x16_bf16 v[160:175], v[228:231], v[56:59], v[160:175]
 ds_read_b64_tr_b16 v[220:221], v233 offset:32768
 ds_read_b64_tr_b16 v[222:223], v233 offset:33280
 s_waitcnt lgkmcnt(4)
 v_mfma_f32_32x32x16_bf16 v[144:159], v[208:211], v[60:63], v[144:159]
 ds_read_b64_tr_b16 v[224:225], v232 offset:34816
 ds_read_b64_tr_b16 v[226:227], v232 offset:35328
 v_mfma_f32_32x32x16_bf16 v[160:175], v[212:215], v[60:63], v[160:175]
 ds_read_b64_tr_b16 v[228:229], v233 offset:34816
 ds_read_b64_tr_b16 v[230:231], v233 offset:35328
 s_mul_i32 s52, s24, 36864
 s_add_u32 s52, s52, 0
 s_waitcnt lgkmcnt(4)
 v_mfma_f32_32x32x16_bf16 v[144:159], v[216:219], v[64:67], v[144:159]
 ds_read_b64_tr_b16 v[208:209], v232 offset:36864
 ds_read_b64_tr_b16 v[210:211], v232 offset:37376
 buffer_load_dwordx4 v239, s[12:15], s21 offen offset:1024 lds
 v_mfma_f32_32x32x16_bf16 v[160:175], v[220:223], v[64:67], v[160:175]
 ds_read_b64_tr_b16 v[212:213], v233 offset:36864
 ds_read_b64_tr_b16 v[214:215], v233 offset:37376
 s_waitcnt lgkmcnt(4)
 v_mfma_f32_32x32x16_bf16 v[144:159], v[224:227], v[68:71], v[144:159]
 ds_read_b64_tr_b16 v[216:217], v232 offset:38912
 ds_read_b64_tr_b16 v[218:219], v232 offset:39424
 v_mfma_f32_32x32x16_bf16 v[160:175], v[228:231], v[68:71], v[160:175]
 ds_read_b64_tr_b16 v[220:221], v233 offset:38912
 ds_read_b64_tr_b16 v[222:223], v233 offset:39424
 s_waitcnt lgkmcnt(4)
 v_mfma_f32_32x32x16_bf16 v[144:159], v[208:211], v[72:75], v[144:159]
 ds_read_b64_tr_b16 v[224:225], v232 offset:40960
 ds_read_b64_tr_b16 v[226:227], v232 offset:41472
 s_add_u32 m0, s30, 131072
 s_add_u32 s21, s48, 128
 buffer_load_dwordx4 v238, s[12:15], s21 offen lds
 v_mfma_f32_32x32x16_bf16 v[160:175], v[212:215], v[72:75], v[160:175]
 ds_read_b64_tr_b16 v[228:229], v233 offset:40960
 ds_read_b64_tr_b16 v[230:231], v233 offset:41472
 s_waitcnt lgkmcnt(4)
 v_mfma_f32_32x32x16_bf16 v[144:159], v[216:219], v[76:79], v[144:159]
 ds_read_b64_tr_b16 v[208:209], v232 offset:43008
 ds_read_b64_tr_b16 v[210:211], v232 offset:43520
 s_mul_i32 s6, s24, 74240
 s_add_u32 s53, s6, 2322432
 s_add_u32 s6, s6, 2396160
 v_mfma_f32_32x32x16_bf16 v[160:175], v[220:223], v[76:79], v[160:175]
 ds_read_b64_tr_b16 v[212:213], v233 offset:43008
 ds_read_b64_tr_b16 v[214:215], v233 offset:43520
 s_waitcnt lgkmcnt(4)
 v_mfma_f32_32x32x16_bf16 v[144:159], v[224:227], v[80:83], v[144:159]
 ds_read_b64_tr_b16 v[216:217], v232 offset:45056
 ds_read_b64_tr_b16 v[218:219], v232 offset:45568
 buffer_load_dwordx4 v239, s[12:15], s21 offen offset:1024 lds
 v_mfma_f32_32x32x16_bf16 v[160:175], v[228:231], v[80:83], v[160:175]
 ds_read_b64_tr_b16 v[220:221], v233 offset:45056
 ds_read_b64_tr_b16 v[222:223], v233 offset:45568
 s_waitcnt lgkmcnt(4)
 v_mfma_f32_32x32x16_bf16 v[144:159], v[208:211], v[84:87], v[144:159]
 ds_read_b64_tr_b16 v[224:225], v232 offset:47104
 ds_read_b64_tr_b16 v[226:227], v232 offset:47616
 v_mfma_f32_32x32x16_bf16 v[160:175], v[212:215], v[84:87], v[160:175]
 ds_read_b64_tr_b16 v[228:229], v233 offset:47104
 ds_read_b64_tr_b16 v[230:231], v233 offset:47616
 s_waitcnt vmcnt(20)
 s_barrier
 s_waitcnt lgkmcnt(4)
 v_mfma_f32_32x32x16_bf16 v[144:159], v[216:219], v[88:91], v[144:159]
 ds_read_b64_tr_b16 v[208:209], v234 offset:0
 ds_read_b64_tr_b16 v[210:211], v234 offset:512
 s_add_u32 m0, s30, 139264
 s_add_u32 s21, s49, 128
 buffer_load_dwordx4 v238, s[12:15], s21 offen lds
 v_mfma_f32_32x32x16_bf16 v[160:175], v[220:223], v[88:91], v[160:175]
 ds_read_b64_tr_b16 v[212:213], v235 offset:0
 ds_read_b64_tr_b16 v[214:215], v235 offset:512
 s_waitcnt lgkmcnt(4)
 v_mfma_f32_32x32x16_bf16 v[144:159], v[224:227], v[92:95], v[144:159]
 ds_read_b64_tr_b16 v[216:217], v234 offset:2048
 ds_read_b64_tr_b16 v[218:219], v234 offset:2560
 v_mfma_f32_32x32x16_bf16 v[160:175], v[228:231], v[92:95], v[160:175]
 ds_read_b64_tr_b16 v[220:221], v235 offset:2048
 ds_read_b64_tr_b16 v[222:223], v235 offset:2560
 v_mul_u32_u24 v245, 9344, v244
 s_waitcnt lgkmcnt(4)
 v_mfma_f32_32x32x16_bf16 v[144:159], v[208:211], v[96:99], v[144:159]
 ds_read_b64_tr_b16 v[224:225], v234 offset:4096
 ds_read_b64_tr_b16 v[226:227], v234 offset:4608
 buffer_load_dwordx4 v239, s[12:15], s21 offen offset:1024 lds
 v_mfma_f32_32x32x16_bf16 v[160:175], v[212:215], v[96:99], v[160:175]
 ds_read_b64_tr_b16 v[228:229], v235 offset:4096
 ds_read_b64_tr_b16 v[230:231], v235 offset:4608
 s_waitcnt lgkmcnt(4)
 v_mfma_f32_32x32x16_bf16 v[144:159], v[216:219], v[100:103], v[144:159]
 ds_read_b64_tr_b16 v[208:209], v234 offset:6144
 ds_read_b64_tr_b16 v[210:211], v234 offset:6656
 v_mfma_f32_32x32x16_bf16 v[160:175], v[220:223], v[100:103], v[160:175]
 ds_read_b64_tr_b16 v[212:213], v235 offset:6144
 ds_read_b64_tr_b16 v[214:215], v235 offset:6656
 s_waitcnt lgkmcnt(4)
 v_mfma_f32_32x32x16_bf16 v[144:159], v[224:227], v[104:107], v[144:159]
 ds_read_b64_tr_b16 v[216:217], v234 offset:8192
 ds_read_b64_tr_b16 v[218:219], v234 offset:8704
 s_add_u32 m0, s30, 0
 s_add_u32 s21, s41, 256
 buffer_load_dwordx4 v238, s[12:15], s21 offen lds
 v_mfma_f32_32x32x16_bf16 v[160:175], v[228:231], v[104:107], v[160:175]
 ds_read_b64_tr_b16 v[220:221], v235 offset:8192
 ds_read_b64_tr_b16 v[222:223], v235 offset:8704
 s_waitcnt lgkmcnt(4)
 v_mfma_f32_32x32x16_bf16 v[144:159], v[208:211], v[108:111], v[144:159]
 ds_read_b64_tr_b16 v[224:225], v234 offset:10240
 ds_read_b64_tr_b16 v[226:227], v234 offset:10752
 v_add_u32 v245, v245, v243
 v_mfma_f32_32x32x16_bf16 v[160:175], v[212:215], v[108:111], v[160:175]
 ds_read_b64_tr_b16 v[228:229], v235 offset:10240
 ds_read_b64_tr_b16 v[230:231], v235 offset:10752
 s_waitcnt lgkmcnt(4)
 v_mfma_f32_32x32x16_bf16 v[144:159], v[216:219], v[112:115], v[144:159]
 ds_read_b64_tr_b16 v[208:209], v234 offset:12288
 ds_read_b64_tr_b16 v[210:211], v234 offset:12800
 buffer_load_dwordx4 v239, s[12:15], s21 offen offset:1024 lds
 v_mfma_f32_32x32x16_bf16 v[160:175], v[220:223], v[112:115], v[160:175]
 ds_read_b64_tr_b16 v[212:213], v235 offset:12288
 ds_read_b64_tr_b16 v[214:215], v235 offset:12800
 s_waitcnt lgkmcnt(4)
 v_mfma_f32_32x32x16_bf16 v[144:159], v[224:227], v[116:119], v[144:159]
 ds_read_b64_tr_b16 v[216:217], v234 offset:14336
 ds_read_b64_tr_b16 v[218:219], v234 offset:14848
 v_mfma_f32_32x32x16_bf16 v[160:175], v[228:231], v[116:119], v[160:175]
 ds_read_b64_tr_b16 v[220:221], v235 offset:14336
 ds_read_b64_tr_b16 v[222:223], v235 offset:14848
 s_waitcnt lgkmcnt(4)
 v_mfma_f32_32x32x16_bf16 v[144:159], v[208:211], v[120:123], v[144:159]
 ds_read_b64_tr_b16 v[224:225], v234 offset:16384
 ds_read_b64_tr_b16 v[226:227], v234 offset:16896
 s_add_u32 m0, s30, 8192
 s_add_u32 s21, s42, 256
 buffer_load_dwordx4 v238, s[12:15], s21 offen lds
 v_mfma_f32_32x32x16_bf16 v[160:175], v[212:215], v[120:123], v[160:175]
 ds_read_b64_tr_b16 v[228:229], v235 offset:16384
 ds_read_b64_tr_b16 v[230:231], v235 offset:16896
 v_add_u32 v246, 18688, v245
 s_waitcnt lgkmcnt(4)
 v_mfma_f32_32x32x16_bf16 v[144:159], v[216:219], v[124:127], v[144:159]
 ds_read_b64_tr_b16 v[208:209], v234 offset:18432
 ds_read_b64_tr_b16 v[210:211], v234 offset:18944
 v_mfma_f32_32x32x16_bf16 v[160:175], v[220:223], v[124:127], v[160:175]
 ds_read_b64_tr_b16 v[212:213], v235 offset:18432
 ds_read_b64_tr_b16 v[214:215], v235 offset:18944
 s_waitcnt lgkmcnt(4)
 v_mfma_f32_32x32x16_bf16 v[144:159], v[224:227], v[128:131], v[144:159]
 ds_read_b64_tr_b16 v[216:217], v234 offset:20480
 ds_read_b64_tr_b16 v[218:219], v234 offset:20992
 buffer_load_dwordx4 v239, s[12:15], s21 offen offset:1024 lds
 v_mfma_f32_32x32x16_bf16 v[160:175], v[228:231], v[128:131], v[160:175]
 ds_read_b64_tr_b16 v[220:221], v235 offset:20480
 ds_read_b64_tr_b16 v[222:223], v235 offset:20992
 s_waitcnt lgkmcnt(4)
 v_mfma_f32_32x32x16_bf16 v[144:159], v[208:211], v[132:135], v[144:159]
 ds_read_b64_tr_b16 v[224:225], v234 offset:22528
 ds_read_b64_tr_b16 v[226:227], v234 offset:23040
 v_mfma_f32_32x32x16_bf16 v[160:175], v[212:215], v[132:135], v[160:175]
 ds_read_b64_tr_b16 v[228:229], v235 offset:22528
 ds_read_b64_tr_b16 v[230:231], v235 offset:23040
 s_waitcnt vmcnt(16)
 s_barrier
 s_waitcnt lgkmcnt(4)
 v_mfma_f32_32x32x16_bf16 v[144:159], v[216:219], v[136:139], v[144:159]
 ds_read_b64_tr_b16 v[208:209], v234 offset:24576
 ds_read_b64_tr_b16 v[210:211], v234 offset:25088
 s_add_u32 m0, s30, 16384
 s_add_u32 s21, s43, 256
 buffer_load_dwordx4 v238, s[12:15], s21 offen lds
 v_mfma_f32_32x32x16_bf16 v[160:175], v[220:223], v[136:139], v[160:175]
 ds_read_b64_tr_b16 v[212:213], v235 offset:24576
 ds_read_b64_tr_b16 v[214:215], v235 offset:25088
 s_waitcnt lgkmcnt(4)
 v_mfma_f32_32x32x16_bf16 v[144:159], v[224:227], v[140:143], v[144:159]
 ds_read_b64_tr_b16 v[216:217], v234 offset:26624
 ds_read_b64_tr_b16 v[218:219], v234 offset:27136
 v_mfma_f32_32x32x16_bf16 v[160:175], v[228:231], v[140:143], v[160:175]
 ds_read_b64_tr_b16 v[220:221], v235 offset:26624
 ds_read_b64_tr_b16 v[222:223], v235 offset:27136
 s_waitcnt lgkmcnt(4)
 v_mfma_f32_32x32x16_bf16 v[176:191], v[208:211], v[0:3], 0
 ds_read_b64_tr_b16 v[224:225], v234 offset:28672
 ds_read_b64_tr_b16 v[226:227], v234 offset:29184
 buffer_load_dwordx4 v239, s[12:15], s21 offen offset:1024 lds
 v_mfma_f32_32x32x16_bf16 v[192:207], v[212:215], v[0:3], 0
 ds_read_b64_tr_b16 v[228:229], v235 offset:28672
 ds_read_b64_tr_b16 v[230:231], v235 offset:29184
 s_waitcnt lgkmcnt(4)
 v_mfma_f32_32x32x16_bf16 v[176:191], v[216:219], v[4:7], v[176:191]
 ds_read_b64_tr_b16 v[208:209], v234 offset:30720
 ds_read_b64_tr_b16 v[210:211], v234 offset:31232
 v_mfma_f32_32x32x16_bf16 v[192:207], v[220:223], v[4:7], v[192:207]
 ds_read_b64_tr_b16 v[212:213], v235 offset:30720
 ds_read_b64_tr_b16 v[214:215], v235 offset:31232
 s_waitcnt lgkmcnt(4)
 v_mfma_f32_32x32x16_bf16 v[176:191], v[224:227], v[8:11], v[176:191]
 ds_read_b64_tr_b16 v[216:217], v234 offset:32768
 ds_read_b64_tr_b16 v[218:219], v234 offset:33280
 s_add_u32 m0, s30, 24576
 s_add_u32 s21, s44, 256
 buffer_load_dwordx4 v238, s[12:15], s21 offen lds
 s_lshl_b32 s3, s27, 2
 s_add_u32 s3, s3, 0
 s_lshl_b32 s4, s3, 12
 s_cmp_lt_u32 s3, 9
 s_cselect_b32 s3, 0x3eae1a93, 1.0
 s_cselect_b32 s5, s52, s53
 s_add_u32 s4, s4, s5
 v_mul_f32 v252, s3, v241
 v_mfma_f32_32x32x16_bf16 v[192:207], v[228:231], v[8:11], v[192:207]
 ds_read_b64_tr_b16 v[220:221], v235 offset:32768
 ds_read_b64_tr_b16 v[222:223], v235 offset:33280
 v_mul_f32 v144, v252, v144
 s_waitcnt lgkmcnt(4)
 v_mfma_f32_32x32x16_bf16 v[176:191], v[208:211], v[12:15], v[176:191]
 ds_read_b64_tr_b16 v[224:225], v234 offset:34816
 ds_read_b64_tr_b16 v[226:227], v234 offset:35328
 v_mul_f32 v145, v252, v145
 v_mfma_f32_32x32x16_bf16 v[192:207], v[212:215], v[12:15], v[192:207]
 ds_read_b64_tr_b16 v[228:229], v235 offset:34816
 ds_read_b64_tr_b16 v[230:231], v235 offset:35328
 v_mul_f32 v146, v252, v146
 s_waitcnt lgkmcnt(4)
 v_mfma_f32_32x32x16_bf16 v[176:191], v[216:219], v[16:19], v[176:191]
 ds_read_b64_tr_b16 v[208:209], v234 offset:36864
 ds_read_b64_tr_b16 v[210:211], v234 offset:37376
 buffer_load_dwordx4 v239, s[12:15], s21 offen offset:1024 lds
 v_mul_f32 v147, v252, v147
 v_mfma_f32_32x32x16_bf16 v[192:207], v[220:223], v[16:19], v[192:207]
 ds_read_b64_tr_b16 v[212:213], v235 offset:36864
 ds_read_b64_tr_b16 v[214:215], v235 offset:37376
 s_waitcnt lgkmcnt(4)
 v_mfma_f32_32x32x16_bf16 v[176:191], v[224:227], v[20:23], v[176:191]
 ds_read_b64_tr_b16 v[216:217], v234 offset:38912
 ds_read_b64_tr_b16 v[218:219], v234 offset:39424
 v_mul_f32 v148, v252, v148
 v_mfma_f32_32x32x16_bf16 v[192:207], v[228:231], v[20:23], v[192:207]
 ds_read_b64_tr_b16 v[220:221], v235 offset:38912
 ds_read_b64_tr_b16 v[222:223], v235 offset:39424
 v_mul_f32 v149, v252, v149
 s_waitcnt lgkmcnt(4)
 v_mfma_f32_32x32x16_bf16 v[176:191], v[208:211], v[24:27], v[176:191]
 ds_read_b64_tr_b16 v[224:225], v234 offset:40960
 ds_read_b64_tr_b16 v[226:227], v234 offset:41472
 s_add_u32 m0, s30, 32768
 s_add_u32 s21, s45, 256
 buffer_load_dwordx4 v238, s[12:15], s21 offen lds
 v_mul_f32 v150, v252, v150
 v_mfma_f32_32x32x16_bf16 v[192:207], v[212:215], v[24:27], v[192:207]
 ds_read_b64_tr_b16 v[228:229], v235 offset:40960
 ds_read_b64_tr_b16 v[230:231], v235 offset:41472
 v_mul_f32 v151, v252, v151
 s_waitcnt lgkmcnt(4)
 v_mfma_f32_32x32x16_bf16 v[176:191], v[216:219], v[28:31], v[176:191]
 ds_read_b64_tr_b16 v[208:209], v234 offset:43008
 ds_read_b64_tr_b16 v[210:211], v234 offset:43520
 v_mfma_f32_32x32x16_bf16 v[192:207], v[220:223], v[28:31], v[192:207]
 ds_read_b64_tr_b16 v[212:213], v235 offset:43008
 ds_read_b64_tr_b16 v[214:215], v235 offset:43520
 v_cvt_pk_bf16_f32 v144, v144, v145
 s_waitcnt lgkmcnt(4)
 v_mfma_f32_32x32x16_bf16 v[176:191], v[224:227], v[32:35], v[176:191]
 ds_read_b64_tr_b16 v[216:217], v234 offset:45056
 ds_read_b64_tr_b16 v[218:219], v234 offset:45568
 buffer_load_dwordx4 v239, s[12:15], s21 offen offset:1024 lds
 v_cvt_pk_bf16_f32 v145, v146, v147
 v_mfma_f32_32x32x16_bf16 v[192:207], v[228:231], v[32:35], v[192:207]
 ds_read_b64_tr_b16 v[220:221], v235 offset:45056
 ds_read_b64_tr_b16 v[222:223], v235 offset:45568
 v_cvt_pk_bf16_f32 v146, v148, v149
 s_waitcnt lgkmcnt(4)
 v_mfma_f32_32x32x16_bf16 v[176:191], v[208:211], v[36:39], v[176:191]
 ds_read_b64_tr_b16 v[224:225], v234 offset:47104
 ds_read_b64_tr_b16 v[226:227], v234 offset:47616
 v_cvt_pk_bf16_f32 v147, v150, v151
 v_mfma_f32_32x32x16_bf16 v[192:207], v[212:215], v[36:39], v[192:207]
 ds_read_b64_tr_b16 v[228:229], v235 offset:47104
 ds_read_b64_tr_b16 v[230:231], v235 offset:47616
 s_waitcnt vmcnt(16)
 s_barrier
 s_waitcnt lgkmcnt(4)
 v_mfma_f32_32x32x16_bf16 v[176:191], v[216:219], v[40:43], v[176:191]
 ds_read_b64_tr_b16 v[208:209], v236 offset:0
 ds_read_b64_tr_b16 v[210:211], v236 offset:512
 s_add_u32 m0, s30, 40960
 s_add_u32 s21, s46, 256
 buffer_load_dwordx4 v238, s[12:15], s21 offen lds
 buffer_store_dwordx4 v[144:147], v254, s[16:19], s4 offen offset:0 sc1
 v_mfma_f32_32x32x16_bf16 v[192:207], v[220:223], v[40:43], v[192:207]
 ds_read_b64_tr_b16 v[212:213], v237 offset:0
 ds_read_b64_tr_b16 v[214:215], v237 offset:512
 s_waitcnt lgkmcnt(4)
 v_mfma_f32_32x32x16_bf16 v[176:191], v[224:227], v[44:47], v[176:191]
 ds_read_b64_tr_b16 v[216:217], v236 offset:2048
 ds_read_b64_tr_b16 v[218:219], v236 offset:2560
 v_mul_f32 v152, v252, v152
 v_mfma_f32_32x32x16_bf16 v[192:207], v[228:231], v[44:47], v[192:207]
 ds_read_b64_tr_b16 v[220:221], v237 offset:2048
 ds_read_b64_tr_b16 v[222:223], v237 offset:2560
 v_mul_f32 v153, v252, v153
 s_waitcnt lgkmcnt(4)
 v_mfma_f32_32x32x16_bf16 v[176:191], v[208:211], v[48:51], v[176:191]
 ds_read_b64_tr_b16 v[224:225], v236 offset:4096
 ds_read_b64_tr_b16 v[226:227], v236 offset:4608
 buffer_load_dwordx4 v239, s[12:15], s21 offen offset:1024 lds
 v_mul_f32 v154, v252, v154
 v_mfma_f32_32x32x16_bf16 v[192:207], v[212:215], v[48:51], v[192:207]
 ds_read_b64_tr_b16 v[228:229], v237 offset:4096
 ds_read_b64_tr_b16 v[230:231], v237 offset:4608
 v_mul_f32 v155, v252, v155
 s_waitcnt lgkmcnt(4)
 v_mfma_f32_32x32x16_bf16 v[176:191], v[216:219], v[52:55], v[176:191]
 ds_read_b64_tr_b16 v[208:209], v236 offset:6144
 ds_read_b64_tr_b16 v[210:211], v236 offset:6656
 v_mfma_f32_32x32x16_bf16 v[192:207], v[220:223], v[52:55], v[192:207]
 ds_read_b64_tr_b16 v[212:213], v237 offset:6144
 ds_read_b64_tr_b16 v[214:215], v237 offset:6656
 v_mul_f32 v156, v252, v156
 s_waitcnt lgkmcnt(4)
 v_mfma_f32_32x32x16_bf16 v[176:191], v[224:227], v[56:59], v[176:191]
 ds_read_b64_tr_b16 v[216:217], v236 offset:8192
 ds_read_b64_tr_b16 v[218:219], v236 offset:8704
 s_add_u32 m0, s30, 49152
 s_add_u32 s21, s47, 256
 buffer_load_dwordx4 v238, s[12:15], s21 offen lds
 v_mul_f32 v157, v252, v157
 v_mfma_f32_32x32x16_bf16 v[192:207], v[228:231], v[56:59], v[192:207]
 ds_read_b64_tr_b16 v[220:221], v237 offset:8192
 ds_read_b64_tr_b16 v[222:223], v237 offset:8704
 v_mul_f32 v158, v252, v158
 s_waitcnt lgkmcnt(4)
 v_mfma_f32_32x32x16_bf16 v[176:191], v[208:211], v[60:63], v[176:191]
 ds_read_b64_tr_b16 v[224:225], v236 offset:10240
 ds_read_b64_tr_b16 v[226:227], v236 offset:10752
 v_mul_f32 v159, v252, v159
 v_mfma_f32_32x32x16_bf16 v[192:207], v[212:215], v[60:63], v[192:207]
 ds_read_b64_tr_b16 v[228:229], v237 offset:10240
 ds_read_b64_tr_b16 v[230:231], v237 offset:10752
 v_cvt_pk_bf16_f32 v152, v152, v153
 s_waitcnt lgkmcnt(4)
 v_mfma_f32_32x32x16_bf16 v[176:191], v[216:219], v[64:67], v[176:191]
 ds_read_b64_tr_b16 v[208:209], v236 offset:12288
 ds_read_b64_tr_b16 v[210:211], v236 offset:12800
 buffer_load_dwordx4 v239, s[12:15], s21 offen offset:1024 lds
 v_mfma_f32_32x32x16_bf16 v[192:207], v[220:223], v[64:67], v[192:207]
 ds_read_b64_tr_b16 v[212:213], v237 offset:12288
 ds_read_b64_tr_b16 v[214:215], v237 offset:12800
 v_cvt_pk_bf16_f32 v153, v154, v155
 s_waitcnt lgkmcnt(4)
 v_mfma_f32_32x32x16_bf16 v[176:191], v[224:227], v[68:71], v[176:191]
 ds_read_b64_tr_b16 v[216:217], v236 offset:14336
 ds_read_b64_tr_b16 v[218:219], v236 offset:14848
 v_cvt_pk_bf16_f32 v154, v156, v157
 v_mfma_f32_32x32x16_bf16 v[192:207], v[228:231], v[68:71], v[192:207]
 ds_read_b64_tr_b16 v[220:221], v237 offset:14336
 ds_read_b64_tr_b16 v[222:223], v237 offset:14848
 v_cvt_pk_bf16_f32 v155, v158, v159
 s_waitcnt lgkmcnt(4)
 v_mfma_f32_32x32x16_bf16 v[176:191], v[208:211], v[72:75], v[176:191]
 ds_read_b64_tr_b16 v[224:225], v236 offset:16384
 ds_read_b64_tr_b16 v[226:227], v236 offset:16896
 s_add_u32 m0, s30, 57344
 s_add_u32 s21, s48, 256
 buffer_load_dwordx4 v238, s[12:15], s21 offen lds
 buffer_store_dwordx4 v[152:155], v254, s[16:19], s4 offen offset:1024 sc1
 v_mfma_f32_32x32x16_bf16 v[192:207], v[212:215], v[72:75], v[192:207]
 ds_read_b64_tr_b16 v[228:229], v237 offset:16384
 ds_read_b64_tr_b16 v[230:231], v237 offset:16896
 s_waitcnt lgkmcnt(4)
 v_mfma_f32_32x32x16_bf16 v[176:191], v[216:219], v[76:79], v[176:191]
 ds_read_b64_tr_b16 v[208:209], v236 offset:18432
 ds_read_b64_tr_b16 v[210:211], v236 offset:18944
 v_mul_f32 v160, v252, v160
 v_mfma_f32_32x32x16_bf16 v[192:207], v[220:223], v[76:79], v[192:207]
 ds_read_b64_tr_b16 v[212:213], v237 offset:18432
 ds_read_b64_tr_b16 v[214:215], v237 offset:18944
 v_mul_f32 v161, v252, v161
 s_waitcnt lgkmcnt(4)
 v_mfma_f32_32x32x16_bf16 v[176:191], v[224:227], v[80:83], v[176:191]
 ds_read_b64_tr_b16 v[216:217], v236 offset:20480
 ds_read_b64_tr_b16 v[218:219], v236 offset:20992
 buffer_load_dwordx4 v239, s[12:15], s21 offen offset:1024 lds
 v_mul_f32 v162, v252, v162
 v_mfma_f32_32x32x16_bf16 v[192:207], v[228:231], v[80:83], v[192:207]
 ds_read_b64_tr_b16 v[220:221], v237 offset:20480
 ds_read_b64_tr_b16 v[222:223], v237 offset:20992
 v_mul_f32 v163, v252, v163
 s_waitcnt lgkmcnt(4)
 v_mfma_f32_32x32x16_bf16 v[176:191], v[208:211], v[84:87], v[176:191]
 ds_read_b64_tr_b16 v[224:225], v236 offset:22528
 ds_read_b64_tr_b16 v[226:227], v236 offset:23040
 v_mfma_f32_32x32x16_bf16 v[192:207], v[212:215], v[84:87], v[192:207]
 ds_read_b64_tr_b16 v[228:229], v237 offset:22528
 ds_read_b64_tr_b16 v[230:231], v237 offset:23040
 s_waitcnt vmcnt(18)
 s_barrier
 s_waitcnt lgkmcnt(4)
 v_mfma_f32_32x32x16_bf16 v[176:191], v[216:219], v[88:91], v[176:191]
 ds_read_b64_tr_b16 v[208:209], v236 offset:24576
 ds_read_b64_tr_b16 v[210:211], v236 offset:25088
 s_add_u32 m0, s30, 65536
 s_add_u32 s21, s49, 256
 buffer_load_dwordx4 v238, s[12:15], s21 offen lds
 v_mul_f32 v164, v252, v164
 v_mfma_f32_32x32x16_bf16 v[192:207], v[220:223], v[88:91], v[192:207]
 ds_read_b64_tr_b16 v[212:213], v237 offset:24576
 ds_read_b64_tr_b16 v[214:215], v237 offset:25088
 v_mul_f32 v165, v252, v165
 s_waitcnt lgkmcnt(4)
 v_mfma_f32_32x32x16_bf16 v[176:191], v[224:227], v[92:95], v[176:191]
 ds_read_b64_tr_b16 v[216:217], v236 offset:26624
 ds_read_b64_tr_b16 v[218:219], v236 offset:27136
 v_mul_f32 v166, v252, v166
 v_mfma_f32_32x32x16_bf16 v[192:207], v[228:231], v[92:95], v[192:207]
 ds_read_b64_tr_b16 v[220:221], v237 offset:26624
 ds_read_b64_tr_b16 v[222:223], v237 offset:27136
 v_mul_f32 v167, v252, v167
 s_waitcnt lgkmcnt(4)
 v_mfma_f32_32x32x16_bf16 v[176:191], v[208:211], v[96:99], v[176:191]
 ds_read_b64_tr_b16 v[224:225], v236 offset:28672
 ds_read_b64_tr_b16 v[226:227], v236 offset:29184
 buffer_load_dwordx4 v239, s[12:15], s21 offen offset:1024 lds
 v_cvt_pk_bf16_f32 v160, v160, v161
 v_mfma_f32_32x32x16_bf16 v[192:207], v[212:215], v[96:99], v[192:207]
 ds_read_b64_tr_b16 v[228:229], v237 offset:28672
 ds_read_b64_tr_b16 v[230:231], v237 offset:29184
 s_waitcnt lgkmcnt(4)
 v_mfma_f32_32x32x16_bf16 v[176:191], v[216:219], v[100:103], v[176:191]
 ds_read_b64_tr_b16 v[208:209], v236 offset:30720
 ds_read_b64_tr_b16 v[210:211], v236 offset:31232
 v_cvt_pk_bf16_f32 v161, v162, v163
 v_mfma_f32_32x32x16_bf16 v[192:207], v[220:223], v[100:103], v[192:207]
 ds_read_b64_tr_b16 v[212:213], v237 offset:30720
 ds_read_b64_tr_b16 v[214:215], v237 offset:31232
 v_cvt_pk_bf16_f32 v162, v164, v165
 s_waitcnt lgkmcnt(4)
 v_mfma_f32_32x32x16_bf16 v[176:191], v[224:227], v[104:107], v[176:191]
 ds_read_b64_tr_b16 v[216:217], v236 offset:32768
 ds_read_b64_tr_b16 v[218:219], v236 offset:33280
 s_add_u32 m0, s30, 73728
 s_add_u32 s21, s41, 384
 buffer_load_dwordx4 v238, s[12:15], s21 offen lds
 v_cvt_pk_bf16_f32 v163, v166, v167
 v_mfma_f32_32x32x16_bf16 v[192:207], v[228:231], v[104:107], v[192:207]
 ds_read_b64_tr_b16 v[220:221], v237 offset:32768
 ds_read_b64_tr_b16 v[222:223], v237 offset:33280
 buffer_store_dwordx4 v[160:163], v254, s[16:19], s4 offen offset:2048 sc1
 s_waitcnt lgkmcnt(4)
 v_mfma_f32_32x32x16_bf16 v[176:191], v[208:211], v[108:111], v[176:191]
 ds_read_b64_tr_b16 v[224:225], v236 offset:34816
 ds_read_b64_tr_b16 v[226:227], v236 offset:35328
 v_mfma_f32_32x32x16_bf16 v[192:207], v[212:215], v[108:111], v[192:207]
 ds_read_b64_tr_b16 v[228:229], v237 offset:34816
 ds_read_b64_tr_b16 v[230:231], v237 offset:35328
 v_mul_f32 v168, v252, v168
 s_waitcnt lgkmcnt(4)
 v_mfma_f32_32x32x16_bf16 v[176:191], v[216:219], v[112:115], v[176:191]
 ds_read_b64_tr_b16 v[208:209], v236 offset:36864
 ds_read_b64_tr_b16 v[210:211], v236 offset:37376
 buffer_load_dwordx4 v239, s[12:15], s21 offen offset:1024 lds
 v_mul_f32 v169, v252, v169
 v_mfma_f32_32x32x16_bf16 v[192:207], v[220:223], v[112:115], v[192:207]
 ds_read_b64_tr_b16 v[212:213], v237 offset:36864
 ds_read_b64_tr_b16 v[214:215], v237 offset:37376
 v_mul_f32 v170, v252, v170
 s_waitcnt lgkmcnt(4)
 v_mfma_f32_32x32x16_bf16 v[176:191], v[224:227], v[116:119], v[176:191]
 ds_read_b64_tr_b16 v[216:217], v236 offset:38912
 ds_read_b64_tr_b16 v[218:219], v236 offset:39424
 v_mul_f32 v171, v252, v171
 v_mfma_f32_32x32x16_bf16 v[192:207], v[228:231], v[116:119], v[192:207]
 ds_read_b64_tr_b16 v[220:221], v237 offset:38912
 ds_read_b64_tr_b16 v[222:223], v237 offset:39424
 v_mul_f32 v172, v252, v172
 s_waitcnt lgkmcnt(4)
 v_mfma_f32_32x32x16_bf16 v[176:191], v[208:211], v[120:123], v[176:191]
 ds_read_b64_tr_b16 v[224:225], v236 offset:40960
 ds_read_b64_tr_b16 v[226:227], v236 offset:41472
 s_add_u32 m0, s30, 81920
 s_add_u32 s21, s42, 384
 buffer_load_dwordx4 v238, s[12:15], s21 offen lds
 v_mfma_f32_32x32x16_bf16 v[192:207], v[212:215], v[120:123], v[192:207]
 ds_read_b64_tr_b16 v[228:229], v237 offset:40960
 ds_read_b64_tr_b16 v[230:231], v237 offset:41472
 v_mul_f32 v173, v252, v173
 s_waitcnt lgkmcnt(4)
 v_mfma_f32_32x32x16_bf16 v[176:191], v[216:219], v[124:127], v[176:191]
 ds_read_b64_tr_b16 v[208:209], v236 offset:43008
 ds_read_b64_tr_b16 v[210:211], v236 offset:43520
 v_mul_f32 v174, v252, v174
 v_mfma_f32_32x32x16_bf16 v[192:207], v[220:223], v[124:127], v[192:207]
 ds_read_b64_tr_b16 v[212:213], v237 offset:43008
 ds_read_b64_tr_b16 v[214:215], v237 offset:43520
 v_mul_f32 v175, v252, v175
 s_waitcnt lgkmcnt(4)
 v_mfma_f32_32x32x16_bf16 v[176:191], v[224:227], v[128:131], v[176:191]
 ds_read_b64_tr_b16 v[216:217], v236 offset:45056
 ds_read_b64_tr_b16 v[218:219], v236 offset:45568
 buffer_load_dwordx4 v239, s[12:15], s21 offen offset:1024 lds
 v_cvt_pk_bf16_f32 v168, v168, v169
 v_mfma_f32_32x32x16_bf16 v[192:207], v[228:231], v[128:131], v[192:207]
 ds_read_b64_tr_b16 v[220:221], v237 offset:45056
 ds_read_b64_tr_b16 v[222:223], v237 offset:45568
 s_waitcnt lgkmcnt(4)
 v_mfma_f32_32x32x16_bf16 v[176:191], v[208:211], v[132:135], v[176:191]
 ds_read_b64_tr_b16 v[224:225], v236 offset:47104
 ds_read_b64_tr_b16 v[226:227], v236 offset:47616
 v_cvt_pk_bf16_f32 v169, v170, v171
 v_mfma_f32_32x32x16_bf16 v[192:207], v[212:215], v[132:135], v[192:207]
 ds_read_b64_tr_b16 v[228:229], v237 offset:47104
 ds_read_b64_tr_b16 v[230:231], v237 offset:47616
 s_waitcnt vmcnt(19)
 s_barrier
 s_waitcnt lgkmcnt(4)
 v_mfma_f32_32x32x16_bf16 v[176:191], v[216:219], v[136:139], v[176:191]
 ds_read_b64_tr_b16 v[208:209], v232 offset:0
 ds_read_b64_tr_b16 v[210:211], v232 offset:512
 s_add_u32 m0, s30, 90112
 s_add_u32 s21, s43, 384
 buffer_load_dwordx4 v238, s[12:15], s21 offen lds
 v_cvt_pk_bf16_f32 v170, v172, v173
 v_mfma_f32_32x32x16_bf16 v[192:207], v[220:223], v[136:139], v[192:207]
 ds_read_b64_tr_b16 v[212:213], v233 offset:0
 ds_read_b64_tr_b16 v[214:215], v233 offset:512
 v_cvt_pk_bf16_f32 v171, v174, v175
 s_waitcnt lgkmcnt(4)
 v_mfma_f32_32x32x16_bf16 v[176:191], v[224:227], v[140:143], v[176:191]
 ds_read_b64_tr_b16 v[216:217], v232 offset:2048
 ds_read_b64_tr_b16 v[218:219], v232 offset:2560
 buffer_store_dwordx4 v[168:171], v254, s[16:19], s4 offen offset:3072 sc1
 v_mfma_f32_32x32x16_bf16 v[192:207], v[228:231], v[140:143], v[192:207]
 ds_read_b64_tr_b16 v[220:221], v233 offset:2048
 ds_read_b64_tr_b16 v[222:223], v233 offset:2560
 s_cmp_eq_u32 s27, 4
 s_cbranch_scc1 L1_mix
 s_waitcnt lgkmcnt(4)
 v_mfma_f32_32x32x16_bf16 v[144:159], v[208:211], v[0:3], 0
 ds_read_b64_tr_b16 v[224:225], v232 offset:4096
 ds_read_b64_tr_b16 v[226:227], v232 offset:4608
 buffer_load_dwordx4 v239, s[12:15], s21 offen offset:1024 lds
 v_mfma_f32_32x32x16_bf16 v[160:175], v[212:215], v[0:3], 0
 ds_read_b64_tr_b16 v[228:229], v233 offset:4096
 ds_read_b64_tr_b16 v[230:231], v233 offset:4608
 s_waitcnt lgkmcnt(4)
 v_mfma_f32_32x32x16_bf16 v[144:159], v[216:219], v[4:7], v[144:159]
 ds_read_b64_tr_b16 v[208:209], v232 offset:6144
 ds_read_b64_tr_b16 v[210:211], v232 offset:6656
 v_mfma_f32_32x32x16_bf16 v[160:175], v[220:223], v[4:7], v[160:175]
 ds_read_b64_tr_b16 v[212:213], v233 offset:6144
 ds_read_b64_tr_b16 v[214:215], v233 offset:6656
 s_waitcnt lgkmcnt(4)
 v_mfma_f32_32x32x16_bf16 v[144:159], v[224:227], v[8:11], v[144:159]
 ds_read_b64_tr_b16 v[216:217], v232 offset:8192
 ds_read_b64_tr_b16 v[218:219], v232 offset:8704
 s_add_u32 m0, s30, 98304
 s_add_u32 s21, s44, 384
 buffer_load_dwordx4 v238, s[12:15], s21 offen lds
 s_lshl_b32 s3, s27, 2
 s_add_u32 s3, s3, 1
 s_lshl_b32 s4, s3, 12
 s_cmp_lt_u32 s3, 9
 s_cselect_b32 s3, 0x3eae1a93, 1.0
 s_cselect_b32 s5, s52, s53
 s_add_u32 s4, s4, s5
 v_mul_f32 v252, s3, v241
 v_mfma_f32_32x32x16_bf16 v[160:175], v[228:231], v[8:11], v[160:175]
 ds_read_b64_tr_b16 v[220:221], v233 offset:8192
 ds_read_b64_tr_b16 v[222:223], v233 offset:8704
 v_mul_f32 v176, v252, v176
 s_waitcnt lgkmcnt(4)
 v_mfma_f32_32x32x16_bf16 v[144:159], v[208:211], v[12:15], v[144:159]
 ds_read_b64_tr_b16 v[224:225], v232 offset:10240
 ds_read_b64_tr_b16 v[226:227], v232 offset:10752
 v_mul_f32 v177, v252, v177
 v_mfma_f32_32x32x16_bf16 v[160:175], v[212:215], v[12:15], v[160:175]
 ds_read_b64_tr_b16 v[228:229], v233 offset:10240
 ds_read_b64_tr_b16 v[230:231], v233 offset:10752
 v_mul_f32 v178, v252, v178
 s_waitcnt lgkmcnt(4)
 v_mfma_f32_32x32x16_bf16 v[144:159], v[216:219], v[16:19], v[144:159]
 ds_read_b64_tr_b16 v[208:209], v232 offset:12288
 ds_read_b64_tr_b16 v[210:211], v232 offset:12800
 buffer_load_dwordx4 v239, s[12:15], s21 offen offset:1024 lds
 v_mul_f32 v179, v252, v179
 v_mfma_f32_32x32x16_bf16 v[160:175], v[220:223], v[16:19], v[160:175]
 ds_read_b64_tr_b16 v[212:213], v233 offset:12288
 ds_read_b64_tr_b16 v[214:215], v233 offset:12800
 s_waitcnt lgkmcnt(4)
 v_mfma_f32_32x32x16_bf16 v[144:159], v[224:227], v[20:23], v[144:159]
 ds_read_b64_tr_b16 v[216:217], v232 offset:14336
 ds_read_b64_tr_b16 v[218:219], v232 offset:14848
 v_mul_f32 v180, v252, v180
 v_mfma_f32_32x32x16_bf16 v[160:175], v[228:231], v[20:23], v[160:175]
 ds_read_b64_tr_b16 v[220:221], v233 offset:14336
 ds_read_b64_tr_b16 v[222:223], v233 offset:14848
 v_mul_f32 v181, v252, v181
 s_waitcnt lgkmcnt(4)
 v_mfma_f32_32x32x16_bf16 v[144:159], v[208:211], v[24:27], v[144:159]
 ds_read_b64_tr_b16 v[224:225], v232 offset:16384
 ds_read_b64_tr_b16 v[226:227], v232 offset:16896
 s_add_u32 m0, s30, 106496
 s_add_u32 s21, s45, 384
 buffer_load_dwordx4 v238, s[12:15], s21 offen lds
 v_mul_f32 v182, v252, v182
 v_mfma_f32_32x32x16_bf16 v[160:175], v[212:215], v[24:27], v[160:175]
 ds_read_b64_tr_b16 v[228:229], v233 offset:16384
 ds_read_b64_tr_b16 v[230:231], v233 offset:16896
 v_mul_f32 v183, v252, v183
 s_waitcnt lgkmcnt(4)
 v_mfma_f32_32x32x16_bf16 v[144:159], v[216:219], v[28:31], v[144:159]
 ds_read_b64_tr_b16 v[208:209], v232 offset:18432
 ds_read_b64_tr_b16 v[210:211], v232 offset:18944
 v_mfma_f32_32x32x16_bf16 v[160:175], v[220:223], v[28:31], v[160:175]
 ds_read_b64_tr_b16 v[212:213], v233 offset:18432
 ds_read_b64_tr_b16 v[214:215], v233 offset:18944
 v_cvt_pk_bf16_f32 v176, v176, v177
 s_waitcnt lgkmcnt(4)
 v_mfma_f32_32x32x16_bf16 v[144:159], v[224:227], v[32:35], v[144:159]
 ds_read_b64_tr_b16 v[216:217], v232 offset:20480
 ds_read_b64_tr_b16 v[218:219], v232 offset:20992
 buffer_load_dwordx4 v239, s[12:15], s21 offen offset:1024 lds
 v_cvt_pk_bf16_f32 v177, v178, v179
 v_mfma_f32_32x32x16_bf16 v[160:175], v[228:231], v[32:35], v[160:175]
 ds_read_b64_tr_b16 v[220:221], v233 offset:20480
 ds_read_b64_tr_b16 v[222:223], v233 offset:20992
 v_cvt_pk_bf16_f32 v178, v180, v181
 s_waitcnt lgkmcnt(4)
 v_mfma_f32_32x32x16_bf16 v[144:159], v[208:211], v[36:39], v[144:159]
 ds_read_b64_tr_b16 v[224:225], v232 offset:22528
 ds_read_b64_tr_b16 v[226:227], v232 offset:23040
 v_cvt_pk_bf16_f32 v179, v182, v183
 v_mfma_f32_32x32x16_bf16 v[160:175], v[212:215], v[36:39], v[160:175]
 ds_read_b64_tr_b16 v[228:229], v233 offset:22528
 ds_read_b64_tr_b16 v[230:231], v233 offset:23040
 s_waitcnt vmcnt(19)
 s_barrier
 s_waitcnt lgkmcnt(4)
 v_mfma_f32_32x32x16_bf16 v[144:159], v[216:219], v[40:43], v[144:159]
 ds_read_b64_tr_b16 v[208:209], v232 offset:24576
 ds_read_b64_tr_b16 v[210:211], v232 offset:25088
 s_add_u32 m0, s30, 114688
 s_add_u32 s21, s46, 384
 buffer_load_dwordx4 v238, s[12:15], s21 offen lds
 buffer_store_dwordx4 v[176:179], v254, s[16:19], s4 offen offset:0 sc1
 v_mfma_f32_32x32x16_bf16 v[160:175], v[220:223], v[40:43], v[160:175]
 ds_read_b64_tr_b16 v[212:213], v233 offset:24576
 ds_read_b64_tr_b16 v[214:215], v233 offset:25088
 s_waitcnt lgkmcnt(4)
 v_mfma_f32_32x32x16_bf16 v[144:159], v[224:227], v[44:47], v[144:159]
 ds_read_b64_tr_b16 v[216:217], v232 offset:26624
 ds_read_b64_tr_b16 v[218:219], v232 offset:27136
 v_mul_f32 v184, v252, v184
 v_mfma_f32_32x32x16_bf16 v[160:175], v[228:231], v[44:47], v[160:175]
 ds_read_b64_tr_b16 v[220:221], v233 offset:26624
 ds_read_b64_tr_b16 v[222:223], v233 offset:27136
 v_mul_f32 v185, v252, v185
 s_waitcnt lgkmcnt(4)
 v_mfma_f32_32x32x16_bf16 v[144:159], v[208:211], v[48:51], v[144:159]
 ds_read_b64_tr_b16 v[224:225], v232 offset:28672
 ds_read_b64_tr_b16 v[226:227], v232 offset:29184
 buffer_load_dwordx4 v239, s[12:15], s21 offen offset:1024 lds
 v_mul_f32 v186, v252, v186
 v_mfma_f32_32x32x16_bf16 v[160:175], v[212:215], v[48:51], v[160:175]
 ds_read_b64_tr_b16 v[228:229], v233 offset:28672
 ds_read_b64_tr_b16 v[230:231], v233 offset:29184
 v_mul_f32 v187, v252, v187
 s_waitcnt lgkmcnt(4)
 v_mfma_f32_32x32x16_bf16 v[144:159], v[216:219], v[52:55], v[144:159]
 ds_read_b64_tr_b16 v[208:209], v232 offset:30720
 ds_read_b64_tr_b16 v[210:211], v232 offset:31232
 v_mfma_f32_32x32x16_bf16 v[160:175], v[220:223], v[52:55], v[160:175]
 ds_read_b64_tr_b16 v[212:213], v233 offset:30720
 ds_read_b64_tr_b16 v[214:215], v233 offset:31232
 v_mul_f32 v188, v252, v188
 s_waitcnt lgkmcnt(4)
 v_mfma_f32_32x32x16_bf16 v[144:159], v[224:227], v[56:59], v[144:159]
 ds_read_b64_tr_b16 v[216:217], v232 offset:32768
 ds_read_b64_tr_b16 v[218:219], v232 offset:33280
 s_add_u32 m0, s30, 122880
 s_add_u32 s21, s47, 384
 buffer_load_dwordx4 v238, s[12:15], s21 offen lds
 v_mul_f32 v189, v252, v189
 v_mfma_f32_32x32x16_bf16 v[160:175], v[228:231], v[56:59], v[160:175]
 ds_read_b64_tr_b16 v[220:221], v233 offset:32768
 ds_read_b64_tr_b16 v[222:223], v233 offset:33280
 v_mul_f32 v190, v252, v190
 s_waitcnt lgkmcnt(4)
 v_mfma_f32_32x32x16_bf16 v[144:159], v[208:211], v[60:63], v[144:159]
 ds_read_b64_tr_b16 v[224:225], v232 offset:34816
 ds_read_b64_tr_b16 v[226:227], v232 offset:35328
 v_mul_f32 v191, v252, v191
 v_mfma_f32_32x32x16_bf16 v[160:175], v[212:215], v[60:63], v[160:175]
 ds_read_b64_tr_b16 v[228:229], v233 offset:34816
 ds_read_b64_tr_b16 v[230:231], v233 offset:35328
 v_cvt_pk_bf16_f32 v184, v184, v185
 s_waitcnt lgkmcnt(4)
 v_mfma_f32_32x32x16_bf16 v[144:159], v[216:219], v[64:67], v[144:159]
 ds_read_b64_tr_b16 v[208:209], v232 offset:36864
 ds_read_b64_tr_b16 v[210:211], v232 offset:37376
 buffer_load_dwordx4 v239, s[12:15], s21 offen offset:1024 lds
 v_mfma_f32_32x32x16_bf16 v[160:175], v[220:223], v[64:67], v[160:175]
 ds_read_b64_tr_b16 v[212:213], v233 offset:36864
 ds_read_b64_tr_b16 v[214:215], v233 offset:37376
 v_cvt_pk_bf16_f32 v185, v186, v187
 s_waitcnt lgkmcnt(4)
 v_mfma_f32_32x32x16_bf16 v[144:159], v[224:227], v[68:71], v[144:159]
 ds_read_b64_tr_b16 v[216:217], v232 offset:38912
 ds_read_b64_tr_b16 v[218:219], v232 offset:39424
 v_cvt_pk_bf16_f32 v186, v188, v189
 v_mfma_f32_32x32x16_bf16 v[160:175], v[228:231], v[68:71], v[160:175]
 ds_read_b64_tr_b16 v[220:221], v233 offset:38912
 ds_read_b64_tr_b16 v[222:223], v233 offset:39424
 v_cvt_pk_bf16_f32 v187, v190, v191
 s_waitcnt lgkmcnt(4)
 v_mfma_f32_32x32x16_bf16 v[144:159], v[208:211], v[72:75], v[144:159]
 ds_read_b64_tr_b16 v[224:225], v232 offset:40960
 ds_read_b64_tr_b16 v[226:227], v232 offset:41472
 s_add_u32 m0, s30, 131072
 s_add_u32 s21, s48, 384
 buffer_load_dwordx4 v238, s[12:15], s21 offen lds
 buffer_store_dwordx4 v[184:187], v254, s[16:19], s4 offen offset:1024 sc1
 v_mfma_f32_32x32x16_bf16 v[160:175], v[212:215], v[72:75], v[160:175]
 ds_read_b64_tr_b16 v[228:229], v233 offset:40960
 ds_read_b64_tr_b16 v[230:231], v233 offset:41472
 s_waitcnt lgkmcnt(4)
 v_mfma_f32_32x32x16_bf16 v[144:159], v[216:219], v[76:79], v[144:159]
 ds_read_b64_tr_b16 v[208:209], v232 offset:43008
 ds_read_b64_tr_b16 v[210:211], v232 offset:43520
 v_mul_f32 v192, v252, v192
 v_mfma_f32_32x32x16_bf16 v[160:175], v[220:223], v[76:79], v[160:175]
 ds_read_b64_tr_b16 v[212:213], v233 offset:43008
 ds_read_b64_tr_b16 v[214:215], v233 offset:43520
 v_mul_f32 v193, v252, v193
 s_waitcnt lgkmcnt(4)
 v_mfma_f32_32x32x16_bf16 v[144:159], v[224:227], v[80:83], v[144:159]
 ds_read_b64_tr_b16 v[216:217], v232 offset:45056
 ds_read_b64_tr_b16 v[218:219], v232 offset:45568
 buffer_load_dwordx4 v239, s[12:15], s21 offen offset:1024 lds
 v_mul_f32 v194, v252, v194
 v_mfma_f32_32x32x16_bf16 v[160:175], v[228:231], v[80:83], v[160:175]
 ds_read_b64_tr_b16 v[220:221], v233 offset:45056
 ds_read_b64_tr_b16 v[222:223], v233 offset:45568
 v_mul_f32 v195, v252, v195
 s_waitcnt lgkmcnt(4)
 v_mfma_f32_32x32x16_bf16 v[144:159], v[208:211], v[84:87], v[144:159]
 ds_read_b64_tr_b16 v[224:225], v232 offset:47104
 ds_read_b64_tr_b16 v[226:227], v232 offset:47616
 v_mfma_f32_32x32x16_bf16 v[160:175], v[212:215], v[84:87], v[160:175]
 ds_read_b64_tr_b16 v[228:229], v233 offset:47104
 ds_read_b64_tr_b16 v[230:231], v233 offset:47616
 s_waitcnt vmcnt(20)
 s_barrier
 s_waitcnt lgkmcnt(4)
 v_mfma_f32_32x32x16_bf16 v[144:159], v[216:219], v[88:91], v[144:159]
 ds_read_b64_tr_b16 v[208:209], v234 offset:0
 ds_read_b64_tr_b16 v[210:211], v234 offset:512
 s_add_u32 m0, s30, 139264
 s_add_u32 s21, s49, 384
 buffer_load_dwordx4 v238, s[12:15], s21 offen lds
 v_mul_f32 v196, v252, v196
 v_mfma_f32_32x32x16_bf16 v[160:175], v[220:223], v[88:91], v[160:175]
 ds_read_b64_tr_b16 v[212:213], v235 offset:0
 ds_read_b64_tr_b16 v[214:215], v235 offset:512
 v_mul_f32 v197, v252, v197
 s_waitcnt lgkmcnt(4)
 v_mfma_f32_32x32x16_bf16 v[144:159], v[224:227], v[92:95], v[144:159]
 ds_read_b64_tr_b16 v[216:217], v234 offset:2048
 ds_read_b64_tr_b16 v[218:219], v234 offset:2560
 v_mul_f32 v198, v252, v198
 v_mfma_f32_32x32x16_bf16 v[160:175], v[228:231], v[92:95], v[160:175]
 ds_read_b64_tr_b16 v[220:221], v235 offset:2048
 ds_read_b64_tr_b16 v[222:223], v235 offset:2560
 v_mul_f32 v199, v252, v199
 s_waitcnt lgkmcnt(4)
 v_mfma_f32_32x32x16_bf16 v[144:159], v[208:211], v[96:99], v[144:159]
 ds_read_b64_tr_b16 v[224:225], v234 offset:4096
 ds_read_b64_tr_b16 v[226:227], v234 offset:4608
 buffer_load_dwordx4 v239, s[12:15], s21 offen offset:1024 lds
 v_cvt_pk_bf16_f32 v192, v192, v193
 v_mfma_f32_32x32x16_bf16 v[160:175], v[212:215], v[96:99], v[160:175]
 ds_read_b64_tr_b16 v[228:229], v235 offset:4096
 ds_read_b64_tr_b16 v[230:231], v235 offset:4608
 s_waitcnt lgkmcnt(4)
 v_mfma_f32_32x32x16_bf16 v[144:159], v[216:219], v[100:103], v[144:159]
 ds_read_b64_tr_b16 v[208:209], v234 offset:6144
 ds_read_b64_tr_b16 v[210:211], v234 offset:6656
 v_cvt_pk_bf16_f32 v193, v194, v195
 v_mfma_f32_32x32x16_bf16 v[160:175], v[220:223], v[100:103], v[160:175]
 ds_read_b64_tr_b16 v[212:213], v235 offset:6144
 ds_read_b64_tr_b16 v[214:215], v235 offset:6656
 v_cvt_pk_bf16_f32 v194, v196, v197
 s_waitcnt lgkmcnt(4)
 v_mfma_f32_32x32x16_bf16 v[144:159], v[224:227], v[104:107], v[144:159]
 ds_read_b64_tr_b16 v[216:217], v234 offset:8192
 ds_read_b64_tr_b16 v[218:219], v234 offset:8704
 v_cvt_pk_bf16_f32 v195, v198, v199
 v_mfma_f32_32x32x16_bf16 v[160:175], v[228:231], v[104:107], v[160:175]
 ds_read_b64_tr_b16 v[220:221], v235 offset:8192
 ds_read_b64_tr_b16 v[222:223], v235 offset:8704
 buffer_store_dwordx4 v[192:195], v254, s[16:19], s4 offen offset:2048 sc1
 s_waitcnt lgkmcnt(4)
 v_mfma_f32_32x32x16_bf16 v[144:159], v[208:211], v[108:111], v[144:159]
 ds_read_b64_tr_b16 v[224:225], v234 offset:10240
 ds_read_b64_tr_b16 v[226:227], v234 offset:10752
 v_mfma_f32_32x32x16_bf16 v[160:175], v[212:215], v[108:111], v[160:175]
 ds_read_b64_tr_b16 v[228:229], v235 offset:10240
 ds_read_b64_tr_b16 v[230:231], v235 offset:10752
 v_mul_f32 v200, v252, v200
 s_waitcnt lgkmcnt(4)
 v_mfma_f32_32x32x16_bf16 v[144:159], v[216:219], v[112:115], v[144:159]
 ds_read_b64_tr_b16 v[208:209], v234 offset:12288
 ds_read_b64_tr_b16 v[210:211], v234 offset:12800
 v_mul_f32 v201, v252, v201
 v_mfma_f32_32x32x16_bf16 v[160:175], v[220:223], v[112:115], v[160:175]
 ds_read_b64_tr_b16 v[212:213], v235 offset:12288
 ds_read_b64_tr_b16 v[214:215], v235 offset:12800
 v_mul_f32 v202, v252, v202
 s_waitcnt lgkmcnt(4)
 v_mfma_f32_32x32x16_bf16 v[144:159], v[224:227], v[116:119], v[144:159]
 ds_read_b64_tr_b16 v[216:217], v234 offset:14336
 ds_read_b64_tr_b16 v[218:219], v234 offset:14848
 v_mul_f32 v203, v252, v203
 v_mfma_f32_32x32x16_bf16 v[160:175], v[228:231], v[116:119], v[160:175]
 ds_read_b64_tr_b16 v[220:221], v235 offset:14336
 ds_read_b64_tr_b16 v[222:223], v235 offset:14848
 v_mul_f32 v204, v252, v204
 s_waitcnt lgkmcnt(4)
 v_mfma_f32_32x32x16_bf16 v[144:159], v[208:211], v[120:123], v[144:159]
 ds_read_b64_tr_b16 v[224:225], v234 offset:16384
 ds_read_b64_tr_b16 v[226:227], v234 offset:16896
 v_mfma_f32_32x32x16_bf16 v[160:175], v[212:215], v[120:123], v[160:175]
 ds_read_b64_tr_b16 v[228:229], v235 offset:16384
 ds_read_b64_tr_b16 v[230:231], v235 offset:16896
 v_mul_f32 v205, v252, v205
 s_waitcnt lgkmcnt(4)
 v_mfma_f32_32x32x16_bf16 v[144:159], v[216:219], v[124:127], v[144:159]
 ds_read_b64_tr_b16 v[208:209], v234 offset:18432
 ds_read_b64_tr_b16 v[210:211], v234 offset:18944
 v_mul_f32 v206, v252, v206
 v_mfma_f32_32x32x16_bf16 v[160:175], v[220:223], v[124:127], v[160:175]
 ds_read_b64_tr_b16 v[212:213], v235 offset:18432
 ds_read_b64_tr_b16 v[214:215], v235 offset:18944
 v_mul_f32 v207, v252, v207
 s_waitcnt lgkmcnt(4)
 v_mfma_f32_32x32x16_bf16 v[144:159], v[224:227], v[128:131], v[144:159]
 ds_read_b64_tr_b16 v[216:217], v234 offset:20480
 ds_read_b64_tr_b16 v[218:219], v234 offset:20992
 v_cvt_pk_bf16_f32 v200, v200, v201
 v_mfma_f32_32x32x16_bf16 v[160:175], v[228:231], v[128:131], v[160:175]
 ds_read_b64_tr_b16 v[220:221], v235 offset:20480
 ds_read_b64_tr_b16 v[222:223], v235 offset:20992
 s_waitcnt lgkmcnt(4)
 v_mfma_f32_32x32x16_bf16 v[144:159], v[208:211], v[132:135], v[144:159]
 ds_read_b64_tr_b16 v[224:225], v234 offset:22528
 ds_read_b64_tr_b16 v[226:227], v234 offset:23040
 v_cvt_pk_bf16_f32 v201, v202, v203
 v_mfma_f32_32x32x16_bf16 v[160:175], v[212:215], v[132:135], v[160:175]
 ds_read_b64_tr_b16 v[228:229], v235 offset:22528
 ds_read_b64_tr_b16 v[230:231], v235 offset:23040
 s_waitcnt vmcnt(15)
 s_barrier
 s_waitcnt lgkmcnt(4)
 v_mfma_f32_32x32x16_bf16 v[144:159], v[216:219], v[136:139], v[144:159]
 ds_read_b64_tr_b16 v[208:209], v234 offset:24576
 ds_read_b64_tr_b16 v[210:211], v234 offset:25088
 v_cvt_pk_bf16_f32 v202, v204, v205
 v_mfma_f32_32x32x16_bf16 v[160:175], v[220:223], v[136:139], v[160:175]
 ds_read_b64_tr_b16 v[212:213], v235 offset:24576
 ds_read_b64_tr_b16 v[214:215], v235 offset:25088
 v_cvt_pk_bf16_f32 v203, v206, v207
 s_waitcnt lgkmcnt(4)
 v_mfma_f32_32x32x16_bf16 v[144:159], v[224:227], v[140:143], v[144:159]
 ds_read_b64_tr_b16 v[216:217], v234 offset:26624
 ds_read_b64_tr_b16 v[218:219], v234 offset:27136
 buffer_store_dwordx4 v[200:203], v254, s[16:19], s4 offen offset:3072 sc1
 v_mfma_f32_32x32x16_bf16 v[160:175], v[228:231], v[140:143], v[160:175]
 ds_read_b64_tr_b16 v[220:221], v235 offset:26624
 ds_read_b64_tr_b16 v[222:223], v235 offset:27136
 s_waitcnt lgkmcnt(4)
 v_mfma_f32_32x32x16_bf16 v[176:191], v[208:211], v[0:3], 0
 ds_read_b64_tr_b16 v[224:225], v234 offset:28672
 ds_read_b64_tr_b16 v[226:227], v234 offset:29184
 v_mfma_f32_32x32x16_bf16 v[192:207], v[212:215], v[0:3], 0
 ds_read_b64_tr_b16 v[228:229], v235 offset:28672
 ds_read_b64_tr_b16 v[230:231], v235 offset:29184
 s_waitcnt lgkmcnt(4)
 v_mfma_f32_32x32x16_bf16 v[176:191], v[216:219], v[4:7], v[176:191]
 ds_read_b64_tr_b16 v[208:209], v234 offset:30720
 ds_read_b64_tr_b16 v[210:211], v234 offset:31232
 v_mfma_f32_32x32x16_bf16 v[192:207], v[220:223], v[4:7], v[192:207]
 ds_read_b64_tr_b16 v[212:213], v235 offset:30720
 ds_read_b64_tr_b16 v[214:215], v235 offset:31232
 s_waitcnt lgkmcnt(4)
 v_mfma_f32_32x32x16_bf16 v[176:191], v[224:227], v[8:11], v[176:191]
 ds_read_b64_tr_b16 v[216:217], v234 offset:32768
 ds_read_b64_tr_b16 v[218:219], v234 offset:33280
 s_lshl_b32 s3, s27, 2
 s_add_u32 s3, s3, 2
 s_lshl_b32 s4, s3, 12
 s_cmp_lt_u32 s3, 9
 s_cselect_b32 s3, 0x3eae1a93, 1.0
 s_cselect_b32 s5, s52, s53
 s_add_u32 s4, s4, s5
 v_mul_f32 v252, s3, v241
 v_mfma_f32_32x32x16_bf16 v[192:207], v[228:231], v[8:11], v[192:207]
 ds_read_b64_tr_b16 v[220:221], v235 offset:32768
 ds_read_b64_tr_b16 v[222:223], v235 offset:33280
 v_mul_f32 v144, v252, v144
 s_waitcnt lgkmcnt(4)
 v_mfma_f32_32x32x16_bf16 v[176:191], v[208:211], v[12:15], v[176:191]
 ds_read_b64_tr_b16 v[224:225], v234 offset:34816
 ds_read_b64_tr_b16 v[226:227], v234 offset:35328
 v_mul_f32 v145, v252, v145
 v_mfma_f32_32x32x16_bf16 v[192:207], v[212:215], v[12:15], v[192:207]
 ds_read_b64_tr_b16 v[228:229], v235 offset:34816
 ds_read_b64_tr_b16 v[230:231], v235 offset:35328
 v_mul_f32 v146, v252, v146
 s_waitcnt lgkmcnt(4)
 v_mfma_f32_32x32x16_bf16 v[176:191], v[216:219], v[16:19], v[176:191]
 ds_read_b64_tr_b16 v[208:209], v234 offset:36864
 ds_read_b64_tr_b16 v[210:211], v234 offset:37376
 v_mul_f32 v147, v252, v147
 v_mfma_f32_32x32x16_bf16 v[192:207], v[220:223], v[16:19], v[192:207]
 ds_read_b64_tr_b16 v[212:213], v235 offset:36864
 ds_read_b64_tr_b16 v[214:215], v235 offset:37376
 s_waitcnt lgkmcnt(4)
 v_mfma_f32_32x32x16_bf16 v[176:191], v[224:227], v[20:23], v[176:191]
 ds_read_b64_tr_b16 v[216:217], v234 offset:38912
 ds_read_b64_tr_b16 v[218:219], v234 offset:39424
 v_mul_f32 v148, v252, v148
 v_mfma_f32_32x32x16_bf16 v[192:207], v[228:231], v[20:23], v[192:207]
 ds_read_b64_tr_b16 v[220:221], v235 offset:38912
 ds_read_b64_tr_b16 v[222:223], v235 offset:39424
 v_mul_f32 v149, v252, v149
 s_waitcnt lgkmcnt(4)
 v_mfma_f32_32x32x16_bf16 v[176:191], v[208:211], v[24:27], v[176:191]
 ds_read_b64_tr_b16 v[224:225], v234 offset:40960
 ds_read_b64_tr_b16 v[226:227], v234 offset:41472
 v_mul_f32 v150, v252, v150
 v_mfma_f32_32x32x16_bf16 v[192:207], v[212:215], v[24:27], v[192:207]
 ds_read_b64_tr_b16 v[228:229], v235 offset:40960
 ds_read_b64_tr_b16 v[230:231], v235 offset:41472
 v_mul_f32 v151, v252, v151
 s_waitcnt lgkmcnt(4)
 v_mfma_f32_32x32x16_bf16 v[176:191], v[216:219], v[28:31], v[176:191]
 ds_read_b64_tr_b16 v[208:209], v234 offset:43008
 ds_read_b64_tr_b16 v[210:211], v234 offset:43520
 v_mfma_f32_32x32x16_bf16 v[192:207], v[220:223], v[28:31], v[192:207]
 ds_read_b64_tr_b16 v[212:213], v235 offset:43008
 ds_read_b64_tr_b16 v[214:215], v235 offset:43520
 v_cvt_pk_bf16_f32 v144, v144, v145
 s_waitcnt lgkmcnt(4)
 v_mfma_f32_32x32x16_bf16 v[176:191], v[224:227], v[32:35], v[176:191]
 ds_read_b64_tr_b16 v[216:217], v234 offset:45056
 ds_read_b64_tr_b16 v[218:219], v234 offset:45568
 v_cvt_pk_bf16_f32 v145, v146, v147
 v_mfma_f32_32x32x16_bf16 v[192:207], v[228:231], v[32:35], v[192:207]
 ds_read_b64_tr_b16 v[220:221], v235 offset:45056
 ds_read_b64_tr_b16 v[222:223], v235 offset:45568
 v_cvt_pk_bf16_f32 v146, v148, v149
 s_waitcnt lgkmcnt(4)
 v_mfma_f32_32x32x16_bf16 v[176:191], v[208:211], v[36:39], v[176:191]
 ds_read_b64_tr_b16 v[224:225], v234 offset:47104
 ds_read_b64_tr_b16 v[226:227], v234 offset:47616
 v_cvt_pk_bf16_f32 v147, v150, v151
 v_mfma_f32_32x32x16_bf16 v[192:207], v[212:215], v[36:39], v[192:207]
 ds_read_b64_tr_b16 v[228:229], v235 offset:47104
 ds_read_b64_tr_b16 v[230:231], v235 offset:47616
 s_waitcnt vmcnt(9)
 s_barrier
 s_waitcnt lgkmcnt(4)
 v_mfma_f32_32x32x16_bf16 v[176:191], v[216:219], v[40:43], v[176:191]
 ds_read_b64_tr_b16 v[208:209], v236 offset:0
 ds_read_b64_tr_b16 v[210:211], v236 offset:512
 buffer_store_dwordx4 v[144:147], v254, s[16:19], s4 offen offset:0 sc1
 v_mfma_f32_32x32x16_bf16 v[192:207], v[220:223], v[40:43], v[192:207]
 ds_read_b64_tr_b16 v[212:213], v237 offset:0
 ds_read_b64_tr_b16 v[214:215], v237 offset:512
 s_waitcnt lgkmcnt(4)
 v_mfma_f32_32x32x16_bf16 v[176:191], v[224:227], v[44:47], v[176:191]
 ds_read_b64_tr_b16 v[216:217], v236 offset:2048
 ds_read_b64_tr_b16 v[218:219], v236 offset:2560
 v_mul_f32 v152, v252, v152
 v_mfma_f32_32x32x16_bf16 v[192:207], v[228:231], v[44:47], v[192:207]
 ds_read_b64_tr_b16 v[220:221], v237 offset:2048
 ds_read_b64_tr_b16 v[222:223], v237 offset:2560
 v_mul_f32 v153, v252, v153
 s_waitcnt lgkmcnt(4)
 v_mfma_f32_32x32x16_bf16 v[176:191], v[208:211], v[48:51], v[176:191]
 ds_read_b64_tr_b16 v[224:225], v236 offset:4096
 ds_read_b64_tr_b16 v[226:227], v236 offset:4608
 v_mul_f32 v154, v252, v154
 v_mfma_f32_32x32x16_bf16 v[192:207], v[212:215], v[48:51], v[192:207]
 ds_read_b64_tr_b16 v[228:229], v237 offset:4096
 ds_read_b64_tr_b16 v[230:231], v237 offset:4608
 v_mul_f32 v155, v252, v155
 s_waitcnt lgkmcnt(4)
 v_mfma_f32_32x32x16_bf16 v[176:191], v[216:219], v[52:55], v[176:191]
 ds_read_b64_tr_b16 v[208:209], v236 offset:6144
 ds_read_b64_tr_b16 v[210:211], v236 offset:6656
 v_mfma_f32_32x32x16_bf16 v[192:207], v[220:223], v[52:55], v[192:207]
 ds_read_b64_tr_b16 v[212:213], v237 offset:6144
 ds_read_b64_tr_b16 v[214:215], v237 offset:6656
 v_mul_f32 v156, v252, v156
 s_waitcnt lgkmcnt(4)
 v_mfma_f32_32x32x16_bf16 v[176:191], v[224:227], v[56:59], v[176:191]
 ds_read_b64_tr_b16 v[216:217], v236 offset:8192
 ds_read_b64_tr_b16 v[218:219], v236 offset:8704
 v_mul_f32 v157, v252, v157
 v_mfma_f32_32x32x16_bf16 v[192:207], v[228:231], v[56:59], v[192:207]
 ds_read_b64_tr_b16 v[220:221], v237 offset:8192
 ds_read_b64_tr_b16 v[222:223], v237 offset:8704
 v_mul_f32 v158, v252, v158
 s_waitcnt lgkmcnt(4)
 v_mfma_f32_32x32x16_bf16 v[176:191], v[208:211], v[60:63], v[176:191]
 ds_read_b64_tr_b16 v[224:225], v236 offset:10240
 ds_read_b64_tr_b16 v[226:227], v236 offset:10752
 v_mul_f32 v159, v252, v159
 v_mfma_f32_32x32x16_bf16 v[192:207], v[212:215], v[60:63], v[192:207]
 ds_read_b64_tr_b16 v[228:229], v237 offset:10240
 ds_read_b64_tr_b16 v[230:231], v237 offset:10752
 v_cvt_pk_bf16_f32 v152, v152, v153
 s_waitcnt lgkmcnt(4)
 v_mfma_f32_32x32x16_bf16 v[176:191], v[216:219], v[64:67], v[176:191]
 ds_read_b64_tr_b16 v[208:209], v236 offset:12288
 ds_read_b64_tr_b16 v[210:211], v236 offset:12800
 v_mfma_f32_32x32x16_bf16 v[192:207], v[220:223], v[64:67], v[192:207]
 ds_read_b64_tr_b16 v[212:213], v237 offset:12288
 ds_read_b64_tr_b16 v[214:215], v237 offset:12800
 v_cvt_pk_bf16_f32 v153, v154, v155
 s_waitcnt lgkmcnt(4)
 v_mfma_f32_32x32x16_bf16 v[176:191], v[224:227], v[68:71], v[176:191]
 ds_read_b64_tr_b16 v[216:217], v236 offset:14336
 ds_read_b64_tr_b16 v[218:219], v236 offset:14848
 v_cvt_pk_bf16_f32 v154, v156, v157
 v_mfma_f32_32x32x16_bf16 v[192:207], v[228:231], v[68:71], v[192:207]
 ds_read_b64_tr_b16 v[220:221], v237 offset:14336
 ds_read_b64_tr_b16 v[222:223], v237 offset:14848
 v_cvt_pk_bf16_f32 v155, v158, v159
 s_waitcnt lgkmcnt(4)
 v_mfma_f32_32x32x16_bf16 v[176:191], v[208:211], v[72:75], v[176:191]
 ds_read_b64_tr_b16 v[224:225], v236 offset:16384
 ds_read_b64_tr_b16 v[226:227], v236 offset:16896
 buffer_store_dwordx4 v[152:155], v254, s[16:19], s4 offen offset:1024 sc1
 v_mfma_f32_32x32x16_bf16 v[192:207], v[212:215], v[72:75], v[192:207]
 ds_read_b64_tr_b16 v[228:229], v237 offset:16384
 ds_read_b64_tr_b16 v[230:231], v237 offset:16896
 s_waitcnt lgkmcnt(4)
 v_mfma_f32_32x32x16_bf16 v[176:191], v[216:219], v[76:79], v[176:191]
 ds_read_b64_tr_b16 v[208:209], v236 offset:18432
 ds_read_b64_tr_b16 v[210:211], v236 offset:18944
 v_mul_f32 v160, v252, v160
 v_mfma_f32_32x32x16_bf16 v[192:207], v[220:223], v[76:79], v[192:207]
 ds_read_b64_tr_b16 v[212:213], v237 offset:18432
 ds_read_b64_tr_b16 v[214:215], v237 offset:18944
 v_mul_f32 v161, v252, v161
 s_waitcnt lgkmcnt(4)
 v_mfma_f32_32x32x16_bf16 v[176:191], v[224:227], v[80:83], v[176:191]
 ds_read_b64_tr_b16 v[216:217], v236 offset:20480
 ds_read_b64_tr_b16 v[218:219], v236 offset:20992
 v_mul_f32 v162, v252, v162
 v_mfma_f32_32x32x16_bf16 v[192:207], v[228:231], v[80:83], v[192:207]
 ds_read_b64_tr_b16 v[220:221], v237 offset:20480
 ds_read_b64_tr_b16 v[222:223], v237 offset:20992
 v_mul_f32 v163, v252, v163
 s_waitcnt lgkmcnt(4)
 v_mfma_f32_32x32x16_bf16 v[176:191], v[208:211], v[84:87], v[176:191]
 ds_read_b64_tr_b16 v[224:225], v236 offset:22528
 ds_read_b64_tr_b16 v[226:227], v236 offset:23040
 v_mfma_f32_32x32x16_bf16 v[192:207], v[212:215], v[84:87], v[192:207]
 ds_read_b64_tr_b16 v[228:229], v237 offset:22528
 ds_read_b64_tr_b16 v[230:231], v237 offset:23040
 s_waitcnt vmcnt(4)
 s_barrier
 s_waitcnt lgkmcnt(4)
 v_mfma_f32_32x32x16_bf16 v[176:191], v[216:219], v[88:91], v[176:191]
 ds_read_b64_tr_b16 v[208:209], v236 offset:24576
 ds_read_b64_tr_b16 v[210:211], v236 offset:25088
 v_mul_f32 v164, v252, v164
 v_mfma_f32_32x32x16_bf16 v[192:207], v[220:223], v[88:91], v[192:207]
 ds_read_b64_tr_b16 v[212:213], v237 offset:24576
 ds_read_b64_tr_b16 v[214:215], v237 offset:25088
 v_mul_f32 v165, v252, v165
 s_waitcnt lgkmcnt(4)
 v_mfma_f32_32x32x16_bf16 v[176:191], v[224:227], v[92:95], v[176:191]
 ds_read_b64_tr_b16 v[216:217], v236 offset:26624
 ds_read_b64_tr_b16 v[218:219], v236 offset:27136
 v_mul_f32 v166, v252, v166
 v_mfma_f32_32x32x16_bf16 v[192:207], v[228:231], v[92:95], v[192:207]
 ds_read_b64_tr_b16 v[220:221], v237 offset:26624
 ds_read_b64_tr_b16 v[222:223], v237 offset:27136
 v_mul_f32 v167, v252, v167
 s_waitcnt lgkmcnt(4)
 v_mfma_f32_32x32x16_bf16 v[176:191], v[208:211], v[96:99], v[176:191]
 ds_read_b64_tr_b16 v[224:225], v236 offset:28672
 ds_read_b64_tr_b16 v[226:227], v236 offset:29184
 v_cvt_pk_bf16_f32 v160, v160, v161
 v_mfma_f32_32x32x16_bf16 v[192:207], v[212:215], v[96:99], v[192:207]
 ds_read_b64_tr_b16 v[228:229], v237 offset:28672
 ds_read_b64_tr_b16 v[230:231], v237 offset:29184
 s_waitcnt lgkmcnt(4)
 v_mfma_f32_32x32x16_bf16 v[176:191], v[216:219], v[100:103], v[176:191]
 ds_read_b64_tr_b16 v[208:209], v236 offset:30720
 ds_read_b64_tr_b16 v[210:211], v236 offset:31232
 v_cvt_pk_bf16_f32 v161, v162, v163
 v_mfma_f32_32x32x16_bf16 v[192:207], v[220:223], v[100:103], v[192:207]
 ds_read_b64_tr_b16 v[212:213], v237 offset:30720
 ds_read_b64_tr_b16 v[214:215], v237 offset:31232
 v_cvt_pk_bf16_f32 v162, v164, v165
 s_waitcnt lgkmcnt(4)
 v_mfma_f32_32x32x16_bf16 v[176:191], v[224:227], v[104:107], v[176:191]
 ds_read_b64_tr_b16 v[216:217], v236 offset:32768
 ds_read_b64_tr_b16 v[218:219], v236 offset:33280
 v_cvt_pk_bf16_f32 v163, v166, v167
 v_mfma_f32_32x32x16_bf16 v[192:207], v[228:231], v[104:107], v[192:207]
 ds_read_b64_tr_b16 v[220:221], v237 offset:32768
 ds_read_b64_tr_b16 v[222:223], v237 offset:33280
 buffer_store_dwordx4 v[160:163], v254, s[16:19], s4 offen offset:2048 sc1
 s_waitcnt lgkmcnt(4)
 v_mfma_f32_32x32x16_bf16 v[176:191], v[208:211], v[108:111], v[176:191]
 ds_read_b64_tr_b16 v[224:225], v236 offset:34816
 ds_read_b64_tr_b16 v[226:227], v236 offset:35328
 v_mfma_f32_32x32x16_bf16 v[192:207], v[212:215], v[108:111], v[192:207]
 ds_read_b64_tr_b16 v[228:229], v237 offset:34816
 ds_read_b64_tr_b16 v[230:231], v237 offset:35328
 v_mul_f32 v168, v252, v168
 s_waitcnt lgkmcnt(4)
 v_mfma_f32_32x32x16_bf16 v[176:191], v[216:219], v[112:115], v[176:191]
 ds_read_b64_tr_b16 v[208:209], v236 offset:36864
 ds_read_b64_tr_b16 v[210:211], v236 offset:37376
 v_mul_f32 v169, v252, v169
 v_mfma_f32_32x32x16_bf16 v[192:207], v[220:223], v[112:115], v[192:207]
 ds_read_b64_tr_b16 v[212:213], v237 offset:36864
 ds_read_b64_tr_b16 v[214:215], v237 offset:37376
 v_mul_f32 v170, v252, v170
 s_waitcnt lgkmcnt(4)
 v_mfma_f32_32x32x16_bf16 v[176:191], v[224:227], v[116:119], v[176:191]
 ds_read_b64_tr_b16 v[216:217], v236 offset:38912
 ds_read_b64_tr_b16 v[218:219], v236 offset:39424
 v_mul_f32 v171, v252, v171
 v_mfma_f32_32x32x16_bf16 v[192:207], v[228:231], v[116:119], v[192:207]
 ds_read_b64_tr_b16 v[220:221], v237 offset:38912
 ds_read_b64_tr_b16 v[222:223], v237 offset:39424
 v_mul_f32 v172, v252, v172
 s_waitcnt lgkmcnt(4)
 v_mfma_f32_32x32x16_bf16 v[176:191], v[208:211], v[120:123], v[176:191]
 ds_read_b64_tr_b16 v[224:225], v236 offset:40960
 ds_read_b64_tr_b16 v[226:227], v236 offset:41472
 v_mfma_f32_32x32x16_bf16 v[192:207], v[212:215], v[120:123], v[192:207]
 ds_read_b64_tr_b16 v[228:229], v237 offset:40960
 ds_read_b64_tr_b16 v[230:231], v237 offset:41472
 v_mul_f32 v173, v252, v173
 s_waitcnt lgkmcnt(4)
 v_mfma_f32_32x32x16_bf16 v[176:191], v[216:219], v[124:127], v[176:191]
 ds_read_b64_tr_b16 v[208:209], v236 offset:43008
 ds_read_b64_tr_b16 v[210:211], v236 offset:43520
 v_mul_f32 v174, v252, v174
 v_mfma_f32_32x32x16_bf16 v[192:207], v[220:223], v[124:127], v[192:207]
 ds_read_b64_tr_b16 v[212:213], v237 offset:43008
 ds_read_b64_tr_b16 v[214:215], v237 offset:43520
 v_mul_f32 v175, v252, v175
 s_waitcnt lgkmcnt(4)
 v_mfma_f32_32x32x16_bf16 v[176:191], v[224:227], v[128:131], v[176:191]
 ds_read_b64_tr_b16 v[216:217], v236 offset:45056
 ds_read_b64_tr_b16 v[218:219], v236 offset:45568
 v_cvt_pk_bf16_f32 v168, v168, v169
 v_mfma_f32_32x32x16_bf16 v[192:207], v[228:231], v[128:131], v[192:207]
 ds_read_b64_tr_b16 v[220:221], v237 offset:45056
 ds_read_b64_tr_b16 v[222:223], v237 offset:45568
 s_waitcnt lgkmcnt(4)
 v_mfma_f32_32x32x16_bf16 v[176:191], v[208:211], v[132:135], v[176:191]
 ds_read_b64_tr_b16 v[224:225], v236 offset:47104
 ds_read_b64_tr_b16 v[226:227], v236 offset:47616
 v_cvt_pk_bf16_f32 v169, v170, v171
 v_mfma_f32_32x32x16_bf16 v[192:207], v[212:215], v[132:135], v[192:207]
 ds_read_b64_tr_b16 v[228:229], v237 offset:47104
 ds_read_b64_tr_b16 v[230:231], v237 offset:47616
 s_waitcnt lgkmcnt(4)
 v_mfma_f32_32x32x16_bf16 v[176:191], v[216:219], v[136:139], v[176:191]
 v_cvt_pk_bf16_f32 v170, v172, v173
 v_mfma_f32_32x32x16_bf16 v[192:207], v[220:223], v[136:139], v[192:207]
 v_cvt_pk_bf16_f32 v171, v174, v175
 s_waitcnt lgkmcnt(0)
 v_mfma_f32_32x32x16_bf16 v[176:191], v[224:227], v[140:143], v[176:191]
 buffer_store_dwordx4 v[168:171], v254, s[16:19], s4 offen offset:3072 sc1
 v_mfma_f32_32x32x16_bf16 v[192:207], v[228:231], v[140:143], v[192:207]
 s_nop 11
 s_lshl_b32 s3, s27, 2
 s_add_u32 s3, s3, 3
 s_lshl_b32 s4, s3, 12
 s_cmp_lt_u32 s3, 9
 s_cselect_b32 s3, 0x3eae1a93, 1.0
 s_cselect_b32 s5, s52, s53
 s_add_u32 s4, s4, s5
 v_mul_f32 v252, s3, v241
 v_mul_f32 v176, v252, v176
 v_mul_f32 v177, v252, v177
 v_mul_f32 v178, v252, v178
 v_mul_f32 v179, v252, v179
 v_mul_f32 v180, v252, v180
 v_mul_f32 v181, v252, v181
 v_mul_f32 v182, v252, v182
 v_mul_f32 v183, v252, v183
 v_cvt_pk_bf16_f32 v176, v176, v177
 v_cvt_pk_bf16_f32 v177, v178, v179
 v_cvt_pk_bf16_f32 v178, v180, v181
 v_cvt_pk_bf16_f32 v179, v182, v183
 buffer_store_dwordx4 v[176:179], v254, s[16:19], s4 offen offset:0 sc1
 v_mul_f32 v184, v252, v184
 v_mul_f32 v185, v252, v185
 v_mul_f32 v186, v252, v186
 v_mul_f32 v187, v252, v187
 v_mul_f32 v188, v252, v188
 v_mul_f32 v189, v252, v189
 v_mul_f32 v190, v252, v190
 v_mul_f32 v191, v252, v191
 v_cvt_pk_bf16_f32 v184, v184, v185
 v_cvt_pk_bf16_f32 v185, v186, v187
 v_cvt_pk_bf16_f32 v186, v188, v189
 v_cvt_pk_bf16_f32 v187, v190, v191
 buffer_store_dwordx4 v[184:187], v254, s[16:19], s4 offen offset:1024 sc1
 v_mul_f32 v192, v252, v192
 v_mul_f32 v193, v252, v193
 v_mul_f32 v194, v252, v194
 v_mul_f32 v195, v252, v195
 v_mul_f32 v196, v252, v196
 v_mul_f32 v197, v252, v197
 v_mul_f32 v198, v252, v198
 v_mul_f32 v199, v252, v199
 v_cvt_pk_bf16_f32 v192, v192, v193
 v_cvt_pk_bf16_f32 v193, v194, v195
 v_cvt_pk_bf16_f32 v194, v196, v197
 v_cvt_pk_bf16_f32 v195, v198, v199
 buffer_store_dwordx4 v[192:195], v254, s[16:19], s4 offen offset:2048 sc1
 v_mul_f32 v200, v252, v200
 v_mul_f32 v201, v252, v201
 v_mul_f32 v202, v252, v202
 v_mul_f32 v203, v252, v203
 v_mul_f32 v204, v252, v204
 v_mul_f32 v205, v252, v205
 v_mul_f32 v206, v252, v206
 v_mul_f32 v207, v252, v207
 v_cvt_pk_bf16_f32 v200, v200, v201
 v_cvt_pk_bf16_f32 v201, v202, v203
 v_cvt_pk_bf16_f32 v202, v204, v205
 v_cvt_pk_bf16_f32 v203, v206, v207
 buffer_store_dwordx4 v[200:203], v254, s[16:19], s4 offen offset:3072 sc1
 s_branch L1_qdone
L1_mix:
 s_waitcnt lgkmcnt(4)
 v_mfma_f32_32x32x16_bf16 v[144:159], v[0:3], v[208:211], 0
 ds_read_b64_tr_b16 v[224:225], v232 offset:4096
 ds_read_b64_tr_b16 v[226:227], v232 offset:4608
 buffer_load_dwordx4 v239, s[12:15], s21 offen offset:1024 lds
 v_mfma_f32_32x32x16_bf16 v[160:175], v[0:3], v[212:215], 0
 ds_read_b64_tr_b16 v[228:229], v233 offset:4096
 ds_read_b64_tr_b16 v[230:231], v233 offset:4608
 s_waitcnt lgkmcnt(4)
 v_mfma_f32_32x32x16_bf16 v[144:159], v[4:7], v[216:219], v[144:159]
 ds_read_b64_tr_b16 v[208:209], v232 offset:6144
 ds_read_b64_tr_b16 v[210:211], v232 offset:6656
 v_mfma_f32_32x32x16_bf16 v[160:175], v[4:7], v[220:223], v[160:175]
 ds_read_b64_tr_b16 v[212:213], v233 offset:6144
 ds_read_b64_tr_b16 v[214:215], v233 offset:6656
 s_waitcnt lgkmcnt(4)
 v_mfma_f32_32x32x16_bf16 v[144:159], v[8:11], v[224:227], v[144:159]
 ds_read_b64_tr_b16 v[216:217], v232 offset:8192
 ds_read_b64_tr_b16 v[218:219], v232 offset:8704
 s_add_u32 m0, s30, 98304
 s_add_u32 s21, s44, 384
 buffer_load_dwordx4 v238, s[12:15], s21 offen lds
 s_lshl_b32 s3, s27, 2
 s_add_u32 s3, s3, 1
 s_lshl_b32 s4, s3, 12
 s_cmp_lt_u32 s3, 9
 s_cselect_b32 s3, 0x3eae1a93, 1.0
 s_cselect_b32 s5, s52, s53
 s_add_u32 s4, s4, s5
 v_mul_f32 v252, s3, v241
 v_mfma_f32_32x32x16_bf16 v[160:175], v[8:11], v[228:231], v[160:175]
 ds_read_b64_tr_b16 v[220:221], v233 offset:8192
 ds_read_b64_tr_b16 v[222:223], v233 offset:8704
 v_mul_f32 v176, v252, v176
 s_waitcnt lgkmcnt(4)
 v_mfma_f32_32x32x16_bf16 v[144:159], v[12:15], v[208:211], v[144:159]
 ds_read_b64_tr_b16 v[224:225], v232 offset:10240
 ds_read_b64_tr_b16 v[226:227], v232 offset:10752
 v_mul_f32 v177, v252, v177
 v_mfma_f32_32x32x16_bf16 v[160:175], v[12:15], v[212:215], v[160:175]
 ds_read_b64_tr_b16 v[228:229], v233 offset:10240
 ds_read_b64_tr_b16 v[230:231], v233 offset:10752
 v_mul_f32 v178, v252, v178
 s_waitcnt lgkmcnt(4)
 v_mfma_f32_32x32x16_bf16 v[144:159], v[16:19], v[216:219], v[144:159]
 ds_read_b64_tr_b16 v[208:209], v232 offset:12288
 ds_read_b64_tr_b16 v[210:211], v232 offset:12800
 buffer_load_dwordx4 v239, s[12:15], s21 offen offset:1024 lds
 v_mul_f32 v179, v252, v179
 v_mfma_f32_32x32x16_bf16 v[160:175], v[16:19], v[220:223], v[160:175]
 ds_read_b64_tr_b16 v[212:213], v233 offset:12288
 ds_read_b64_tr_b16 v[214:215], v233 offset:12800
 s_waitcnt lgkmcnt(4)
 v_mfma_f32_32x32x16_bf16 v[144:159], v[20:23], v[224:227], v[144:159]
 ds_read_b64_tr_b16 v[216:217], v232 offset:14336
 ds_read_b64_tr_b16 v[218:219], v232 offset:14848
 v_mul_f32 v180, v252, v180
 v_mfma_f32_32x32x16_bf16 v[160:175], v[20:23], v[228:231], v[160:175]
 ds_read_b64_tr_b16 v[220:221], v233 offset:14336
 ds_read_b64_tr_b16 v[222:223], v233 offset:14848
 v_mul_f32 v181, v252, v181
 s_waitcnt lgkmcnt(4)
 v_mfma_f32_32x32x16_bf16 v[144:159], v[24:27], v[208:211], v[144:159]
 ds_read_b64_tr_b16 v[224:225], v232 offset:16384
 ds_read_b64_tr_b16 v[226:227], v232 offset:16896
 s_add_u32 m0, s30, 106496
 s_add_u32 s21, s45, 384
 buffer_load_dwordx4 v238, s[12:15], s21 offen lds
 v_mul_f32 v182, v252, v182
 v_mfma_f32_32x32x16_bf16 v[160:175], v[24:27], v[212:215], v[160:175]
 ds_read_b64_tr_b16 v[228:229], v233 offset:16384
 ds_read_b64_tr_b16 v[230:231], v233 offset:16896
 v_mul_f32 v183, v252, v183
 s_waitcnt lgkmcnt(4)
 v_mfma_f32_32x32x16_bf16 v[144:159], v[28:31], v[216:219], v[144:159]
 ds_read_b64_tr_b16 v[208:209], v232 offset:18432
 ds_read_b64_tr_b16 v[210:211], v232 offset:18944
 v_mfma_f32_32x32x16_bf16 v[160:175], v[28:31], v[220:223], v[160:175]
 ds_read_b64_tr_b16 v[212:213], v233 offset:18432
 ds_read_b64_tr_b16 v[214:215], v233 offset:18944
 v_cvt_pk_bf16_f32 v176, v176, v177
 s_waitcnt lgkmcnt(4)
 v_mfma_f32_32x32x16_bf16 v[144:159], v[32:35], v[224:227], v[144:159]
 ds_read_b64_tr_b16 v[216:217], v232 offset:20480
 ds_read_b64_tr_b16 v[218:219], v232 offset:20992
 buffer_load_dwordx4 v239, s[12:15], s21 offen offset:1024 lds
 v_cvt_pk_bf16_f32 v177, v178, v179
 v_mfma_f32_32x32x16_bf16 v[160:175], v[32:35], v[228:231], v[160:175]
 ds_read_b64_tr_b16 v[220:221], v233 offset:20480
 ds_read_b64_tr_b16 v[222:223], v233 offset:20992
 v_cvt_pk_bf16_f32 v178, v180, v181
 s_waitcnt lgkmcnt(4)
 v_mfma_f32_32x32x16_bf16 v[144:159], v[36:39], v[208:211], v[144:159]
 ds_read_b64_tr_b16 v[224:225], v232 offset:22528
 ds_read_b64_tr_b16 v[226:227], v232 offset:23040
 v_cvt_pk_bf16_f32 v179, v182, v183
 v_mfma_f32_32x32x16_bf16 v[160:175], v[36:39], v[212:215], v[160:175]
 ds_read_b64_tr_b16 v[228:229], v233 offset:22528
 ds_read_b64_tr_b16 v[230:231], v233 offset:23040
 s_waitcnt vmcnt(19)
 s_barrier
 s_waitcnt lgkmcnt(4)
 v_mfma_f32_32x32x16_bf16 v[144:159], v[40:43], v[216:219], v[144:159]
 ds_read_b64_tr_b16 v[208:209], v232 offset:24576
 ds_read_b64_tr_b16 v[210:211], v232 offset:25088
 s_add_u32 m0, s30, 114688
 s_add_u32 s21, s46, 384
 buffer_load_dwordx4 v238, s[12:15], s21 offen lds
 buffer_store_dwordx4 v[176:179], v254, s[16:19], s4 offen offset:0 sc1
 v_mfma_f32_32x32x16_bf16 v[160:175], v[40:43], v[220:223], v[160:175]
 ds_read_b64_tr_b16 v[212:213], v233 offset:24576
 ds_read_b64_tr_b16 v[214:215], v233 offset:25088
 s_waitcnt lgkmcnt(4)
 v_mfma_f32_32x32x16_bf16 v[144:159], v[44:47], v[224:227], v[144:159]
 ds_read_b64_tr_b16 v[216:217], v232 offset:26624
 ds_read_b64_tr_b16 v[218:219], v232 offset:27136
 v_mul_f32 v184, v252, v184
 v_mfma_f32_32x32x16_bf16 v[160:175], v[44:47], v[228:231], v[160:175]
 ds_read_b64_tr_b16 v[220:221], v233 offset:26624
 ds_read_b64_tr_b16 v[222:223], v233 offset:27136
 v_mul_f32 v185, v252, v185
 s_waitcnt lgkmcnt(4)
 v_mfma_f32_32x32x16_bf16 v[144:159], v[48:51], v[208:211], v[144:159]
 ds_read_b64_tr_b16 v[224:225], v232 offset:28672
 ds_read_b64_tr_b16 v[226:227], v232 offset:29184
 buffer_load_dwordx4 v239, s[12:15], s21 offen offset:1024 lds
 v_mul_f32 v186, v252, v186
 v_mfma_f32_32x32x16_bf16 v[160:175], v[48:51], v[212:215], v[160:175]
 ds_read_b64_tr_b16 v[228:229], v233 offset:28672
 ds_read_b64_tr_b16 v[230:231], v233 offset:29184
 v_mul_f32 v187, v252, v187
 s_waitcnt lgkmcnt(4)
 v_mfma_f32_32x32x16_bf16 v[144:159], v[52:55], v[216:219], v[144:159]
 ds_read_b64_tr_b16 v[208:209], v232 offset:30720
 ds_read_b64_tr_b16 v[210:211], v232 offset:31232
 v_mfma_f32_32x32x16_bf16 v[160:175], v[52:55], v[220:223], v[160:175]
 ds_read_b64_tr_b16 v[212:213], v233 offset:30720
 ds_read_b64_tr_b16 v[214:215], v233 offset:31232
 v_mul_f32 v188, v252, v188
 s_waitcnt lgkmcnt(4)
 v_mfma_f32_32x32x16_bf16 v[144:159], v[56:59], v[224:227], v[144:159]
 ds_read_b64_tr_b16 v[216:217], v232 offset:32768
 ds_read_b64_tr_b16 v[218:219], v232 offset:33280
 s_add_u32 m0, s30, 122880
 s_add_u32 s21, s47, 384
 buffer_load_dwordx4 v238, s[12:15], s21 offen lds
 v_mul_f32 v189, v252, v189
 v_mfma_f32_32x32x16_bf16 v[160:175], v[56:59], v[228:231], v[160:175]
 ds_read_b64_tr_b16 v[220:221], v233 offset:32768
 ds_read_b64_tr_b16 v[222:223], v233 offset:33280
 v_mul_f32 v190, v252, v190
 s_waitcnt lgkmcnt(4)
 v_mfma_f32_32x32x16_bf16 v[144:159], v[60:63], v[208:211], v[144:159]
 ds_read_b64_tr_b16 v[224:225], v232 offset:34816
 ds_read_b64_tr_b16 v[226:227], v232 offset:35328
 v_mul_f32 v191, v252, v191
 v_mfma_f32_32x32x16_bf16 v[160:175], v[60:63], v[212:215], v[160:175]
 ds_read_b64_tr_b16 v[228:229], v233 offset:34816
 ds_read_b64_tr_b16 v[230:231], v233 offset:35328
 v_cvt_pk_bf16_f32 v184, v184, v185
 s_waitcnt lgkmcnt(4)
 v_mfma_f32_32x32x16_bf16 v[144:159], v[64:67], v[216:219], v[144:159]
 ds_read_b64_tr_b16 v[208:209], v232 offset:36864
 ds_read_b64_tr_b16 v[210:211], v232 offset:37376
 buffer_load_dwordx4 v239, s[12:15], s21 offen offset:1024 lds
 v_mfma_f32_32x32x16_bf16 v[160:175], v[64:67], v[220:223], v[160:175]
 ds_read_b64_tr_b16 v[212:213], v233 offset:36864
 ds_read_b64_tr_b16 v[214:215], v233 offset:37376
 v_cvt_pk_bf16_f32 v185, v186, v187
 s_waitcnt lgkmcnt(4)
 v_mfma_f32_32x32x16_bf16 v[144:159], v[68:71], v[224:227], v[144:159]
 ds_read_b64_tr_b16 v[216:217], v232 offset:38912
 ds_read_b64_tr_b16 v[218:219], v232 offset:39424
 v_cvt_pk_bf16_f32 v186, v188, v189
 v_mfma_f32_32x32x16_bf16 v[160:175], v[68:71], v[228:231], v[160:175]
 ds_read_b64_tr_b16 v[220:221], v233 offset:38912
 ds_read_b64_tr_b16 v[222:223], v233 offset:39424
 v_cvt_pk_bf16_f32 v187, v190, v191
 s_waitcnt lgkmcnt(4)
 v_mfma_f32_32x32x16_bf16 v[144:159], v[72:75], v[208:211], v[144:159]
 ds_read_b64_tr_b16 v[224:225], v232 offset:40960
 ds_read_b64_tr_b16 v[226:227], v232 offset:41472
 s_add_u32 m0, s30, 131072
 s_add_u32 s21, s48, 384
 buffer_load_dwordx4 v238, s[12:15], s21 offen lds
 buffer_store_dwordx4 v[184:187], v254, s[16:19], s4 offen offset:1024 sc1
 v_mfma_f32_32x32x16_bf16 v[160:175], v[72:75], v[212:215], v[160:175]
 ds_read_b64_tr_b16 v[228:229], v233 offset:40960
 ds_read_b64_tr_b16 v[230:231], v233 offset:41472
 s_waitcnt lgkmcnt(4)
 v_mfma_f32_32x32x16_bf16 v[144:159], v[76:79], v[216:219], v[144:159]
 ds_read_b64_tr_b16 v[208:209], v232 offset:43008
 ds_read_b64_tr_b16 v[210:211], v232 offset:43520
 v_mul_f32 v192, v252, v192
 v_mfma_f32_32x32x16_bf16 v[160:175], v[76:79], v[220:223], v[160:175]
 ds_read_b64_tr_b16 v[212:213], v233 offset:43008
 ds_read_b64_tr_b16 v[214:215], v233 offset:43520
 v_mul_f32 v193, v252, v193
 s_waitcnt lgkmcnt(4)
 v_mfma_f32_32x32x16_bf16 v[144:159], v[80:83], v[224:227], v[144:159]
 ds_read_b64_tr_b16 v[216:217], v232 offset:45056
 ds_read_b64_tr_b16 v[218:219], v232 offset:45568
 buffer_load_dwordx4 v239, s[12:15], s21 offen offset:1024 lds
 v_mul_f32 v194, v252, v194
 v_mfma_f32_32x32x16_bf16 v[160:175], v[80:83], v[228:231], v[160:175]
 ds_read_b64_tr_b16 v[220:221], v233 offset:45056
 ds_read_b64_tr_b16 v[222:223], v233 offset:45568
 v_mul_f32 v195, v252, v195
 s_waitcnt lgkmcnt(4)
 v_mfma_f32_32x32x16_bf16 v[144:159], v[84:87], v[208:211], v[144:159]
 ds_read_b64_tr_b16 v[224:225], v232 offset:47104
 ds_read_b64_tr_b16 v[226:227], v232 offset:47616
 v_mfma_f32_32x32x16_bf16 v[160:175], v[84:87], v[212:215], v[160:175]
 ds_read_b64_tr_b16 v[228:229], v233 offset:47104
 ds_read_b64_tr_b16 v[230:231], v233 offset:47616
 s_waitcnt vmcnt(20)
 s_barrier
 s_waitcnt lgkmcnt(4)
 v_mfma_f32_32x32x16_bf16 v[144:159], v[88:91], v[216:219], v[144:159]
 ds_read_b64_tr_b16 v[208:209], v234 offset:0
 ds_read_b64_tr_b16 v[210:211], v234 offset:512
 s_add_u32 m0, s30, 139264
 s_add_u32 s21, s49, 384
 buffer_load_dwordx4 v238, s[12:15], s21 offen lds
 v_mul_f32 v196, v252, v196
 v_mfma_f32_32x32x16_bf16 v[160:175], v[88:91], v[220:223], v[160:175]
 ds_read_b64_tr_b16 v[212:213], v235 offset:0
 ds_read_b64_tr_b16 v[214:215], v235 offset:512
 v_mul_f32 v197, v252, v197
 s_waitcnt lgkmcnt(4)
 v_mfma_f32_32x32x16_bf16 v[144:159], v[92:95], v[224:227], v[144:159]
 ds_read_b64_tr_b16 v[216:217], v234 offset:2048
 ds_read_b64_tr_b16 v[218:219], v234 offset:2560
 v_mul_f32 v198, v252, v198
 v_mfma_f32_32x32x16_bf16 v[160:175], v[92:95], v[228:231], v[160:175]
 ds_read_b64_tr_b16 v[220:221], v235 offset:2048
 ds_read_b64_tr_b16 v[222:223], v235 offset:2560
 v_mul_f32 v199, v252, v199
 s_waitcnt lgkmcnt(4)
 v_mfma_f32_32x32x16_bf16 v[144:159], v[96:99], v[208:211], v[144:159]
 ds_read_b64_tr_b16 v[224:225], v234 offset:4096
 ds_read_b64_tr_b16 v[226:227], v234 offset:4608
 buffer_load_dwordx4 v239, s[12:15], s21 offen offset:1024 lds
 v_cvt_pk_bf16_f32 v192, v192, v193
 v_mfma_f32_32x32x16_bf16 v[160:175], v[96:99], v[212:215], v[160:175]
 ds_read_b64_tr_b16 v[228:229], v235 offset:4096
 ds_read_b64_tr_b16 v[230:231], v235 offset:4608
 s_waitcnt lgkmcnt(4)
 v_mfma_f32_32x32x16_bf16 v[144:159], v[100:103], v[216:219], v[144:159]
 ds_read_b64_tr_b16 v[208:209], v234 offset:6144
 ds_read_b64_tr_b16 v[210:211], v234 offset:6656
 v_cvt_pk_bf16_f32 v193, v194, v195
 v_mfma_f32_32x32x16_bf16 v[160:175], v[100:103], v[220:223], v[160:175]
 ds_read_b64_tr_b16 v[212:213], v235 offset:6144
 ds_read_b64_tr_b16 v[214:215], v235 offset:6656
 v_cvt_pk_bf16_f32 v194, v196, v197
 s_waitcnt lgkmcnt(4)
 v_mfma_f32_32x32x16_bf16 v[144:159], v[104:107], v[224:227], v[144:159]
 ds_read_b64_tr_b16 v[216:217], v234 offset:8192
 ds_read_b64_tr_b16 v[218:219], v234 offset:8704
 v_cvt_pk_bf16_f32 v195, v198, v199
 v_mfma_f32_32x32x16_bf16 v[160:175], v[104:107], v[228:231], v[160:175]
 ds_read_b64_tr_b16 v[220:221], v235 offset:8192
 ds_read_b64_tr_b16 v[222:223], v235 offset:8704
 buffer_store_dwordx4 v[192:195], v254, s[16:19], s4 offen offset:2048 sc1
 s_waitcnt lgkmcnt(4)
 v_mfma_f32_32x32x16_bf16 v[144:159], v[108:111], v[208:211], v[144:159]
 ds_read_b64_tr_b16 v[224:225], v234 offset:10240
 ds_read_b64_tr_b16 v[226:227], v234 offset:10752
 v_mfma_f32_32x32x16_bf16 v[160:175], v[108:111], v[212:215], v[160:175]
 ds_read_b64_tr_b16 v[228:229], v235 offset:10240
 ds_read_b64_tr_b16 v[230:231], v235 offset:10752
 v_mul_f32 v200, v252, v200
 s_waitcnt lgkmcnt(4)
 v_mfma_f32_32x32x16_bf16 v[144:159], v[112:115], v[216:219], v[144:159]
 ds_read_b64_tr_b16 v[208:209], v234 offset:12288
 ds_read_b64_tr_b16 v[210:211], v234 offset:12800
 v_mul_f32 v201, v252, v201
 v_mfma_f32_32x32x16_bf16 v[160:175], v[112:115], v[220:223], v[160:175]
 ds_read_b64_tr_b16 v[212:213], v235 offset:12288
 ds_read_b64_tr_b16 v[214:215], v235 offset:12800
 v_mul_f32 v202, v252, v202
 s_waitcnt lgkmcnt(4)
 v_mfma_f32_32x32x16_bf16 v[144:159], v[116:119], v[224:227], v[144:159]
 ds_read_b64_tr_b16 v[216:217], v234 offset:14336
 ds_read_b64_tr_b16 v[218:219], v234 offset:14848
 v_mul_f32 v203, v252, v203
 v_mfma_f32_32x32x16_bf16 v[160:175], v[116:119], v[228:231], v[160:175]
 ds_read_b64_tr_b16 v[220:221], v235 offset:14336
 ds_read_b64_tr_b16 v[222:223], v235 offset:14848
 v_mul_f32 v204, v252, v204
 s_waitcnt lgkmcnt(4)
 v_mfma_f32_32x32x16_bf16 v[144:159], v[120:123], v[208:211], v[144:159]
 ds_read_b64_tr_b16 v[224:225], v234 offset:16384
 ds_read_b64_tr_b16 v[226:227], v234 offset:16896
 v_mfma_f32_32x32x16_bf16 v[160:175], v[120:123], v[212:215], v[160:175]
 ds_read_b64_tr_b16 v[228:229], v235 offset:16384
 ds_read_b64_tr_b16 v[230:231], v235 offset:16896
 v_mul_f32 v205, v252, v205
 s_waitcnt lgkmcnt(4)
 v_mfma_f32_32x32x16_bf16 v[144:159], v[124:127], v[216:219], v[144:159]
 ds_read_b64_tr_b16 v[208:209], v234 offset:18432
 ds_read_b64_tr_b16 v[210:211], v234 offset:18944
 v_mul_f32 v206, v252, v206
 v_mfma_f32_32x32x16_bf16 v[160:175], v[124:127], v[220:223], v[160:175]
 ds_read_b64_tr_b16 v[212:213], v235 offset:18432
 ds_read_b64_tr_b16 v[214:215], v235 offset:18944
 v_mul_f32 v207, v252, v207
 s_waitcnt lgkmcnt(4)
 v_mfma_f32_32x32x16_bf16 v[144:159], v[128:131], v[224:227], v[144:159]
 ds_read_b64_tr_b16 v[216:217], v234 offset:20480
 ds_read_b64_tr_b16 v[218:219], v234 offset:20992
 v_cvt_pk_bf16_f32 v200, v200, v201
 v_mfma_f32_32x32x16_bf16 v[160:175], v[128:131], v[228:231], v[160:175]
 ds_read_b64_tr_b16 v[220:221], v235 offset:20480
 ds_read_b64_tr_b16 v[222:223], v235 offset:20992
 s_waitcnt lgkmcnt(4)
 v_mfma_f32_32x32x16_bf16 v[144:159], v[132:135], v[208:211], v[144:159]
 ds_read_b64_tr_b16 v[224:225], v234 offset:22528
 ds_read_b64_tr_b16 v[226:227], v234 offset:23040
 v_cvt_pk_bf16_f32 v201, v202, v203
 v_mfma_f32_32x32x16_bf16 v[160:175], v[132:135], v[212:215], v[160:175]
 ds_read_b64_tr_b16 v[228:229], v235 offset:22528
 ds_read_b64_tr_b16 v[230:231], v235 offset:23040
 s_waitcnt vmcnt(15)
 s_barrier
 s_waitcnt lgkmcnt(4)
 v_mfma_f32_32x32x16_bf16 v[144:159], v[136:139], v[216:219], v[144:159]
 ds_read_b64_tr_b16 v[208:209], v234 offset:24576
 ds_read_b64_tr_b16 v[210:211], v234 offset:25088
 v_cvt_pk_bf16_f32 v202, v204, v205
 v_mfma_f32_32x32x16_bf16 v[160:175], v[136:139], v[220:223], v[160:175]
 ds_read_b64_tr_b16 v[212:213], v235 offset:24576
 ds_read_b64_tr_b16 v[214:215], v235 offset:25088
 v_cvt_pk_bf16_f32 v203, v206, v207
 s_waitcnt lgkmcnt(4)
 v_mfma_f32_32x32x16_bf16 v[144:159], v[140:143], v[224:227], v[144:159]
 ds_read_b64_tr_b16 v[216:217], v234 offset:26624
 ds_read_b64_tr_b16 v[218:219], v234 offset:27136
 buffer_store_dwordx4 v[200:203], v254, s[16:19], s4 offen offset:3072 sc1
 v_mfma_f32_32x32x16_bf16 v[160:175], v[140:143], v[228:231], v[160:175]
 ds_read_b64_tr_b16 v[220:221], v235 offset:26624
 ds_read_b64_tr_b16 v[222:223], v235 offset:27136
 s_waitcnt lgkmcnt(4)
 v_mfma_f32_32x32x16_bf16 v[176:191], v[0:3], v[208:211], 0
 ds_read_b64_tr_b16 v[224:225], v234 offset:28672
 ds_read_b64_tr_b16 v[226:227], v234 offset:29184
 v_mfma_f32_32x32x16_bf16 v[192:207], v[0:3], v[212:215], 0
 ds_read_b64_tr_b16 v[228:229], v235 offset:28672
 ds_read_b64_tr_b16 v[230:231], v235 offset:29184
 s_waitcnt lgkmcnt(4)
 v_mfma_f32_32x32x16_bf16 v[176:191], v[4:7], v[216:219], v[176:191]
 ds_read_b64_tr_b16 v[208:209], v234 offset:30720
 ds_read_b64_tr_b16 v[210:211], v234 offset:31232
 v_mfma_f32_32x32x16_bf16 v[192:207], v[4:7], v[220:223], v[192:207]
 ds_read_b64_tr_b16 v[212:213], v235 offset:30720
 ds_read_b64_tr_b16 v[214:215], v235 offset:31232
 s_waitcnt lgkmcnt(4)
 v_mfma_f32_32x32x16_bf16 v[176:191], v[8:11], v[224:227], v[176:191]
 ds_read_b64_tr_b16 v[216:217], v234 offset:32768
 ds_read_b64_tr_b16 v[218:219], v234 offset:33280
 s_add_u32 s7, s6, 0
 ds_read_b128 v[248:251], v247 offset:0
 v_mfma_f32_32x32x16_bf16 v[192:207], v[8:11], v[228:231], v[192:207]
 ds_read_b64_tr_b16 v[220:221], v235 offset:32768
 ds_read_b64_tr_b16 v[222:223], v235 offset:33280
 s_nop 0
 s_waitcnt lgkmcnt(5)
 v_mfma_f32_32x32x16_bf16 v[176:191], v[12:15], v[208:211], v[176:191]
 ds_read_b64_tr_b16 v[224:225], v234 offset:34816
 ds_read_b64_tr_b16 v[226:227], v234 offset:35328
 s_nop 0
 v_mfma_f32_32x32x16_bf16 v[192:207], v[12:15], v[212:215], v[192:207]
 ds_read_b64_tr_b16 v[228:229], v235 offset:34816
 ds_read_b64_tr_b16 v[230:231], v235 offset:35328
 s_waitcnt lgkmcnt(6)
 s_waitcnt lgkmcnt(4)
 v_mfma_f32_32x32x16_bf16 v[176:191], v[16:19], v[216:219], v[176:191]
 ds_read_b64_tr_b16 v[208:209], v234 offset:36864
 ds_read_b64_tr_b16 v[210:211], v234 offset:37376
 v_mul_f32 v144, v248, v144
 v_mfma_f32_32x32x16_bf16 v[192:207], v[16:19], v[220:223], v[192:207]
 ds_read_b64_tr_b16 v[212:213], v235 offset:36864
 ds_read_b64_tr_b16 v[214:215], v235 offset:37376
 v_mul_f32 v145, v249, v145
 s_waitcnt lgkmcnt(4)
 v_mfma_f32_32x32x16_bf16 v[176:191], v[20:23], v[224:227], v[176:191]
 ds_read_b64_tr_b16 v[216:217], v234 offset:38912
 ds_read_b64_tr_b16 v[218:219], v234 offset:39424
 v_mul_f32 v146, v250, v146
 v_mfma_f32_32x32x16_bf16 v[192:207], v[20:23], v[228:231], v[192:207]
 ds_read_b64_tr_b16 v[220:221], v235 offset:38912
 ds_read_b64_tr_b16 v[222:223], v235 offset:39424
 v_mul_f32 v147, v251, v147
 s_waitcnt lgkmcnt(4)
 v_mfma_f32_32x32x16_bf16 v[176:191], v[24:27], v[208:211], v[176:191]
 ds_read_b64_tr_b16 v[224:225], v234 offset:40960
 ds_read_b64_tr_b16 v[226:227], v234 offset:41472
 v_mul_f32 v160, v248, v160
 v_mfma_f32_32x32x16_bf16 v[192:207], v[24:27], v[212:215], v[192:207]
 ds_read_b64_tr_b16 v[228:229], v235 offset:40960
 ds_read_b64_tr_b16 v[230:231], v235 offset:41472
 v_mul_f32 v161, v249, v161
 s_waitcnt lgkmcnt(4)
 v_mfma_f32_32x32x16_bf16 v[176:191], v[28:31], v[216:219], v[176:191]
 ds_read_b64_tr_b16 v[208:209], v234 offset:43008
 ds_read_b64_tr_b16 v[210:211], v234 offset:43520
 v_mul_f32 v162, v250, v162
 v_mfma_f32_32x32x16_bf16 v[192:207], v[28:31], v[220:223], v[192:207]
 ds_read_b64_tr_b16 v[212:213], v235 offset:43008
 ds_read_b64_tr_b16 v[214:215], v235 offset:43520
 v_mul_f32 v163, v251, v163
 s_waitcnt lgkmcnt(4)
 v_mfma_f32_32x32x16_bf16 v[176:191], v[32:35], v[224:227], v[176:191]
 ds_read_b64_tr_b16 v[216:217], v234 offset:45056
 ds_read_b64_tr_b16 v[218:219], v234 offset:45568
 ds_read_b128 v[248:251], v247 offset:32
 v_mfma_f32_32x32x16_bf16 v[192:207], v[32:35], v[228:231], v[192:207]
 ds_read_b64_tr_b16 v[220:221], v235 offset:45056
 ds_read_b64_tr_b16 v[222:223], v235 offset:45568
 s_nop 0
 s_waitcnt lgkmcnt(5)
 v_mfma_f32_32x32x16_bf16 v[176:191], v[36:39], v[208:211], v[176:191]
 ds_read_b64_tr_b16 v[224:225], v234 offset:47104
 ds_read_b64_tr_b16 v[226:227], v234 offset:47616
 s_nop 0
 v_mfma_f32_32x32x16_bf16 v[192:207], v[36:39], v[212:215], v[192:207]
 ds_read_b64_tr_b16 v[228:229], v235 offset:47104
 ds_read_b64_tr_b16 v[230:231], v235 offset:47616
 s_waitcnt vmcnt(9)
 s_barrier
 s_waitcnt lgkmcnt(4)
 v_mfma_f32_32x32x16_bf16 v[176:191], v[40:43], v[216:219], v[176:191]
 ds_read_b64_tr_b16 v[208:209], v236 offset:0
 ds_read_b64_tr_b16 v[210:211], v236 offset:512
 s_waitcnt lgkmcnt(8)
 v_mfma_f32_32x32x16_bf16 v[192:207], v[40:43], v[220:223], v[192:207]
 ds_read_b64_tr_b16 v[212:213], v237 offset:0
 ds_read_b64_tr_b16 v[214:215], v237 offset:512
 v_mul_f32 v148, v248, v148
 v_mul_f32 v149, v249, v149
 s_waitcnt lgkmcnt(4)
 v_mfma_f32_32x32x16_bf16 v[176:191], v[44:47], v[224:227], v[176:191]
 ds_read_b64_tr_b16 v[216:217], v236 offset:2048
 ds_read_b64_tr_b16 v[218:219], v236 offset:2560
 v_mul_f32 v150, v250, v150
 v_mfma_f32_32x32x16_bf16 v[192:207], v[44:47], v[228:231], v[192:207]
 ds_read_b64_tr_b16 v[220:221], v237 offset:2048
 ds_read_b64_tr_b16 v[222:223], v237 offset:2560
 v_mul_f32 v151, v251, v151
 s_waitcnt lgkmcnt(4)
 v_mfma_f32_32x32x16_bf16 v[176:191], v[48:51], v[208:211], v[176:191]
 ds_read_b64_tr_b16 v[224:225], v236 offset:4096
 ds_read_b64_tr_b16 v[226:227], v236 offset:4608
 v_mul_f32 v164, v248, v164
 v_mfma_f32_32x32x16_bf16 v[192:207], v[48:51], v[212:215], v[192:207]
 ds_read_b64_tr_b16 v[228:229], v237 offset:4096
 ds_read_b64_tr_b16 v[230:231], v237 offset:4608
 v_mul_f32 v165, v249, v165
 s_waitcnt lgkmcnt(4)
 v_mfma_f32_32x32x16_bf16 v[176:191], v[52:55], v[216:219], v[176:191]
 ds_read_b64_tr_b16 v[208:209], v236 offset:6144
 ds_read_b64_tr_b16 v[210:211], v236 offset:6656
 v_mul_f32 v166, v250, v166
 v_mfma_f32_32x32x16_bf16 v[192:207], v[52:55], v[220:223], v[192:207]
 ds_read_b64_tr_b16 v[212:213], v237 offset:6144
 ds_read_b64_tr_b16 v[214:215], v237 offset:6656
 v_mul_f32 v167, v251, v167
 s_waitcnt lgkmcnt(4)
 v_mfma_f32_32x32x16_bf16 v[176:191], v[56:59], v[224:227], v[176:191]
 ds_read_b64_tr_b16 v[216:217], v236 offset:8192
 ds_read_b64_tr_b16 v[218:219], v236 offset:8704
 v_cvt_pk_bf16_f32 v144, v144, v145
 v_mfma_f32_32x32x16_bf16 v[192:207], v[56:59], v[228:231], v[192:207]
 ds_read_b64_tr_b16 v[220:221], v237 offset:8192
 ds_read_b64_tr_b16 v[222:223], v237 offset:8704
 v_cvt_pk_bf16_f32 v145, v146, v147
 s_waitcnt lgkmcnt(4)
 v_mfma_f32_32x32x16_bf16 v[176:191], v[60:63], v[208:211], v[176:191]
 ds_read_b64_tr_b16 v[224:225], v236 offset:10240
 ds_read_b64_tr_b16 v[226:227], v236 offset:10752
 v_cvt_pk_bf16_f32 v146, v148, v149
 v_mfma_f32_32x32x16_bf16 v[192:207], v[60:63], v[212:215], v[192:207]
 ds_read_b64_tr_b16 v[228:229], v237 offset:10240
 ds_read_b64_tr_b16 v[230:231], v237 offset:10752
 v_cvt_pk_bf16_f32 v147, v150, v151
 s_waitcnt lgkmcnt(4)
 v_mfma_f32_32x32x16_bf16 v[176:191], v[64:67], v[216:219], v[176:191]
 ds_read_b64_tr_b16 v[208:209], v236 offset:12288
 ds_read_b64_tr_b16 v[210:211], v236 offset:12800
 buffer_store_dwordx4 v[144:147], v245, s[16:19], s7 offen offset:0 sc1
 v_mfma_f32_32x32x16_bf16 v[192:207], v[64:67], v[220:223], v[192:207]
 ds_read_b64_tr_b16 v[212:213], v237 offset:12288
 ds_read_b64_tr_b16 v[214:215], v237 offset:12800
 v_cvt_pk_bf16_f32 v160, v160, v161
 s_waitcnt lgkmcnt(4)
 v_mfma_f32_32x32x16_bf16 v[176:191], v[68:71], v[224:227], v[176:191]
 ds_read_b64_tr_b16 v[216:217], v236 offset:14336
 ds_read_b64_tr_b16 v[218:219], v236 offset:14848
 v_cvt_pk_bf16_f32 v161, v162, v163
 v_mfma_f32_32x32x16_bf16 v[192:207], v[68:71], v[228:231], v[192:207]
 ds_read_b64_tr_b16 v[220:221], v237 offset:14336
 ds_read_b64_tr_b16 v[222:223], v237 offset:14848
 v_cvt_pk_bf16_f32 v162, v164, v165
 s_waitcnt lgkmcnt(4)
 v_mfma_f32_32x32x16_bf16 v[176:191], v[72:75], v[208:211], v[176:191]
 ds_read_b64_tr_b16 v[224:225], v236 offset:16384
 ds_read_b64_tr_b16 v[226:227], v236 offset:16896
 v_cvt_pk_bf16_f32 v163, v166, v167
 v_mfma_f32_32x32x16_bf16 v[192:207], v[72:75], v[212:215], v[192:207]
 ds_read_b64_tr_b16 v[228:229], v237 offset:16384
 ds_read_b64_tr_b16 v[230:231], v237 offset:16896
 buffer_store_dwordx4 v[160:163], v245, s[16:19], s7 offen offset:512 sc1
 ds_read_b128 v[248:251], v247 offset:64
 s_waitcnt lgkmcnt(5)
 v_mfma_f32_32x32x16_bf16 v[176:191], v[76:79], v[216:219], v[176:191]
 ds_read_b64_tr_b16 v[208:209], v236 offset:18432
 ds_read_b64_tr_b16 v[210:211], v236 offset:18944
 s_nop 0
 v_mfma_f32_32x32x16_bf16 v[192:207], v[76:79], v[220:223], v[192:207]
 ds_read_b64_tr_b16 v[212:213], v237 offset:18432
 ds_read_b64_tr_b16 v[214:215], v237 offset:18944
 s_nop 0
 s_waitcnt lgkmcnt(5)
 v_mfma_f32_32x32x16_bf16 v[176:191], v[80:83], v[224:227], v[176:191]
 ds_read_b64_tr_b16 v[216:217], v236 offset:20480
 ds_read_b64_tr_b16 v[218:219], v236 offset:20992
 s_waitcnt lgkmcnt(6)
 v_mfma_f32_32x32x16_bf16 v[192:207], v[80:83], v[228:231], v[192:207]
 ds_read_b64_tr_b16 v[220:221], v237 offset:20480
 ds_read_b64_tr_b16 v[222:223], v237 offset:20992
 v_mul_f32 v152, v248, v152
 s_waitcnt lgkmcnt(4)
 v_mfma_f32_32x32x16_bf16 v[176:191], v[84:87], v[208:211], v[176:191]
 ds_read_b64_tr_b16 v[224:225], v236 offset:22528
 ds_read_b64_tr_b16 v[226:227], v236 offset:23040
 v_mul_f32 v153, v249, v153
 v_mfma_f32_32x32x16_bf16 v[192:207], v[84:87], v[212:215], v[192:207]
 ds_read_b64_tr_b16 v[228:229], v237 offset:22528
 ds_read_b64_tr_b16 v[230:231], v237 offset:23040
 s_waitcnt vmcnt(4)
 s_barrier
 s_waitcnt lgkmcnt(4)
 v_mfma_f32_32x32x16_bf16 v[176:191], v[88:91], v[216:219], v[176:191]
 ds_read_b64_tr_b16 v[208:209], v236 offset:24576
 ds_read_b64_tr_b16 v[210:211], v236 offset:25088
 v_mul_f32 v154, v250, v154
 v_mfma_f32_32x32x16_bf16 v[192:207], v[88:91], v[220:223], v[192:207]
 ds_read_b64_tr_b16 v[212:213], v237 offset:24576
 ds_read_b64_tr_b16 v[214:215], v237 offset:25088
 v_mul_f32 v155, v251, v155
 s_waitcnt lgkmcnt(4)
 v_mfma_f32_32x32x16_bf16 v[176:191], v[92:95], v[224:227], v[176:191]
 ds_read_b64_tr_b16 v[216:217], v236 offset:26624
 ds_read_b64_tr_b16 v[218:219], v236 offset:27136
 v_mul_f32 v168, v248, v168
 v_mfma_f32_32x32x16_bf16 v[192:207], v[92:95], v[228:231], v[192:207]
 ds_read_b64_tr_b16 v[220:221], v237 offset:26624
 ds_read_b64_tr_b16 v[222:223], v237 offset:27136
 v_mul_f32 v169, v249, v169
 s_waitcnt lgkmcnt(4)
 v_mfma_f32_32x32x16_bf16 v[176:191], v[96:99], v[208:211], v[176:191]
 ds_read_b64_tr_b16 v[224:225], v236 offset:28672
 ds_read_b64_tr_b16 v[226:227], v236 offset:29184
 v_mul_f32 v170, v250, v170
 v_mfma_f32_32x32x16_bf16 v[192:207], v[96:99], v[212:215], v[192:207]
 ds_read_b64_tr_b16 v[228:229], v237 offset:28672
 ds_read_b64_tr_b16 v[230:231], v237 offset:29184
 v_mul_f32 v171, v251, v171
 s_waitcnt lgkmcnt(4)
 v_mfma_f32_32x32x16_bf16 v[176:191], v[100:103], v[216:219], v[176:191]
 ds_read_b64_tr_b16 v[208:209], v236 offset:30720
 ds_read_b64_tr_b16 v[210:211], v236 offset:31232
 ds_read_b128 v[248:251], v247 offset:96
 v_mfma_f32_32x32x16_bf16 v[192:207], v[100:103], v[220:223], v[192:207]
 ds_read_b64_tr_b16 v[212:213], v237 offset:30720
 ds_read_b64_tr_b16 v[214:215], v237 offset:31232
 s_nop 0
 s_waitcnt lgkmcnt(5)
 v_mfma_f32_32x32x16_bf16 v[176:191], v[104:107], v[224:227], v[176:191]
 ds_read_b64_tr_b16 v[216:217], v236 offset:32768
 ds_read_b64_tr_b16 v[218:219], v236 offset:33280
 s_nop 0
 v_mfma_f32_32x32x16_bf16 v[192:207], v[104:107], v[228:231], v[192:207]
 ds_read_b64_tr_b16 v[220:221], v237 offset:32768
 ds_read_b64_tr_b16 v[222:223], v237 offset:33280
 s_waitcnt lgkmcnt(6)
 s_waitcnt lgkmcnt(4)
 v_mfma_f32_32x32x16_bf16 v[176:191], v[108:111], v[208:211], v[176:191]
 ds_read_b64_tr_b16 v[224:225], v236 offset:34816
 ds_read_b64_tr_b16 v[226:227], v236 offset:35328
 v_mul_f32 v156, v248, v156
 v_mul_f32 v157, v249, v157
 v_mfma_f32_32x32x16_bf16 v[192:207], v[108:111], v[212:215], v[192:207]
 ds_read_b64_tr_b16 v[228:229], v237 offset:34816
 ds_read_b64_tr_b16 v[230:231], v237 offset:35328
 v_mul_f32 v158, v250, v158
 s_waitcnt lgkmcnt(4)
 v_mfma_f32_32x32x16_bf16 v[176:191], v[112:115], v[216:219], v[176:191]
 ds_read_b64_tr_b16 v[208:209], v236 offset:36864
 ds_read_b64_tr_b16 v[210:211], v236 offset:37376
 v_mul_f32 v159, v251, v159
 v_mfma_f32_32x32x16_bf16 v[192:207], v[112:115], v[220:223], v[192:207]
 ds_read_b64_tr_b16 v[212:213], v237 offset:36864
 ds_read_b64_tr_b16 v[214:215], v237 offset:37376
 v_mul_f32 v172, v248, v172
 s_waitcnt lgkmcnt(4)
 v_mfma_f32_32x32x16_bf16 v[176:191], v[116:119], v[224:227], v[176:191]
 ds_read_b64_tr_b16 v[216:217], v236 offset:38912
 ds_read_b64_tr_b16 v[218:219], v236 offset:39424
 v_mul_f32 v173, v249, v173
 v_mfma_f32_32x32x16_bf16 v[192:207], v[116:119], v[228:231], v[192:207]
 ds_read_b64_tr_b16 v[220:221], v237 offset:38912
 ds_read_b64_tr_b16 v[222:223], v237 offset:39424
 v_mul_f32 v174, v250, v174
 s_waitcnt lgkmcnt(4)
 v_mfma_f32_32x32x16_bf16 v[176:191], v[120:123], v[208:211], v[176:191]
 ds_read_b64_tr_b16 v[224:225], v236 offset:40960
 ds_read_b64_tr_b16 v[226:227], v236 offset:41472
 v_mul_f32 v175, v251, v175
 v_mfma_f32_32x32x16_bf16 v[192:207], v[120:123], v[212:215], v[192:207]
 ds_read_b64_tr_b16 v[228:229], v237 offset:40960
 ds_read_b64_tr_b16 v[230:231], v237 offset:41472
 v_cvt_pk_bf16_f32 v152, v152, v153
 s_waitcnt lgkmcnt(4)
 v_mfma_f32_32x32x16_bf16 v[176:191], v[124:127], v[216:219], v[176:191]
 ds_read_b64_tr_b16 v[208:209], v236 offset:43008
 ds_read_b64_tr_b16 v[210:211], v236 offset:43520
 v_cvt_pk_bf16_f32 v153, v154, v155
 v_mfma_f32_32x32x16_bf16 v[192:207], v[124:127], v[220:223], v[192:207]
 ds_read_b64_tr_b16 v[212:213], v237 offset:43008
 ds_read_b64_tr_b16 v[214:215], v237 offset:43520
 v_cvt_pk_bf16_f32 v154, v156, v157
 s_waitcnt lgkmcnt(4)
 v_mfma_f32_32x32x16_bf16 v[176:191], v[128:131], v[224:227], v[176:191]
 ds_read_b64_tr_b16 v[216:217], v236 offset:45056
 ds_read_b64_tr_b16 v[218:219], v236 offset:45568
 v_cvt_pk_bf16_f32 v155, v158, v159
 v_mfma_f32_32x32x16_bf16 v[192:207], v[128:131], v[228:231], v[192:207]
 ds_read_b64_tr_b16 v[220:221], v237 offset:45056
 ds_read_b64_tr_b16 v[222:223], v237 offset:45568
 buffer_store_dwordx4 v[152:155], v246, s[16:19], s7 offen offset:0 sc1
 s_waitcnt lgkmcnt(4)
 v_mfma_f32_32x32x16_bf16 v[176:191], v[132:135], v[208:211], v[176:191]
 ds_read_b64_tr_b16 v[224:225], v236 offset:47104
 ds_read_b64_tr_b16 v[226:227], v236 offset:47616
 v_cvt_pk_bf16_f32 v168, v168, v169
 v_mfma_f32_32x32x16_bf16 v[192:207], v[132:135], v[212:215], v[192:207]
 ds_read_b64_tr_b16 v[228:229], v237 offset:47104
 ds_read_b64_tr_b16 v[230:231], v237 offset:47616
 s_waitcnt lgkmcnt(4)
 v_mfma_f32_32x32x16_bf16 v[176:191], v[136:139], v[216:219], v[176:191]
 v_cvt_pk_bf16_f32 v169, v170, v171
 v_mfma_f32_32x32x16_bf16 v[192:207], v[136:139], v[220:223], v[192:207]
 v_cvt_pk_bf16_f32 v170, v172, v173
 s_waitcnt lgkmcnt(0)
 v_mfma_f32_32x32x16_bf16 v[176:191], v[140:143], v[224:227], v[176:191]
 v_cvt_pk_bf16_f32 v171, v174, v175
 v_mfma_f32_32x32x16_bf16 v[192:207], v[140:143], v[228:231], v[192:207]
 buffer_store_dwordx4 v[168:171], v246, s[16:19], s7 offen offset:512 sc1
 s_nop 11
 s_add_u32 s7, s6, 1024
 ds_read_b128 v[248:251], v247 offset:0
 s_nop 0
 s_nop 0
 s_waitcnt lgkmcnt(0)
 v_mul_f32 v176, v248, v176
 v_mul_f32 v177, v249, v177
 v_mul_f32 v178, v250, v178
 v_mul_f32 v179, v251, v179
 v_mul_f32 v192, v248, v192
 v_mul_f32 v193, v249, v193
 v_mul_f32 v194, v250, v194
 v_mul_f32 v195, v251, v195
 ds_read_b128 v[248:251], v247 offset:32
 s_nop 0
 s_nop 0
 s_waitcnt lgkmcnt(0)
 v_mul_f32 v180, v248, v180
 v_mul_f32 v181, v249, v181
 v_mul_f32 v182, v250, v182
 v_mul_f32 v183, v251, v183
 v_mul_f32 v196, v248, v196
 v_mul_f32 v197, v249, v197
 v_mul_f32 v198, v250, v198
 v_mul_f32 v199, v251, v199
 v_cvt_pk_bf16_f32 v176, v176, v177
 v_cvt_pk_bf16_f32 v177, v178, v179
 v_cvt_pk_bf16_f32 v178, v180, v181
 v_cvt_pk_bf16_f32 v179, v182, v183
 buffer_store_dwordx4 v[176:179], v245, s[16:19], s7 offen offset:0 sc1
 v_cvt_pk_bf16_f32 v192, v192, v193
 v_cvt_pk_bf16_f32 v193, v194, v195
 v_cvt_pk_bf16_f32 v194, v196, v197
 v_cvt_pk_bf16_f32 v195, v198, v199
 buffer_store_dwordx4 v[192:195], v245, s[16:19], s7 offen offset:512 sc1
 ds_read_b128 v[248:251], v247 offset:64
 s_nop 0
 s_nop 0
 s_waitcnt lgkmcnt(0)
 v_mul_f32 v184, v248, v184
 v_mul_f32 v185, v249, v185
 v_mul_f32 v186, v250, v186
 v_mul_f32 v187, v251, v187
 v_mul_f32 v200, v248, v200
 v_mul_f32 v201, v249, v201
 v_mul_f32 v202, v250, v202
 v_mul_f32 v203, v251, v203
 ds_read_b128 v[248:251], v247 offset:96
 s_nop 0
 s_nop 0
 s_waitcnt lgkmcnt(0)
 v_mul_f32 v188, v248, v188
 v_mul_f32 v189, v249, v189
 v_mul_f32 v190, v250, v190
 v_mul_f32 v191, v251, v191
 v_mul_f32 v204, v248, v204
 v_mul_f32 v205, v249, v205
 v_mul_f32 v206, v250, v206
 v_mul_f32 v207, v251, v207
 v_cvt_pk_bf16_f32 v184, v184, v185
 v_cvt_pk_bf16_f32 v185, v186, v187
 v_cvt_pk_bf16_f32 v186, v188, v189
 v_cvt_pk_bf16_f32 v187, v190, v191
 buffer_store_dwordx4 v[184:187], v246, s[16:19], s7 offen offset:0 sc1
 v_cvt_pk_bf16_f32 v200, v200, v201
 v_cvt_pk_bf16_f32 v201, v202, v203
 v_cvt_pk_bf16_f32 v202, v204, v205
 v_cvt_pk_bf16_f32 v203, v206, v207
 buffer_store_dwordx4 v[200:203], v246, s[16:19], s7 offen offset:512 sc1
 s_branch L1_qdone
L1_v4:
 s_waitcnt lgkmcnt(4)
 v_mfma_f32_32x32x16_bf16 v[144:159], v[0:3], v[208:211], 0
 ds_read_b64_tr_b16 v[224:225], v232 offset:4096
 ds_read_b64_tr_b16 v[226:227], v232 offset:4608
 v_mfma_f32_32x32x16_bf16 v[160:175], v[0:3], v[212:215], 0
 ds_read_b64_tr_b16 v[228:229], v233 offset:4096
 ds_read_b64_tr_b16 v[230:231], v233 offset:4608
 s_waitcnt lgkmcnt(4)
 v_mfma_f32_32x32x16_bf16 v[144:159], v[4:7], v[216:219], v[144:159]
 ds_read_b64_tr_b16 v[208:209], v232 offset:6144
 ds_read_b64_tr_b16 v[210:211], v232 offset:6656
 v_mfma_f32_32x32x16_bf16 v[160:175], v[4:7], v[220:223], v[160:175]
 ds_read_b64_tr_b16 v[212:213], v233 offset:6144
 ds_read_b64_tr_b16 v[214:215], v233 offset:6656
 s_waitcnt lgkmcnt(4)
 v_mfma_f32_32x32x16_bf16 v[144:159], v[8:11], v[224:227], v[144:159]
 ds_read_b64_tr_b16 v[216:217], v232 offset:8192
 ds_read_b64_tr_b16 v[218:219], v232 offset:8704
 s_add_u32 m0, s30, 98304
 s_add_u32 s21, s44, 128
 buffer_load_dwordx4 v238, s[12:15], s21 offen lds
 v_mfma_f32_32x32x16_bf16 v[160:175], v[8:11], v[228:231], v[160:175]
 ds_read_b64_tr_b16 v[220:221], v233 offset:8192
 ds_read_b64_tr_b16 v[222:223], v233 offset:8704
 s_waitcnt lgkmcnt(4)
 v_mfma_f32_32x32x16_bf16 v[144:159], v[12:15], v[208:211], v[144:159]
 ds_read_b64_tr_b16 v[224:225], v232 offset:10240
 ds_read_b64_tr_b16 v[226:227], v232 offset:10752
 v_mfma_f32_32x32x16_bf16 v[160:175], v[12:15], v[212:215], v[160:175]
 ds_read_b64_tr_b16 v[228:229], v233 offset:10240
 ds_read_b64_tr_b16 v[230:231], v233 offset:10752
 s_waitcnt lgkmcnt(4)
 v_mfma_f32_32x32x16_bf16 v[144:159], v[16:19], v[216:219], v[144:159]
 ds_read_b64_tr_b16 v[208:209], v232 offset:12288
 ds_read_b64_tr_b16 v[210:211], v232 offset:12800
 buffer_load_dwordx4 v239, s[12:15], s21 offen offset:1024 lds
 v_mfma_f32_32x32x16_bf16 v[160:175], v[16:19], v[220:223], v[160:175]
 ds_read_b64_tr_b16 v[212:213], v233 offset:12288
 ds_read_b64_tr_b16 v[214:215], v233 offset:12800
 s_waitcnt lgkmcnt(4)
 v_mfma_f32_32x32x16_bf16 v[144:159], v[20:23], v[224:227], v[144:159]
 ds_read_b64_tr_b16 v[216:217], v232 offset:14336
 ds_read_b64_tr_b16 v[218:219], v232 offset:14848
 v_mfma_f32_32x32x16_bf16 v[160:175], v[20:23], v[228:231], v[160:175]
 ds_read_b64_tr_b16 v[220:221], v233 offset:14336
 ds_read_b64_tr_b16 v[222:223], v233 offset:14848
 s_waitcnt lgkmcnt(4)
 v_mfma_f32_32x32x16_bf16 v[144:159], v[24:27], v[208:211], v[144:159]
 ds_read_b64_tr_b16 v[224:225], v232 offset:16384
 ds_read_b64_tr_b16 v[226:227], v232 offset:16896
 s_add_u32 m0, s30, 106496
 s_add_u32 s21, s45, 128
 buffer_load_dwordx4 v238, s[12:15], s21 offen lds
 v_mfma_f32_32x32x16_bf16 v[160:175], v[24:27], v[212:215], v[160:175]
 ds_read_b64_tr_b16 v[228:229], v233 offset:16384
 ds_read_b64_tr_b16 v[230:231], v233 offset:16896
 s_waitcnt lgkmcnt(4)
 v_mfma_f32_32x32x16_bf16 v[144:159], v[28:31], v[216:219], v[144:159]
 ds_read_b64_tr_b16 v[208:209], v232 offset:18432
 ds_read_b64_tr_b16 v[210:211], v232 offset:18944
 v_mfma_f32_32x32x16_bf16 v[160:175], v[28:31], v[220:223], v[160:175]
 ds_read_b64_tr_b16 v[212:213], v233 offset:18432
 ds_read_b64_tr_b16 v[214:215], v233 offset:18944
 s_waitcnt lgkmcnt(4)
 v_mfma_f32_32x32x16_bf16 v[144:159], v[32:35], v[224:227], v[144:159]
 ds_read_b64_tr_b16 v[216:217], v232 offset:20480
 ds_read_b64_tr_b16 v[218:219], v232 offset:20992
 buffer_load_dwordx4 v239, s[12:15], s21 offen offset:1024 lds
 v_mfma_f32_32x32x16_bf16 v[160:175], v[32:35], v[228:231], v[160:175]
 ds_read_b64_tr_b16 v[220:221], v233 offset:20480
 ds_read_b64_tr_b16 v[222:223], v233 offset:20992
 s_waitcnt lgkmcnt(4)
 v_mfma_f32_32x32x16_bf16 v[144:159], v[36:39], v[208:211], v[144:159]
 ds_read_b64_tr_b16 v[224:225], v232 offset:22528
 ds_read_b64_tr_b16 v[226:227], v232 offset:23040
 v_mfma_f32_32x32x16_bf16 v[160:175], v[36:39], v[212:215], v[160:175]
 ds_read_b64_tr_b16 v[228:229], v233 offset:22528
 ds_read_b64_tr_b16 v[230:231], v233 offset:23040
 s_waitcnt vmcnt(20)
 s_barrier
 s_waitcnt lgkmcnt(4)
 v_mfma_f32_32x32x16_bf16 v[144:159], v[40:43], v[216:219], v[144:159]
 ds_read_b64_tr_b16 v[208:209], v232 offset:24576
 ds_read_b64_tr_b16 v[210:211], v232 offset:25088
 s_add_u32 m0, s30, 114688
 s_add_u32 s21, s46, 128
 buffer_load_dwordx4 v238, s[12:15], s21 offen lds
 v_mfma_f32_32x32x16_bf16 v[160:175], v[40:43], v[220:223], v[160:175]
 ds_read_b64_tr_b16 v[212:213], v233 offset:24576
 ds_read_b64_tr_b16 v[214:215], v233 offset:25088
 s_waitcnt lgkmcnt(4)
 v_mfma_f32_32x32x16_bf16 v[144:159], v[44:47], v[224:227], v[144:159]
 ds_read_b64_tr_b16 v[216:217], v232 offset:26624
 ds_read_b64_tr_b16 v[218:219], v232 offset:27136
 v_mfma_f32_32x32x16_bf16 v[160:175], v[44:47], v[228:231], v[160:175]
 ds_read_b64_tr_b16 v[220:221], v233 offset:26624
 ds_read_b64_tr_b16 v[222:223], v233 offset:27136
 s_waitcnt lgkmcnt(4)
 v_mfma_f32_32x32x16_bf16 v[144:159], v[48:51], v[208:211], v[144:159]
 ds_read_b64_tr_b16 v[224:225], v232 offset:28672
 ds_read_b64_tr_b16 v[226:227], v232 offset:29184
 buffer_load_dwordx4 v239, s[12:15], s21 offen offset:1024 lds
 s_waitcnt vmcnt(12)
 v_mfma_f32_32x32x16_bf16 v[160:175], v[48:51], v[212:215], v[160:175]
 ds_read_b64_tr_b16 v[228:229], v233 offset:28672
 ds_read_b64_tr_b16 v[230:231], v233 offset:29184
 s_waitcnt lgkmcnt(4)
 v_mfma_f32_32x32x16_bf16 v[144:159], v[52:55], v[216:219], v[144:159]
 ds_read_b64_tr_b16 v[208:209], v232 offset:30720
 ds_read_b64_tr_b16 v[210:211], v232 offset:31232
 v_mfma_f32_32x32x16_bf16 v[160:175], v[52:55], v[220:223], v[160:175]
 ds_read_b64_tr_b16 v[212:213], v233 offset:30720
 ds_read_b64_tr_b16 v[214:215], v233 offset:31232
 s_waitcnt lgkmcnt(4)
 v_mfma_f32_32x32x16_bf16 v[144:159], v[56:59], v[224:227], v[144:159]
 ds_read_b64_tr_b16 v[216:217], v232 offset:32768
 ds_read_b64_tr_b16 v[218:219], v232 offset:33280
 s_add_u32 m0, s30, 122880
 s_add_u32 s21, s47, 128
 buffer_load_dwordx4 v238, s[12:15], s21 offen lds
 v_mfma_f32_32x32x16_bf16 v[160:175], v[56:59], v[228:231], v[160:175]
 ds_read_b64_tr_b16 v[220:221], v233 offset:32768
 ds_read_b64_tr_b16 v[222:223], v233 offset:33280
 s_waitcnt lgkmcnt(4)
 v_mfma_f32_32x32x16_bf16 v[144:159], v[60:63], v[208:211], v[144:159]
 ds_read_b64_tr_b16 v[224:225], v232 offset:34816
 ds_read_b64_tr_b16 v[226:227], v232 offset:35328
 v_mfma_f32_32x32x16_bf16 v[160:175], v[60:63], v[212:215], v[160:175]
 ds_read_b64_tr_b16 v[228:229], v233 offset:34816
 ds_read_b64_tr_b16 v[230:231], v233 offset:35328
 s_mul_i32 s52, s24, 36864
 s_add_u32 s52, s52, 0
 s_waitcnt lgkmcnt(4)
 v_mfma_f32_32x32x16_bf16 v[144:159], v[64:67], v[216:219], v[144:159]
 ds_read_b64_tr_b16 v[208:209], v232 offset:36864
 ds_read_b64_tr_b16 v[210:211], v232 offset:37376
 buffer_load_dwordx4 v239, s[12:15], s21 offen offset:1024 lds
 v_mfma_f32_32x32x16_bf16 v[160:175], v[64:67], v[220:223], v[160:175]
 ds_read_b64_tr_b16 v[212:213], v233 offset:36864
 ds_read_b64_tr_b16 v[214:215], v233 offset:37376
 s_waitcnt lgkmcnt(4)
 v_mfma_f32_32x32x16_bf16 v[144:159], v[68:71], v[224:227], v[144:159]
 ds_read_b64_tr_b16 v[216:217], v232 offset:38912
 ds_read_b64_tr_b16 v[218:219], v232 offset:39424
 v_mfma_f32_32x32x16_bf16 v[160:175], v[68:71], v[228:231], v[160:175]
 ds_read_b64_tr_b16 v[220:221], v233 offset:38912
 ds_read_b64_tr_b16 v[222:223], v233 offset:39424
 s_waitcnt lgkmcnt(4)
 v_mfma_f32_32x32x16_bf16 v[144:159], v[72:75], v[208:211], v[144:159]
 ds_read_b64_tr_b16 v[224:225], v232 offset:40960
 ds_read_b64_tr_b16 v[226:227], v232 offset:41472
 s_add_u32 m0, s30, 131072
 s_add_u32 s21, s48, 128
 buffer_load_dwordx4 v238, s[12:15], s21 offen lds
 v_mfma_f32_32x32x16_bf16 v[160:175], v[72:75], v[212:215], v[160:175]
 ds_read_b64_tr_b16 v[228:229], v233 offset:40960
 ds_read_b64_tr_b16 v[230:231], v233 offset:41472
 s_waitcnt lgkmcnt(4)
 v_mfma_f32_32x32x16_bf16 v[144:159], v[76:79], v[216:219], v[144:159]
 ds_read_b64_tr_b16 v[208:209], v232 offset:43008
 ds_read_b64_tr_b16 v[210:211], v232 offset:43520
 s_mul_i32 s6, s24, 74240
 s_add_u32 s53, s6, 2322432
 s_add_u32 s6, s6, 2396160
 v_mfma_f32_32x32x16_bf16 v[160:175], v[76:79], v[220:223], v[160:175]
 ds_read_b64_tr_b16 v[212:213], v233 offset:43008
 ds_read_b64_tr_b16 v[214:215], v233 offset:43520
 s_waitcnt lgkmcnt(4)
 v_mfma_f32_32x32x16_bf16 v[144:159], v[80:83], v[224:227], v[144:159]
 ds_read_b64_tr_b16 v[216:217], v232 offset:45056
 ds_read_b64_tr_b16 v[218:219], v232 offset:45568
 buffer_load_dwordx4 v239, s[12:15], s21 offen offset:1024 lds
 v_mfma_f32_32x32x16_bf16 v[160:175], v[80:83], v[228:231], v[160:175]
 ds_read_b64_tr_b16 v[220:221], v233 offset:45056
 ds_read_b64_tr_b16 v[222:223], v233 offset:45568
 s_waitcnt lgkmcnt(4)
 v_mfma_f32_32x32x16_bf16 v[144:159], v[84:87], v[208:211], v[144:159]
 ds_read_b64_tr_b16 v[224:225], v232 offset:47104
 ds_read_b64_tr_b16 v[226:227], v232 offset:47616
 v_mfma_f32_32x32x16_bf16 v[160:175], v[84:87], v[212:215], v[160:175]
 ds_read_b64_tr_b16 v[228:229], v233 offset:47104
 ds_read_b64_tr_b16 v[230:231], v233 offset:47616
 s_waitcnt vmcnt(20)
 s_barrier
 s_waitcnt lgkmcnt(4)
 v_mfma_f32_32x32x16_bf16 v[144:159], v[88:91], v[216:219], v[144:159]
 ds_read_b64_tr_b16 v[208:209], v234 offset:0
 ds_read_b64_tr_b16 v[210:211], v234 offset:512
 s_add_u32 m0, s30, 139264
 s_add_u32 s21, s49, 128
 buffer_load_dwordx4 v238, s[12:15], s21 offen lds
 v_mfma_f32_32x32x16_bf16 v[160:175], v[88:91], v[220:223], v[160:175]
 ds_read_b64_tr_b16 v[212:213], v235 offset:0
 ds_read_b64_tr_b16 v[214:215], v235 offset:512
 s_waitcnt lgkmcnt(4)
 v_mfma_f32_32x32x16_bf16 v[144:159], v[92:95], v[224:227], v[144:159]
 ds_read_b64_tr_b16 v[216:217], v234 offset:2048
 ds_read_b64_tr_b16 v[218:219], v234 offset:2560
 v_mfma_f32_32x32x16_bf16 v[160:175], v[92:95], v[228:231], v[160:175]
 ds_read_b64_tr_b16 v[220:221], v235 offset:2048
 ds_read_b64_tr_b16 v[222:223], v235 offset:2560
 v_mul_u32_u24 v245, 9344, v244
 s_waitcnt lgkmcnt(4)
 v_mfma_f32_32x32x16_bf16 v[144:159], v[96:99], v[208:211], v[144:159]
 ds_read_b64_tr_b16 v[224:225], v234 offset:4096
 ds_read_b64_tr_b16 v[226:227], v234 offset:4608
 buffer_load_dwordx4 v239, s[12:15], s21 offen offset:1024 lds
 v_mfma_f32_32x32x16_bf16 v[160:175], v[96:99], v[212:215], v[160:175]
 ds_read_b64_tr_b16 v[228:229], v235 offset:4096
 ds_read_b64_tr_b16 v[230:231], v235 offset:4608
 s_waitcnt lgkmcnt(4)
 v_mfma_f32_32x32x16_bf16 v[144:159], v[100:103], v[216:219], v[144:159]
 ds_read_b64_tr_b16 v[208:209], v234 offset:6144
 ds_read_b64_tr_b16 v[210:211], v234 offset:6656
 v_mfma_f32_32x32x16_bf16 v[160:175], v[100:103], v[220:223], v[160:175]
 ds_read_b64_tr_b16 v[212:213], v235 offset:6144
 ds_read_b64_tr_b16 v[214:215], v235 offset:6656
 s_waitcnt lgkmcnt(4)
 v_mfma_f32_32x32x16_bf16 v[144:159], v[104:107], v[224:227], v[144:159]
 ds_read_b64_tr_b16 v[216:217], v234 offset:8192
 ds_read_b64_tr_b16 v[218:219], v234 offset:8704
 s_add_u32 m0, s30, 0
 s_add_u32 s21, s41, 256
 buffer_load_dwordx4 v238, s[12:15], s21 offen lds
 v_mfma_f32_32x32x16_bf16 v[160:175], v[104:107], v[228:231], v[160:175]
 ds_read_b64_tr_b16 v[220:221], v235 offset:8192
 ds_read_b64_tr_b16 v[222:223], v235 offset:8704
 s_waitcnt lgkmcnt(4)
 v_mfma_f32_32x32x16_bf16 v[144:159], v[108:111], v[208:211], v[144:159]
 ds_read_b64_tr_b16 v[224:225], v234 offset:10240
 ds_read_b64_tr_b16 v[226:227], v234 offset:10752
 v_add_u32 v245, v245, v243
 v_mfma_f32_32x32x16_bf16 v[160:175], v[108:111], v[212:215], v[160:175]
 ds_read_b64_tr_b16 v[228:229], v235 offset:10240
 ds_read_b64_tr_b16 v[230:231], v235 offset:10752
 s_waitcnt lgkmcnt(4)
 v_mfma_f32_32x32x16_bf16 v[144:159], v[112:115], v[216:219], v[144:159]
 ds_read_b64_tr_b16 v[208:209], v234 offset:12288
 ds_read_b64_tr_b16 v[210:211], v234 offset:12800
 buffer_load_dwordx4 v239, s[12:15], s21 offen offset:1024 lds
 v_mfma_f32_32x32x16_bf16 v[160:175], v[112:115], v[220:223], v[160:175]
 ds_read_b64_tr_b16 v[212:213], v235 offset:12288
 ds_read_b64_tr_b16 v[214:215], v235 offset:12800
 s_waitcnt lgkmcnt(4)
 v_mfma_f32_32x32x16_bf16 v[144:159], v[116:119], v[224:227], v[144:159]
 ds_read_b64_tr_b16 v[216:217], v234 offset:14336
 ds_read_b64_tr_b16 v[218:219], v234 offset:14848
 v_mfma_f32_32x32x16_bf16 v[160:175], v[116:119], v[228:231], v[160:175]
 ds_read_b64_tr_b16 v[220:221], v235 offset:14336
 ds_read_b64_tr_b16 v[222:223], v235 offset:14848
 s_waitcnt lgkmcnt(4)
 v_mfma_f32_32x32x16_bf16 v[144:159], v[120:123], v[208:211], v[144:159]
 ds_read_b64_tr_b16 v[224:225], v234 offset:16384
 ds_read_b64_tr_b16 v[226:227], v234 offset:16896
 s_add_u32 m0, s30, 8192
 s_add_u32 s21, s42, 256
 buffer_load_dwordx4 v238, s[12:15], s21 offen lds
 v_mfma_f32_32x32x16_bf16 v[160:175], v[120:123], v[212:215], v[160:175]
 ds_read_b64_tr_b16 v[228:229], v235 offset:16384
 ds_read_b64_tr_b16 v[230:231], v235 offset:16896
 v_add_u32 v246, 18688, v245
 s_waitcnt lgkmcnt(4)
 v_mfma_f32_32x32x16_bf16 v[144:159], v[124:127], v[216:219], v[144:159]
 ds_read_b64_tr_b16 v[208:209], v234 offset:18432
 ds_read_b64_tr_b16 v[210:211], v234 offset:18944
 v_mfma_f32_32x32x16_bf16 v[160:175], v[124:127], v[220:223], v[160:175]
 ds_read_b64_tr_b16 v[212:213], v235 offset:18432
 ds_read_b64_tr_b16 v[214:215], v235 offset:18944
 s_waitcnt lgkmcnt(4)
 v_mfma_f32_32x32x16_bf16 v[144:159], v[128:131], v[224:227], v[144:159]
 ds_read_b64_tr_b16 v[216:217], v234 offset:20480
 ds_read_b64_tr_b16 v[218:219], v234 offset:20992
 buffer_load_dwordx4 v239, s[12:15], s21 offen offset:1024 lds
 v_mfma_f32_32x32x16_bf16 v[160:175], v[128:131], v[228:231], v[160:175]
 ds_read_b64_tr_b16 v[220:221], v235 offset:20480
 ds_read_b64_tr_b16 v[222:223], v235 offset:20992
 s_waitcnt lgkmcnt(4)
 v_mfma_f32_32x32x16_bf16 v[144:159], v[132:135], v[208:211], v[144:159]
 ds_read_b64_tr_b16 v[224:225], v234 offset:22528
 ds_read_b64_tr_b16 v[226:227], v234 offset:23040
 v_mfma_f32_32x32x16_bf16 v[160:175], v[132:135], v[212:215], v[160:175]
 ds_read_b64_tr_b16 v[228:229], v235 offset:22528
 ds_read_b64_tr_b16 v[230:231], v235 offset:23040
 s_waitcnt vmcnt(16)
 s_barrier
 s_waitcnt lgkmcnt(4)
 v_mfma_f32_32x32x16_bf16 v[144:159], v[136:139], v[216:219], v[144:159]
 ds_read_b64_tr_b16 v[208:209], v234 offset:24576
 ds_read_b64_tr_b16 v[210:211], v234 offset:25088
 s_add_u32 m0, s30, 16384
 s_add_u32 s21, s43, 256
 buffer_load_dwordx4 v238, s[12:15], s21 offen lds
 v_mfma_f32_32x32x16_bf16 v[160:175], v[136:139], v[220:223], v[160:175]
 ds_read_b64_tr_b16 v[212:213], v235 offset:24576
 ds_read_b64_tr_b16 v[214:215], v235 offset:25088
 s_waitcnt lgkmcnt(4)
 v_mfma_f32_32x32x16_bf16 v[144:159], v[140:143], v[224:227], v[144:159]
 ds_read_b64_tr_b16 v[216:217], v234 offset:26624
 ds_read_b64_tr_b16 v[218:219], v234 offset:27136
 v_mfma_f32_32x32x16_bf16 v[160:175], v[140:143], v[228:231], v[160:175]
 ds_read_b64_tr_b16 v[220:221], v235 offset:26624
 ds_read_b64_tr_b16 v[222:223], v235 offset:27136
 s_waitcnt lgkmcnt(4)
 v_mfma_f32_32x32x16_bf16 v[176:191], v[0:3], v[208:211], 0
 ds_read_b64_tr_b16 v[224:225], v234 offset:28672
 ds_read_b64_tr_b16 v[226:227], v234 offset:29184
 buffer_load_dwordx4 v239, s[12:15], s21 offen offset:1024 lds
 v_mfma_f32_32x32x16_bf16 v[192:207], v[0:3], v[212:215], 0
 ds_read_b64_tr_b16 v[228:229], v235 offset:28672
 ds_read_b64_tr_b16 v[230:231], v235 offset:29184
 s_waitcnt lgkmcnt(4)
 v_mfma_f32_32x32x16_bf16 v[176:191], v[4:7], v[216:219], v[176:191]
 ds_read_b64_tr_b16 v[208:209], v234 offset:30720
 ds_read_b64_tr_b16 v[210:211], v234 offset:31232
 v_mfma_f32_32x32x16_bf16 v[192:207], v[4:7], v[220:223], v[192:207]
 ds_read_b64_tr_b16 v[212:213], v235 offset:30720
 ds_read_b64_tr_b16 v[214:215], v235 offset:31232
 s_waitcnt lgkmcnt(4)
 v_mfma_f32_32x32x16_bf16 v[176:191], v[8:11], v[224:227], v[176:191]
 ds_read_b64_tr_b16 v[216:217], v234 offset:32768
 ds_read_b64_tr_b16 v[218:219], v234 offset:33280
 s_add_u32 m0, s30, 24576
 s_add_u32 s21, s44, 256
 buffer_load_dwordx4 v238, s[12:15], s21 offen lds
 s_add_u32 s7, s6, 2048
 ds_read_b128 v[248:251], v247 offset:0
 v_mfma_f32_32x32x16_bf16 v[192:207], v[8:11], v[228:231], v[192:207]
 ds_read_b64_tr_b16 v[220:221], v235 offset:32768
 ds_read_b64_tr_b16 v[222:223], v235 offset:33280
 s_nop 0
 s_waitcnt lgkmcnt(5)
 v_mfma_f32_32x32x16_bf16 v[176:191], v[12:15], v[208:211], v[176:191]
 ds_read_b64_tr_b16 v[224:225], v234 offset:34816
 ds_read_b64_tr_b16 v[226:227], v234 offset:35328
 s_nop 0
 v_mfma_f32_32x32x16_bf16 v[192:207], v[12:15], v[212:215], v[192:207]
 ds_read_b64_tr_b16 v[228:229], v235 offset:34816
 ds_read_b64_tr_b16 v[230:231], v235 offset:35328
 s_waitcnt lgkmcnt(6)
 s_waitcnt lgkmcnt(4)
 v_mfma_f32_32x32x16_bf16 v[176:191], v[16:19], v[216:219], v[176:191]
 ds_read_b64_tr_b16 v[208:209], v234 offset:36864
 ds_read_b64_tr_b16 v[210:211], v234 offset:37376
 buffer_load_dwordx4 v239, s[12:15], s21 offen offset:1024 lds
 v_mul_f32 v144, v248, v144
 v_mfma_f32_32x32x16_bf16 v[192:207], v[16:19], v[220:223], v[192:207]
 ds_read_b64_tr_b16 v[212:213], v235 offset:36864
 ds_read_b64_tr_b16 v[214:215], v235 offset:37376
 v_mul_f32 v145, v249, v145
 s_waitcnt lgkmcnt(4)
 v_mfma_f32_32x32x16_bf16 v[176:191], v[20:23], v[224:227], v[176:191]
 ds_read_b64_tr_b16 v[216:217], v234 offset:38912
 ds_read_b64_tr_b16 v[218:219], v234 offset:39424
 v_mul_f32 v146, v250, v146
 v_mfma_f32_32x32x16_bf16 v[192:207], v[20:23], v[228:231], v[192:207]
 ds_read_b64_tr_b16 v[220:221], v235 offset:38912
 ds_read_b64_tr_b16 v[222:223], v235 offset:39424
 v_mul_f32 v147, v251, v147
 s_waitcnt lgkmcnt(4)
 v_mfma_f32_32x32x16_bf16 v[176:191], v[24:27], v[208:211], v[176:191]
 ds_read_b64_tr_b16 v[224:225], v234 offset:40960
 ds_read_b64_tr_b16 v[226:227], v234 offset:41472
 s_add_u32 m0, s30, 32768
 s_add_u32 s21, s45, 256
 buffer_load_dwordx4 v238, s[12:15], s21 offen lds
 v_mul_f32 v160, v248, v160
 v_mfma_f32_32x32x16_bf16 v[192:207], v[24:27], v[212:215], v[192:207]
 ds_read_b64_tr_b16 v[228:229], v235 offset:40960
 ds_read_b64_tr_b16 v[230:231], v235 offset:41472
 v_mul_f32 v161, v249, v161
 s_waitcnt lgkmcnt(4)
 v_mfma_f32_32x32x16_bf16 v[176:191], v[28:31], v[216:219], v[176:191]
 ds_read_b64_tr_b16 v[208:209], v234 offset:43008
 ds_read_b64_tr_b16 v[210:211], v234 offset:43520
 v_mul_f32 v162, v250, v162
 v_mfma_f32_32x32x16_bf16 v[192:207], v[28:31], v[220:223], v[192:207]
 ds_read_b64_tr_b16 v[212:213], v235 offset:43008
 ds_read_b64_tr_b16 v[214:215], v235 offset:43520
 v_mul_f32 v163, v251, v163
 s_waitcnt lgkmcnt(4)
 v_mfma_f32_32x32x16_bf16 v[176:191], v[32:35], v[224:227], v[176:191]
 ds_read_b64_tr_b16 v[216:217], v234 offset:45056
 ds_read_b64_tr_b16 v[218:219], v234 offset:45568
 buffer_load_dwordx4 v239, s[12:15], s21 offen offset:1024 lds
 ds_read_b128 v[248:251], v247 offset:32
 v_mfma_f32_32x32x16_bf16 v[192:207], v[32:35], v[228:231], v[192:207]
 ds_read_b64_tr_b16 v[220:221], v235 offset:45056
 ds_read_b64_tr_b16 v[222:223], v235 offset:45568
 s_nop 0
 s_waitcnt lgkmcnt(5)
 v_mfma_f32_32x32x16_bf16 v[176:191], v[36:39], v[208:211], v[176:191]
 ds_read_b64_tr_b16 v[224:225], v234 offset:47104
 ds_read_b64_tr_b16 v[226:227], v234 offset:47616
 s_nop 0
 v_mfma_f32_32x32x16_bf16 v[192:207], v[36:39], v[212:215], v[192:207]
 ds_read_b64_tr_b16 v[228:229], v235 offset:47104
 ds_read_b64_tr_b16 v[230:231], v235 offset:47616
 s_waitcnt vmcnt(16)
 s_barrier
 s_waitcnt lgkmcnt(4)
 v_mfma_f32_32x32x16_bf16 v[176:191], v[40:43], v[216:219], v[176:191]
 ds_read_b64_tr_b16 v[208:209], v236 offset:0
 ds_read_b64_tr_b16 v[210:211], v236 offset:512
 s_add_u32 m0, s30, 40960
 s_add_u32 s21, s46, 256
 buffer_load_dwordx4 v238, s[12:15], s21 offen lds
 s_waitcnt lgkmcnt(8)
 v_mfma_f32_32x32x16_bf16 v[192:207], v[40:43], v[220:223], v[192:207]
 ds_read_b64_tr_b16 v[212:213], v237 offset:0
 ds_read_b64_tr_b16 v[214:215], v237 offset:512
 v_mul_f32 v148, v248, v148
 v_mul_f32 v149, v249, v149
 s_waitcnt lgkmcnt(4)
 v_mfma_f32_32x32x16_bf16 v[176:191], v[44:47], v[224:227], v[176:191]
 ds_read_b64_tr_b16 v[216:217], v236 offset:2048
 ds_read_b64_tr_b16 v[218:219], v236 offset:2560
 v_mul_f32 v150, v250, v150
 v_mfma_f32_32x32x16_bf16 v[192:207], v[44:47], v[228:231], v[192:207]
 ds_read_b64_tr_b16 v[220:221], v237 offset:2048
 ds_read_b64_tr_b16 v[222:223], v237 offset:2560
 v_mul_f32 v151, v251, v151
 s_waitcnt lgkmcnt(4)
 v_mfma_f32_32x32x16_bf16 v[176:191], v[48:51], v[208:211], v[176:191]
 ds_read_b64_tr_b16 v[224:225], v236 offset:4096
 ds_read_b64_tr_b16 v[226:227], v236 offset:4608
 buffer_load_dwordx4 v239, s[12:15], s21 offen offset:1024 lds
 v_mul_f32 v164, v248, v164
 v_mfma_f32_32x32x16_bf16 v[192:207], v[48:51], v[212:215], v[192:207]
 ds_read_b64_tr_b16 v[228:229], v237 offset:4096
 ds_read_b64_tr_b16 v[230:231], v237 offset:4608
 v_mul_f32 v165, v249, v165
 s_waitcnt lgkmcnt(4)
 v_mfma_f32_32x32x16_bf16 v[176:191], v[52:55], v[216:219], v[176:191]
 ds_read_b64_tr_b16 v[208:209], v236 offset:6144
 ds_read_b64_tr_b16 v[210:211], v236 offset:6656
 v_mul_f32 v166, v250, v166
 v_mfma_f32_32x32x16_bf16 v[192:207], v[52:55], v[220:223], v[192:207]
 ds_read_b64_tr_b16 v[212:213], v237 offset:6144
 ds_read_b64_tr_b16 v[214:215], v237 offset:6656
 v_mul_f32 v167, v251, v167
 s_waitcnt lgkmcnt(4)
 v_mfma_f32_32x32x16_bf16 v[176:191], v[56:59], v[224:227], v[176:191]
 ds_read_b64_tr_b16 v[216:217], v236 offset:8192
 ds_read_b64_tr_b16 v[218:219], v236 offset:8704
 s_add_u32 m0, s30, 49152
 s_add_u32 s21, s47, 256
 buffer_load_dwordx4 v238, s[12:15], s21 offen lds
 v_cvt_pk_bf16_f32 v144, v144, v145
 v_mfma_f32_32x32x16_bf16 v[192:207], v[56:59], v[228:231], v[192:207]
 ds_read_b64_tr_b16 v[220:221], v237 offset:8192
 ds_read_b64_tr_b16 v[222:223], v237 offset:8704
 v_cvt_pk_bf16_f32 v145, v146, v147
 s_waitcnt lgkmcnt(4)
 v_mfma_f32_32x32x16_bf16 v[176:191], v[60:63], v[208:211], v[176:191]
 ds_read_b64_tr_b16 v[224:225], v236 offset:10240
 ds_read_b64_tr_b16 v[226:227], v236 offset:10752
 v_cvt_pk_bf16_f32 v146, v148, v149
 v_mfma_f32_32x32x16_bf16 v[192:207], v[60:63], v[212:215], v[192:207]
 ds_read_b64_tr_b16 v[228:229], v237 offset:10240
 ds_read_b64_tr_b16 v[230:231], v237 offset:10752
 v_cvt_pk_bf16_f32 v147, v150, v151
 s_waitcnt lgkmcnt(4)
 v_mfma_f32_32x32x16_bf16 v[176:191], v[64:67], v[216:219], v[176:191]
 ds_read_b64_tr_b16 v[208:209], v236 offset:12288
 ds_read_b64_tr_b16 v[210:211], v236 offset:12800
 buffer_load_dwordx4 v239, s[12:15], s21 offen offset:1024 lds
 buffer_store_dwordx4 v[144:147], v245, s[16:19], s7 offen offset:0 sc1
 v_mfma_f32_32x32x16_bf16 v[192:207], v[64:67], v[220:223], v[192:207]
 ds_read_b64_tr_b16 v[212:213], v237 offset:12288
 ds_read_b64_tr_b16 v[214:215], v237 offset:12800
 v_cvt_pk_bf16_f32 v160, v160, v161
 s_waitcnt lgkmcnt(4)
 v_mfma_f32_32x32x16_bf16 v[176:191], v[68:71], v[224:227], v[176:191]
 ds_read_b64_tr_b16 v[216:217], v236 offset:14336
 ds_read_b64_tr_b16 v[218:219], v236 offset:14848
 v_cvt_pk_bf16_f32 v161, v162, v163
 v_mfma_f32_32x32x16_bf16 v[192:207], v[68:71], v[228:231], v[192:207]
 ds_read_b64_tr_b16 v[220:221], v237 offset:14336
 ds_read_b64_tr_b16 v[222:223], v237 offset:14848
 v_cvt_pk_bf16_f32 v162, v164, v165
 s_waitcnt lgkmcnt(4)
 v_mfma_f32_32x32x16_bf16 v[176:191], v[72:75], v[208:211], v[176:191]
 ds_read_b64_tr_b16 v[224:225], v236 offset:16384
 ds_read_b64_tr_b16 v[226:227], v236 offset:16896
 s_add_u32 m0, s30, 57344
 s_add_u32 s21, s48, 256
 buffer_load_dwordx4 v238, s[12:15], s21 offen lds
 v_cvt_pk_bf16_f32 v163, v166, v167
 v_mfma_f32_32x32x16_bf16 v[192:207], v[72:75], v[212:215], v[192:207]
 ds_read_b64_tr_b16 v[228:229], v237 offset:16384
 ds_read_b64_tr_b16 v[230:231], v237 offset:16896
 buffer_store_dwordx4 v[160:163], v245, s[16:19], s7 offen offset:512 sc1
 ds_read_b128 v[248:251], v247 offset:64
 s_waitcnt lgkmcnt(5)
 v_mfma_f32_32x32x16_bf16 v[176:191], v[76:79], v[216:219], v[176:191]
 ds_read_b64_tr_b16 v[208:209], v236 offset:18432
 ds_read_b64_tr_b16 v[210:211], v236 offset:18944
 s_nop 0
 v_mfma_f32_32x32x16_bf16 v[192:207], v[76:79], v[220:223], v[192:207]
 ds_read_b64_tr_b16 v[212:213], v237 offset:18432
 ds_read_b64_tr_b16 v[214:215], v237 offset:18944
 s_nop 0
 s_waitcnt lgkmcnt(5)
 v_mfma_f32_32x32x16_bf16 v[176:191], v[80:83], v[224:227], v[176:191]
 ds_read_b64_tr_b16 v[216:217], v236 offset:20480
 ds_read_b64_tr_b16 v[218:219], v236 offset:20992
 buffer_load_dwordx4 v239, s[12:15], s21 offen offset:1024 lds
 s_waitcnt lgkmcnt(6)
 v_mfma_f32_32x32x16_bf16 v[192:207], v[80:83], v[228:231], v[192:207]
 ds_read_b64_tr_b16 v[220:221], v237 offset:20480
 ds_read_b64_tr_b16 v[222:223], v237 offset:20992
 v_mul_f32 v152, v248, v152
 s_waitcnt lgkmcnt(4)
 v_mfma_f32_32x32x16_bf16 v[176:191], v[84:87], v[208:211], v[176:191]
 ds_read_b64_tr_b16 v[224:225], v236 offset:22528
 ds_read_b64_tr_b16 v[226:227], v236 offset:23040
 v_mul_f32 v153, v249, v153
 v_mfma_f32_32x32x16_bf16 v[192:207], v[84:87], v[212:215], v[192:207]
 ds_read_b64_tr_b16 v[228:229], v237 offset:22528
 ds_read_b64_tr_b16 v[230:231], v237 offset:23040
 s_waitcnt vmcnt(18)
 s_barrier
 s_waitcnt lgkmcnt(4)
 v_mfma_f32_32x32x16_bf16 v[176:191], v[88:91], v[216:219], v[176:191]
 ds_read_b64_tr_b16 v[208:209], v236 offset:24576
 ds_read_b64_tr_b16 v[210:211], v236 offset:25088
 s_add_u32 m0, s30, 65536
 s_add_u32 s21, s49, 256
 buffer_load_dwordx4 v238, s[12:15], s21 offen lds
 v_mul_f32 v154, v250, v154
 v_mfma_f32_32x32x16_bf16 v[192:207], v[88:91], v[220:223], v[192:207]
 ds_read_b64_tr_b16 v[212:213], v237 offset:24576
 ds_read_b64_tr_b16 v[214:215], v237 offset:25088
 v_mul_f32 v155, v251, v155
 s_waitcnt lgkmcnt(4)
 v_mfma_f32_32x32x16_bf16 v[176:191], v[92:95], v[224:227], v[176:191]
 ds_read_b64_tr_b16 v[216:217], v236 offset:26624
 ds_read_b64_tr_b16 v[218:219], v236 offset:27136
 v_mul_f32 v168, v248, v168
 v_mfma_f32_32x32x16_bf16 v[192:207], v[92:95], v[228:231], v[192:207]
 ds_read_b64_tr_b16 v[220:221], v237 offset:26624
 ds_read_b64_tr_b16 v[222:223], v237 offset:27136
 v_mul_f32 v169, v249, v169
 s_waitcnt lgkmcnt(4)
 v_mfma_f32_32x32x16_bf16 v[176:191], v[96:99], v[208:211], v[176:191]
 ds_read_b64_tr_b16 v[224:225], v236 offset:28672
 ds_read_b64_tr_b16 v[226:227], v236 offset:29184
 buffer_load_dwordx4 v239, s[12:15], s21 offen offset:1024 lds
 v_mul_f32 v170, v250, v170
 v_mfma_f32_32x32x16_bf16 v[192:207], v[96:99], v[212:215], v[192:207]
 ds_read_b64_tr_b16 v[228:229], v237 offset:28672
 ds_read_b64_tr_b16 v[230:231], v237 offset:29184
 v_mul_f32 v171, v251, v171
 s_waitcnt lgkmcnt(4)
 v_mfma_f32_32x32x16_bf16 v[176:191], v[100:103], v[216:219], v[176:191]
 ds_read_b64_tr_b16 v[208:209], v236 offset:30720
 ds_read_b64_tr_b16 v[210:211], v236 offset:31232
 ds_read_b128 v[248:251], v247 offset:96
 v_mfma_f32_32x32x16_bf16 v[192:207], v[100:103], v[220:223], v[192:207]
 ds_read_b64_tr_b16 v[212:213], v237 offset:30720
 ds_read_b64_tr_b16 v[214:215], v237 offset:31232
 s_nop 0
 s_waitcnt lgkmcnt(5)
 v_mfma_f32_32x32x16_bf16 v[176:191], v[104:107], v[224:227], v[176:191]
 ds_read_b64_tr_b16 v[216:217], v236 offset:32768
 ds_read_b64_tr_b16 v[218:219], v236 offset:33280
 s_add_u32 m0, s30, 73728
 s_add_u32 s21, s41, 384
 buffer_load_dwordx4 v238, s[12:15], s21 offen lds
 s_nop 0
 v_mfma_f32_32x32x16_bf16 v[192:207], v[104:107], v[228:231], v[192:207]
 ds_read_b64_tr_b16 v[220:221], v237 offset:32768
 ds_read_b64_tr_b16 v[222:223], v237 offset:33280
 s_waitcnt lgkmcnt(6)
 s_waitcnt lgkmcnt(4)
 v_mfma_f32_32x32x16_bf16 v[176:191], v[108:111], v[208:211], v[176:191]
 ds_read_b64_tr_b16 v[224:225], v236 offset:34816
 ds_read_b64_tr_b16 v[226:227], v236 offset:35328
 v_mul_f32 v156, v248, v156
 v_mul_f32 v157, v249, v157
 v_mfma_f32_32x32x16_bf16 v[192:207], v[108:111], v[212:215], v[192:207]
 ds_read_b64_tr_b16 v[228:229], v237 offset:34816
 ds_read_b64_tr_b16 v[230:231], v237 offset:35328
 v_mul_f32 v158, v250, v158
 s_waitcnt lgkmcnt(4)
 v_mfma_f32_32x32x16_bf16 v[176:191], v[112:115], v[216:219], v[176:191]
 ds_read_b64_tr_b16 v[208:209], v236 offset:36864
 ds_read_b64_tr_b16 v[210:211], v236 offset:37376
 buffer_load_dwordx4 v239, s[12:15], s21 offen offset:1024 lds
 v_mul_f32 v159, v251, v159
 v_mfma_f32_32x32x16_bf16 v[192:207], v[112:115], v[220:223], v[192:207]
 ds_read_b64_tr_b16 v[212:213], v237 offset:36864
 ds_read_b64_tr_b16 v[214:215], v237 offset:37376
 v_mul_f32 v172, v248, v172
 s_waitcnt lgkmcnt(4)
 v_mfma_f32_32x32x16_bf16 v[176:191], v[116:119], v[224:227], v[176:191]
 ds_read_b64_tr_b16 v[216:217], v236 offset:38912
 ds_read_b64_tr_b16 v[218:219], v236 offset:39424
 v_mul_f32 v173, v249, v173
 v_mfma_f32_32x32x16_bf16 v[192:207], v[116:119], v[228:231], v[192:207]
 ds_read_b64_tr_b16 v[220:221], v237 offset:38912
 ds_read_b64_tr_b16 v[222:223], v237 offset:39424
 v_mul_f32 v174, v250, v174
 s_waitcnt lgkmcnt(4)
 v_mfma_f32_32x32x16_bf16 v[176:191], v[120:123], v[208:211], v[176:191]
 ds_read_b64_tr_b16 v[224:225], v236 offset:40960
 ds_read_b64_tr_b16 v[226:227], v236 offset:41472
 s_add_u32 m0, s30, 81920
 s_add_u32 s21, s42, 384
 buffer_load_dwordx4 v238, s[12:15], s21 offen lds
 v_mul_f32 v175, v251, v175
 v_mfma_f32_32x32x16_bf16 v[192:207], v[120:123], v[212:215], v[192:207]
 ds_read_b64_tr_b16 v[228:229], v237 offset:40960
 ds_read_b64_tr_b16 v[230:231], v237 offset:41472
 v_cvt_pk_bf16_f32 v152, v152, v153
 s_waitcnt lgkmcnt(4)
 v_mfma_f32_32x32x16_bf16 v[176:191], v[124:127], v[216:219], v[176:191]
 ds_read_b64_tr_b16 v[208:209], v236 offset:43008
 ds_read_b64_tr_b16 v[210:211], v236 offset:43520
 v_cvt_pk_bf16_f32 v153, v154, v155
 v_mfma_f32_32x32x16_bf16 v[192:207], v[124:127], v[220:223], v[192:207]
 ds_read_b64_tr_b16 v[212:213], v237 offset:43008
 ds_read_b64_tr_b16 v[214:215], v237 offset:43520
 v_cvt_pk_bf16_f32 v154, v156, v157
 s_waitcnt lgkmcnt(4)
 v_mfma_f32_32x32x16_bf16 v[176:191], v[128:131], v[224:227], v[176:191]
 ds_read_b64_tr_b16 v[216:217], v236 offset:45056
 ds_read_b64_tr_b16 v[218:219], v236 offset:45568
 buffer_load_dwordx4 v239, s[12:15], s21 offen offset:1024 lds
 v_cvt_pk_bf16_f32 v155, v158, v159
 v_mfma_f32_32x32x16_bf16 v[192:207], v[128:131], v[228:231], v[192:207]
 ds_read_b64_tr_b16 v[220:221], v237 offset:45056
 ds_read_b64_tr_b16 v[222:223], v237 offset:45568
 buffer_store_dwordx4 v[152:155], v246, s[16:19], s7 offen offset:0 sc1
 s_waitcnt lgkmcnt(4)
 v_mfma_f32_32x32x16_bf16 v[176:191], v[132:135], v[208:211], v[176:191]
 ds_read_b64_tr_b16 v[224:225], v236 offset:47104
 ds_read_b64_tr_b16 v[226:227], v236 offset:47616
 v_cvt_pk_bf16_f32 v168, v168, v169
 v_mfma_f32_32x32x16_bf16 v[192:207], v[132:135], v[212:215], v[192:207]
 ds_read_b64_tr_b16 v[228:229], v237 offset:47104
 ds_read_b64_tr_b16 v[230:231], v237 offset:47616
 s_waitcnt vmcnt(19)
 s_barrier
 s_waitcnt lgkmcnt(4)
 v_mfma_f32_32x32x16_bf16 v[176:191], v[136:139], v[216:219], v[176:191]
 ds_read_b64_tr_b16 v[208:209], v232 offset:0
 ds_read_b64_tr_b16 v[210:211], v232 offset:512
 s_add_u32 m0, s30, 90112
 s_add_u32 s21, s43, 384
 buffer_load_dwordx4 v238, s[12:15], s21 offen lds
 v_cvt_pk_bf16_f32 v169, v170, v171
 v_mfma_f32_32x32x16_bf16 v[192:207], v[136:139], v[220:223], v[192:207]
 ds_read_b64_tr_b16 v[212:213], v233 offset:0
 ds_read_b64_tr_b16 v[214:215], v233 offset:512
 v_cvt_pk_bf16_f32 v170, v172, v173
 s_waitcnt lgkmcnt(4)
 v_mfma_f32_32x32x16_bf16 v[176:191], v[140:143], v[224:227], v[176:191]
 ds_read_b64_tr_b16 v[216:217], v232 offset:2048
 ds_read_b64_tr_b16 v[218:219], v232 offset:2560
 v_cvt_pk_bf16_f32 v171, v174, v175
 v_mfma_f32_32x32x16_bf16 v[192:207], v[140:143], v[228:231], v[192:207]
 ds_read_b64_tr_b16 v[220:221], v233 offset:2048
 ds_read_b64_tr_b16 v[222:223], v233 offset:2560
 buffer_store_dwordx4 v[168:171], v246, s[16:19], s7 offen offset:512 sc1
 s_waitcnt lgkmcnt(4)
 v_mfma_f32_32x32x16_bf16 v[144:159], v[0:3], v[208:211], 0
 ds_read_b64_tr_b16 v[224:225], v232 offset:4096
 ds_read_b64_tr_b16 v[226:227], v232 offset:4608
 buffer_load_dwordx4 v239, s[12:15], s21 offen offset:1024 lds
 v_mfma_f32_32x32x16_bf16 v[160:175], v[0:3], v[212:215], 0
 ds_read_b64_tr_b16 v[228:229], v233 offset:4096
 ds_read_b64_tr_b16 v[230:231], v233 offset:4608
 s_waitcnt lgkmcnt(4)
 v_mfma_f32_32x32x16_bf16 v[144:159], v[4:7], v[216:219], v[144:159]
 ds_read_b64_tr_b16 v[208:209], v232 offset:6144
 ds_read_b64_tr_b16 v[210:211], v232 offset:6656
 v_mfma_f32_32x32x16_bf16 v[160:175], v[4:7], v[220:223], v[160:175]
 ds_read_b64_tr_b16 v[212:213], v233 offset:6144
 ds_read_b64_tr_b16 v[214:215], v233 offset:6656
 s_waitcnt lgkmcnt(4)
 v_mfma_f32_32x32x16_bf16 v[144:159], v[8:11], v[224:227], v[144:159]
 ds_read_b64_tr_b16 v[216:217], v232 offset:8192
 ds_read_b64_tr_b16 v[218:219], v232 offset:8704
 s_add_u32 m0, s30, 98304
 s_add_u32 s21, s44, 384
 buffer_load_dwordx4 v238, s[12:15], s21 offen lds
 s_add_u32 s7, s6, 3072
 ds_read_b128 v[248:251], v247 offset:0
 v_mfma_f32_32x32x16_bf16 v[160:175], v[8:11], v[228:231], v[160:175]
 ds_read_b64_tr_b16 v[220:221], v233 offset:8192
 ds_read_b64_tr_b16 v[222:223], v233 offset:8704
 s_nop 0
 s_waitcnt lgkmcnt(5)
 v_mfma_f32_32x32x16_bf16 v[144:159], v[12:15], v[208:211], v[144:159]
 ds_read_b64_tr_b16 v[224:225], v232 offset:10240
 ds_read_b64_tr_b16 v[226:227], v232 offset:10752
 s_nop 0
 v_mfma_f32_32x32x16_bf16 v[160:175], v[12:15], v[212:215], v[160:175]
 ds_read_b64_tr_b16 v[228:229], v233 offset:10240
 ds_read_b64_tr_b16 v[230:231], v233 offset:10752
 s_waitcnt lgkmcnt(6)
 s_waitcnt lgkmcnt(4)
 v_mfma_f32_32x32x16_bf16 v[144:159], v[16:19], v[216:219], v[144:159]
 ds_read_b64_tr_b16 v[208:209], v232 offset:12288
 ds_read_b64_tr_b16 v[210:211], v232 offset:12800
 buffer_load_dwordx4 v239, s[12:15], s21 offen offset:1024 lds
 v_mul_f32 v176, v248, v176
 v_mfma_f32_32x32x16_bf16 v[160:175], v[16:19], v[220:223], v[160:175]
 ds_read_b64_tr_b16 v[212:213], v233 offset:12288
 ds_read_b64_tr_b16 v[214:215], v233 offset:12800
 v_mul_f32 v177, v249, v177
 s_waitcnt lgkmcnt(4)
 v_mfma_f32_32x32x16_bf16 v[144:159], v[20:23], v[224:227], v[144:159]
 ds_read_b64_tr_b16 v[216:217], v232 offset:14336
 ds_read_b64_tr_b16 v[218:219], v232 offset:14848
 v_mul_f32 v178, v250, v178
 v_mfma_f32_32x32x16_bf16 v[160:175], v[20:23], v[228:231], v[160:175]
 ds_read_b64_tr_b16 v[220:221], v233 offset:14336
 ds_read_b64_tr_b16 v[222:223], v233 offset:14848
 v_mul_f32 v179, v251, v179
 s_waitcnt lgkmcnt(4)
 v_mfma_f32_32x32x16_bf16 v[144:159], v[24:27], v[208:211], v[144:159]
 ds_read_b64_tr_b16 v[224:225], v232 offset:16384
 ds_read_b64_tr_b16 v[226:227], v232 offset:16896
 s_add_u32 m0, s30, 106496
 s_add_u32 s21, s45, 384
 buffer_load_dwordx4 v238, s[12:15], s21 offen lds
 v_mul_f32 v192, v248, v192
 v_mfma_f32_32x32x16_bf16 v[160:175], v[24:27], v[212:215], v[160:175]
 ds_read_b64_tr_b16 v[228:229], v233 offset:16384
 ds_read_b64_tr_b16 v[230:231], v233 offset:16896
 v_mul_f32 v193, v249, v193
 s_waitcnt lgkmcnt(4)
 v_mfma_f32_32x32x16_bf16 v[144:159], v[28:31], v[216:219], v[144:159]
 ds_read_b64_tr_b16 v[208:209], v232 offset:18432
 ds_read_b64_tr_b16 v[210:211], v232 offset:18944
 v_mul_f32 v194, v250, v194
 v_mfma_f32_32x32x16_bf16 v[160:175], v[28:31], v[220:223], v[160:175]
 ds_read_b64_tr_b16 v[212:213], v233 offset:18432
 ds_read_b64_tr_b16 v[214:215], v233 offset:18944
 v_mul_f32 v195, v251, v195
 s_waitcnt lgkmcnt(4)
 v_mfma_f32_32x32x16_bf16 v[144:159], v[32:35], v[224:227], v[144:159]
 ds_read_b64_tr_b16 v[216:217], v232 offset:20480
 ds_read_b64_tr_b16 v[218:219], v232 offset:20992
 buffer_load_dwordx4 v239, s[12:15], s21 offen offset:1024 lds
 ds_read_b128 v[248:251], v247 offset:32
 v_mfma_f32_32x32x16_bf16 v[160:175], v[32:35], v[228:231], v[160:175]
 ds_read_b64_tr_b16 v[220:221], v233 offset:20480
 ds_read_b64_tr_b16 v[222:223], v233 offset:20992
 s_nop 0
 s_waitcnt lgkmcnt(5)
 v_mfma_f32_32x32x16_bf16 v[144:159], v[36:39], v[208:211], v[144:159]
 ds_read_b64_tr_b16 v[224:225], v232 offset:22528
 ds_read_b64_tr_b16 v[226:227], v232 offset:23040
 s_nop 0
 v_mfma_f32_32x32x16_bf16 v[160:175], v[36:39], v[212:215], v[160:175]
 ds_read_b64_tr_b16 v[228:229], v233 offset:22528
 ds_read_b64_tr_b16 v[230:231], v233 offset:23040
 s_waitcnt vmcnt(20)
 s_barrier
 s_waitcnt lgkmcnt(4)
 v_mfma_f32_32x32x16_bf16 v[144:159], v[40:43], v[216:219], v[144:159]
 ds_read_b64_tr_b16 v[208:209], v232 offset:24576
 ds_read_b64_tr_b16 v[210:211], v232 offset:25088
 s_add_u32 m0, s30, 114688
 s_add_u32 s21, s46, 384
 buffer_load_dwordx4 v238, s[12:15], s21 offen lds
 s_waitcnt lgkmcnt(8)
 v_mfma_f32_32x32x16_bf16 v[160:175], v[40:43], v[220:223], v[160:175]
 ds_read_b64_tr_b16 v[212:213], v233 offset:24576
 ds_read_b64_tr_b16 v[214:215], v233 offset:25088
 v_mul_f32 v180, v248, v180
 v_mul_f32 v181, v249, v181
 s_waitcnt lgkmcnt(4)
 v_mfma_f32_32x32x16_bf16 v[144:159], v[44:47], v[224:227], v[144:159]
 ds_read_b64_tr_b16 v[216:217], v232 offset:26624
 ds_read_b64_tr_b16 v[218:219], v232 offset:27136
 v_mul_f32 v182, v250, v182
 v_mfma_f32_32x32x16_bf16 v[160:175], v[44:47], v[228:231], v[160:175]
 ds_read_b64_tr_b16 v[220:221], v233 offset:26624
 ds_read_b64_tr_b16 v[222:223], v233 offset:27136
 v_mul_f32 v183, v251, v183
 s_waitcnt lgkmcnt(4)
 v_mfma_f32_32x32x16_bf16 v[144:159], v[48:51], v[208:211], v[144:159]
 ds_read_b64_tr_b16 v[224:225], v232 offset:28672
 ds_read_b64_tr_b16 v[226:227], v232 offset:29184
 buffer_load_dwordx4 v239, s[12:15], s21 offen offset:1024 lds
 v_mul_f32 v196, v248, v196
 v_mfma_f32_32x32x16_bf16 v[160:175], v[48:51], v[212:215], v[160:175]
 ds_read_b64_tr_b16 v[228:229], v233 offset:28672
 ds_read_b64_tr_b16 v[230:231], v233 offset:29184
 v_mul_f32 v197, v249, v197
 s_waitcnt lgkmcnt(4)
 v_mfma_f32_32x32x16_bf16 v[144:159], v[52:55], v[216:219], v[144:159]
 ds_read_b64_tr_b16 v[208:209], v232 offset:30720
 ds_read_b64_tr_b16 v[210:211], v232 offset:31232
 v_mul_f32 v198, v250, v198
 v_mfma_f32_32x32x16_bf16 v[160:175], v[52:55], v[220:223], v[160:175]
 ds_read_b64_tr_b16 v[212:213], v233 offset:30720
 ds_read_b64_tr_b16 v[214:215], v233 offset:31232
 v_mul_f32 v199, v251, v199
 s_waitcnt lgkmcnt(4)
 v_mfma_f32_32x32x16_bf16 v[144:159], v[56:59], v[224:227], v[144:159]
 ds_read_b64_tr_b16 v[216:217], v232 offset:32768
 ds_read_b64_tr_b16 v[218:219], v232 offset:33280
 s_add_u32 m0, s30, 122880
 s_add_u32 s21, s47, 384
 buffer_load_dwordx4 v238, s[12:15], s21 offen lds
 v_cvt_pk_bf16_f32 v176, v176, v177
 v_mfma_f32_32x32x16_bf16 v[160:175], v[56:59], v[228:231], v[160:175]
 ds_read_b64_tr_b16 v[220:221], v233 offset:32768
 ds_read_b64_tr_b16 v[222:223], v233 offset:33280
 v_cvt_pk_bf16_f32 v177, v178, v179
 s_waitcnt lgkmcnt(4)
 v_mfma_f32_32x32x16_bf16 v[144:159], v[60:63], v[208:211], v[144:159]
 ds_read_b64_tr_b16 v[224:225], v232 offset:34816
 ds_read_b64_tr_b16 v[226:227], v232 offset:35328
 v_cvt_pk_bf16_f32 v178, v180, v181
 v_mfma_f32_32x32x16_bf16 v[160:175], v[60:63], v[212:215], v[160:175]
 ds_read_b64_tr_b16 v[228:229], v233 offset:34816
 ds_read_b64_tr_b16 v[230:231], v233 offset:35328
 v_cvt_pk_bf16_f32 v179, v182, v183
 s_waitcnt lgkmcnt(4)
 v_mfma_f32_32x32x16_bf16 v[144:159], v[64:67], v[216:219], v[144:159]
 ds_read_b64_tr_b16 v[208:209], v232 offset:36864
 ds_read_b64_tr_b16 v[210:211], v232 offset:37376
 buffer_load_dwordx4 v239, s[12:15], s21 offen offset:1024 lds
 buffer_store_dwordx4 v[176:179], v245, s[16:19], s7 offen offset:0 sc1
 v_mfma_f32_32x32x16_bf16 v[160:175], v[64:67], v[220:223], v[160:175]
 ds_read_b64_tr_b16 v[212:213], v233 offset:36864
 ds_read_b64_tr_b16 v[214:215], v233 offset:37376
 v_cvt_pk_bf16_f32 v192, v192, v193
 s_waitcnt lgkmcnt(4)
 v_mfma_f32_32x32x16_bf16 v[144:159], v[68:71], v[224:227], v[144:159]
 ds_read_b64_tr_b16 v[216:217], v232 offset:38912
 ds_read_b64_tr_b16 v[218:219], v232 offset:39424
 v_cvt_pk_bf16_f32 v193, v194, v195
 v_mfma_f32_32x32x16_bf16 v[160:175], v[68:71], v[228:231], v[160:175]
 ds_read_b64_tr_b16 v[220:221], v233 offset:38912
 ds_read_b64_tr_b16 v[222:223], v233 offset:39424
 v_cvt_pk_bf16_f32 v194, v196, v197
 s_waitcnt lgkmcnt(4)
 v_mfma_f32_32x32x16_bf16 v[144:159], v[72:75], v[208:211], v[144:159]
 ds_read_b64_tr_b16 v[224:225], v232 offset:40960
 ds_read_b64_tr_b16 v[226:227], v232 offset:41472
 s_add_u32 m0, s30, 131072
 s_add_u32 s21, s48, 384
 buffer_load_dwordx4 v238, s[12:15], s21 offen lds
 v_cvt_pk_bf16_f32 v195, v198, v199
 v_mfma_f32_32x32x16_bf16 v[160:175], v[72:75], v[212:215], v[160:175]
 ds_read_b64_tr_b16 v[228:229], v233 offset:40960
 ds_read_b64_tr_b16 v[230:231], v233 offset:41472
 buffer_store_dwordx4 v[192:195], v245, s[16:19], s7 offen offset:512 sc1
 ds_read_b128 v[248:251], v247 offset:64
 s_waitcnt lgkmcnt(5)
 v_mfma_f32_32x32x16_bf16 v[144:159], v[76:79], v[216:219], v[144:159]
 ds_read_b64_tr_b16 v[208:209], v232 offset:43008
 ds_read_b64_tr_b16 v[210:211], v232 offset:43520
 s_nop 0
 v_mfma_f32_32x32x16_bf16 v[160:175], v[76:79], v[220:223], v[160:175]
 ds_read_b64_tr_b16 v[212:213], v233 offset:43008
 ds_read_b64_tr_b16 v[214:215], v233 offset:43520
 s_nop 0
 s_waitcnt lgkmcnt(5)
 v_mfma_f32_32x32x16_bf16 v[144:159], v[80:83], v[224:227], v[144:159]
 ds_read_b64_tr_b16 v[216:217], v232 offset:45056
 ds_read_b64_tr_b16 v[218:219], v232 offset:45568
 buffer_load_dwordx4 v239, s[12:15], s21 offen offset:1024 lds
 s_waitcnt lgkmcnt(6)
 v_mfma_f32_32x32x16_bf16 v[160:175], v[80:83], v[228:231], v[160:175]
 ds_read_b64_tr_b16 v[220:221], v233 offset:45056
 ds_read_b64_tr_b16 v[222:223], v233 offset:45568
 v_mul_f32 v184, v248, v184
 s_waitcnt lgkmcnt(4)
 v_mfma_f32_32x32x16_bf16 v[144:159], v[84:87], v[208:211], v[144:159]
 ds_read_b64_tr_b16 v[224:225], v232 offset:47104
 ds_read_b64_tr_b16 v[226:227], v232 offset:47616
 v_mul_f32 v185, v249, v185
 v_mfma_f32_32x32x16_bf16 v[160:175], v[84:87], v[212:215], v[160:175]
 ds_read_b64_tr_b16 v[228:229], v233 offset:47104
 ds_read_b64_tr_b16 v[230:231], v233 offset:47616
 s_waitcnt vmcnt(20)
 s_barrier
 s_waitcnt lgkmcnt(4)
 v_mfma_f32_32x32x16_bf16 v[144:159], v[88:91], v[216:219], v[144:159]
 ds_read_b64_tr_b16 v[208:209], v234 offset:0
 ds_read_b64_tr_b16 v[210:211], v234 offset:512
 s_add_u32 m0, s30, 139264
 s_add_u32 s21, s49, 384
 buffer_load_dwordx4 v238, s[12:15], s21 offen lds
 v_mul_f32 v186, v250, v186
 v_mfma_f32_32x32x16_bf16 v[160:175], v[88:91], v[220:223], v[160:175]
 ds_read_b64_tr_b16 v[212:213], v235 offset:0
 ds_read_b64_tr_b16 v[214:215], v235 offset:512
 v_mul_f32 v187, v251, v187
 s_waitcnt lgkmcnt(4)
 v_mfma_f32_32x32x16_bf16 v[144:159], v[92:95], v[224:227], v[144:159]
 ds_read_b64_tr_b16 v[216:217], v234 offset:2048
 ds_read_b64_tr_b16 v[218:219], v234 offset:2560
 v_mul_f32 v200, v248, v200
 v_mfma_f32_32x32x16_bf16 v[160:175], v[92:95], v[228:231], v[160:175]
 ds_read_b64_tr_b16 v[220:221], v235 offset:2048
 ds_read_b64_tr_b16 v[222:223], v235 offset:2560
 v_mul_f32 v201, v249, v201
 s_waitcnt lgkmcnt(4)
 v_mfma_f32_32x32x16_bf16 v[144:159], v[96:99], v[208:211], v[144:159]
 ds_read_b64_tr_b16 v[224:225], v234 offset:4096
 ds_read_b64_tr_b16 v[226:227], v234 offset:4608
 buffer_load_dwordx4 v239, s[12:15], s21 offen offset:1024 lds
 v_mul_f32 v202, v250, v202
 v_mfma_f32_32x32x16_bf16 v[160:175], v[96:99], v[212:215], v[160:175]
 ds_read_b64_tr_b16 v[228:229], v235 offset:4096
 ds_read_b64_tr_b16 v[230:231], v235 offset:4608
 v_mul_f32 v203, v251, v203
 s_waitcnt lgkmcnt(4)
 v_mfma_f32_32x32x16_bf16 v[144:159], v[100:103], v[216:219], v[144:159]
 ds_read_b64_tr_b16 v[208:209], v234 offset:6144
 ds_read_b64_tr_b16 v[210:211], v234 offset:6656
 ds_read_b128 v[248:251], v247 offset:96
 v_mfma_f32_32x32x16_bf16 v[160:175], v[100:103], v[220:223], v[160:175]
 ds_read_b64_tr_b16 v[212:213], v235 offset:6144
 ds_read_b64_tr_b16 v[214:215], v235 offset:6656
 s_nop 0
 s_waitcnt lgkmcnt(5)
 v_mfma_f32_32x32x16_bf16 v[144:159], v[104:107], v[224:227], v[144:159]
 ds_read_b64_tr_b16 v[216:217], v234 offset:8192
 ds_read_b64_tr_b16 v[218:219], v234 offset:8704
 s_nop 0
 v_mfma_f32_32x32x16_bf16 v[160:175], v[104:107], v[228:231], v[160:175]
 ds_read_b64_tr_b16 v[220:221], v235 offset:8192
 ds_read_b64_tr_b16 v[222:223], v235 offset:8704
 s_waitcnt lgkmcnt(6)
 s_waitcnt lgkmcnt(4)
 v_mfma_f32_32x32x16_bf16 v[144:159], v[108:111], v[208:211], v[144:159]
 ds_read_b64_tr_b16 v[224:225], v234 offset:10240
 ds_read_b64_tr_b16 v[226:227], v234 offset:10752
 v_mul_f32 v188, v248, v188
 v_mul_f32 v189, v249, v189
 v_mfma_f32_32x32x16_bf16 v[160:175], v[108:111], v[212:215], v[160:175]
 ds_read_b64_tr_b16 v[228:229], v235 offset:10240
 ds_read_b64_tr_b16 v[230:231], v235 offset:10752
 v_mul_f32 v190, v250, v190
 s_waitcnt lgkmcnt(4)
 v_mfma_f32_32x32x16_bf16 v[144:159], v[112:115], v[216:219], v[144:159]
 ds_read_b64_tr_b16 v[208:209], v234 offset:12288
 ds_read_b64_tr_b16 v[210:211], v234 offset:12800
 v_mul_f32 v191, v251, v191
 v_mfma_f32_32x32x16_bf16 v[160:175], v[112:115], v[220:223], v[160:175]
 ds_read_b64_tr_b16 v[212:213], v235 offset:12288
 ds_read_b64_tr_b16 v[214:215], v235 offset:12800
 v_mul_f32 v204, v248, v204
 s_waitcnt lgkmcnt(4)
 v_mfma_f32_32x32x16_bf16 v[144:159], v[116:119], v[224:227], v[144:159]
 ds_read_b64_tr_b16 v[216:217], v234 offset:14336
 ds_read_b64_tr_b16 v[218:219], v234 offset:14848
 v_mul_f32 v205, v249, v205
 v_mfma_f32_32x32x16_bf16 v[160:175], v[116:119], v[228:231], v[160:175]
 ds_read_b64_tr_b16 v[220:221], v235 offset:14336
 ds_read_b64_tr_b16 v[222:223], v235 offset:14848
 v_mul_f32 v206, v250, v206
 s_waitcnt lgkmcnt(4)
 v_mfma_f32_32x32x16_bf16 v[144:159], v[120:123], v[208:211], v[144:159]
 ds_read_b64_tr_b16 v[224:225], v234 offset:16384
 ds_read_b64_tr_b16 v[226:227], v234 offset:16896
 v_mul_f32 v207, v251, v207
 v_mfma_f32_32x32x16_bf16 v[160:175], v[120:123], v[212:215], v[160:175]
 ds_read_b64_tr_b16 v[228:229], v235 offset:16384
 ds_read_b64_tr_b16 v[230:231], v235 offset:16896
 v_cvt_pk_bf16_f32 v184, v184, v185
 s_waitcnt lgkmcnt(4)
 v_mfma_f32_32x32x16_bf16 v[144:159], v[124:127], v[216:219], v[144:159]
 ds_read_b64_tr_b16 v[208:209], v234 offset:18432
 ds_read_b64_tr_b16 v[210:211], v234 offset:18944
 v_cvt_pk_bf16_f32 v185, v186, v187
 v_mfma_f32_32x32x16_bf16 v[160:175], v[124:127], v[220:223], v[160:175]
 ds_read_b64_tr_b16 v[212:213], v235 offset:18432
 ds_read_b64_tr_b16 v[214:215], v235 offset:18944
 v_cvt_pk_bf16_f32 v186, v188, v189
 s_waitcnt lgkmcnt(4)
 v_mfma_f32_32x32x16_bf16 v[144:159], v[128:131], v[224:227], v[144:159]
 ds_read_b64_tr_b16 v[216:217], v234 offset:20480
 ds_read_b64_tr_b16 v[218:219], v234 offset:20992
 v_cvt_pk_bf16_f32 v187, v190, v191
 v_mfma_f32_32x32x16_bf16 v[160:175], v[128:131], v[228:231], v[160:175]
 ds_read_b64_tr_b16 v[220:221], v235 offset:20480
 ds_read_b64_tr_b16 v[222:223], v235 offset:20992
 buffer_store_dwordx4 v[184:187], v246, s[16:19], s7 offen offset:0 sc1
 s_waitcnt lgkmcnt(4)
 v_mfma_f32_32x32x16_bf16 v[144:159], v[132:135], v[208:211], v[144:159]
 ds_read_b64_tr_b16 v[224:225], v234 offset:22528
 ds_read_b64_tr_b16 v[226:227], v234 offset:23040
 v_cvt_pk_bf16_f32 v200, v200, v201
 v_mfma_f32_32x32x16_bf16 v[160:175], v[132:135], v[212:215], v[160:175]
 ds_read_b64_tr_b16 v[228:229], v235 offset:22528
 ds_read_b64_tr_b16 v[230:231], v235 offset:23040
 s_waitcnt vmcnt(15)
 s_barrier
 s_waitcnt lgkmcnt(4)
 v_mfma_f32_32x32x16_bf16 v[144:159], v[136:139], v[216:219], v[144:159]
 ds_read_b64_tr_b16 v[208:209], v234 offset:24576
 ds_read_b64_tr_b16 v[210:211], v234 offset:25088
 v_cvt_pk_bf16_f32 v201, v202, v203
 v_mfma_f32_32x32x16_bf16 v[160:175], v[136:139], v[220:223], v[160:175]
 ds_read_b64_tr_b16 v[212:213], v235 offset:24576
 ds_read_b64_tr_b16 v[214:215], v235 offset:25088
 v_cvt_pk_bf16_f32 v202, v204, v205
 s_waitcnt lgkmcnt(4)
 v_mfma_f32_32x32x16_bf16 v[144:159], v[140:143], v[224:227], v[144:159]
 ds_read_b64_tr_b16 v[216:217], v234 offset:26624
 ds_read_b64_tr_b16 v[218:219], v234 offset:27136
 v_cvt_pk_bf16_f32 v203, v206, v207
 v_mfma_f32_32x32x16_bf16 v[160:175], v[140:143], v[228:231], v[160:175]
 ds_read_b64_tr_b16 v[220:221], v235 offset:26624
 ds_read_b64_tr_b16 v[222:223], v235 offset:27136
 buffer_store_dwordx4 v[200:203], v246, s[16:19], s7 offen offset:512 sc1
 s_waitcnt lgkmcnt(4)
 v_mfma_f32_32x32x16_bf16 v[176:191], v[0:3], v[208:211], 0
 ds_read_b64_tr_b16 v[224:225], v234 offset:28672
 ds_read_b64_tr_b16 v[226:227], v234 offset:29184
 v_mfma_f32_32x32x16_bf16 v[192:207], v[0:3], v[212:215], 0
 ds_read_b64_tr_b16 v[228:229], v235 offset:28672
 ds_read_b64_tr_b16 v[230:231], v235 offset:29184
 s_waitcnt lgkmcnt(4)
 v_mfma_f32_32x32x16_bf16 v[176:191], v[4:7], v[216:219], v[176:191]
 ds_read_b64_tr_b16 v[208:209], v234 offset:30720
 ds_read_b64_tr_b16 v[210:211], v234 offset:31232
 v_mfma_f32_32x32x16_bf16 v[192:207], v[4:7], v[220:223], v[192:207]
 ds_read_b64_tr_b16 v[212:213], v235 offset:30720
 ds_read_b64_tr_b16 v[214:215], v235 offset:31232
 s_waitcnt lgkmcnt(4)
 v_mfma_f32_32x32x16_bf16 v[176:191], v[8:11], v[224:227], v[176:191]
 ds_read_b64_tr_b16 v[216:217], v234 offset:32768
 ds_read_b64_tr_b16 v[218:219], v234 offset:33280
 s_add_u32 s7, s6, 4096
 ds_read_b128 v[248:251], v247 offset:0
 v_mfma_f32_32x32x16_bf16 v[192:207], v[8:11], v[228:231], v[192:207]
 ds_read_b64_tr_b16 v[220:221], v235 offset:32768
 ds_read_b64_tr_b16 v[222:223], v235 offset:33280
 s_nop 0
 s_waitcnt lgkmcnt(5)
 v_mfma_f32_32x32x16_bf16 v[176:191], v[12:15], v[208:211], v[176:191]
 ds_read_b64_tr_b16 v[224:225], v234 offset:34816
 ds_read_b64_tr_b16 v[226:227], v234 offset:35328
 s_nop 0
 v_mfma_f32_32x32x16_bf16 v[192:207], v[12:15], v[212:215], v[192:207]
 ds_read_b64_tr_b16 v[228:229], v235 offset:34816
 ds_read_b64_tr_b16 v[230:231], v235 offset:35328
 s_waitcnt lgkmcnt(6)
 s_waitcnt lgkmcnt(4)
 v_mfma_f32_32x32x16_bf16 v[176:191], v[16:19], v[216:219], v[176:191]
 ds_read_b64_tr_b16 v[208:209], v234 offset:36864
 ds_read_b64_tr_b16 v[210:211], v234 offset:37376
 v_mul_f32 v144, v248, v144
 v_mfma_f32_32x32x16_bf16 v[192:207], v[16:19], v[220:223], v[192:207]
 ds_read_b64_tr_b16 v[212:213], v235 offset:36864
 ds_read_b64_tr_b16 v[214:215], v235 offset:37376
 v_mul_f32 v145, v249, v145
 s_waitcnt lgkmcnt(4)
 v_mfma_f32_32x32x16_bf16 v[176:191], v[20:23], v[224:227], v[176:191]
 ds_read_b64_tr_b16 v[216:217], v234 offset:38912
 ds_read_b64_tr_b16 v[218:219], v234 offset:39424
 v_mul_f32 v146, v250, v146
 v_mfma_f32_32x32x16_bf16 v[192:207], v[20:23], v[228:231], v[192:207]
 ds_read_b64_tr_b16 v[220:221], v235 offset:38912
 ds_read_b64_tr_b16 v[222:223], v235 offset:39424
 v_mul_f32 v147, v251, v147
 s_waitcnt lgkmcnt(4)
 v_mfma_f32_32x32x16_bf16 v[176:191], v[24:27], v[208:211], v[176:191]
 ds_read_b64_tr_b16 v[224:225], v234 offset:40960
 ds_read_b64_tr_b16 v[226:227], v234 offset:41472
 v_mul_f32 v160, v248, v160
 v_mfma_f32_32x32x16_bf16 v[192:207], v[24:27], v[212:215], v[192:207]
 ds_read_b64_tr_b16 v[228:229], v235 offset:40960
 ds_read_b64_tr_b16 v[230:231], v235 offset:41472
 v_mul_f32 v161, v249, v161
 s_waitcnt lgkmcnt(4)
 v_mfma_f32_32x32x16_bf16 v[176:191], v[28:31], v[216:219], v[176:191]
 ds_read_b64_tr_b16 v[208:209], v234 offset:43008
 ds_read_b64_tr_b16 v[210:211], v234 offset:43520
 v_mul_f32 v162, v250, v162
 v_mfma_f32_32x32x16_bf16 v[192:207], v[28:31], v[220:223], v[192:207]
 ds_read_b64_tr_b16 v[212:213], v235 offset:43008
 ds_read_b64_tr_b16 v[214:215], v235 offset:43520
 v_mul_f32 v163, v251, v163
 s_waitcnt lgkmcnt(4)
 v_mfma_f32_32x32x16_bf16 v[176:191], v[32:35], v[224:227], v[176:191]
 ds_read_b64_tr_b16 v[216:217], v234 offset:45056
 ds_read_b64_tr_b16 v[218:219], v234 offset:45568
 ds_read_b128 v[248:251], v247 offset:32
 v_mfma_f32_32x32x16_bf16 v[192:207], v[32:35], v[228:231], v[192:207]
 ds_read_b64_tr_b16 v[220:221], v235 offset:45056
 ds_read_b64_tr_b16 v[222:223], v235 offset:45568
 s_nop 0
 s_waitcnt lgkmcnt(5)
 v_mfma_f32_32x32x16_bf16 v[176:191], v[36:39], v[208:211], v[176:191]
 ds_read_b64_tr_b16 v[224:225], v234 offset:47104
 ds_read_b64_tr_b16 v[226:227], v234 offset:47616
 s_nop 0
 v_mfma_f32_32x32x16_bf16 v[192:207], v[36:39], v[212:215], v[192:207]
 ds_read_b64_tr_b16 v[228:229], v235 offset:47104
 ds_read_b64_tr_b16 v[230:231], v235 offset:47616
 s_waitcnt vmcnt(10)
 s_barrier
 s_waitcnt lgkmcnt(4)
 v_mfma_f32_32x32x16_bf16 v[176:191], v[40:43], v[216:219], v[176:191]
 ds_read_b64_tr_b16 v[208:209], v236 offset:0
 ds_read_b64_tr_b16 v[210:211], v236 offset:512
 s_waitcnt lgkmcnt(8)
 v_mfma_f32_32x32x16_bf16 v[192:207], v[40:43], v[220:223], v[192:207]
 ds_read_b64_tr_b16 v[212:213], v237 offset:0
 ds_read_b64_tr_b16 v[214:215], v237 offset:512
 v_mul_f32 v148, v248, v148
 v_mul_f32 v149, v249, v149
 s_waitcnt lgkmcnt(4)
 v_mfma_f32_32x32x16_bf16 v[176:191], v[44:47], v[224:227], v[176:191]
 ds_read_b64_tr_b16 v[216:217], v236 offset:2048
 ds_read_b64_tr_b16 v[218:219], v236 offset:2560
 v_mul_f32 v150, v250, v150
 v_mfma_f32_32x32x16_bf16 v[192:207], v[44:47], v[228:231], v[192:207]
 ds_read_b64_tr_b16 v[220:221], v237 offset:2048
 ds_read_b64_tr_b16 v[222:223], v237 offset:2560
 v_mul_f32 v151, v251, v151
 s_waitcnt lgkmcnt(4)
 v_mfma_f32_32x32x16_bf16 v[176:191], v[48:51], v[208:211], v[176:191]
 ds_read_b64_tr_b16 v[224:225], v236 offset:4096
 ds_read_b64_tr_b16 v[226:227], v236 offset:4608
 v_mul_f32 v164, v248, v164
 v_mfma_f32_32x32x16_bf16 v[192:207], v[48:51], v[212:215], v[192:207]
 ds_read_b64_tr_b16 v[228:229], v237 offset:4096
 ds_read_b64_tr_b16 v[230:231], v237 offset:4608
 v_mul_f32 v165, v249, v165
 s_waitcnt lgkmcnt(4)
 v_mfma_f32_32x32x16_bf16 v[176:191], v[52:55], v[216:219], v[176:191]
 ds_read_b64_tr_b16 v[208:209], v236 offset:6144
 ds_read_b64_tr_b16 v[210:211], v236 offset:6656
 v_mul_f32 v166, v250, v166
 v_mfma_f32_32x32x16_bf16 v[192:207], v[52:55], v[220:223], v[192:207]
 ds_read_b64_tr_b16 v[212:213], v237 offset:6144
 ds_read_b64_tr_b16 v[214:215], v237 offset:6656
 v_mul_f32 v167, v251, v167
 s_waitcnt lgkmcnt(4)
 v_mfma_f32_32x32x16_bf16 v[176:191], v[56:59], v[224:227], v[176:191]
 ds_read_b64_tr_b16 v[216:217], v236 offset:8192
 ds_read_b64_tr_b16 v[218:219], v236 offset:8704
 v_cvt_pk_bf16_f32 v144, v144, v145
 v_mfma_f32_32x32x16_bf16 v[192:207], v[56:59], v[228:231], v[192:207]
 ds_read_b64_tr_b16 v[220:221], v237 offset:8192
 ds_read_b64_tr_b16 v[222:223], v237 offset:8704
 v_cvt_pk_bf16_f32 v145, v146, v147
 s_waitcnt lgkmcnt(4)
 v_mfma_f32_32x32x16_bf16 v[176:191], v[60:63], v[208:211], v[176:191]
 ds_read_b64_tr_b16 v[224:225], v236 offset:10240
 ds_read_b64_tr_b16 v[226:227], v236 offset:10752
 v_cvt_pk_bf16_f32 v146, v148, v149
 v_mfma_f32_32x32x16_bf16 v[192:207], v[60:63], v[212:215], v[192:207]
 ds_read_b64_tr_b16 v[228:229], v237 offset:10240
 ds_read_b64_tr_b16 v[230:231], v237 offset:10752
 v_cvt_pk_bf16_f32 v147, v150, v151
 s_waitcnt lgkmcnt(4)
 v_mfma_f32_32x32x16_bf16 v[176:191], v[64:67], v[216:219], v[176:191]
 ds_read_b64_tr_b16 v[208:209], v236 offset:12288
 ds_read_b64_tr_b16 v[210:211], v236 offset:12800
 buffer_store_dwordx4 v[144:147], v245, s[16:19], s7 offen offset:0 sc1
 v_mfma_f32_32x32x16_bf16 v[192:207], v[64:67], v[220:223], v[192:207]
 ds_read_b64_tr_b16 v[212:213], v237 offset:12288
 ds_read_b64_tr_b16 v[214:215], v237 offset:12800
 v_cvt_pk_bf16_f32 v160, v160, v161
 s_waitcnt lgkmcnt(4)
 v_mfma_f32_32x32x16_bf16 v[176:191], v[68:71], v[224:227], v[176:191]
 ds_read_b64_tr_b16 v[216:217], v236 offset:14336
 ds_read_b64_tr_b16 v[218:219], v236 offset:14848
 v_cvt_pk_bf16_f32 v161, v162, v163
 v_mfma_f32_32x32x16_bf16 v[192:207], v[68:71], v[228:231], v[192:207]
 ds_read_b64_tr_b16 v[220:221], v237 offset:14336
 ds_read_b64_tr_b16 v[222:223], v237 offset:14848
 v_cvt_pk_bf16_f32 v162, v164, v165
 s_waitcnt lgkmcnt(4)
 v_mfma_f32_32x32x16_bf16 v[176:191], v[72:75], v[208:211], v[176:191]
 ds_read_b64_tr_b16 v[224:225], v236 offset:16384
 ds_read_b64_tr_b16 v[226:227], v236 offset:16896
 v_cvt_pk_bf16_f32 v163, v166, v167
 v_mfma_f32_32x32x16_bf16 v[192:207], v[72:75], v[212:215], v[192:207]
 ds_read_b64_tr_b16 v[228:229], v237 offset:16384
 ds_read_b64_tr_b16 v[230:231], v237 offset:16896
 buffer_store_dwordx4 v[160:163], v245, s[16:19], s7 offen offset:512 sc1
 ds_read_b128 v[248:251], v247 offset:64
 s_waitcnt lgkmcnt(5)
 v_mfma_f32_32x32x16_bf16 v[176:191], v[76:79], v[216:219], v[176:191]
 ds_read_b64_tr_b16 v[208:209], v236 offset:18432
 ds_read_b64_tr_b16 v[210:211], v236 offset:18944
 s_nop 0
 v_mfma_f32_32x32x16_bf16 v[192:207], v[76:79], v[220:223], v[192:207]
 ds_read_b64_tr_b16 v[212:213], v237 offset:18432
 ds_read_b64_tr_b16 v[214:215], v237 offset:18944
 s_nop 0
 s_waitcnt lgkmcnt(5)
 v_mfma_f32_32x32x16_bf16 v[176:191], v[80:83], v[224:227], v[176:191]
 ds_read_b64_tr_b16 v[216:217], v236 offset:20480
 ds_read_b64_tr_b16 v[218:219], v236 offset:20992
 s_waitcnt lgkmcnt(6)
 v_mfma_f32_32x32x16_bf16 v[192:207], v[80:83], v[228:231], v[192:207]
 ds_read_b64_tr_b16 v[220:221], v237 offset:20480
 ds_read_b64_tr_b16 v[222:223], v237 offset:20992
 v_mul_f32 v152, v248, v152
 s_waitcnt lgkmcnt(4)
 v_mfma_f32_32x32x16_bf16 v[176:191], v[84:87], v[208:211], v[176:191]
 ds_read_b64_tr_b16 v[224:225], v236 offset:22528
 ds_read_b64_tr_b16 v[226:227], v236 offset:23040
 v_mul_f32 v153, v249, v153
 v_mfma_f32_32x32x16_bf16 v[192:207], v[84:87], v[212:215], v[192:207]
 ds_read_b64_tr_b16 v[228:229], v237 offset:22528
 ds_read_b64_tr_b16 v[230:231], v237 offset:23040
 s_waitcnt vmcnt(4)
 s_barrier
 s_waitcnt lgkmcnt(4)
 v_mfma_f32_32x32x16_bf16 v[176:191], v[88:91], v[216:219], v[176:191]
 ds_read_b64_tr_b16 v[208:209], v236 offset:24576
 ds_read_b64_tr_b16 v[210:211], v236 offset:25088
 v_mul_f32 v154, v250, v154
 v_mfma_f32_32x32x16_bf16 v[192:207], v[88:91], v[220:223], v[192:207]
 ds_read_b64_tr_b16 v[212:213], v237 offset:24576
 ds_read_b64_tr_b16 v[214:215], v237 offset:25088
 v_mul_f32 v155, v251, v155
 s_waitcnt lgkmcnt(4)
 v_mfma_f32_32x32x16_bf16 v[176:191], v[92:95], v[224:227], v[176:191]
 ds_read_b64_tr_b16 v[216:217], v236 offset:26624
 ds_read_b64_tr_b16 v[218:219], v236 offset:27136
 v_mul_f32 v168, v248, v168
 v_mfma_f32_32x32x16_bf16 v[192:207], v[92:95], v[228:231], v[192:207]
 ds_read_b64_tr_b16 v[220:221], v237 offset:26624
 ds_read_b64_tr_b16 v[222:223], v237 offset:27136
 v_mul_f32 v169, v249, v169
 s_waitcnt lgkmcnt(4)
 v_mfma_f32_32x32x16_bf16 v[176:191], v[96:99], v[208:211], v[176:191]
 ds_read_b64_tr_b16 v[224:225], v236 offset:28672
 ds_read_b64_tr_b16 v[226:227], v236 offset:29184
 v_mul_f32 v170, v250, v170
 v_mfma_f32_32x32x16_bf16 v[192:207], v[96:99], v[212:215], v[192:207]
 ds_read_b64_tr_b16 v[228:229], v237 offset:28672
 ds_read_b64_tr_b16 v[230:231], v237 offset:29184
 v_mul_f32 v171, v251, v171
 s_waitcnt lgkmcnt(4)
 v_mfma_f32_32x32x16_bf16 v[176:191], v[100:103], v[216:219], v[176:191]
 ds_read_b64_tr_b16 v[208:209], v236 offset:30720
 ds_read_b64_tr_b16 v[210:211], v236 offset:31232
 ds_read_b128 v[248:251], v247 offset:96
 v_mfma_f32_32x32x16_bf16 v[192:207], v[100:103], v[220:223], v[192:207]
 ds_read_b64_tr_b16 v[212:213], v237 offset:30720
 ds_read_b64_tr_b16 v[214:215], v237 offset:31232
 s_nop 0
 s_waitcnt lgkmcnt(5)
 v_mfma_f32_32x32x16_bf16 v[176:191], v[104:107], v[224:227], v[176:191]
 ds_read_b64_tr_b16 v[216:217], v236 offset:32768
 ds_read_b64_tr_b16 v[218:219], v236 offset:33280
 s_nop 0
 v_mfma_f32_32x32x16_bf16 v[192:207], v[104:107], v[228:231], v[192:207]
 ds_read_b64_tr_b16 v[220:221], v237 offset:32768
 ds_read_b64_tr_b16 v[222:223], v237 offset:33280
 s_waitcnt lgkmcnt(6)
 s_waitcnt lgkmcnt(4)
 v_mfma_f32_32x32x16_bf16 v[176:191], v[108:111], v[208:211], v[176:191]
 ds_read_b64_tr_b16 v[224:225], v236 offset:34816
 ds_read_b64_tr_b16 v[226:227], v236 offset:35328
 v_mul_f32 v156, v248, v156
 v_mul_f32 v157, v249, v157
 v_mfma_f32_32x32x16_bf16 v[192:207], v[108:111], v[212:215], v[192:207]
 ds_read_b64_tr_b16 v[228:229], v237 offset:34816
 ds_read_b64_tr_b16 v[230:231], v237 offset:35328
 v_mul_f32 v158, v250, v158
 s_waitcnt lgkmcnt(4)
 v_mfma_f32_32x32x16_bf16 v[176:191], v[112:115], v[216:219], v[176:191]
 ds_read_b64_tr_b16 v[208:209], v236 offset:36864
 ds_read_b64_tr_b16 v[210:211], v236 offset:37376
 v_mul_f32 v159, v251, v159
 v_mfma_f32_32x32x16_bf16 v[192:207], v[112:115], v[220:223], v[192:207]
 ds_read_b64_tr_b16 v[212:213], v237 offset:36864
 ds_read_b64_tr_b16 v[214:215], v237 offset:37376
 v_mul_f32 v172, v248, v172
 s_waitcnt lgkmcnt(4)
 v_mfma_f32_32x32x16_bf16 v[176:191], v[116:119], v[224:227], v[176:191]
 ds_read_b64_tr_b16 v[216:217], v236 offset:38912
 ds_read_b64_tr_b16 v[218:219], v236 offset:39424
 v_mul_f32 v173, v249, v173
 v_mfma_f32_32x32x16_bf16 v[192:207], v[116:119], v[228:231], v[192:207]
 ds_read_b64_tr_b16 v[220:221], v237 offset:38912
 ds_read_b64_tr_b16 v[222:223], v237 offset:39424
 v_mul_f32 v174, v250, v174
 s_waitcnt lgkmcnt(4)
 v_mfma_f32_32x32x16_bf16 v[176:191], v[120:123], v[208:211], v[176:191]
 ds_read_b64_tr_b16 v[224:225], v236 offset:40960
 ds_read_b64_tr_b16 v[226:227], v236 offset:41472
 v_mul_f32 v175, v251, v175
 v_mfma_f32_32x32x16_bf16 v[192:207], v[120:123], v[212:215], v[192:207]
 ds_read_b64_tr_b16 v[228:229], v237 offset:40960
 ds_read_b64_tr_b16 v[230:231], v237 offset:41472
 v_cvt_pk_bf16_f32 v152, v152, v153
 s_waitcnt lgkmcnt(4)
 v_mfma_f32_32x32x16_bf16 v[176:191], v[124:127], v[216:219], v[176:191]
 ds_read_b64_tr_b16 v[208:209], v236 offset:43008
 ds_read_b64_tr_b16 v[210:211], v236 offset:43520
 v_cvt_pk_bf16_f32 v153, v154, v155
 v_mfma_f32_32x32x16_bf16 v[192:207], v[124:127], v[220:223], v[192:207]
 ds_read_b64_tr_b16 v[212:213], v237 offset:43008
 ds_read_b64_tr_b16 v[214:215], v237 offset:43520
 v_cvt_pk_bf16_f32 v154, v156, v157
 s_waitcnt lgkmcnt(4)
 v_mfma_f32_32x32x16_bf16 v[176:191], v[128:131], v[224:227], v[176:191]
 ds_read_b64_tr_b16 v[216:217], v236 offset:45056
 ds_read_b64_tr_b16 v[218:219], v236 offset:45568
 v_cvt_pk_bf16_f32 v155, v158, v159
 v_mfma_f32_32x32x16_bf16 v[192:207], v[128:131], v[228:231], v[192:207]
 ds_read_b64_tr_b16 v[220:221], v237 offset:45056
 ds_read_b64_tr_b16 v[222:223], v237 offset:45568
 buffer_store_dwordx4 v[152:155], v246, s[16:19], s7 offen offset:0 sc1
 s_waitcnt lgkmcnt(4)
 v_mfma_f32_32x32x16_bf16 v[176:191], v[132:135], v[208:211], v[176:191]
 ds_read_b64_tr_b16 v[224:225], v236 offset:47104
 ds_read_b64_tr_b16 v[226:227], v236 offset:47616
 v_cvt_pk_bf16_f32 v168, v168, v169
 v_mfma_f32_32x32x16_bf16 v[192:207], v[132:135], v[212:215], v[192:207]
 ds_read_b64_tr_b16 v[228:229], v237 offset:47104
 ds_read_b64_tr_b16 v[230:231], v237 offset:47616
 s_waitcnt lgkmcnt(4)
 v_mfma_f32_32x32x16_bf16 v[176:191], v[136:139], v[216:219], v[176:191]
 v_cvt_pk_bf16_f32 v169, v170, v171
 v_mfma_f32_32x32x16_bf16 v[192:207], v[136:139], v[220:223], v[192:207]
 v_cvt_pk_bf16_f32 v170, v172, v173
 s_waitcnt lgkmcnt(0)
 v_mfma_f32_32x32x16_bf16 v[176:191], v[140:143], v[224:227], v[176:191]
 v_cvt_pk_bf16_f32 v171, v174, v175
 v_mfma_f32_32x32x16_bf16 v[192:207], v[140:143], v[228:231], v[192:207]
 buffer_store_dwordx4 v[168:171], v246, s[16:19], s7 offen offset:512 sc1
 s_nop 11
 s_add_u32 s7, s6, 5120
 ds_read_b128 v[248:251], v247 offset:0
 s_nop 0
 s_nop 0
 s_waitcnt lgkmcnt(0)
 v_mul_f32 v176, v248, v176
 v_mul_f32 v177, v249, v177
 v_mul_f32 v178, v250, v178
 v_mul_f32 v179, v251, v179
 v_mul_f32 v192, v248, v192
 v_mul_f32 v193, v249, v193
 v_mul_f32 v194, v250, v194
 v_mul_f32 v195, v251, v195
 ds_read_b128 v[248:251], v247 offset:32
 s_nop 0
 s_nop 0
 s_waitcnt lgkmcnt(0)
 v_mul_f32 v180, v248, v180
 v_mul_f32 v181, v249, v181
 v_mul_f32 v182, v250, v182
 v_mul_f32 v183, v251, v183
 v_mul_f32 v196, v248, v196
 v_mul_f32 v197, v249, v197
 v_mul_f32 v198, v250, v198
 v_mul_f32 v199, v251, v199
 v_cvt_pk_bf16_f32 v176, v176, v177
 v_cvt_pk_bf16_f32 v177, v178, v179
 v_cvt_pk_bf16_f32 v178, v180, v181
 v_cvt_pk_bf16_f32 v179, v182, v183
 buffer_store_dwordx4 v[176:179], v245, s[16:19], s7 offen offset:0 sc1
 v_cvt_pk_bf16_f32 v192, v192, v193
 v_cvt_pk_bf16_f32 v193, v194, v195
 v_cvt_pk_bf16_f32 v194, v196, v197
 v_cvt_pk_bf16_f32 v195, v198, v199
 buffer_store_dwordx4 v[192:195], v245, s[16:19], s7 offen offset:512 sc1
 ds_read_b128 v[248:251], v247 offset:64
 s_nop 0
 s_nop 0
 s_waitcnt lgkmcnt(0)
 v_mul_f32 v184, v248, v184
 v_mul_f32 v185, v249, v185
 v_mul_f32 v186, v250, v186
 v_mul_f32 v187, v251, v187
 v_mul_f32 v200, v248, v200
 v_mul_f32 v201, v249, v201
 v_mul_f32 v202, v250, v202
 v_mul_f32 v203, v251, v203
 ds_read_b128 v[248:251], v247 offset:96
 s_nop 0
 s_nop 0
 s_waitcnt lgkmcnt(0)
 v_mul_f32 v188, v248, v188
 v_mul_f32 v189, v249, v189
 v_mul_f32 v190, v250, v190
 v_mul_f32 v191, v251, v191
 v_mul_f32 v204, v248, v204
 v_mul_f32 v205, v249, v205
 v_mul_f32 v206, v250, v206
 v_mul_f32 v207, v251, v207
 v_cvt_pk_bf16_f32 v184, v184, v185
 v_cvt_pk_bf16_f32 v185, v186, v187
 v_cvt_pk_bf16_f32 v186, v188, v189
 v_cvt_pk_bf16_f32 v187, v190, v191
 buffer_store_dwordx4 v[184:187], v246, s[16:19], s7 offen offset:0 sc1
 v_cvt_pk_bf16_f32 v200, v200, v201
 v_cvt_pk_bf16_f32 v201, v202, v203
 v_cvt_pk_bf16_f32 v202, v204, v205
 v_cvt_pk_bf16_f32 v203, v206, v207
 buffer_store_dwordx4 v[200:203], v246, s[16:19], s7 offen offset:512 sc1
 s_branch L1_qdone
L1_v3:
 s_waitcnt lgkmcnt(4)
 v_mfma_f32_32x32x16_bf16 v[144:159], v[0:3], v[208:211], 0
 ds_read_b64_tr_b16 v[224:225], v232 offset:4096
 ds_read_b64_tr_b16 v[226:227], v232 offset:4608
 v_mfma_f32_32x32x16_bf16 v[160:175], v[0:3], v[212:215], 0
 ds_read_b64_tr_b16 v[228:229], v233 offset:4096
 ds_read_b64_tr_b16 v[230:231], v233 offset:4608
 s_waitcnt lgkmcnt(4)
 v_mfma_f32_32x32x16_bf16 v[144:159], v[4:7], v[216:219], v[144:159]
 ds_read_b64_tr_b16 v[208:209], v232 offset:6144
 ds_read_b64_tr_b16 v[210:211], v232 offset:6656
 v_mfma_f32_32x32x16_bf16 v[160:175], v[4:7], v[220:223], v[160:175]
 ds_read_b64_tr_b16 v[212:213], v233 offset:6144
 ds_read_b64_tr_b16 v[214:215], v233 offset:6656
 s_waitcnt lgkmcnt(4)
 v_mfma_f32_32x32x16_bf16 v[144:159], v[8:11], v[224:227], v[144:159]
 ds_read_b64_tr_b16 v[216:217], v232 offset:8192
 ds_read_b64_tr_b16 v[218:219], v232 offset:8704
 s_add_u32 m0, s30, 98304
 s_add_u32 s21, s44, 128
 buffer_load_dwordx4 v238, s[12:15], s21 offen lds
 v_mfma_f32_32x32x16_bf16 v[160:175], v[8:11], v[228:231], v[160:175]
 ds_read_b64_tr_b16 v[220:221], v233 offset:8192
 ds_read_b64_tr_b16 v[222:223], v233 offset:8704
 s_waitcnt lgkmcnt(4)
 v_mfma_f32_32x32x16_bf16 v[144:159], v[12:15], v[208:211], v[144:159]
 ds_read_b64_tr_b16 v[224:225], v232 offset:10240
 ds_read_b64_tr_b16 v[226:227], v232 offset:10752
 v_mfma_f32_32x32x16_bf16 v[160:175], v[12:15], v[212:215], v[160:175]
 ds_read_b64_tr_b16 v[228:229], v233 offset:10240
 ds_read_b64_tr_b16 v[230:231], v233 offset:10752
 s_waitcnt lgkmcnt(4)
 v_mfma_f32_32x32x16_bf16 v[144:159], v[16:19], v[216:219], v[144:159]
 ds_read_b64_tr_b16 v[208:209], v232 offset:12288
 ds_read_b64_tr_b16 v[210:211], v232 offset:12800
 buffer_load_dwordx4 v239, s[12:15], s21 offen offset:1024 lds
 v_mfma_f32_32x32x16_bf16 v[160:175], v[16:19], v[220:223], v[160:175]
 ds_read_b64_tr_b16 v[212:213], v233 offset:12288
 ds_read_b64_tr_b16 v[214:215], v233 offset:12800
 s_waitcnt lgkmcnt(4)
 v_mfma_f32_32x32x16_bf16 v[144:159], v[20:23], v[224:227], v[144:159]
 ds_read_b64_tr_b16 v[216:217], v232 offset:14336
 ds_read_b64_tr_b16 v[218:219], v232 offset:14848
 v_mfma_f32_32x32x16_bf16 v[160:175], v[20:23], v[228:231], v[160:175]
 ds_read_b64_tr_b16 v[220:221], v233 offset:14336
 ds_read_b64_tr_b16 v[222:223], v233 offset:14848
 s_waitcnt lgkmcnt(4)
 v_mfma_f32_32x32x16_bf16 v[144:159], v[24:27], v[208:211], v[144:159]
 ds_read_b64_tr_b16 v[224:225], v232 offset:16384
 ds_read_b64_tr_b16 v[226:227], v232 offset:16896
 s_add_u32 m0, s30, 106496
 s_add_u32 s21, s45, 128
 buffer_load_dwordx4 v238, s[12:15], s21 offen lds
 v_mfma_f32_32x32x16_bf16 v[160:175], v[24:27], v[212:215], v[160:175]
 ds_read_b64_tr_b16 v[228:229], v233 offset:16384
 ds_read_b64_tr_b16 v[230:231], v233 offset:16896
 s_waitcnt lgkmcnt(4)
 v_mfma_f32_32x32x16_bf16 v[144:159], v[28:31], v[216:219], v[144:159]
 ds_read_b64_tr_b16 v[208:209], v232 offset:18432
 ds_read_b64_tr_b16 v[210:211], v232 offset:18944
 v_mfma_f32_32x32x16_bf16 v[160:175], v[28:31], v[220:223], v[160:175]
 ds_read_b64_tr_b16 v[212:213], v233 offset:18432
 ds_read_b64_tr_b16 v[214:215], v233 offset:18944
 s_waitcnt lgkmcnt(4)
 v_mfma_f32_32x32x16_bf16 v[144:159], v[32:35], v[224:227], v[144:159]
 ds_read_b64_tr_b16 v[216:217], v232 offset:20480
 ds_read_b64_tr_b16 v[218:219], v232 offset:20992
 buffer_load_dwordx4 v239, s[12:15], s21 offen offset:1024 lds
 v_mfma_f32_32x32x16_bf16 v[160:175], v[32:35], v[228:231], v[160:175]
 ds_read_b64_tr_b16 v[220:221], v233 offset:20480
 ds_read_b64_tr_b16 v[222:223], v233 offset:20992
 s_waitcnt lgkmcnt(4)
 v_mfma_f32_32x32x16_bf16 v[144:159], v[36:39], v[208:211], v[144:159]
 ds_read_b64_tr_b16 v[224:225], v232 offset:22528
 ds_read_b64_tr_b16 v[226:227], v232 offset:23040
 v_mfma_f32_32x32x16_bf16 v[160:175], v[36:39], v[212:215], v[160:175]
 ds_read_b64_tr_b16 v[228:229], v233 offset:22528
 ds_read_b64_tr_b16 v[230:231], v233 offset:23040
 s_waitcnt vmcnt(20)
 s_barrier
 s_waitcnt lgkmcnt(4)
 v_mfma_f32_32x32x16_bf16 v[144:159], v[40:43], v[216:219], v[144:159]
 ds_read_b64_tr_b16 v[208:209], v232 offset:24576
 ds_read_b64_tr_b16 v[210:211], v232 offset:25088
 s_add_u32 m0, s30, 114688
 s_add_u32 s21, s46, 128
 buffer_load_dwordx4 v238, s[12:15], s21 offen lds
 v_mfma_f32_32x32x16_bf16 v[160:175], v[40:43], v[220:223], v[160:175]
 ds_read_b64_tr_b16 v[212:213], v233 offset:24576
 ds_read_b64_tr_b16 v[214:215], v233 offset:25088
 s_waitcnt lgkmcnt(4)
 v_mfma_f32_32x32x16_bf16 v[144:159], v[44:47], v[224:227], v[144:159]
 ds_read_b64_tr_b16 v[216:217], v232 offset:26624
 ds_read_b64_tr_b16 v[218:219], v232 offset:27136
 v_mfma_f32_32x32x16_bf16 v[160:175], v[44:47], v[228:231], v[160:175]
 ds_read_b64_tr_b16 v[220:221], v233 offset:26624
 ds_read_b64_tr_b16 v[222:223], v233 offset:27136
 s_waitcnt lgkmcnt(4)
 v_mfma_f32_32x32x16_bf16 v[144:159], v[48:51], v[208:211], v[144:159]
 ds_read_b64_tr_b16 v[224:225], v232 offset:28672
 ds_read_b64_tr_b16 v[226:227], v232 offset:29184
 buffer_load_dwordx4 v239, s[12:15], s21 offen offset:1024 lds
 s_waitcnt vmcnt(12)
 v_mfma_f32_32x32x16_bf16 v[160:175], v[48:51], v[212:215], v[160:175]
 ds_read_b64_tr_b16 v[228:229], v233 offset:28672
 ds_read_b64_tr_b16 v[230:231], v233 offset:29184
 s_waitcnt lgkmcnt(4)
 v_mfma_f32_32x32x16_bf16 v[144:159], v[52:55], v[216:219], v[144:159]
 ds_read_b64_tr_b16 v[208:209], v232 offset:30720
 ds_read_b64_tr_b16 v[210:211], v232 offset:31232
 v_mfma_f32_32x32x16_bf16 v[160:175], v[52:55], v[220:223], v[160:175]
 ds_read_b64_tr_b16 v[212:213], v233 offset:30720
 ds_read_b64_tr_b16 v[214:215], v233 offset:31232
 s_mul_i32 s52, s24, 36864
 s_add_u32 s52, s52, 0
 s_waitcnt lgkmcnt(4)
 v_mfma_f32_32x32x16_bf16 v[144:159], v[56:59], v[224:227], v[144:159]
 ds_read_b64_tr_b16 v[216:217], v232 offset:32768
 ds_read_b64_tr_b16 v[218:219], v232 offset:33280
 s_add_u32 m0, s30, 122880
 s_add_u32 s21, s47, 128
 buffer_load_dwordx4 v238, s[12:15], s21 offen lds
 v_mfma_f32_32x32x16_bf16 v[160:175], v[56:59], v[228:231], v[160:175]
 ds_read_b64_tr_b16 v[220:221], v233 offset:32768
 ds_read_b64_tr_b16 v[222:223], v233 offset:33280
 s_waitcnt lgkmcnt(4)
 v_mfma_f32_32x32x16_bf16 v[144:159], v[60:63], v[208:211], v[144:159]
 ds_read_b64_tr_b16 v[224:225], v232 offset:34816
 ds_read_b64_tr_b16 v[226:227], v232 offset:35328
 s_mul_i32 s6, s24, 74240
 s_add_u32 s53, s6, 2322432
 s_add_u32 s6, s6, 2396160
 v_mfma_f32_32x32x16_bf16 v[160:175], v[60:63], v[212:215], v[160:175]
 ds_read_b64_tr_b16 v[228:229], v233 offset:34816
 ds_read_b64_tr_b16 v[230:231], v233 offset:35328
 s_waitcnt lgkmcnt(4)
 v_mfma_f32_32x32x16_bf16 v[144:159], v[64:67], v[216:219], v[144:159]
 ds_read_b64_tr_b16 v[208:209], v232 offset:36864
 ds_read_b64_tr_b16 v[210:211], v232 offset:37376
 buffer_load_dwordx4 v239, s[12:15], s21 offen offset:1024 lds
 v_mfma_f32_32x32x16_bf16 v[160:175], v[64:67], v[220:223], v[160:175]
 ds_read_b64_tr_b16 v[212:213], v233 offset:36864
 ds_read_b64_tr_b16 v[214:215], v233 offset:37376
 v_mul_u32_u24 v245, 9344, v244
 s_waitcnt lgkmcnt(4)
 v_mfma_f32_32x32x16_bf16 v[144:159], v[68:71], v[224:227], v[144:159]
 ds_read_b64_tr_b16 v[216:217], v232 offset:38912
 ds_read_b64_tr_b16 v[218:219], v232 offset:39424
 v_mfma_f32_32x32x16_bf16 v[160:175], v[68:71], v[228:231], v[160:175]
 ds_read_b64_tr_b16 v[220:221], v233 offset:38912
 ds_read_b64_tr_b16 v[222:223], v233 offset:39424
 s_waitcnt lgkmcnt(4)
 v_mfma_f32_32x32x16_bf16 v[144:159], v[72:75], v[208:211], v[144:159]
 ds_read_b64_tr_b16 v[224:225], v232 offset:40960
 ds_read_b64_tr_b16 v[226:227], v232 offset:41472
 s_add_u32 m0, s30, 131072
 s_add_u32 s21, s48, 128
 buffer_load_dwordx4 v238, s[12:15], s21 offen lds
 v_add_u32 v245, v245, v243
 v_mfma_f32_32x32x16_bf16 v[160:175], v[72:75], v[212:215], v[160:175]
 ds_read_b64_tr_b16 v[228:229], v233 offset:40960
 ds_read_b64_tr_b16 v[230:231], v233 offset:41472
 s_waitcnt lgkmcnt(4)
 v_mfma_f32_32x32x16_bf16 v[144:159], v[76:79], v[216:219], v[144:159]
 ds_read_b64_tr_b16 v[208:209], v232 offset:43008
 ds_read_b64_tr_b16 v[210:211], v232 offset:43520
 v_mfma_f32_32x32x16_bf16 v[160:175], v[76:79], v[220:223], v[160:175]
 ds_read_b64_tr_b16 v[212:213], v233 offset:43008
 ds_read_b64_tr_b16 v[214:215], v233 offset:43520
 v_add_u32 v246, 18688, v245
 s_waitcnt lgkmcnt(4)
 v_mfma_f32_32x32x16_bf16 v[144:159], v[80:83], v[224:227], v[144:159]
 ds_read_b64_tr_b16 v[216:217], v232 offset:45056
 ds_read_b64_tr_b16 v[218:219], v232 offset:45568
 buffer_load_dwordx4 v239, s[12:15], s21 offen offset:1024 lds
 v_mfma_f32_32x32x16_bf16 v[160:175], v[80:83], v[228:231], v[160:175]
 ds_read_b64_tr_b16 v[220:221], v233 offset:45056
 ds_read_b64_tr_b16 v[222:223], v233 offset:45568
 s_waitcnt lgkmcnt(4)
 v_mfma_f32_32x32x16_bf16 v[144:159], v[84:87], v[208:211], v[144:159]
 ds_read_b64_tr_b16 v[224:225], v232 offset:47104
 ds_read_b64_tr_b16 v[226:227], v232 offset:47616
 v_mov_b32 v248, 0x3f803f80
 v_mfma_f32_32x32x16_bf16 v[160:175], v[84:87], v[212:215], v[160:175]
 ds_read_b64_tr_b16 v[228:229], v233 offset:47104
 ds_read_b64_tr_b16 v[230:231], v233 offset:47616
 s_waitcnt vmcnt(20)
 s_barrier
 s_waitcnt lgkmcnt(4)
 v_mfma_f32_32x32x16_bf16 v[144:159], v[88:91], v[216:219], v[144:159]
 ds_read_b64_tr_b16 v[208:209], v234 offset:0
 ds_read_b64_tr_b16 v[210:211], v234 offset:512
 s_add_u32 m0, s30, 139264
 s_add_u32 s21, s49, 128
 buffer_load_dwordx4 v238, s[12:15], s21 offen lds
 v_mfma_f32_32x32x16_bf16 v[160:175], v[88:91], v[220:223], v[160:175]
 ds_read_b64_tr_b16 v[212:213], v235 offset:0
 ds_read_b64_tr_b16 v[214:215], v235 offset:512
 s_waitcnt lgkmcnt(4)
 v_mfma_f32_32x32x16_bf16 v[144:159], v[92:95], v[224:227], v[144:159]
 ds_read_b64_tr_b16 v[216:217], v234 offset:2048
 ds_read_b64_tr_b16 v[218:219], v234 offset:2560
 v_mfma_f32_32x32x16_bf16 v[160:175], v[92:95], v[228:231], v[160:175]
 ds_read_b64_tr_b16 v[220:221], v235 offset:2048
 ds_read_b64_tr_b16 v[222:223], v235 offset:2560
 v_mov_b32 v249, 0x3f803f80
 s_waitcnt lgkmcnt(4)
 v_mfma_f32_32x32x16_bf16 v[144:159], v[96:99], v[208:211], v[144:159]
 ds_read_b64_tr_b16 v[224:225], v234 offset:4096
 ds_read_b64_tr_b16 v[226:227], v234 offset:4608
 buffer_load_dwordx4 v239, s[12:15], s21 offen offset:1024 lds
 v_mfma_f32_32x32x16_bf16 v[160:175], v[96:99], v[212:215], v[160:175]
 ds_read_b64_tr_b16 v[228:229], v235 offset:4096
 ds_read_b64_tr_b16 v[230:231], v235 offset:4608
 s_waitcnt lgkmcnt(4)
 v_mfma_f32_32x32x16_bf16 v[144:159], v[100:103], v[216:219], v[144:159]
 ds_read_b64_tr_b16 v[208:209], v234 offset:6144
 ds_read_b64_tr_b16 v[210:211], v234 offset:6656
 v_mov_b32 v250, 0x3f803f80
 v_mfma_f32_32x32x16_bf16 v[160:175], v[100:103], v[220:223], v[160:175]
 ds_read_b64_tr_b16 v[212:213], v235 offset:6144
 ds_read_b64_tr_b16 v[214:215], v235 offset:6656
 s_waitcnt lgkmcnt(4)
 v_mfma_f32_32x32x16_bf16 v[144:159], v[104:107], v[224:227], v[144:159]
 ds_read_b64_tr_b16 v[216:217], v234 offset:8192
 ds_read_b64_tr_b16 v[218:219], v234 offset:8704
 s_add_u32 m0, s30, 0
 s_add_u32 s21, s41, 256
 buffer_load_dwordx4 v238, s[12:15], s21 offen lds
 v_mfma_f32_32x32x16_bf16 v[160:175], v[104:107], v[228:231], v[160:175]
 ds_read_b64_tr_b16 v[220:221], v235 offset:8192
 ds_read_b64_tr_b16 v[222:223], v235 offset:8704
 v_mov_b32 v251, 0x3f803f80
 s_waitcnt lgkmcnt(4)
 v_mfma_f32_32x32x16_bf16 v[144:159], v[108:111], v[208:211], v[144:159]
 ds_read_b64_tr_b16 v[224:225], v234 offset:10240
 ds_read_b64_tr_b16 v[226:227], v234 offset:10752
 v_mfma_f32_32x32x16_bf16 v[160:175], v[108:111], v[212:215], v[160:175]
 ds_read_b64_tr_b16 v[228:229], v235 offset:10240
 ds_read_b64_tr_b16 v[230:231], v235 offset:10752
 s_waitcnt lgkmcnt(4)
 v_mfma_f32_32x32x16_bf16 v[144:159], v[112:115], v[216:219], v[144:159]
 ds_read_b64_tr_b16 v[208:209], v234 offset:12288
 ds_read_b64_tr_b16 v[210:211], v234 offset:12800
 buffer_load_dwordx4 v239, s[12:15], s21 offen offset:1024 lds
 v_mul_u32_u24 v252, 9344, v255
 v_mfma_f32_32x32x16_bf16 v[160:175], v[112:115], v[220:223], v[160:175]
 ds_read_b64_tr_b16 v[212:213], v235 offset:12288
 ds_read_b64_tr_b16 v[214:215], v235 offset:12800
 s_waitcnt lgkmcnt(4)
 v_mfma_f32_32x32x16_bf16 v[144:159], v[116:119], v[224:227], v[144:159]
 ds_read_b64_tr_b16 v[216:217], v234 offset:14336
 ds_read_b64_tr_b16 v[218:219], v234 offset:14848
 v_mfma_f32_32x32x16_bf16 v[160:175], v[116:119], v[228:231], v[160:175]
 ds_read_b64_tr_b16 v[220:221], v235 offset:14336
 ds_read_b64_tr_b16 v[222:223], v235 offset:14848
 v_add_u32 v252, 9216, v252
 s_waitcnt lgkmcnt(4)
 v_mfma_f32_32x32x16_bf16 v[144:159], v[120:123], v[208:211], v[144:159]
 ds_read_b64_tr_b16 v[224:225], v234 offset:16384
 ds_read_b64_tr_b16 v[226:227], v234 offset:16896
 s_add_u32 m0, s30, 8192
 s_add_u32 s21, s42, 256
 buffer_load_dwordx4 v238, s[12:15], s21 offen lds
 v_mfma_f32_32x32x16_bf16 v[160:175], v[120:123], v[212:215], v[160:175]
 ds_read_b64_tr_b16 v[228:229], v235 offset:16384
 ds_read_b64_tr_b16 v[230:231], v235 offset:16896
 s_waitcnt lgkmcnt(4)
 v_mfma_f32_32x32x16_bf16 v[144:159], v[124:127], v[216:219], v[144:159]
 ds_read_b64_tr_b16 v[208:209], v234 offset:18432
 ds_read_b64_tr_b16 v[210:211], v234 offset:18944
 v_cmp_gt_u32 vcc, 4, v255
 v_mov_b32 v253, 0x40000000
 s_nop 0
 v_cndmask_b32 v252, v253, v252, vcc
 v_mfma_f32_32x32x16_bf16 v[160:175], v[124:127], v[220:223], v[160:175]
 ds_read_b64_tr_b16 v[212:213], v235 offset:18432
 ds_read_b64_tr_b16 v[214:215], v235 offset:18944
 s_waitcnt lgkmcnt(4)
 v_mfma_f32_32x32x16_bf16 v[144:159], v[128:131], v[224:227], v[144:159]
 ds_read_b64_tr_b16 v[216:217], v234 offset:20480
 ds_read_b64_tr_b16 v[218:219], v234 offset:20992
 buffer_load_dwordx4 v239, s[12:15], s21 offen offset:1024 lds
 v_mfma_f32_32x32x16_bf16 v[160:175], v[128:131], v[228:231], v[160:175]
 ds_read_b64_tr_b16 v[220:221], v235 offset:20480
 ds_read_b64_tr_b16 v[222:223], v235 offset:20992
 buffer_store_dwordx4 v[248:251], v252, s[16:19], s6 offen sc1
 s_waitcnt lgkmcnt(4)
 v_mfma_f32_32x32x16_bf16 v[144:159], v[132:135], v[208:211], v[144:159]
 ds_read_b64_tr_b16 v[224:225], v234 offset:22528
 ds_read_b64_tr_b16 v[226:227], v234 offset:23040
 v_mfma_f32_32x32x16_bf16 v[160:175], v[132:135], v[212:215], v[160:175]
 ds_read_b64_tr_b16 v[228:229], v235 offset:22528
 ds_read_b64_tr_b16 v[230:231], v235 offset:23040
 s_waitcnt vmcnt(17)
 s_barrier
 s_waitcnt lgkmcnt(4)
 v_mfma_f32_32x32x16_bf16 v[144:159], v[136:139], v[216:219], v[144:159]
 ds_read_b64_tr_b16 v[208:209], v234 offset:24576
 ds_read_b64_tr_b16 v[210:211], v234 offset:25088
 s_add_u32 m0, s30, 16384
 s_add_u32 s21, s43, 256
 buffer_load_dwordx4 v238, s[12:15], s21 offen lds
 v_mfma_f32_32x32x16_bf16 v[160:175], v[136:139], v[220:223], v[160:175]
 ds_read_b64_tr_b16 v[212:213], v235 offset:24576
 ds_read_b64_tr_b16 v[214:215], v235 offset:25088
 s_waitcnt lgkmcnt(4)
 v_mfma_f32_32x32x16_bf16 v[144:159], v[140:143], v[224:227], v[144:159]
 ds_read_b64_tr_b16 v[216:217], v234 offset:26624
 ds_read_b64_tr_b16 v[218:219], v234 offset:27136
 v_mfma_f32_32x32x16_bf16 v[160:175], v[140:143], v[228:231], v[160:175]
 ds_read_b64_tr_b16 v[220:221], v235 offset:26624
 ds_read_b64_tr_b16 v[222:223], v235 offset:27136
 s_waitcnt lgkmcnt(4)
 v_mfma_f32_32x32x16_bf16 v[176:191], v[0:3], v[208:211], 0
 ds_read_b64_tr_b16 v[224:225], v234 offset:28672
 ds_read_b64_tr_b16 v[226:227], v234 offset:29184
 buffer_load_dwordx4 v239, s[12:15], s21 offen offset:1024 lds
 v_mfma_f32_32x32x16_bf16 v[192:207], v[0:3], v[212:215], 0
 ds_read_b64_tr_b16 v[228:229], v235 offset:28672
 ds_read_b64_tr_b16 v[230:231], v235 offset:29184
 s_waitcnt lgkmcnt(4)
 v_mfma_f32_32x32x16_bf16 v[176:191], v[4:7], v[216:219], v[176:191]
 ds_read_b64_tr_b16 v[208:209], v234 offset:30720
 ds_read_b64_tr_b16 v[210:211], v234 offset:31232
 v_mfma_f32_32x32x16_bf16 v[192:207], v[4:7], v[220:223], v[192:207]
 ds_read_b64_tr_b16 v[212:213], v235 offset:30720
 ds_read_b64_tr_b16 v[214:215], v235 offset:31232
 s_waitcnt lgkmcnt(4)
 v_mfma_f32_32x32x16_bf16 v[176:191], v[8:11], v[224:227], v[176:191]
 ds_read_b64_tr_b16 v[216:217], v234 offset:32768
 ds_read_b64_tr_b16 v[218:219], v234 offset:33280
 s_add_u32 m0, s30, 24576
 s_add_u32 s21, s44, 256
 buffer_load_dwordx4 v238, s[12:15], s21 offen lds
 s_add_u32 s7, s6, 6144
 ds_read_b128 v[248:251], v247 offset:0
 v_mfma_f32_32x32x16_bf16 v[192:207], v[8:11], v[228:231], v[192:207]
 ds_read_b64_tr_b16 v[220:221], v235 offset:32768
 ds_read_b64_tr_b16 v[222:223], v235 offset:33280
 s_nop 0
 s_waitcnt lgkmcnt(5)
 v_mfma_f32_32x32x16_bf16 v[176:191], v[12:15], v[208:211], v[176:191]
 ds_read_b64_tr_b16 v[224:225], v234 offset:34816
 ds_read_b64_tr_b16 v[226:227], v234 offset:35328
 s_nop 0
 v_mfma_f32_32x32x16_bf16 v[192:207], v[12:15], v[212:215], v[192:207]
 ds_read_b64_tr_b16 v[228:229], v235 offset:34816
 ds_read_b64_tr_b16 v[230:231], v235 offset:35328
 s_waitcnt lgkmcnt(6)
 s_waitcnt lgkmcnt(4)
 v_mfma_f32_32x32x16_bf16 v[176:191], v[16:19], v[216:219], v[176:191]
 ds_read_b64_tr_b16 v[208:209], v234 offset:36864
 ds_read_b64_tr_b16 v[210:211], v234 offset:37376
 buffer_load_dwordx4 v239, s[12:15], s21 offen offset:1024 lds
 v_mul_f32 v144, v248, v144
 v_mfma_f32_32x32x16_bf16 v[192:207], v[16:19], v[220:223], v[192:207]
 ds_read_b64_tr_b16 v[212:213], v235 offset:36864
 ds_read_b64_tr_b16 v[214:215], v235 offset:37376
 v_mul_f32 v145, v249, v145
 s_waitcnt lgkmcnt(4)
 v_mfma_f32_32x32x16_bf16 v[176:191], v[20:23], v[224:227], v[176:191]
 ds_read_b64_tr_b16 v[216:217], v234 offset:38912
 ds_read_b64_tr_b16 v[218:219], v234 offset:39424
 v_mul_f32 v146, v250, v146
 v_mfma_f32_32x32x16_bf16 v[192:207], v[20:23], v[228:231], v[192:207]
 ds_read_b64_tr_b16 v[220:221], v235 offset:38912
 ds_read_b64_tr_b16 v[222:223], v235 offset:39424
 v_mul_f32 v147, v251, v147
 s_waitcnt lgkmcnt(4)
 v_mfma_f32_32x32x16_bf16 v[176:191], v[24:27], v[208:211], v[176:191]
 ds_read_b64_tr_b16 v[224:225], v234 offset:40960
 ds_read_b64_tr_b16 v[226:227], v234 offset:41472
 s_add_u32 m0, s30, 32768
 s_add_u32 s21, s45, 256
 buffer_load_dwordx4 v238, s[12:15], s21 offen lds
 v_mul_f32 v160, v248, v160
 v_mfma_f32_32x32x16_bf16 v[192:207], v[24:27], v[212:215], v[192:207]
 ds_read_b64_tr_b16 v[228:229], v235 offset:40960
 ds_read_b64_tr_b16 v[230:231], v235 offset:41472
 v_mul_f32 v161, v249, v161
 s_waitcnt lgkmcnt(4)
 v_mfma_f32_32x32x16_bf16 v[176:191], v[28:31], v[216:219], v[176:191]
 ds_read_b64_tr_b16 v[208:209], v234 offset:43008
 ds_read_b64_tr_b16 v[210:211], v234 offset:43520
 v_mul_f32 v162, v250, v162
 v_mfma_f32_32x32x16_bf16 v[192:207], v[28:31], v[220:223], v[192:207]
 ds_read_b64_tr_b16 v[212:213], v235 offset:43008
 ds_read_b64_tr_b16 v[214:215], v235 offset:43520
 v_mul_f32 v163, v251, v163
 s_waitcnt lgkmcnt(4)
 v_mfma_f32_32x32x16_bf16 v[176:191], v[32:35], v[224:227], v[176:191]
 ds_read_b64_tr_b16 v[216:217], v234 offset:45056
 ds_read_b64_tr_b16 v[218:219], v234 offset:45568
 buffer_load_dwordx4 v239, s[12:15], s21 offen offset:1024 lds
 ds_read_b128 v[248:251], v247 offset:32
 v_mfma_f32_32x32x16_bf16 v[192:207], v[32:35], v[228:231], v[192:207]
 ds_read_b64_tr_b16 v[220:221], v235 offset:45056
 ds_read_b64_tr_b16 v[222:223], v235 offset:45568
 s_nop 0
 s_waitcnt lgkmcnt(5)
 v_mfma_f32_32x32x16_bf16 v[176:191], v[36:39], v[208:211], v[176:191]
 ds_read_b64_tr_b16 v[224:225], v234 offset:47104
 ds_read_b64_tr_b16 v[226:227], v234 offset:47616
 s_nop 0
 v_mfma_f32_32x32x16_bf16 v[192:207], v[36:39], v[212:215], v[192:207]
 ds_read_b64_tr_b16 v[228:229], v235 offset:47104
 ds_read_b64_tr_b16 v[230:231], v235 offset:47616
 s_waitcnt vmcnt(17)
 s_barrier
 s_waitcnt lgkmcnt(4)
 v_mfma_f32_32x32x16_bf16 v[176:191], v[40:43], v[216:219], v[176:191]
 ds_read_b64_tr_b16 v[208:209], v236 offset:0
 ds_read_b64_tr_b16 v[210:211], v236 offset:512
 s_add_u32 m0, s30, 40960
 s_add_u32 s21, s46, 256
 buffer_load_dwordx4 v238, s[12:15], s21 offen lds
 s_waitcnt lgkmcnt(8)
 v_mfma_f32_32x32x16_bf16 v[192:207], v[40:43], v[220:223], v[192:207]
 ds_read_b64_tr_b16 v[212:213], v237 offset:0
 ds_read_b64_tr_b16 v[214:215], v237 offset:512
 v_mul_f32 v148, v248, v148
 v_mul_f32 v149, v249, v149
 s_waitcnt lgkmcnt(4)
 v_mfma_f32_32x32x16_bf16 v[176:191], v[44:47], v[224:227], v[176:191]
 ds_read_b64_tr_b16 v[216:217], v236 offset:2048
 ds_read_b64_tr_b16 v[218:219], v236 offset:2560
 v_mul_f32 v150, v250, v150
 v_mfma_f32_32x32x16_bf16 v[192:207], v[44:47], v[228:231], v[192:207]
 ds_read_b64_tr_b16 v[220:221], v237 offset:2048
 ds_read_b64_tr_b16 v[222:223], v237 offset:2560
 v_mul_f32 v151, v251, v151
 s_waitcnt lgkmcnt(4)
 v_mfma_f32_32x32x16_bf16 v[176:191], v[48:51], v[208:211], v[176:191]
 ds_read_b64_tr_b16 v[224:225], v236 offset:4096
 ds_read_b64_tr_b16 v[226:227], v236 offset:4608
 buffer_load_dwordx4 v239, s[12:15], s21 offen offset:1024 lds
 v_mul_f32 v164, v248, v164
 v_mfma_f32_32x32x16_bf16 v[192:207], v[48:51], v[212:215], v[192:207]
 ds_read_b64_tr_b16 v[228:229], v237 offset:4096
 ds_read_b64_tr_b16 v[230:231], v237 offset:4608
 v_mul_f32 v165, v249, v165
 s_waitcnt lgkmcnt(4)
 v_mfma_f32_32x32x16_bf16 v[176:191], v[52:55], v[216:219], v[176:191]
 ds_read_b64_tr_b16 v[208:209], v236 offset:6144
 ds_read_b64_tr_b16 v[210:211], v236 offset:6656
 v_mul_f32 v166, v250, v166
 v_mfma_f32_32x32x16_bf16 v[192:207], v[52:55], v[220:223], v[192:207]
 ds_read_b64_tr_b16 v[212:213], v237 offset:6144
 ds_read_b64_tr_b16 v[214:215], v237 offset:6656
 v_mul_f32 v167, v251, v167
 s_waitcnt lgkmcnt(4)
 v_mfma_f32_32x32x16_bf16 v[176:191], v[56:59], v[224:227], v[176:191]
 ds_read_b64_tr_b16 v[216:217], v236 offset:8192
 ds_read_b64_tr_b16 v[218:219], v236 offset:8704
 s_add_u32 m0, s30, 49152
 s_add_u32 s21, s47, 256
 buffer_load_dwordx4 v238, s[12:15], s21 offen lds
 v_cvt_pk_bf16_f32 v144, v144, v145
 v_mfma_f32_32x32x16_bf16 v[192:207], v[56:59], v[228:231], v[192:207]
 ds_read_b64_tr_b16 v[220:221], v237 offset:8192
 ds_read_b64_tr_b16 v[222:223], v237 offset:8704
 v_cvt_pk_bf16_f32 v145, v146, v147
 s_waitcnt lgkmcnt(4)
 v_mfma_f32_32x32x16_bf16 v[176:191], v[60:63], v[208:211], v[176:191]
 ds_read_b64_tr_b16 v[224:225], v236 offset:10240
 ds_read_b64_tr_b16 v[226:227], v236 offset:10752
 v_cvt_pk_bf16_f32 v146, v148, v149
 v_mfma_f32_32x32x16_bf16 v[192:207], v[60:63], v[212:215], v[192:207]
 ds_read_b64_tr_b16 v[228:229], v237 offset:10240
 ds_read_b64_tr_b16 v[230:231], v237 offset:10752
 v_cvt_pk_bf16_f32 v147, v150, v151
 s_waitcnt lgkmcnt(4)
 v_mfma_f32_32x32x16_bf16 v[176:191], v[64:67], v[216:219], v[176:191]
 ds_read_b64_tr_b16 v[208:209], v236 offset:12288
 ds_read_b64_tr_b16 v[210:211], v236 offset:12800
 buffer_load_dwordx4 v239, s[12:15], s21 offen offset:1024 lds
 buffer_store_dwordx4 v[144:147], v245, s[16:19], s7 offen offset:0 sc1
 v_mfma_f32_32x32x16_bf16 v[192:207], v[64:67], v[220:223], v[192:207]
 ds_read_b64_tr_b16 v[212:213], v237 offset:12288
 ds_read_b64_tr_b16 v[214:215], v237 offset:12800
 v_cvt_pk_bf16_f32 v160, v160, v161
 s_waitcnt lgkmcnt(4)
 v_mfma_f32_32x32x16_bf16 v[176:191], v[68:71], v[224:227], v[176:191]
 ds_read_b64_tr_b16 v[216:217], v236 offset:14336
 ds_read_b64_tr_b16 v[218:219], v236 offset:14848
 v_cvt_pk_bf16_f32 v161, v162, v163
 v_mfma_f32_32x32x16_bf16 v[192:207], v[68:71], v[228:231], v[192:207]
 ds_read_b64_tr_b16 v[220:221], v237 offset:14336
 ds_read_b64_tr_b16 v[222:223], v237 offset:14848
 v_cvt_pk_bf16_f32 v162, v164, v165
 s_waitcnt lgkmcnt(4)
 v_mfma_f32_32x32x16_bf16 v[176:191], v[72:75], v[208:211], v[176:191]
 ds_read_b64_tr_b16 v[224:225], v236 offset:16384
 ds_read_b64_tr_b16 v[226:227], v236 offset:16896
 s_add_u32 m0, s30, 57344
 s_add_u32 s21, s48, 256
 buffer_load_dwordx4 v238, s[12:15], s21 offen lds
 v_cvt_pk_bf16_f32 v163, v166, v167
 v_mfma_f32_32x32x16_bf16 v[192:207], v[72:75], v[212:215], v[192:207]
 ds_read_b64_tr_b16 v[228:229], v237 offset:16384
 ds_read_b64_tr_b16 v[230:231], v237 offset:16896
 buffer_store_dwordx4 v[160:163], v245, s[16:19], s7 offen offset:512 sc1
 ds_read_b128 v[248:251], v247 offset:64
 s_waitcnt lgkmcnt(5)
 v_mfma_f32_32x32x16_bf16 v[176:191], v[76:79], v[216:219], v[176:191]
 ds_read_b64_tr_b16 v[208:209], v236 offset:18432
 ds_read_b64_tr_b16 v[210:211], v236 offset:18944
 s_nop 0
 v_mfma_f32_32x32x16_bf16 v[192:207], v[76:79], v[220:223], v[192:207]
 ds_read_b64_tr_b16 v[212:213], v237 offset:18432
 ds_read_b64_tr_b16 v[214:215], v237 offset:18944
 s_nop 0
 s_waitcnt lgkmcnt(5)
 v_mfma_f32_32x32x16_bf16 v[176:191], v[80:83], v[224:227], v[176:191]
 ds_read_b64_tr_b16 v[216:217], v236 offset:20480
 ds_read_b64_tr_b16 v[218:219], v236 offset:20992
 buffer_load_dwordx4 v239, s[12:15], s21 offen offset:1024 lds
 s_waitcnt lgkmcnt(6)
 v_mfma_f32_32x32x16_bf16 v[192:207], v[80:83], v[228:231], v[192:207]
 ds_read_b64_tr_b16 v[220:221], v237 offset:20480
 ds_read_b64_tr_b16 v[222:223], v237 offset:20992
 v_mul_f32 v152, v248, v152
 s_waitcnt lgkmcnt(4)
 v_mfma_f32_32x32x16_bf16 v[176:191], v[84:87], v[208:211], v[176:191]
 ds_read_b64_tr_b16 v[224:225], v236 offset:22528
 ds_read_b64_tr_b16 v[226:227], v236 offset:23040
 v_mul_f32 v153, v249, v153
 v_mfma_f32_32x32x16_bf16 v[192:207], v[84:87], v[212:215], v[192:207]
 ds_read_b64_tr_b16 v[228:229], v237 offset:22528
 ds_read_b64_tr_b16 v[230:231], v237 offset:23040
 s_waitcnt vmcnt(19)
 s_barrier
 s_waitcnt lgkmcnt(4)
 v_mfma_f32_32x32x16_bf16 v[176:191], v[88:91], v[216:219], v[176:191]
 ds_read_b64_tr_b16 v[208:209], v236 offset:24576
 ds_read_b64_tr_b16 v[210:211], v236 offset:25088
 s_add_u32 m0, s30, 65536
 s_add_u32 s21, s49, 256
 buffer_load_dwordx4 v238, s[12:15], s21 offen lds
 v_mul_f32 v154, v250, v154
 v_mfma_f32_32x32x16_bf16 v[192:207], v[88:91], v[220:223], v[192:207]
 ds_read_b64_tr_b16 v[212:213], v237 offset:24576
 ds_read_b64_tr_b16 v[214:215], v237 offset:25088
 v_mul_f32 v155, v251, v155
 s_waitcnt lgkmcnt(4)
 v_mfma_f32_32x32x16_bf16 v[176:191], v[92:95], v[224:227], v[176:191]
 ds_read_b64_tr_b16 v[216:217], v236 offset:26624
 ds_read_b64_tr_b16 v[218:219], v236 offset:27136
 v_mul_f32 v168, v248, v168
 v_mfma_f32_32x32x16_bf16 v[192:207], v[92:95], v[228:231], v[192:207]
 ds_read_b64_tr_b16 v[220:221], v237 offset:26624
 ds_read_b64_tr_b16 v[222:223], v237 offset:27136
 v_mul_f32 v169, v249, v169
 s_waitcnt lgkmcnt(4)
 v_mfma_f32_32x32x16_bf16 v[176:191], v[96:99], v[208:211], v[176:191]
 ds_read_b64_tr_b16 v[224:225], v236 offset:28672
 ds_read_b64_tr_b16 v[226:227], v236 offset:29184
 buffer_load_dwordx4 v239, s[12:15], s21 offen offset:1024 lds
 v_mul_f32 v170, v250, v170
 v_mfma_f32_32x32x16_bf16 v[192:207], v[96:99], v[212:215], v[192:207]
 ds_read_b64_tr_b16 v[228:229], v237 offset:28672
 ds_read_b64_tr_b16 v[230:231], v237 offset:29184
 v_mul_f32 v171, v251, v171
 s_waitcnt lgkmcnt(4)
 v_mfma_f32_32x32x16_bf16 v[176:191], v[100:103], v[216:219], v[176:191]
 ds_read_b64_tr_b16 v[208:209], v236 offset:30720
 ds_read_b64_tr_b16 v[210:211], v236 offset:31232
 ds_read_b128 v[248:251], v247 offset:96
 v_mfma_f32_32x32x16_bf16 v[192:207], v[100:103], v[220:223], v[192:207]
 ds_read_b64_tr_b16 v[212:213], v237 offset:30720
 ds_read_b64_tr_b16 v[214:215], v237 offset:31232
 s_nop 0
 s_waitcnt lgkmcnt(5)
 v_mfma_f32_32x32x16_bf16 v[176:191], v[104:107], v[224:227], v[176:191]
 ds_read_b64_tr_b16 v[216:217], v236 offset:32768
 ds_read_b64_tr_b16 v[218:219], v236 offset:33280
 s_nop 0
 v_mfma_f32_32x32x16_bf16 v[192:207], v[104:107], v[228:231], v[192:207]
 ds_read_b64_tr_b16 v[220:221], v237 offset:32768
 ds_read_b64_tr_b16 v[222:223], v237 offset:33280
 s_waitcnt lgkmcnt(6)
 s_waitcnt lgkmcnt(4)
 v_mfma_f32_32x32x16_bf16 v[176:191], v[108:111], v[208:211], v[176:191]
 ds_read_b64_tr_b16 v[224:225], v236 offset:34816
 ds_read_b64_tr_b16 v[226:227], v236 offset:35328
 v_mul_f32 v156, v248, v156
 v_mul_f32 v157, v249, v157
 v_mfma_f32_32x32x16_bf16 v[192:207], v[108:111], v[212:215], v[192:207]
 ds_read_b64_tr_b16 v[228:229], v237 offset:34816
 ds_read_b64_tr_b16 v[230:231], v237 offset:35328
 v_mul_f32 v158, v250, v158
 s_waitcnt lgkmcnt(4)
 v_mfma_f32_32x32x16_bf16 v[176:191], v[112:115], v[216:219], v[176:191]
 ds_read_b64_tr_b16 v[208:209], v236 offset:36864
 ds_read_b64_tr_b16 v[210:211], v236 offset:37376
 v_mul_f32 v159, v251, v159
 v_mfma_f32_32x32x16_bf16 v[192:207], v[112:115], v[220:223], v[192:207]
 ds_read_b64_tr_b16 v[212:213], v237 offset:36864
 ds_read_b64_tr_b16 v[214:215], v237 offset:37376
 v_mul_f32 v172, v248, v172
 s_waitcnt lgkmcnt(4)
 v_mfma_f32_32x32x16_bf16 v[176:191], v[116:119], v[224:227], v[176:191]
 ds_read_b64_tr_b16 v[216:217], v236 offset:38912
 ds_read_b64_tr_b16 v[218:219], v236 offset:39424
 v_mul_f32 v173, v249, v173
 v_mfma_f32_32x32x16_bf16 v[192:207], v[116:119], v[228:231], v[192:207]
 ds_read_b64_tr_b16 v[220:221], v237 offset:38912
 ds_read_b64_tr_b16 v[222:223], v237 offset:39424
 v_mul_f32 v174, v250, v174
 s_waitcnt lgkmcnt(4)
 v_mfma_f32_32x32x16_bf16 v[176:191], v[120:123], v[208:211], v[176:191]
 ds_read_b64_tr_b16 v[224:225], v236 offset:40960
 ds_read_b64_tr_b16 v[226:227], v236 offset:41472
 v_mul_f32 v175, v251, v175
 v_mfma_f32_32x32x16_bf16 v[192:207], v[120:123], v[212:215], v[192:207]
 ds_read_b64_tr_b16 v[228:229], v237 offset:40960
 ds_read_b64_tr_b16 v[230:231], v237 offset:41472
 v_cvt_pk_bf16_f32 v152, v152, v153
 s_waitcnt lgkmcnt(4)
 v_mfma_f32_32x32x16_bf16 v[176:191], v[124:127], v[216:219], v[176:191]
 ds_read_b64_tr_b16 v[208:209], v236 offset:43008
 ds_read_b64_tr_b16 v[210:211], v236 offset:43520
 v_cvt_pk_bf16_f32 v153, v154, v155
 v_mfma_f32_32x32x16_bf16 v[192:207], v[124:127], v[220:223], v[192:207]
 ds_read_b64_tr_b16 v[212:213], v237 offset:43008
 ds_read_b64_tr_b16 v[214:215], v237 offset:43520
 v_cvt_pk_bf16_f32 v154, v156, v157
 s_waitcnt lgkmcnt(4)
 v_mfma_f32_32x32x16_bf16 v[176:191], v[128:131], v[224:227], v[176:191]
 ds_read_b64_tr_b16 v[216:217], v236 offset:45056
 ds_read_b64_tr_b16 v[218:219], v236 offset:45568
 v_cvt_pk_bf16_f32 v155, v158, v159
 v_mfma_f32_32x32x16_bf16 v[192:207], v[128:131], v[228:231], v[192:207]
 ds_read_b64_tr_b16 v[220:221], v237 offset:45056
 ds_read_b64_tr_b16 v[222:223], v237 offset:45568
 buffer_store_dwordx4 v[152:155], v246, s[16:19], s7 offen offset:0 sc1
 s_waitcnt lgkmcnt(4)
 v_mfma_f32_32x32x16_bf16 v[176:191], v[132:135], v[208:211], v[176:191]
 ds_read_b64_tr_b16 v[224:225], v236 offset:47104
 ds_read_b64_tr_b16 v[226:227], v236 offset:47616
 v_cvt_pk_bf16_f32 v168, v168, v169
 v_mfma_f32_32x32x16_bf16 v[192:207], v[132:135], v[212:215], v[192:207]
 ds_read_b64_tr_b16 v[228:229], v237 offset:47104
 ds_read_b64_tr_b16 v[230:231], v237 offset:47616
 s_waitcnt vmcnt(15)
 s_barrier
 s_waitcnt lgkmcnt(4)
 v_mfma_f32_32x32x16_bf16 v[176:191], v[136:139], v[216:219], v[176:191]
 ds_read_b64_tr_b16 v[208:209], v232 offset:0
 ds_read_b64_tr_b16 v[210:211], v232 offset:512
 v_cvt_pk_bf16_f32 v169, v170, v171
 v_mfma_f32_32x32x16_bf16 v[192:207], v[136:139], v[220:223], v[192:207]
 ds_read_b64_tr_b16 v[212:213], v233 offset:0
 ds_read_b64_tr_b16 v[214:215], v233 offset:512
 v_cvt_pk_bf16_f32 v170, v172, v173
 s_waitcnt lgkmcnt(4)
 v_mfma_f32_32x32x16_bf16 v[176:191], v[140:143], v[224:227], v[176:191]
 ds_read_b64_tr_b16 v[216:217], v232 offset:2048
 ds_read_b64_tr_b16 v[218:219], v232 offset:2560
 v_cvt_pk_bf16_f32 v171, v174, v175
 v_mfma_f32_32x32x16_bf16 v[192:207], v[140:143], v[228:231], v[192:207]
 ds_read_b64_tr_b16 v[220:221], v233 offset:2048
 ds_read_b64_tr_b16 v[222:223], v233 offset:2560
 buffer_store_dwordx4 v[168:171], v246, s[16:19], s7 offen offset:512 sc1
 s_waitcnt lgkmcnt(4)
 v_mfma_f32_32x32x16_bf16 v[144:159], v[0:3], v[208:211], 0
 ds_read_b64_tr_b16 v[224:225], v232 offset:4096
 ds_read_b64_tr_b16 v[226:227], v232 offset:4608
 v_mfma_f32_32x32x16_bf16 v[160:175], v[0:3], v[212:215], 0
 ds_read_b64_tr_b16 v[228:229], v233 offset:4096
 ds_read_b64_tr_b16 v[230:231], v233 offset:4608
 s_waitcnt lgkmcnt(4)
 v_mfma_f32_32x32x16_bf16 v[144:159], v[4:7], v[216:219], v[144:159]
 ds_read_b64_tr_b16 v[208:209], v232 offset:6144
 ds_read_b64_tr_b16 v[210:211], v232 offset:6656
 v_mfma_f32_32x32x16_bf16 v[160:175], v[4:7], v[220:223], v[160:175]
 ds_read_b64_tr_b16 v[212:213], v233 offset:6144
 ds_read_b64_tr_b16 v[214:215], v233 offset:6656
 s_waitcnt lgkmcnt(4)
 v_mfma_f32_32x32x16_bf16 v[144:159], v[8:11], v[224:227], v[144:159]
 ds_read_b64_tr_b16 v[216:217], v232 offset:8192
 ds_read_b64_tr_b16 v[218:219], v232 offset:8704
 s_add_u32 s7, s6, 7168
 ds_read_b128 v[248:251], v247 offset:0
 v_mfma_f32_32x32x16_bf16 v[160:175], v[8:11], v[228:231], v[160:175]
 ds_read_b64_tr_b16 v[220:221], v233 offset:8192
 ds_read_b64_tr_b16 v[222:223], v233 offset:8704
 s_nop 0
 s_waitcnt lgkmcnt(5)
 v_mfma_f32_32x32x16_bf16 v[144:159], v[12:15], v[208:211], v[144:159]
 ds_read_b64_tr_b16 v[224:225], v232 offset:10240
 ds_read_b64_tr_b16 v[226:227], v232 offset:10752
 s_nop 0
 v_mfma_f32_32x32x16_bf16 v[160:175], v[12:15], v[212:215], v[160:175]
 ds_read_b64_tr_b16 v[228:229], v233 offset:10240
 ds_read_b64_tr_b16 v[230:231], v233 offset:10752
 s_waitcnt lgkmcnt(6)
 s_waitcnt lgkmcnt(4)
 v_mfma_f32_32x32x16_bf16 v[144:159], v[16:19], v[216:219], v[144:159]
 ds_read_b64_tr_b16 v[208:209], v232 offset:12288
 ds_read_b64_tr_b16 v[210:211], v232 offset:12800
 v_mul_f32 v176, v248, v176
 v_mfma_f32_32x32x16_bf16 v[160:175], v[16:19], v[220:223], v[160:175]
 ds_read_b64_tr_b16 v[212:213], v233 offset:12288
 ds_read_b64_tr_b16 v[214:215], v233 offset:12800
 v_mul_f32 v177, v249, v177
 s_waitcnt lgkmcnt(4)
 v_mfma_f32_32x32x16_bf16 v[144:159], v[20:23], v[224:227], v[144:159]
 ds_read_b64_tr_b16 v[216:217], v232 offset:14336
 ds_read_b64_tr_b16 v[218:219], v232 offset:14848
 v_mul_f32 v178, v250, v178
 v_mfma_f32_32x32x16_bf16 v[160:175], v[20:23], v[228:231], v[160:175]
 ds_read_b64_tr_b16 v[220:221], v233 offset:14336
 ds_read_b64_tr_b16 v[222:223], v233 offset:14848
 v_mul_f32 v179, v251, v179
 s_waitcnt lgkmcnt(4)
 v_mfma_f32_32x32x16_bf16 v[144:159], v[24:27], v[208:211], v[144:159]
 ds_read_b64_tr_b16 v[224:225], v232 offset:16384
 ds_read_b64_tr_b16 v[226:227], v232 offset:16896
 v_mul_f32 v192, v248, v192
 v_mfma_f32_32x32x16_bf16 v[160:175], v[24:27], v[212:215], v[160:175]
 ds_read_b64_tr_b16 v[228:229], v233 offset:16384
 ds_read_b64_tr_b16 v[230:231], v233 offset:16896
 v_mul_f32 v193, v249, v193
 s_waitcnt lgkmcnt(4)
 v_mfma_f32_32x32x16_bf16 v[144:159], v[28:31], v[216:219], v[144:159]
 ds_read_b64_tr_b16 v[208:209], v232 offset:18432
 ds_read_b64_tr_b16 v[210:211], v232 offset:18944
 v_mul_f32 v194, v250, v194
 v_mfma_f32_32x32x16_bf16 v[160:175], v[28:31], v[220:223], v[160:175]
 ds_read_b64_tr_b16 v[212:213], v233 offset:18432
 ds_read_b64_tr_b16 v[214:215], v233 offset:18944
 v_mul_f32 v195, v251, v195
 s_waitcnt lgkmcnt(4)
 v_mfma_f32_32x32x16_bf16 v[144:159], v[32:35], v[224:227], v[144:159]
 ds_read_b64_tr_b16 v[216:217], v232 offset:20480
 ds_read_b64_tr_b16 v[218:219], v232 offset:20992
 ds_read_b128 v[248:251], v247 offset:32
 v_mfma_f32_32x32x16_bf16 v[160:175], v[32:35], v[228:231], v[160:175]
 ds_read_b64_tr_b16 v[220:221], v233 offset:20480
 ds_read_b64_tr_b16 v[222:223], v233 offset:20992
 s_nop 0
 s_waitcnt lgkmcnt(5)
 v_mfma_f32_32x32x16_bf16 v[144:159], v[36:39], v[208:211], v[144:159]
 ds_read_b64_tr_b16 v[224:225], v232 offset:22528
 ds_read_b64_tr_b16 v[226:227], v232 offset:23040
 s_nop 0
 v_mfma_f32_32x32x16_bf16 v[160:175], v[36:39], v[212:215], v[160:175]
 ds_read_b64_tr_b16 v[228:229], v233 offset:22528
 ds_read_b64_tr_b16 v[230:231], v233 offset:23040
 s_waitcnt vmcnt(10)
 s_barrier
 s_waitcnt lgkmcnt(4)
 v_mfma_f32_32x32x16_bf16 v[144:159], v[40:43], v[216:219], v[144:159]
 ds_read_b64_tr_b16 v[208:209], v232 offset:24576
 ds_read_b64_tr_b16 v[210:211], v232 offset:25088
 s_waitcnt lgkmcnt(8)
 v_mfma_f32_32x32x16_bf16 v[160:175], v[40:43], v[220:223], v[160:175]
 ds_read_b64_tr_b16 v[212:213], v233 offset:24576
 ds_read_b64_tr_b16 v[214:215], v233 offset:25088
 v_mul_f32 v180, v248, v180
 v_mul_f32 v181, v249, v181
 s_waitcnt lgkmcnt(4)
 v_mfma_f32_32x32x16_bf16 v[144:159], v[44:47], v[224:227], v[144:159]
 ds_read_b64_tr_b16 v[216:217], v232 offset:26624
 ds_read_b64_tr_b16 v[218:219], v232 offset:27136
 v_mul_f32 v182, v250, v182
 v_mfma_f32_32x32x16_bf16 v[160:175], v[44:47], v[228:231], v[160:175]
 ds_read_b64_tr_b16 v[220:221], v233 offset:26624
 ds_read_b64_tr_b16 v[222:223], v233 offset:27136
 v_mul_f32 v183, v251, v183
 s_waitcnt lgkmcnt(4)
 v_mfma_f32_32x32x16_bf16 v[144:159], v[48:51], v[208:211], v[144:159]
 ds_read_b64_tr_b16 v[224:225], v232 offset:28672
 ds_read_b64_tr_b16 v[226:227], v232 offset:29184
 v_mul_f32 v196, v248, v196
 v_mfma_f32_32x32x16_bf16 v[160:175], v[48:51], v[212:215], v[160:175]
 ds_read_b64_tr_b16 v[228:229], v233 offset:28672
 ds_read_b64_tr_b16 v[230:231], v233 offset:29184
 v_mul_f32 v197, v249, v197
 s_waitcnt lgkmcnt(4)
 v_mfma_f32_32x32x16_bf16 v[144:159], v[52:55], v[216:219], v[144:159]
 ds_read_b64_tr_b16 v[208:209], v232 offset:30720
 ds_read_b64_tr_b16 v[210:211], v232 offset:31232
 v_mul_f32 v198, v250, v198
 v_mfma_f32_32x32x16_bf16 v[160:175], v[52:55], v[220:223], v[160:175]
 ds_read_b64_tr_b16 v[212:213], v233 offset:30720
 ds_read_b64_tr_b16 v[214:215], v233 offset:31232
 v_mul_f32 v199, v251, v199
 s_waitcnt lgkmcnt(4)
 v_mfma_f32_32x32x16_bf16 v[144:159], v[56:59], v[224:227], v[144:159]
 ds_read_b64_tr_b16 v[216:217], v232 offset:32768
 ds_read_b64_tr_b16 v[218:219], v232 offset:33280
 v_cvt_pk_bf16_f32 v176, v176, v177
 v_mfma_f32_32x32x16_bf16 v[160:175], v[56:59], v[228:231], v[160:175]
 ds_read_b64_tr_b16 v[220:221], v233 offset:32768
 ds_read_b64_tr_b16 v[222:223], v233 offset:33280
 v_cvt_pk_bf16_f32 v177, v178, v179
 s_waitcnt lgkmcnt(4)
 v_mfma_f32_32x32x16_bf16 v[144:159], v[60:63], v[208:211], v[144:159]
 ds_read_b64_tr_b16 v[224:225], v232 offset:34816
 ds_read_b64_tr_b16 v[226:227], v232 offset:35328
 v_cvt_pk_bf16_f32 v178, v180, v181
 v_mfma_f32_32x32x16_bf16 v[160:175], v[60:63], v[212:215], v[160:175]
 ds_read_b64_tr_b16 v[228:229], v233 offset:34816
 ds_read_b64_tr_b16 v[230:231], v233 offset:35328
 v_cvt_pk_bf16_f32 v179, v182, v183
 s_waitcnt lgkmcnt(4)
 v_mfma_f32_32x32x16_bf16 v[144:159], v[64:67], v[216:219], v[144:159]
 ds_read_b64_tr_b16 v[208:209], v232 offset:36864
 ds_read_b64_tr_b16 v[210:211], v232 offset:37376
 buffer_store_dwordx4 v[176:179], v245, s[16:19], s7 offen offset:0 sc1
 v_mfma_f32_32x32x16_bf16 v[160:175], v[64:67], v[220:223], v[160:175]
 ds_read_b64_tr_b16 v[212:213], v233 offset:36864
 ds_read_b64_tr_b16 v[214:215], v233 offset:37376
 v_cvt_pk_bf16_f32 v192, v192, v193
 s_waitcnt lgkmcnt(4)
 v_mfma_f32_32x32x16_bf16 v[144:159], v[68:71], v[224:227], v[144:159]
 ds_read_b64_tr_b16 v[216:217], v232 offset:38912
 ds_read_b64_tr_b16 v[218:219], v232 offset:39424
 v_cvt_pk_bf16_f32 v193, v194, v195
 v_mfma_f32_32x32x16_bf16 v[160:175], v[68:71], v[228:231], v[160:175]
 ds_read_b64_tr_b16 v[220:221], v233 offset:38912
 ds_read_b64_tr_b16 v[222:223], v233 offset:39424
 v_cvt_pk_bf16_f32 v194, v196, v197
 s_waitcnt lgkmcnt(4)
 v_mfma_f32_32x32x16_bf16 v[144:159], v[72:75], v[208:211], v[144:159]
 ds_read_b64_tr_b16 v[224:225], v232 offset:40960
 ds_read_b64_tr_b16 v[226:227], v232 offset:41472
 v_cvt_pk_bf16_f32 v195, v198, v199
 v_mfma_f32_32x32x16_bf16 v[160:175], v[72:75], v[212:215], v[160:175]
 ds_read_b64_tr_b16 v[228:229], v233 offset:40960
 ds_read_b64_tr_b16 v[230:231], v233 offset:41472
 buffer_store_dwordx4 v[192:195], v245, s[16:19], s7 offen offset:512 sc1
 ds_read_b128 v[248:251], v247 offset:64
 s_waitcnt lgkmcnt(5)
 v_mfma_f32_32x32x16_bf16 v[144:159], v[76:79], v[216:219], v[144:159]
 ds_read_b64_tr_b16 v[208:209], v232 offset:43008
 ds_read_b64_tr_b16 v[210:211], v232 offset:43520
 s_nop 0
 v_mfma_f32_32x32x16_bf16 v[160:175], v[76:79], v[220:223], v[160:175]
 ds_read_b64_tr_b16 v[212:213], v233 offset:43008
 ds_read_b64_tr_b16 v[214:215], v233 offset:43520
 s_nop 0
 s_waitcnt lgkmcnt(5)
 v_mfma_f32_32x32x16_bf16 v[144:159], v[80:83], v[224:227], v[144:159]
 ds_read_b64_tr_b16 v[216:217], v232 offset:45056
 ds_read_b64_tr_b16 v[218:219], v232 offset:45568
 s_waitcnt lgkmcnt(6)
 v_mfma_f32_32x32x16_bf16 v[160:175], v[80:83], v[228:231], v[160:175]
 ds_read_b64_tr_b16 v[220:221], v233 offset:45056
 ds_read_b64_tr_b16 v[222:223], v233 offset:45568
 v_mul_f32 v184, v248, v184
 s_waitcnt lgkmcnt(4)
 v_mfma_f32_32x32x16_bf16 v[144:159], v[84:87], v[208:211], v[144:159]
 ds_read_b64_tr_b16 v[224:225], v232 offset:47104
 ds_read_b64_tr_b16 v[226:227], v232 offset:47616
 v_mul_f32 v185, v249, v185
 v_mfma_f32_32x32x16_bf16 v[160:175], v[84:87], v[212:215], v[160:175]
 ds_read_b64_tr_b16 v[228:229], v233 offset:47104
 ds_read_b64_tr_b16 v[230:231], v233 offset:47616
 s_waitcnt vmcnt(4)
 s_barrier
 s_waitcnt lgkmcnt(4)
 v_mfma_f32_32x32x16_bf16 v[144:159], v[88:91], v[216:219], v[144:159]
 ds_read_b64_tr_b16 v[208:209], v234 offset:0
 ds_read_b64_tr_b16 v[210:211], v234 offset:512
 v_mul_f32 v186, v250, v186
 v_mfma_f32_32x32x16_bf16 v[160:175], v[88:91], v[220:223], v[160:175]
 ds_read_b64_tr_b16 v[212:213], v235 offset:0
 ds_read_b64_tr_b16 v[214:215], v235 offset:512
 v_mul_f32 v187, v251, v187
 s_waitcnt lgkmcnt(4)
 v_mfma_f32_32x32x16_bf16 v[144:159], v[92:95], v[224:227], v[144:159]
 ds_read_b64_tr_b16 v[216:217], v234 offset:2048
 ds_read_b64_tr_b16 v[218:219], v234 offset:2560
 v_mul_f32 v200, v248, v200
 v_mfma_f32_32x32x16_bf16 v[160:175], v[92:95], v[228:231], v[160:175]
 ds_read_b64_tr_b16 v[220:221], v235 offset:2048
 ds_read_b64_tr_b16 v[222:223], v235 offset:2560
 v_mul_f32 v201, v249, v201
 s_waitcnt lgkmcnt(4)
 v_mfma_f32_32x32x16_bf16 v[144:159], v[96:99], v[208:211], v[144:159]
 ds_read_b64_tr_b16 v[224:225], v234 offset:4096
 ds_read_b64_tr_b16 v[226:227], v234 offset:4608
 v_mul_f32 v202, v250, v202
 v_mfma_f32_32x32x16_bf16 v[160:175], v[96:99], v[212:215], v[160:175]
 ds_read_b64_tr_b16 v[228:229], v235 offset:4096
 ds_read_b64_tr_b16 v[230:231], v235 offset:4608
 v_mul_f32 v203, v251, v203
 s_waitcnt lgkmcnt(4)
 v_mfma_f32_32x32x16_bf16 v[144:159], v[100:103], v[216:219], v[144:159]
 ds_read_b64_tr_b16 v[208:209], v234 offset:6144
 ds_read_b64_tr_b16 v[210:211], v234 offset:6656
 ds_read_b128 v[248:251], v247 offset:96
 v_mfma_f32_32x32x16_bf16 v[160:175], v[100:103], v[220:223], v[160:175]
 ds_read_b64_tr_b16 v[212:213], v235 offset:6144
 ds_read_b64_tr_b16 v[214:215], v235 offset:6656
 s_nop 0
 s_waitcnt lgkmcnt(5)
 v_mfma_f32_32x32x16_bf16 v[144:159], v[104:107], v[224:227], v[144:159]
 ds_read_b64_tr_b16 v[216:217], v234 offset:8192
 ds_read_b64_tr_b16 v[218:219], v234 offset:8704
 s_nop 0
 v_mfma_f32_32x32x16_bf16 v[160:175], v[104:107], v[228:231], v[160:175]
 ds_read_b64_tr_b16 v[220:221], v235 offset:8192
 ds_read_b64_tr_b16 v[222:223], v235 offset:8704
 s_waitcnt lgkmcnt(6)
 s_waitcnt lgkmcnt(4)
 v_mfma_f32_32x32x16_bf16 v[144:159], v[108:111], v[208:211], v[144:159]
 ds_read_b64_tr_b16 v[224:225], v234 offset:10240
 ds_read_b64_tr_b16 v[226:227], v234 offset:10752
 v_mul_f32 v188, v248, v188
 v_mul_f32 v189, v249, v189
 v_mfma_f32_32x32x16_bf16 v[160:175], v[108:111], v[212:215], v[160:175]
 ds_read_b64_tr_b16 v[228:229], v235 offset:10240
 ds_read_b64_tr_b16 v[230:231], v235 offset:10752
 v_mul_f32 v190, v250, v190
 s_waitcnt lgkmcnt(4)
 v_mfma_f32_32x32x16_bf16 v[144:159], v[112:115], v[216:219], v[144:159]
 ds_read_b64_tr_b16 v[208:209], v234 offset:12288
 ds_read_b64_tr_b16 v[210:211], v234 offset:12800
 v_mul_f32 v191, v251, v191
 v_mfma_f32_32x32x16_bf16 v[160:175], v[112:115], v[220:223], v[160:175]
 ds_read_b64_tr_b16 v[212:213], v235 offset:12288
 ds_read_b64_tr_b16 v[214:215], v235 offset:12800
 v_mul_f32 v204, v248, v204
 s_waitcnt lgkmcnt(4)
 v_mfma_f32_32x32x16_bf16 v[144:159], v[116:119], v[224:227], v[144:159]
 ds_read_b64_tr_b16 v[216:217], v234 offset:14336
 ds_read_b64_tr_b16 v[218:219], v234 offset:14848
 v_mul_f32 v205, v249, v205
 v_mfma_f32_32x32x16_bf16 v[160:175], v[116:119], v[228:231], v[160:175]
 ds_read_b64_tr_b16 v[220:221], v235 offset:14336
 ds_read_b64_tr_b16 v[222:223], v235 offset:14848
 v_mul_f32 v206, v250, v206
 s_waitcnt lgkmcnt(4)
 v_mfma_f32_32x32x16_bf16 v[144:159], v[120:123], v[208:211], v[144:159]
 ds_read_b64_tr_b16 v[224:225], v234 offset:16384
 ds_read_b64_tr_b16 v[226:227], v234 offset:16896
 v_mul_f32 v207, v251, v207
 v_mfma_f32_32x32x16_bf16 v[160:175], v[120:123], v[212:215], v[160:175]
 ds_read_b64_tr_b16 v[228:229], v235 offset:16384
 ds_read_b64_tr_b16 v[230:231], v235 offset:16896
 v_cvt_pk_bf16_f32 v184, v184, v185
 s_waitcnt lgkmcnt(4)
 v_mfma_f32_32x32x16_bf16 v[144:159], v[124:127], v[216:219], v[144:159]
 ds_read_b64_tr_b16 v[208:209], v234 offset:18432
 ds_read_b64_tr_b16 v[210:211], v234 offset:18944
 v_cvt_pk_bf16_f32 v185, v186, v187
 v_mfma_f32_32x32x16_bf16 v[160:175], v[124:127], v[220:223], v[160:175]
 ds_read_b64_tr_b16 v[212:213], v235 offset:18432
 ds_read_b64_tr_b16 v[214:215], v235 offset:18944
 v_cvt_pk_bf16_f32 v186, v188, v189
 s_waitcnt lgkmcnt(4)
 v_mfma_f32_32x32x16_bf16 v[144:159], v[128:131], v[224:227], v[144:159]
 ds_read_b64_tr_b16 v[216:217], v234 offset:20480
 ds_read_b64_tr_b16 v[218:219], v234 offset:20992
 v_cvt_pk_bf16_f32 v187, v190, v191
 v_mfma_f32_32x32x16_bf16 v[160:175], v[128:131], v[228:231], v[160:175]
 ds_read_b64_tr_b16 v[220:221], v235 offset:20480
 ds_read_b64_tr_b16 v[222:223], v235 offset:20992
 buffer_store_dwordx4 v[184:187], v246, s[16:19], s7 offen offset:0 sc1
 s_waitcnt lgkmcnt(4)
 v_mfma_f32_32x32x16_bf16 v[144:159], v[132:135], v[208:211], v[144:159]
 ds_read_b64_tr_b16 v[224:225], v234 offset:22528
 ds_read_b64_tr_b16 v[226:227], v234 offset:23040
 v_cvt_pk_bf16_f32 v200, v200, v201
 v_mfma_f32_32x32x16_bf16 v[160:175], v[132:135], v[212:215], v[160:175]
 ds_read_b64_tr_b16 v[228:229], v235 offset:22528
 ds_read_b64_tr_b16 v[230:231], v235 offset:23040
 s_waitcnt lgkmcnt(4)
 v_mfma_f32_32x32x16_bf16 v[144:159], v[136:139], v[216:219], v[144:159]
 v_cvt_pk_bf16_f32 v201, v202, v203
 v_mfma_f32_32x32x16_bf16 v[160:175], v[136:139], v[220:223], v[160:175]
 v_cvt_pk_bf16_f32 v202, v204, v205
 s_waitcnt lgkmcnt(0)
 v_mfma_f32_32x32x16_bf16 v[144:159], v[140:143], v[224:227], v[144:159]
 v_cvt_pk_bf16_f32 v203, v206, v207
 v_mfma_f32_32x32x16_bf16 v[160:175], v[140:143], v[228:231], v[160:175]
 buffer_store_dwordx4 v[200:203], v246, s[16:19], s7 offen offset:512 sc1
 s_nop 11
 s_add_u32 s7, s6, 8192
 ds_read_b128 v[248:251], v247 offset:0
 s_nop 0
 s_nop 0
 s_waitcnt lgkmcnt(0)
 v_mul_f32 v144, v248, v144
 v_mul_f32 v145, v249, v145
 v_mul_f32 v146, v250, v146
 v_mul_f32 v147, v251, v147
 v_mul_f32 v160, v248, v160
 v_mul_f32 v161, v249, v161
 v_mul_f32 v162, v250, v162
 v_mul_f32 v163, v251, v163
 ds_read_b128 v[248:251], v247 offset:32
 s_nop 0
 s_nop 0
 s_waitcnt lgkmcnt(0)
 v_mul_f32 v148, v248, v148
 v_mul_f32 v149, v249, v149
 v_mul_f32 v150, v250, v150
 v_mul_f32 v151, v251, v151
 v_mul_f32 v164, v248, v164
 v_mul_f32 v165, v249, v165
 v_mul_f32 v166, v250, v166
 v_mul_f32 v167, v251, v167
 v_cvt_pk_bf16_f32 v144, v144, v145
 v_cvt_pk_bf16_f32 v145, v146, v147
 v_cvt_pk_bf16_f32 v146, v148, v149
 v_cvt_pk_bf16_f32 v147, v150, v151
 buffer_store_dwordx4 v[144:147], v245, s[16:19], s7 offen offset:0 sc1
 v_cvt_pk_bf16_f32 v160, v160, v161
 v_cvt_pk_bf16_f32 v161, v162, v163
 v_cvt_pk_bf16_f32 v162, v164, v165
 v_cvt_pk_bf16_f32 v163, v166, v167
 buffer_store_dwordx4 v[160:163], v245, s[16:19], s7 offen offset:512 sc1
 ds_read_b128 v[248:251], v247 offset:64
 s_nop 0
 s_nop 0
 s_waitcnt lgkmcnt(0)
 v_mul_f32 v152, v248, v152
 v_mul_f32 v153, v249, v153
 v_mul_f32 v154, v250, v154
 v_mul_f32 v155, v251, v155
 v_mul_f32 v168, v248, v168
 v_mul_f32 v169, v249, v169
 v_mul_f32 v170, v250, v170
 v_mul_f32 v171, v251, v171
 ds_read_b128 v[248:251], v247 offset:96
 s_nop 0
 s_nop 0
 s_waitcnt lgkmcnt(0)
 v_mul_f32 v156, v248, v156
 v_mul_f32 v157, v249, v157
 v_mul_f32 v158, v250, v158
 v_mul_f32 v159, v251, v159
 v_mul_f32 v172, v248, v172
 v_mul_f32 v173, v249, v173
 v_mul_f32 v174, v250, v174
 v_mul_f32 v175, v251, v175
 v_cvt_pk_bf16_f32 v152, v152, v153
 v_cvt_pk_bf16_f32 v153, v154, v155
 v_cvt_pk_bf16_f32 v154, v156, v157
 v_cvt_pk_bf16_f32 v155, v158, v159
 buffer_store_dwordx4 v[152:155], v246, s[16:19], s7 offen offset:0 sc1
 v_cvt_pk_bf16_f32 v168, v168, v169
 v_cvt_pk_bf16_f32 v169, v170, v171
 v_cvt_pk_bf16_f32 v170, v172, v173
 v_cvt_pk_bf16_f32 v171, v174, v175
 buffer_store_dwordx4 v[168:171], v246, s[16:19], s7 offen offset:512 sc1
 s_branch L1_qdone
L1_w:
 s_add_u32 m0, s30, 16384
 s_add_u32 s21, s43, 0
 buffer_load_dwordx4 v238, s[12:15], s21 offen lds
 buffer_load_dwordx4 v239, s[12:15], s21 offen offset:1024 lds
 v_dot2_f32_bf16 v144, v0, s50, v240
 v_dot2_f32_bf16 v145, v0, s51, v240
 v_dot2_f32_bf16 v146, v1, s50, v240
 v_dot2_f32_bf16 v147, v1, s51, v240
 v_dot2_f32_bf16 v148, v2, s50, v240
 v_dot2_f32_bf16 v149, v2, s51, v240
 v_dot2_f32_bf16 v150, v3, s50, v240
 v_dot2_f32_bf16 v151, v3, s51, v240
 v_cvt_pk_bf16_f32 v0, v144, v145
 v_cvt_pk_bf16_f32 v1, v146, v147
 v_cvt_pk_bf16_f32 v2, v148, v149
 v_cvt_pk_bf16_f32 v3, v150, v151
 v_dot2_f32_bf16 v152, v4, s50, v240
 v_dot2_f32_bf16 v153, v4, s51, v240
 v_dot2_f32_bf16 v154, v5, s50, v240
 v_dot2_f32_bf16 v155, v5, s51, v240
 v_dot2_f32_bf16 v156, v6, s50, v240
 v_dot2_f32_bf16 v157, v6, s51, v240
 v_dot2_f32_bf16 v158, v7, s50, v240
 v_dot2_f32_bf16 v159, v7, s51, v240
 v_cvt_pk_bf16_f32 v4, v152, v153
 v_cvt_pk_bf16_f32 v5, v154, v155
 v_cvt_pk_bf16_f32 v6, v156, v157
 v_cvt_pk_bf16_f32 v7, v158, v159
 v_dot2_f32_bf16 v144, v8, s50, v240
 v_dot2_f32_bf16 v145, v8, s51, v240
 v_dot2_f32_bf16 v146, v9, s50, v240
 v_dot2_f32_bf16 v147, v9, s51, v240
 v_dot2_f32_bf16 v148, v10, s50, v240
 v_dot2_f32_bf16 v149, v10, s51, v240
 v_dot2_f32_bf16 v150, v11, s50, v240
 v_dot2_f32_bf16 v151, v11, s51, v240
 v_cvt_pk_bf16_f32 v8, v144, v145
 v_cvt_pk_bf16_f32 v9, v146, v147
 v_cvt_pk_bf16_f32 v10, v148, v149
 v_cvt_pk_bf16_f32 v11, v150, v151
 global_load_dwordx4 v[248:251], v253, s[4:5]
 s_add_u32 s4, s4, 4096
 s_addc_u32 s5, s5, 0
 v_dot2_f32_bf16 v152, v12, s50, v240
 v_dot2_f32_bf16 v153, v12, s51, v240
 v_dot2_f32_bf16 v154, v13, s50, v240
 v_dot2_f32_bf16 v155, v13, s51, v240
 v_dot2_f32_bf16 v156, v14, s50, v240
 v_dot2_f32_bf16 v157, v14, s51, v240
 v_dot2_f32_bf16 v158, v15, s50, v240
 v_dot2_f32_bf16 v159, v15, s51, v240
 v_cvt_pk_bf16_f32 v12, v152, v153
 v_cvt_pk_bf16_f32 v13, v154, v155
 v_cvt_pk_bf16_f32 v14, v156, v157
 v_cvt_pk_bf16_f32 v15, v158, v159
 v_dot2_f32_bf16 v144, v16, s50, v240
 v_dot2_f32_bf16 v145, v16, s51, v240
 v_dot2_f32_bf16 v146, v17, s50, v240
 v_dot2_f32_bf16 v147, v17, s51, v240
 v_dot2_f32_bf16 v148, v18, s50, v240
 v_dot2_f32_bf16 v149, v18, s51, v240
 v_dot2_f32_bf16 v150, v19, s50, v240
 v_dot2_f32_bf16 v151, v19, s51, v240
 v_cvt_pk_bf16_f32 v16, v144, v145
 v_cvt_pk_bf16_f32 v17, v146, v147
 v_cvt_pk_bf16_f32 v18, v148, v149
 v_cvt_pk_bf16_f32 v19, v150, v151
 v_dot2_f32_bf16 v152, v20, s50, v240
 v_dot2_f32_bf16 v153, v20, s51, v240
 v_dot2_f32_bf16 v154, v21, s50, v240
 v_dot2_f32_bf16 v155, v21, s51, v240
 v_dot2_f32_bf16 v156, v22, s50, v240
 v_dot2_f32_bf16 v157, v22, s51, v240
 v_dot2_f32_bf16 v158, v23, s50, v240
 v_dot2_f32_bf16 v159, v23, s51, v240
 v_cvt_pk_bf16_f32 v20, v152, v153
 v_cvt_pk_bf16_f32 v21, v154, v155
 v_cvt_pk_bf16_f32 v22, v156, v157
 v_cvt_pk_bf16_f32 v23, v158, v159
 v_dot2_f32_bf16 v144, v24, s50, v240
 v_dot2_f32_bf16 v145, v24, s51, v240
 v_dot2_f32_bf16 v146, v25, s50, v240
 v_dot2_f32_bf16 v147, v25, s51, v240
 v_dot2_f32_bf16 v148, v26, s50, v240
 v_dot2_f32_bf16 v149, v26, s51, v240
 v_dot2_f32_bf16 v150, v27, s50, v240
 v_dot2_f32_bf16 v151, v27, s51, v240
 v_cvt_pk_bf16_f32 v24, v144, v145
 v_cvt_pk_bf16_f32 v25, v146, v147
 v_cvt_pk_bf16_f32 v26, v148, v149
 v_cvt_pk_bf16_f32 v27, v150, v151
 s_add_u32 m0, s30, 24576
 s_add_u32 s21, s44, 0
 buffer_load_dwordx4 v238, s[12:15], s21 offen lds
 buffer_load_dwordx4 v239, s[12:15], s21 offen offset:1024 lds
 v_dot2_f32_bf16 v152, v28, s50, v240
 v_dot2_f32_bf16 v153, v28, s51, v240
 v_dot2_f32_bf16 v154, v29, s50, v240
 v_dot2_f32_bf16 v155, v29, s51, v240
 v_dot2_f32_bf16 v156, v30, s50, v240
 v_dot2_f32_bf16 v157, v30, s51, v240
 v_dot2_f32_bf16 v158, v31, s50, v240
 v_dot2_f32_bf16 v159, v31, s51, v240
 v_cvt_pk_bf16_f32 v28, v152, v153
 v_cvt_pk_bf16_f32 v29, v154, v155
 v_cvt_pk_bf16_f32 v30, v156, v157
 v_cvt_pk_bf16_f32 v31, v158, v159
 v_dot2_f32_bf16 v144, v32, s50, v240
 v_dot2_f32_bf16 v145, v32, s51, v240
 v_dot2_f32_bf16 v146, v33, s50, v240
 v_dot2_f32_bf16 v147, v33, s51, v240
 v_dot2_f32_bf16 v148, v34, s50, v240
 v_dot2_f32_bf16 v149, v34, s51, v240
 v_dot2_f32_bf16 v150, v35, s50, v240
 v_dot2_f32_bf16 v151, v35, s51, v240
 v_cvt_pk_bf16_f32 v32, v144, v145
 v_cvt_pk_bf16_f32 v33, v146, v147
 v_cvt_pk_bf16_f32 v34, v148, v149
 v_cvt_pk_bf16_f32 v35, v150, v151
 v_dot2_f32_bf16 v152, v36, s50, v240
 v_dot2_f32_bf16 v153, v36, s51, v240
 v_dot2_f32_bf16 v154, v37, s50, v240
 v_dot2_f32_bf16 v155, v37, s51, v240
 v_dot2_f32_bf16 v156, v38, s50, v240
 v_dot2_f32_bf16 v157, v38, s51, v240
 v_dot2_f32_bf16 v158, v39, s50, v240
 v_dot2_f32_bf16 v159, v39, s51, v240
 v_cvt_pk_bf16_f32 v36, v152, v153
 v_cvt_pk_bf16_f32 v37, v154, v155
 v_cvt_pk_bf16_f32 v38, v156, v157
 v_cvt_pk_bf16_f32 v39, v158, v159
 s_add_u32 m0, s30, 32768
 s_add_u32 s21, s45, 0
 buffer_load_dwordx4 v238, s[12:15], s21 offen lds
 buffer_load_dwordx4 v239, s[12:15], s21 offen offset:1024 lds
 v_dot2_f32_bf16 v144, v40, s50, v240
 v_dot2_f32_bf16 v145, v40, s51, v240
 v_dot2_f32_bf16 v146, v41, s50, v240
 v_dot2_f32_bf16 v147, v41, s51, v240
 v_dot2_f32_bf16 v148, v42, s50, v240
 v_dot2_f32_bf16 v149, v42, s51, v240
 v_dot2_f32_bf16 v150, v43, s50, v240
 v_dot2_f32_bf16 v151, v43, s51, v240
 v_cvt_pk_bf16_f32 v40, v144, v145
 v_cvt_pk_bf16_f32 v41, v146, v147
 v_cvt_pk_bf16_f32 v42, v148, v149
 v_cvt_pk_bf16_f32 v43, v150, v151
 v_dot2_f32_bf16 v152, v44, s50, v240
 v_dot2_f32_bf16 v153, v44, s51, v240
 v_dot2_f32_bf16 v154, v45, s50, v240
 v_dot2_f32_bf16 v155, v45, s51, v240
 v_dot2_f32_bf16 v156, v46, s50, v240
 v_dot2_f32_bf16 v157, v46, s51, v240
 v_dot2_f32_bf16 v158, v47, s50, v240
 v_dot2_f32_bf16 v159, v47, s51, v240
 v_cvt_pk_bf16_f32 v44, v152, v153
 v_cvt_pk_bf16_f32 v45, v154, v155
 v_cvt_pk_bf16_f32 v46, v156, v157
 v_cvt_pk_bf16_f32 v47, v158, v159
 v_dot2_f32_bf16 v144, v48, s50, v240
 v_dot2_f32_bf16 v145, v48, s51, v240
 v_dot2_f32_bf16 v146, v49, s50, v240
 v_dot2_f32_bf16 v147, v49, s51, v240
 v_dot2_f32_bf16 v148, v50, s50, v240
 v_dot2_f32_bf16 v149, v50, s51, v240
 v_dot2_f32_bf16 v150, v51, s50, v240
 v_dot2_f32_bf16 v151, v51, s51, v240
 v_cvt_pk_bf16_f32 v48, v144, v145
 v_cvt_pk_bf16_f32 v49, v146, v147
 v_cvt_pk_bf16_f32 v50, v148, v149
 v_cvt_pk_bf16_f32 v51, v150, v151
 v_dot2_f32_bf16 v152, v52, s50, v240
 v_dot2_f32_bf16 v153, v52, s51, v240
 v_dot2_f32_bf16 v154, v53, s50, v240
 v_dot2_f32_bf16 v155, v53, s51, v240
 v_dot2_f32_bf16 v156, v54, s50, v240
 v_dot2_f32_bf16 v157, v54, s51, v240
 v_dot2_f32_bf16 v158, v55, s50, v240
 v_dot2_f32_bf16 v159, v55, s51, v240
 v_cvt_pk_bf16_f32 v52, v152, v153
 v_cvt_pk_bf16_f32 v53, v154, v155
 v_cvt_pk_bf16_f32 v54, v156, v157
 v_cvt_pk_bf16_f32 v55, v158, v159
 s_add_u32 m0, s30, 40960
 s_add_u32 s21, s46, 0
 buffer_load_dwordx4 v238, s[12:15], s21 offen lds
 buffer_load_dwordx4 v239, s[12:15], s21 offen offset:1024 lds
 v_dot2_f32_bf16 v144, v56, s50, v240
 v_dot2_f32_bf16 v145, v56, s51, v240
 v_dot2_f32_bf16 v146, v57, s50, v240
 v_dot2_f32_bf16 v147, v57, s51, v240
 v_dot2_f32_bf16 v148, v58, s50, v240
 v_dot2_f32_bf16 v149, v58, s51, v240
 v_dot2_f32_bf16 v150, v59, s50, v240
 v_dot2_f32_bf16 v151, v59, s51, v240
 v_cvt_pk_bf16_f32 v56, v144, v145
 v_cvt_pk_bf16_f32 v57, v146, v147
 v_cvt_pk_bf16_f32 v58, v148, v149
 v_cvt_pk_bf16_f32 v59, v150, v151
 v_dot2_f32_bf16 v152, v60, s50, v240
 v_dot2_f32_bf16 v153, v60, s51, v240
 v_dot2_f32_bf16 v154, v61, s50, v240
 v_dot2_f32_bf16 v155, v61, s51, v240
 v_dot2_f32_bf16 v156, v62, s50, v240
 v_dot2_f32_bf16 v157, v62, s51, v240
 v_dot2_f32_bf16 v158, v63, s50, v240
 v_dot2_f32_bf16 v159, v63, s51, v240
 v_cvt_pk_bf16_f32 v60, v152, v153
 v_cvt_pk_bf16_f32 v61, v154, v155
 v_cvt_pk_bf16_f32 v62, v156, v157
 v_cvt_pk_bf16_f32 v63, v158, v159
 v_dot2_f32_bf16 v144, v64, s50, v240
 v_dot2_f32_bf16 v145, v64, s51, v240
 v_dot2_f32_bf16 v146, v65, s50, v240
 v_dot2_f32_bf16 v147, v65, s51, v240
 v_dot2_f32_bf16 v148, v66, s50, v240
 v_dot2_f32_bf16 v149, v66, s51, v240
 v_dot2_f32_bf16 v150, v67, s50, v240
 v_dot2_f32_bf16 v151, v67, s51, v240
 v_cvt_pk_bf16_f32 v64, v144, v145
 v_cvt_pk_bf16_f32 v65, v146, v147
 v_cvt_pk_bf16_f32 v66, v148, v149
 v_cvt_pk_bf16_f32 v67, v150, v151
 v_dot2_f32_bf16 v152, v68, s50, v240
 v_dot2_f32_bf16 v153, v68, s51, v240
 v_dot2_f32_bf16 v154, v69, s50, v240
 v_dot2_f32_bf16 v155, v69, s51, v240
 v_dot2_f32_bf16 v156, v70, s50, v240
 v_dot2_f32_bf16 v157, v70, s51, v240
 v_dot2_f32_bf16 v158, v71, s50, v240
 v_dot2_f32_bf16 v159, v71, s51, v240
 v_cvt_pk_bf16_f32 v68, v152, v153
 v_cvt_pk_bf16_f32 v69, v154, v155
 v_cvt_pk_bf16_f32 v70, v156, v157
 v_cvt_pk_bf16_f32 v71, v158, v159
 s_add_u32 m0, s30, 49152
 s_add_u32 s21, s47, 0
 buffer_load_dwordx4 v238, s[12:15], s21 offen lds
 buffer_load_dwordx4 v239, s[12:15], s21 offen offset:1024 lds
 v_dot2_f32_bf16 v144, v72, s50, v240
 v_dot2_f32_bf16 v145, v72, s51, v240
 v_dot2_f32_bf16 v146, v73, s50, v240
 v_dot2_f32_bf16 v147, v73, s51, v240
 v_dot2_f32_bf16 v148, v74, s50, v240
 v_dot2_f32_bf16 v149, v74, s51, v240
 v_dot2_f32_bf16 v150, v75, s50, v240
 v_dot2_f32_bf16 v151, v75, s51, v240
 v_cvt_pk_bf16_f32 v72, v144, v145
 v_cvt_pk_bf16_f32 v73, v146, v147
 v_cvt_pk_bf16_f32 v74, v148, v149
 v_cvt_pk_bf16_f32 v75, v150, v151
 v_dot2_f32_bf16 v152, v76, s50, v240
 v_dot2_f32_bf16 v153, v76, s51, v240
 v_dot2_f32_bf16 v154, v77, s50, v240
 v_dot2_f32_bf16 v155, v77, s51, v240
 v_dot2_f32_bf16 v156, v78, s50, v240
 v_dot2_f32_bf16 v157, v78, s51, v240
 v_dot2_f32_bf16 v158, v79, s50, v240
 v_dot2_f32_bf16 v159, v79, s51, v240
 v_cvt_pk_bf16_f32 v76, v152, v153
 v_cvt_pk_bf16_f32 v77, v154, v155
 v_cvt_pk_bf16_f32 v78, v156, v157
 v_cvt_pk_bf16_f32 v79, v158, v159
 v_dot2_f32_bf16 v144, v80, s50, v240
 v_dot2_f32_bf16 v145, v80, s51, v240
 v_dot2_f32_bf16 v146, v81, s50, v240
 v_dot2_f32_bf16 v147, v81, s51, v240
 v_dot2_f32_bf16 v148, v82, s50, v240
 v_dot2_f32_bf16 v149, v82, s51, v240
 v_dot2_f32_bf16 v150, v83, s50, v240
 v_dot2_f32_bf16 v151, v83, s51, v240
 v_cvt_pk_bf16_f32 v80, v144, v145
 v_cvt_pk_bf16_f32 v81, v146, v147
 v_cvt_pk_bf16_f32 v82, v148, v149
 v_cvt_pk_bf16_f32 v83, v150, v151
 s_add_u32 m0, s30, 57344
 s_add_u32 s21, s48, 0
 buffer_load_dwordx4 v238, s[12:15], s21 offen lds
 buffer_load_dwordx4 v239, s[12:15], s21 offen offset:1024 lds
 v_dot2_f32_bf16 v152, v84, s50, v240
 v_dot2_f32_bf16 v153, v84, s51, v240
 v_dot2_f32_bf16 v154, v85, s50, v240
 v_dot2_f32_bf16 v155, v85, s51, v240
 v_dot2_f32_bf16 v156, v86, s50, v240
 v_dot2_f32_bf16 v157, v86, s51, v240
 v_dot2_f32_bf16 v158, v87, s50, v240
 v_dot2_f32_bf16 v159, v87, s51, v240
 v_cvt_pk_bf16_f32 v84, v152, v153
 v_cvt_pk_bf16_f32 v85, v154, v155
 v_cvt_pk_bf16_f32 v86, v156, v157
 v_cvt_pk_bf16_f32 v87, v158, v159
 v_dot2_f32_bf16 v144, v88, s50, v240
 v_dot2_f32_bf16 v145, v88, s51, v240
 v_dot2_f32_bf16 v146, v89, s50, v240
 v_dot2_f32_bf16 v147, v89, s51, v240
 v_dot2_f32_bf16 v148, v90, s50, v240
 v_dot2_f32_bf16 v149, v90, s51, v240
 v_dot2_f32_bf16 v150, v91, s50, v240
 v_dot2_f32_bf16 v151, v91, s51, v240
 v_cvt_pk_bf16_f32 v88, v144, v145
 v_cvt_pk_bf16_f32 v89, v146, v147
 v_cvt_pk_bf16_f32 v90, v148, v149
 v_cvt_pk_bf16_f32 v91, v150, v151
 v_dot2_f32_bf16 v152, v92, s50, v240
 v_dot2_f32_bf16 v153, v92, s51, v240
 v_dot2_f32_bf16 v154, v93, s50, v240
 v_dot2_f32_bf16 v155, v93, s51, v240
 v_dot2_f32_bf16 v156, v94, s50, v240
 v_dot2_f32_bf16 v157, v94, s51, v240
 v_dot2_f32_bf16 v158, v95, s50, v240
 v_dot2_f32_bf16 v159, v95, s51, v240
 v_cvt_pk_bf16_f32 v92, v152, v153
 v_cvt_pk_bf16_f32 v93, v154, v155
 v_cvt_pk_bf16_f32 v94, v156, v157
 v_cvt_pk_bf16_f32 v95, v158, v159
 v_dot2_f32_bf16 v144, v96, s50, v240
 v_dot2_f32_bf16 v145, v96, s51, v240
 v_dot2_f32_bf16 v146, v97, s50, v240
 v_dot2_f32_bf16 v147, v97, s51, v240
 v_dot2_f32_bf16 v148, v98, s50, v240
 v_dot2_f32_bf16 v149, v98, s51, v240
 v_dot2_f32_bf16 v150, v99, s50, v240
 v_dot2_f32_bf16 v151, v99, s51, v240
 v_cvt_pk_bf16_f32 v96, v144, v145
 v_cvt_pk_bf16_f32 v97, v146, v147
 v_cvt_pk_bf16_f32 v98, v148, v149
 v_cvt_pk_bf16_f32 v99, v150, v151
 s_add_u32 m0, s30, 65536
 s_add_u32 s21, s49, 0
 buffer_load_dwordx4 v238, s[12:15], s21 offen lds
 buffer_load_dwordx4 v239, s[12:15], s21 offen offset:1024 lds
 v_dot2_f32_bf16 v152, v100, s50, v240
 v_dot2_f32_bf16 v153, v100, s51, v240
 v_dot2_f32_bf16 v154, v101, s50, v240
 v_dot2_f32_bf16 v155, v101, s51, v240
 v_dot2_f32_bf16 v156, v102, s50, v240
 v_dot2_f32_bf16 v157, v102, s51, v240
 v_dot2_f32_bf16 v158, v103, s50, v240
 v_dot2_f32_bf16 v159, v103, s51, v240
 v_cvt_pk_bf16_f32 v100, v152, v153
 v_cvt_pk_bf16_f32 v101, v154, v155
 v_cvt_pk_bf16_f32 v102, v156, v157
 v_cvt_pk_bf16_f32 v103, v158, v159
 v_dot2_f32_bf16 v144, v104, s50, v240
 v_dot2_f32_bf16 v145, v104, s51, v240
 v_dot2_f32_bf16 v146, v105, s50, v240
 v_dot2_f32_bf16 v147, v105, s51, v240
 v_dot2_f32_bf16 v148, v106, s50, v240
 v_dot2_f32_bf16 v149, v106, s51, v240
 v_dot2_f32_bf16 v150, v107, s50, v240
 v_dot2_f32_bf16 v151, v107, s51, v240
 v_cvt_pk_bf16_f32 v104, v144, v145
 v_cvt_pk_bf16_f32 v105, v146, v147
 v_cvt_pk_bf16_f32 v106, v148, v149
 v_cvt_pk_bf16_f32 v107, v150, v151
 v_dot2_f32_bf16 v152, v108, s50, v240
 v_dot2_f32_bf16 v153, v108, s51, v240
 v_dot2_f32_bf16 v154, v109, s50, v240
 v_dot2_f32_bf16 v155, v109, s51, v240
 v_dot2_f32_bf16 v156, v110, s50, v240
 v_dot2_f32_bf16 v157, v110, s51, v240
 v_dot2_f32_bf16 v158, v111, s50, v240
 v_dot2_f32_bf16 v159, v111, s51, v240
 v_cvt_pk_bf16_f32 v108, v152, v153
 v_cvt_pk_bf16_f32 v109, v154, v155
 v_cvt_pk_bf16_f32 v110, v156, v157
 v_cvt_pk_bf16_f32 v111, v158, v159
 global_load_dwordx4 v[248:251], v253, s[4:5]
 s_add_u32 s4, s4, 4096
 s_addc_u32 s5, s5, 0
 v_dot2_f32_bf16 v144, v112, s50, v240
 v_dot2_f32_bf16 v145, v112, s51, v240
 v_dot2_f32_bf16 v146, v113, s50, v240
 v_dot2_f32_bf16 v147, v113, s51, v240
 v_dot2_f32_bf16 v148, v114, s50, v240
 v_dot2_f32_bf16 v149, v114, s51, v240
 v_dot2_f32_bf16 v150, v115, s50, v240
 v_dot2_f32_bf16 v151, v115, s51, v240
 v_cvt_pk_bf16_f32 v112, v144, v145
 v_cvt_pk_bf16_f32 v113, v146, v147
 v_cvt_pk_bf16_f32 v114, v148, v149
 v_cvt_pk_bf16_f32 v115, v150, v151
 v_dot2_f32_bf16 v152, v116, s50, v240
 v_dot2_f32_bf16 v153, v116, s51, v240
 v_dot2_f32_bf16 v154, v117, s50, v240
 v_dot2_f32_bf16 v155, v117, s51, v240
 v_dot2_f32_bf16 v156, v118, s50, v240
 v_dot2_f32_bf16 v157, v118, s51, v240
 v_dot2_f32_bf16 v158, v119, s50, v240
 v_dot2_f32_bf16 v159, v119, s51, v240
 v_cvt_pk_bf16_f32 v116, v152, v153
 v_cvt_pk_bf16_f32 v117, v154, v155
 v_cvt_pk_bf16_f32 v118, v156, v157
 v_cvt_pk_bf16_f32 v119, v158, v159
 v_dot2_f32_bf16 v144, v120, s50, v240
 v_dot2_f32_bf16 v145, v120, s51, v240
 v_dot2_f32_bf16 v146, v121, s50, v240
 v_dot2_f32_bf16 v147, v121, s51, v240
 v_dot2_f32_bf16 v148, v122, s50, v240
 v_dot2_f32_bf16 v149, v122, s51, v240
 v_dot2_f32_bf16 v150, v123, s50, v240
 v_dot2_f32_bf16 v151, v123, s51, v240
 v_cvt_pk_bf16_f32 v120, v144, v145
 v_cvt_pk_bf16_f32 v121, v146, v147
 v_cvt_pk_bf16_f32 v122, v148, v149
 v_cvt_pk_bf16_f32 v123, v150, v151
 v_dot2_f32_bf16 v152, v124, s50, v240
 v_dot2_f32_bf16 v153, v124, s51, v240
 v_dot2_f32_bf16 v154, v125, s50, v240
 v_dot2_f32_bf16 v155, v125, s51, v240
 v_dot2_f32_bf16 v156, v126, s50, v240
 v_dot2_f32_bf16 v157, v126, s51, v240
 v_dot2_f32_bf16 v158, v127, s50, v240
 v_dot2_f32_bf16 v159, v127, s51, v240
 v_cvt_pk_bf16_f32 v124, v152, v153
 v_cvt_pk_bf16_f32 v125, v154, v155
 v_cvt_pk_bf16_f32 v126, v156, v157
 v_cvt_pk_bf16_f32 v127, v158, v159
 global_load_dwordx4 v[248:251], v253, s[4:5]
 s_add_u32 s4, s4, 4096
 s_addc_u32 s5, s5, 0
 v_dot2_f32_bf16 v144, v128, s50, v240
 v_dot2_f32_bf16 v145, v128, s51, v240
 v_dot2_f32_bf16 v146, v129, s50, v240
 v_dot2_f32_bf16 v147, v129, s51, v240
 v_dot2_f32_bf16 v148, v130, s50, v240
 v_dot2_f32_bf16 v149, v130, s51, v240
 v_dot2_f32_bf16 v150, v131, s50, v240
 v_dot2_f32_bf16 v151, v131, s51, v240
 v_cvt_pk_bf16_f32 v128, v144, v145
 v_cvt_pk_bf16_f32 v129, v146, v147
 v_cvt_pk_bf16_f32 v130, v148, v149
 v_cvt_pk_bf16_f32 v131, v150, v151
 v_dot2_f32_bf16 v152, v132, s50, v240
 v_dot2_f32_bf16 v153, v132, s51, v240
 v_dot2_f32_bf16 v154, v133, s50, v240
 v_dot2_f32_bf16 v155, v133, s51, v240
 v_dot2_f32_bf16 v156, v134, s50, v240
 v_dot2_f32_bf16 v157, v134, s51, v240
 v_dot2_f32_bf16 v158, v135, s50, v240
 v_dot2_f32_bf16 v159, v135, s51, v240
 v_cvt_pk_bf16_f32 v132, v152, v153
 v_cvt_pk_bf16_f32 v133, v154, v155
 v_cvt_pk_bf16_f32 v134, v156, v157
 v_cvt_pk_bf16_f32 v135, v158, v159
 v_dot2_f32_bf16 v144, v136, s50, v240
 v_dot2_f32_bf16 v145, v136, s51, v240
 v_dot2_f32_bf16 v146, v137, s50, v240
 v_dot2_f32_bf16 v147, v137, s51, v240
 v_dot2_f32_bf16 v148, v138, s50, v240
 v_dot2_f32_bf16 v149, v138, s51, v240
 v_dot2_f32_bf16 v150, v139, s50, v240
 v_dot2_f32_bf16 v151, v139, s51, v240
 v_cvt_pk_bf16_f32 v136, v144, v145
 v_cvt_pk_bf16_f32 v137, v146, v147
 v_cvt_pk_bf16_f32 v138, v148, v149
 v_cvt_pk_bf16_f32 v139, v150, v151
 v_dot2_f32_bf16 v152, v140, s50, v240
 v_dot2_f32_bf16 v153, v140, s51, v240
 v_dot2_f32_bf16 v154, v141, s50, v240
 v_dot2_f32_bf16 v155, v141, s51, v240
 v_dot2_f32_bf16 v156, v142, s50, v240
 v_dot2_f32_bf16 v157, v142, s51, v240
 v_dot2_f32_bf16 v158, v143, s50, v240
 v_dot2_f32_bf16 v159, v143, s51, v240
 v_cvt_pk_bf16_f32 v140, v152, v153
 v_cvt_pk_bf16_f32 v141, v154, v155
 v_cvt_pk_bf16_f32 v142, v156, v157
 v_cvt_pk_bf16_f32 v143, v158, v159
 s_waitcnt vmcnt(15)
 s_barrier
 ds_read_b64_tr_b16 v[208:209], v232 offset:0
 ds_read_b64_tr_b16 v[210:211], v232 offset:512
 ds_read_b64_tr_b16 v[212:213], v233 offset:0
 ds_read_b64_tr_b16 v[214:215], v233 offset:512
 ds_read_b64_tr_b16 v[216:217], v232 offset:2048
 ds_read_b64_tr_b16 v[218:219], v232 offset:2560
 ds_read_b64_tr_b16 v[220:221], v233 offset:2048
 ds_read_b64_tr_b16 v[222:223], v233 offset:2560
L1_wm:
 s_mul_i32 s52, s24, 36864
 s_lshl_b32 s3, s25, 5
 s_add_u32 s52, s52, s3
 s_add_u32 s6, s52, 11903488
 s_add_u32 s7, s52, 7184896
 s_mov_b32 s53, 0xbdd2d3e8
 s_waitcnt lgkmcnt(4)
 v_mfma_f32_32x32x16_bf16 v[144:159], v[208:211], v[0:3], 0
 ds_read_b64_tr_b16 v[224:225], v232 offset:4096
 ds_read_b64_tr_b16 v[226:227], v232 offset:4608
 v_mfma_f32_32x32x16_bf16 v[160:175], v[212:215], v[0:3], 0
 ds_read_b64_tr_b16 v[228:229], v233 offset:4096
 ds_read_b64_tr_b16 v[230:231], v233 offset:4608
 s_waitcnt lgkmcnt(4)
 v_mfma_f32_32x32x16_bf16 v[144:159], v[216:219], v[4:7], v[144:159]
 ds_read_b64_tr_b16 v[208:209], v232 offset:6144
 ds_read_b64_tr_b16 v[210:211], v232 offset:6656
 v_mfma_f32_32x32x16_bf16 v[160:175], v[220:223], v[4:7], v[160:175]
 ds_read_b64_tr_b16 v[212:213], v233 offset:6144
 ds_read_b64_tr_b16 v[214:215], v233 offset:6656
 s_waitcnt lgkmcnt(4)
 v_mfma_f32_32x32x16_bf16 v[144:159], v[224:227], v[8:11], v[144:159]
 ds_read_b64_tr_b16 v[216:217], v232 offset:8192
 ds_read_b64_tr_b16 v[218:219], v232 offset:8704
 v_mfma_f32_32x32x16_bf16 v[160:175], v[228:231], v[8:11], v[160:175]
 ds_read_b64_tr_b16 v[220:221], v233 offset:8192
 ds_read_b64_tr_b16 v[222:223], v233 offset:8704
 s_waitcnt lgkmcnt(4)
 v_mfma_f32_32x32x16_bf16 v[144:159], v[208:211], v[12:15], v[144:159]
 ds_read_b64_tr_b16 v[224:225], v232 offset:10240
 ds_read_b64_tr_b16 v[226:227], v232 offset:10752
 v_mfma_f32_32x32x16_bf16 v[160:175], v[212:215], v[12:15], v[160:175]
 ds_read_b64_tr_b16 v[228:229], v233 offset:10240
 ds_read_b64_tr_b16 v[230:231], v233 offset:10752
 s_waitcnt lgkmcnt(4)
 v_mfma_f32_32x32x16_bf16 v[144:159], v[216:219], v[16:19], v[144:159]
 ds_read_b64_tr_b16 v[208:209], v232 offset:12288
 ds_read_b64_tr_b16 v[210:211], v232 offset:12800
 v_mfma_f32_32x32x16_bf16 v[160:175], v[220:223], v[16:19], v[160:175]
 ds_read_b64_tr_b16 v[212:213], v233 offset:12288
 ds_read_b64_tr_b16 v[214:215], v233 offset:12800
 s_waitcnt lgkmcnt(4)
 v_mfma_f32_32x32x16_bf16 v[144:159], v[224:227], v[20:23], v[144:159]
 ds_read_b64_tr_b16 v[216:217], v232 offset:14336
 ds_read_b64_tr_b16 v[218:219], v232 offset:14848
 v_mfma_f32_32x32x16_bf16 v[160:175], v[228:231], v[20:23], v[160:175]
 ds_read_b64_tr_b16 v[220:221], v233 offset:14336
 ds_read_b64_tr_b16 v[222:223], v233 offset:14848
 s_waitcnt lgkmcnt(4)
 v_mfma_f32_32x32x16_bf16 v[144:159], v[208:211], v[24:27], v[144:159]
 ds_read_b64_tr_b16 v[224:225], v232 offset:16384
 ds_read_b64_tr_b16 v[226:227], v232 offset:16896
 v_mfma_f32_32x32x16_bf16 v[160:175], v[212:215], v[24:27], v[160:175]
 ds_read_b64_tr_b16 v[228:229], v233 offset:16384
 ds_read_b64_tr_b16 v[230:231], v233 offset:16896
 s_waitcnt lgkmcnt(4)
 v_mfma_f32_32x32x16_bf16 v[144:159], v[216:219], v[28:31], v[144:159]
 ds_read_b64_tr_b16 v[208:209], v232 offset:18432
 ds_read_b64_tr_b16 v[210:211], v232 offset:18944
 v_mfma_f32_32x32x16_bf16 v[160:175], v[220:223], v[28:31], v[160:175]
 ds_read_b64_tr_b16 v[212:213], v233 offset:18432
 ds_read_b64_tr_b16 v[214:215], v233 offset:18944
 s_waitcnt lgkmcnt(4)
 v_mfma_f32_32x32x16_bf16 v[144:159], v[224:227], v[32:35], v[144:159]
 ds_read_b64_tr_b16 v[216:217], v232 offset:20480
 ds_read_b64_tr_b16 v[218:219], v232 offset:20992
 v_mfma_f32_32x32x16_bf16 v[160:175], v[228:231], v[32:35], v[160:175]
 ds_read_b64_tr_b16 v[220:221], v233 offset:20480
 ds_read_b64_tr_b16 v[222:223], v233 offset:20992
 s_waitcnt lgkmcnt(4)
 v_mfma_f32_32x32x16_bf16 v[144:159], v[208:211], v[36:39], v[144:159]
 ds_read_b64_tr_b16 v[224:225], v232 offset:22528
 ds_read_b64_tr_b16 v[226:227], v232 offset:23040
 v_mfma_f32_32x32x16_bf16 v[160:175], v[212:215], v[36:39], v[160:175]
 ds_read_b64_tr_b16 v[228:229], v233 offset:22528
 ds_read_b64_tr_b16 v[230:231], v233 offset:23040
 s_waitcnt vmcnt(8)
 s_barrier
 s_waitcnt lgkmcnt(4)
 v_mfma_f32_32x32x16_bf16 v[144:159], v[216:219], v[40:43], v[144:159]
 ds_read_b64_tr_b16 v[208:209], v232 offset:24576
 ds_read_b64_tr_b16 v[210:211], v232 offset:25088
 v_mfma_f32_32x32x16_bf16 v[160:175], v[220:223], v[40:43], v[160:175]
 ds_read_b64_tr_b16 v[212:213], v233 offset:24576
 ds_read_b64_tr_b16 v[214:215], v233 offset:25088
 s_waitcnt lgkmcnt(4)
 v_mfma_f32_32x32x16_bf16 v[144:159], v[224:227], v[44:47], v[144:159]
 ds_read_b64_tr_b16 v[216:217], v232 offset:26624
 ds_read_b64_tr_b16 v[218:219], v232 offset:27136
 v_mfma_f32_32x32x16_bf16 v[160:175], v[228:231], v[44:47], v[160:175]
 ds_read_b64_tr_b16 v[220:221], v233 offset:26624
 ds_read_b64_tr_b16 v[222:223], v233 offset:27136
 s_waitcnt lgkmcnt(4)
 v_mfma_f32_32x32x16_bf16 v[144:159], v[208:211], v[48:51], v[144:159]
 ds_read_b64_tr_b16 v[224:225], v232 offset:28672
 ds_read_b64_tr_b16 v[226:227], v232 offset:29184
 s_waitcnt vmcnt(0)
 v_mul_f32 v240, v240, v241
 v_mfma_f32_32x32x16_bf16 v[160:175], v[212:215], v[48:51], v[160:175]
 ds_read_b64_tr_b16 v[228:229], v233 offset:28672
 ds_read_b64_tr_b16 v[230:231], v233 offset:29184
 s_nop 1
 v_permlane32_swap_b32 v192, v194
 v_permlane32_swap_b32 v193, v195
 buffer_store_dwordx4 v[192:195], v254, s[16:19], s6 offen offset:0 sc1
 v_lshlrev_b32 v248, 16, v192
 s_waitcnt lgkmcnt(4)
 v_mfma_f32_32x32x16_bf16 v[144:159], v[216:219], v[52:55], v[144:159]
 ds_read_b64_tr_b16 v[208:209], v232 offset:30720
 ds_read_b64_tr_b16 v[210:211], v232 offset:31232
 v_and_b32 v249, 0xffff0000, v192
 v_fma_f32 v248, v248, v241, v240
 v_mfma_f32_32x32x16_bf16 v[160:175], v[220:223], v[52:55], v[160:175]
 ds_read_b64_tr_b16 v[212:213], v233 offset:30720
 ds_read_b64_tr_b16 v[214:215], v233 offset:31232
 v_fma_f32 v249, v249, v241, v240
 v_cvt_pk_bf16_f32 v176, v248, v249
 s_waitcnt lgkmcnt(4)
 v_mfma_f32_32x32x16_bf16 v[144:159], v[224:227], v[56:59], v[144:159]
 ds_read_b64_tr_b16 v[216:217], v232 offset:32768
 ds_read_b64_tr_b16 v[218:219], v232 offset:33280
 v_lshlrev_b32 v248, 16, v193
 v_and_b32 v249, 0xffff0000, v193
 v_mfma_f32_32x32x16_bf16 v[160:175], v[228:231], v[56:59], v[160:175]
 ds_read_b64_tr_b16 v[220:221], v233 offset:32768
 ds_read_b64_tr_b16 v[222:223], v233 offset:33280
 v_fma_f32 v248, v248, v241, v240
 v_fma_f32 v249, v249, v241, v240
 s_waitcnt lgkmcnt(4)
 v_mfma_f32_32x32x16_bf16 v[144:159], v[208:211], v[60:63], v[144:159]
 ds_read_b64_tr_b16 v[224:225], v232 offset:34816
 ds_read_b64_tr_b16 v[226:227], v232 offset:35328
 v_cvt_pk_bf16_f32 v177, v248, v249
 v_lshlrev_b32 v248, 16, v194
 v_mfma_f32_32x32x16_bf16 v[160:175], v[212:215], v[60:63], v[160:175]
 ds_read_b64_tr_b16 v[228:229], v233 offset:34816
 ds_read_b64_tr_b16 v[230:231], v233 offset:35328
 v_and_b32 v249, 0xffff0000, v194
 v_fma_f32 v248, v248, v241, v240
 s_waitcnt lgkmcnt(4)
 v_mfma_f32_32x32x16_bf16 v[144:159], v[216:219], v[64:67], v[144:159]
 ds_read_b64_tr_b16 v[208:209], v232 offset:36864
 ds_read_b64_tr_b16 v[210:211], v232 offset:37376
 v_fma_f32 v249, v249, v241, v240
 v_cvt_pk_bf16_f32 v178, v248, v249
 v_mfma_f32_32x32x16_bf16 v[160:175], v[220:223], v[64:67], v[160:175]
 ds_read_b64_tr_b16 v[212:213], v233 offset:36864
 ds_read_b64_tr_b16 v[214:215], v233 offset:37376
 v_lshlrev_b32 v248, 16, v195
 v_and_b32 v249, 0xffff0000, v195
 s_waitcnt lgkmcnt(4)
 v_mfma_f32_32x32x16_bf16 v[144:159], v[224:227], v[68:71], v[144:159]
 ds_read_b64_tr_b16 v[216:217], v232 offset:38912
 ds_read_b64_tr_b16 v[218:219], v232 offset:39424
 v_fma_f32 v248, v248, v241, v240
 v_fma_f32 v249, v249, v241, v240
 v_mfma_f32_32x32x16_bf16 v[160:175], v[228:231], v[68:71], v[160:175]
 ds_read_b64_tr_b16 v[220:221], v233 offset:38912
 ds_read_b64_tr_b16 v[222:223], v233 offset:39424
 v_cvt_pk_bf16_f32 v179, v248, v249
 s_nop 1
 v_permlane32_swap_b32 v196, v198
 v_permlane32_swap_b32 v197, v199
 buffer_store_dwordx4 v[196:199], v254, s[16:19], s6 offen offset:1024 sc1
 s_waitcnt lgkmcnt(4)
 v_mfma_f32_32x32x16_bf16 v[144:159], v[208:211], v[72:75], v[144:159]
 ds_read_b64_tr_b16 v[224:225], v232 offset:40960
 ds_read_b64_tr_b16 v[226:227], v232 offset:41472
 v_lshlrev_b32 v248, 16, v196
 v_and_b32 v249, 0xffff0000, v196
 v_mfma_f32_32x32x16_bf16 v[160:175], v[212:215], v[72:75], v[160:175]
 ds_read_b64_tr_b16 v[228:229], v233 offset:40960
 ds_read_b64_tr_b16 v[230:231], v233 offset:41472
 v_fma_f32 v248, v248, v241, v240
 v_fma_f32 v249, v249, v241, v240
 s_waitcnt lgkmcnt(4)
 v_mfma_f32_32x32x16_bf16 v[144:159], v[216:219], v[76:79], v[144:159]
 ds_read_b64_tr_b16 v[208:209], v232 offset:43008
 ds_read_b64_tr_b16 v[210:211], v232 offset:43520
 v_cvt_pk_bf16_f32 v180, v248, v249
 v_lshlrev_b32 v248, 16, v197
 v_mfma_f32_32x32x16_bf16 v[160:175], v[220:223], v[76:79], v[160:175]
 ds_read_b64_tr_b16 v[212:213], v233 offset:43008
 ds_read_b64_tr_b16 v[214:215], v233 offset:43520
 v_and_b32 v249, 0xffff0000, v197
 v_fma_f32 v248, v248, v241, v240
 s_waitcnt lgkmcnt(4)
 v_mfma_f32_32x32x16_bf16 v[144:159], v[224:227], v[80:83], v[144:159]
 ds_read_b64_tr_b16 v[216:217], v232 offset:45056
 ds_read_b64_tr_b16 v[218:219], v232 offset:45568
 v_fma_f32 v249, v249, v241, v240
 v_cvt_pk_bf16_f32 v181, v248, v249
 v_mfma_f32_32x32x16_bf16 v[160:175], v[228:231], v[80:83], v[160:175]
 ds_read_b64_tr_b16 v[220:221], v233 offset:45056
 ds_read_b64_tr_b16 v[222:223], v233 offset:45568
 v_lshlrev_b32 v248, 16, v198
 v_and_b32 v249, 0xffff0000, v198
 s_waitcnt lgkmcnt(4)
 v_mfma_f32_32x32x16_bf16 v[144:159], v[208:211], v[84:87], v[144:159]
 ds_read_b64_tr_b16 v[224:225], v232 offset:47104
 ds_read_b64_tr_b16 v[226:227], v232 offset:47616
 v_fma_f32 v248, v248, v241, v240
 v_fma_f32 v249, v249, v241, v240
 v_mfma_f32_32x32x16_bf16 v[160:175], v[212:215], v[84:87], v[160:175]
 ds_read_b64_tr_b16 v[228:229], v233 offset:47104
 ds_read_b64_tr_b16 v[230:231], v233 offset:47616
 s_waitcnt vmcnt(4)
 s_barrier
 s_waitcnt lgkmcnt(4)
 v_mfma_f32_32x32x16_bf16 v[144:159], v[216:219], v[88:91], v[144:159]
 ds_read_b64_tr_b16 v[208:209], v234 offset:0
 ds_read_b64_tr_b16 v[210:211], v234 offset:512
 v_cvt_pk_bf16_f32 v182, v248, v249
 v_lshlrev_b32 v248, 16, v199
 v_mfma_f32_32x32x16_bf16 v[160:175], v[220:223], v[88:91], v[160:175]
 ds_read_b64_tr_b16 v[212:213], v235 offset:0
 ds_read_b64_tr_b16 v[214:215], v235 offset:512
 v_and_b32 v249, 0xffff0000, v199
 v_fma_f32 v248, v248, v241, v240
 s_waitcnt lgkmcnt(4)
 v_mfma_f32_32x32x16_bf16 v[144:159], v[224:227], v[92:95], v[144:159]
 ds_read_b64_tr_b16 v[216:217], v234 offset:2048
 ds_read_b64_tr_b16 v[218:219], v234 offset:2560
 v_fma_f32 v249, v249, v241, v240
 s_lshr_b32 s3, s25, 7
 s_mul_i32 s4, s26, 9
 s_add_u32 s3, s3, s4
 s_mul_i32 s4, s3, 36864
 v_mfma_f32_32x32x16_bf16 v[160:175], v[228:231], v[92:95], v[160:175]
 ds_read_b64_tr_b16 v[220:221], v235 offset:2048
 ds_read_b64_tr_b16 v[222:223], v235 offset:2560
 v_cvt_pk_bf16_f32 v183, v248, v249
 s_nop 1
 v_permlane32_swap_b32 v200, v202
 v_permlane32_swap_b32 v201, v203
 buffer_store_dwordx4 v[200:203], v254, s[16:19], s6 offen offset:2048 sc1
 s_mov_b32 s8, s96
 s_and_b32 s9, s97, 0xffff
 s_mov_b32 s10, 0x510000
 s_mov_b32 s11, 0x20000
 s_waitcnt lgkmcnt(4)
 v_mfma_f32_32x32x16_bf16 v[144:159], v[208:211], v[96:99], v[144:159]
 ds_read_b64_tr_b16 v[224:225], v234 offset:4096
 ds_read_b64_tr_b16 v[226:227], v234 offset:4608
 v_lshlrev_b32 v248, 16, v200
 v_and_b32 v249, 0xffff0000, v200
 v_mfma_f32_32x32x16_bf16 v[160:175], v[212:215], v[96:99], v[160:175]
 ds_read_b64_tr_b16 v[228:229], v235 offset:4096
 ds_read_b64_tr_b16 v[230:231], v235 offset:4608
 v_fma_f32 v248, v248, v241, v240
 v_fma_f32 v249, v249, v241, v240
 buffer_load_dword v252, v253, s[8:11], s4 offen
 s_add_u32 s4, s4, 4096
 s_waitcnt lgkmcnt(4)
 v_mfma_f32_32x32x16_bf16 v[144:159], v[216:219], v[100:103], v[144:159]
 ds_read_b64_tr_b16 v[208:209], v234 offset:6144
 ds_read_b64_tr_b16 v[210:211], v234 offset:6656
 v_cvt_pk_bf16_f32 v184, v248, v249
 v_lshlrev_b32 v248, 16, v201
 v_mfma_f32_32x32x16_bf16 v[160:175], v[220:223], v[100:103], v[160:175]
 ds_read_b64_tr_b16 v[212:213], v235 offset:6144
 ds_read_b64_tr_b16 v[214:215], v235 offset:6656
 v_and_b32 v249, 0xffff0000, v201
 v_fma_f32 v248, v248, v241, v240
 buffer_load_dword v252, v253, s[8:11], s4 offen
 s_add_u32 s4, s4, 4096
 s_waitcnt lgkmcnt(4)
 v_mfma_f32_32x32x16_bf16 v[144:159], v[224:227], v[104:107], v[144:159]
 ds_read_b64_tr_b16 v[216:217], v234 offset:8192
 ds_read_b64_tr_b16 v[218:219], v234 offset:8704
 v_fma_f32 v249, v249, v241, v240
 v_cvt_pk_bf16_f32 v185, v248, v249
 v_mfma_f32_32x32x16_bf16 v[160:175], v[228:231], v[104:107], v[160:175]
 ds_read_b64_tr_b16 v[220:221], v235 offset:8192
 ds_read_b64_tr_b16 v[222:223], v235 offset:8704
 v_lshlrev_b32 v248, 16, v202
 v_and_b32 v249, 0xffff0000, v202
 buffer_load_dword v252, v253, s[8:11], s4 offen
 s_add_u32 s4, s4, 4096
 s_waitcnt lgkmcnt(4)
 v_mfma_f32_32x32x16_bf16 v[144:159], v[208:211], v[108:111], v[144:159]
 ds_read_b64_tr_b16 v[224:225], v234 offset:10240
 ds_read_b64_tr_b16 v[226:227], v234 offset:10752
 v_fma_f32 v248, v248, v241, v240
 v_fma_f32 v249, v249, v241, v240
 v_mfma_f32_32x32x16_bf16 v[160:175], v[212:215], v[108:111], v[160:175]
 ds_read_b64_tr_b16 v[228:229], v235 offset:10240
 ds_read_b64_tr_b16 v[230:231], v235 offset:10752
 v_cvt_pk_bf16_f32 v186, v248, v249
 v_lshlrev_b32 v248, 16, v203
 buffer_load_dword v252, v253, s[8:11], s4 offen
 s_add_u32 s4, s4, 4096
 s_waitcnt lgkmcnt(4)
 v_mfma_f32_32x32x16_bf16 v[144:159], v[216:219], v[112:115], v[144:159]
 ds_read_b64_tr_b16 v[208:209], v234 offset:12288
 ds_read_b64_tr_b16 v[210:211], v234 offset:12800
 v_and_b32 v249, 0xffff0000, v203
 v_fma_f32 v248, v248, v241, v240
 v_mfma_f32_32x32x16_bf16 v[160:175], v[220:223], v[112:115], v[160:175]
 ds_read_b64_tr_b16 v[212:213], v235 offset:12288
 ds_read_b64_tr_b16 v[214:215], v235 offset:12800
 v_fma_f32 v249, v249, v241, v240
 v_cvt_pk_bf16_f32 v187, v248, v249
 buffer_load_dword v252, v253, s[8:11], s4 offen
 s_add_u32 s4, s4, 4096
 s_waitcnt lgkmcnt(4)
 v_mfma_f32_32x32x16_bf16 v[144:159], v[224:227], v[116:119], v[144:159]
 ds_read_b64_tr_b16 v[216:217], v234 offset:14336
 ds_read_b64_tr_b16 v[218:219], v234 offset:14848
 s_nop 1
 v_permlane32_swap_b32 v204, v206
 v_permlane32_swap_b32 v205, v207
 buffer_store_dwordx4 v[204:207], v254, s[16:19], s6 offen offset:3072 sc1
 v_lshlrev_b32 v248, 16, v204
 v_mfma_f32_32x32x16_bf16 v[160:175], v[228:231], v[116:119], v[160:175]
 ds_read_b64_tr_b16 v[220:221], v235 offset:14336
 ds_read_b64_tr_b16 v[222:223], v235 offset:14848
 v_and_b32 v249, 0xffff0000, v204
 v_fma_f32 v248, v248, v241, v240
 buffer_load_dword v252, v253, s[8:11], s4 offen
 s_add_u32 s4, s4, 4096
 s_waitcnt lgkmcnt(4)
 v_mfma_f32_32x32x16_bf16 v[144:159], v[208:211], v[120:123], v[144:159]
 ds_read_b64_tr_b16 v[224:225], v234 offset:16384
 ds_read_b64_tr_b16 v[226:227], v234 offset:16896
 v_fma_f32 v249, v249, v241, v240
 v_cvt_pk_bf16_f32 v188, v248, v249
 v_mfma_f32_32x32x16_bf16 v[160:175], v[212:215], v[120:123], v[160:175]
 ds_read_b64_tr_b16 v[228:229], v235 offset:16384
 ds_read_b64_tr_b16 v[230:231], v235 offset:16896
 v_lshlrev_b32 v248, 16, v205
 v_and_b32 v249, 0xffff0000, v205
 buffer_load_dword v252, v253, s[8:11], s4 offen
 s_add_u32 s4, s4, 4096
 s_waitcnt lgkmcnt(4)
 v_mfma_f32_32x32x16_bf16 v[144:159], v[216:219], v[124:127], v[144:159]
 ds_read_b64_tr_b16 v[208:209], v234 offset:18432
 ds_read_b64_tr_b16 v[210:211], v234 offset:18944
 v_fma_f32 v248, v248, v241, v240
 v_fma_f32 v249, v249, v241, v240
 v_mfma_f32_32x32x16_bf16 v[160:175], v[220:223], v[124:127], v[160:175]
 ds_read_b64_tr_b16 v[212:213], v235 offset:18432
 ds_read_b64_tr_b16 v[214:215], v235 offset:18944
 v_cvt_pk_bf16_f32 v189, v248, v249
 v_lshlrev_b32 v248, 16, v206
 buffer_load_dword v252, v253, s[8:11], s4 offen
 s_add_u32 s4, s4, 4096
 s_waitcnt lgkmcnt(4)
 v_mfma_f32_32x32x16_bf16 v[144:159], v[224:227], v[128:131], v[144:159]
 ds_read_b64_tr_b16 v[216:217], v234 offset:20480
 ds_read_b64_tr_b16 v[218:219], v234 offset:20992
 v_and_b32 v249, 0xffff0000, v206
 v_fma_f32 v248, v248, v241, v240
 v_mfma_f32_32x32x16_bf16 v[160:175], v[228:231], v[128:131], v[160:175]
 ds_read_b64_tr_b16 v[220:221], v235 offset:20480
 ds_read_b64_tr_b16 v[222:223], v235 offset:20992
 v_fma_f32 v249, v249, v241, v240
 v_cvt_pk_bf16_f32 v190, v248, v249
 buffer_load_dword v252, v253, s[8:11], s4 offen
 s_add_u32 s4, s4, 4096
 s_waitcnt lgkmcnt(4)
 v_mfma_f32_32x32x16_bf16 v[144:159], v[208:211], v[132:135], v[144:159]
 ds_read_b64_tr_b16 v[224:225], v234 offset:22528
 ds_read_b64_tr_b16 v[226:227], v234 offset:23040
 v_lshlrev_b32 v248, 16, v207
 v_and_b32 v249, 0xffff0000, v207
 v_mfma_f32_32x32x16_bf16 v[160:175], v[212:215], v[132:135], v[160:175]
 ds_read_b64_tr_b16 v[228:229], v235 offset:22528
 ds_read_b64_tr_b16 v[230:231], v235 offset:23040
 s_waitcnt lgkmcnt(4)
 v_mfma_f32_32x32x16_bf16 v[144:159], v[216:219], v[136:139], v[144:159]
 v_fma_f32 v248, v248, v241, v240
 v_fma_f32 v249, v249, v241, v240
 v_mfma_f32_32x32x16_bf16 v[160:175], v[220:223], v[136:139], v[160:175]
 v_cvt_pk_bf16_f32 v191, v248, v249
 s_waitcnt lgkmcnt(0)
 v_mfma_f32_32x32x16_bf16 v[144:159], v[224:227], v[140:143], v[144:159]
 v_mfma_f32_32x32x16_bf16 v[160:175], v[228:231], v[140:143], v[160:175]
 v_mov_b32 v245, 0xc0135761
 s_nop 10
 v_mul_f32 v144, v242, v144
 v_mul_f32 v145, v242, v145
 v_mul_f32 v246, v144, v144
 v_mul_f32 v247, v145, v145
 v_fma_f32 v246, v246, s53, v245
 v_fma_f32 v247, v247, s53, v245
 v_mul_f32 v246, v246, v144
 v_mul_f32 v247, v247, v145
 v_exp_f32 v246, v246
 v_exp_f32 v247, v247
 v_add_f32 v246, 1.0, v246
 v_add_f32 v247, 1.0, v247
 v_rcp_f32 v246, v246
 v_rcp_f32 v247, v247
 v_mul_f32 v144, v246, v144
 v_mul_f32 v145, v247, v145
 v_cvt_pk_bf16_f32 v144, v144, v145
 v_mul_f32 v146, v242, v146
 v_mul_f32 v147, v242, v147
 v_mul_f32 v246, v146, v146
 v_mul_f32 v247, v147, v147
 v_fma_f32 v246, v246, s53, v245
 v_fma_f32 v247, v247, s53, v245
 v_mul_f32 v246, v246, v146
 v_mul_f32 v247, v247, v147
 v_exp_f32 v246, v246
 v_exp_f32 v247, v247
 v_add_f32 v246, 1.0, v246
 v_add_f32 v247, 1.0, v247
 v_rcp_f32 v246, v246
 v_rcp_f32 v247, v247
 v_mul_f32 v146, v246, v146
 v_mul_f32 v147, v247, v147
 v_cvt_pk_bf16_f32 v145, v146, v147
 v_mul_f32 v148, v242, v148
 v_mul_f32 v149, v242, v149
 v_mul_f32 v246, v148, v148
 v_mul_f32 v247, v149, v149
 v_fma_f32 v246, v246, s53, v245
 v_fma_f32 v247, v247, s53, v245
 v_mul_f32 v246, v246, v148
 v_mul_f32 v247, v247, v149
 v_exp_f32 v246, v246
 v_exp_f32 v247, v247
 v_add_f32 v246, 1.0, v246
 v_add_f32 v247, 1.0, v247
 v_rcp_f32 v246, v246
 v_rcp_f32 v247, v247
 v_mul_f32 v148, v246, v148
 v_mul_f32 v149, v247, v149
 v_cvt_pk_bf16_f32 v146, v148, v149
 v_mul_f32 v150, v242, v150
 v_mul_f32 v151, v242, v151
 v_mul_f32 v246, v150, v150
 v_mul_f32 v247, v151, v151
 v_fma_f32 v246, v246, s53, v245
 v_fma_f32 v247, v247, s53, v245
 v_mul_f32 v246, v246, v150
 v_mul_f32 v247, v247, v151
 v_exp_f32 v246, v246
 v_exp_f32 v247, v247
 v_add_f32 v246, 1.0, v246
 v_add_f32 v247, 1.0, v247
 v_rcp_f32 v246, v246
 v_rcp_f32 v247, v247
 v_mul_f32 v150, v246, v150
 v_mul_f32 v151, v247, v151
 v_cvt_pk_bf16_f32 v147, v150, v151
 buffer_store_dwordx4 v[144:147], v254, s[16:19], s7 offen offset:0 sc1
 v_mul_f32 v152, v242, v152
 v_mul_f32 v153, v242, v153
 v_mul_f32 v246, v152, v152
 v_mul_f32 v247, v153, v153
 v_fma_f32 v246, v246, s53, v245
 v_fma_f32 v247, v247, s53, v245
 v_mul_f32 v246, v246, v152
 v_mul_f32 v247, v247, v153
 v_exp_f32 v246, v246
 v_exp_f32 v247, v247
 v_add_f32 v246, 1.0, v246
 v_add_f32 v247, 1.0, v247
 v_rcp_f32 v246, v246
 v_rcp_f32 v247, v247
 v_mul_f32 v152, v246, v152
 v_mul_f32 v153, v247, v153
 v_cvt_pk_bf16_f32 v152, v152, v153
 v_mul_f32 v154, v242, v154
 v_mul_f32 v155, v242, v155
 v_mul_f32 v246, v154, v154
 v_mul_f32 v247, v155, v155
 v_fma_f32 v246, v246, s53, v245
 v_fma_f32 v247, v247, s53, v245
 v_mul_f32 v246, v246, v154
 v_mul_f32 v247, v247, v155
 v_exp_f32 v246, v246
 v_exp_f32 v247, v247
 v_add_f32 v246, 1.0, v246
 v_add_f32 v247, 1.0, v247
 v_rcp_f32 v246, v246
 v_rcp_f32 v247, v247
 v_mul_f32 v154, v246, v154
 v_mul_f32 v155, v247, v155
 v_cvt_pk_bf16_f32 v153, v154, v155
 v_mul_f32 v156, v242, v156
 v_mul_f32 v157, v242, v157
 v_mul_f32 v246, v156, v156
 v_mul_f32 v247, v157, v157
 v_fma_f32 v246, v246, s53, v245
 v_fma_f32 v247, v247, s53, v245
 v_mul_f32 v246, v246, v156
 v_mul_f32 v247, v247, v157
 v_exp_f32 v246, v246
 v_exp_f32 v247, v247
 v_add_f32 v246, 1.0, v246
 v_add_f32 v247, 1.0, v247
 v_rcp_f32 v246, v246
 v_rcp_f32 v247, v247
 v_mul_f32 v156, v246, v156
 v_mul_f32 v157, v247, v157
 v_cvt_pk_bf16_f32 v154, v156, v157
 v_mul_f32 v158, v242, v158
 v_mul_f32 v159, v242, v159
 v_mul_f32 v246, v158, v158
 v_mul_f32 v247, v159, v159
 v_fma_f32 v246, v246, s53, v245
 v_fma_f32 v247, v247, s53, v245
 v_mul_f32 v246, v246, v158
 v_mul_f32 v247, v247, v159
 v_exp_f32 v246, v246
 v_exp_f32 v247, v247
 v_add_f32 v246, 1.0, v246
 v_add_f32 v247, 1.0, v247
 v_rcp_f32 v246, v246
 v_rcp_f32 v247, v247
 v_mul_f32 v158, v246, v158
 v_mul_f32 v159, v247, v159
 v_cvt_pk_bf16_f32 v155, v158, v159
 buffer_store_dwordx4 v[152:155], v254, s[16:19], s7 offen offset:1024 sc1
 v_mul_f32 v160, v242, v160
 v_mul_f32 v161, v242, v161
 v_mul_f32 v246, v160, v160
 v_mul_f32 v247, v161, v161
 v_fma_f32 v246, v246, s53, v245
 v_fma_f32 v247, v247, s53, v245
 v_mul_f32 v246, v246, v160
 v_mul_f32 v247, v247, v161
 v_exp_f32 v246, v246
 v_exp_f32 v247, v247
 v_add_f32 v246, 1.0, v246
 v_add_f32 v247, 1.0, v247
 v_rcp_f32 v246, v246
 v_rcp_f32 v247, v247
 v_mul_f32 v160, v246, v160
 v_mul_f32 v161, v247, v161
 v_cvt_pk_bf16_f32 v160, v160, v161
 v_mul_f32 v162, v242, v162
 v_mul_f32 v163, v242, v163
 v_mul_f32 v246, v162, v162
 v_mul_f32 v247, v163, v163
 v_fma_f32 v246, v246, s53, v245
 v_fma_f32 v247, v247, s53, v245
 v_mul_f32 v246, v246, v162
 v_mul_f32 v247, v247, v163
 v_exp_f32 v246, v246
 v_exp_f32 v247, v247
 v_add_f32 v246, 1.0, v246
 v_add_f32 v247, 1.0, v247
 v_rcp_f32 v246, v246
 v_rcp_f32 v247, v247
 v_mul_f32 v162, v246, v162
 v_mul_f32 v163, v247, v163
 v_cvt_pk_bf16_f32 v161, v162, v163
 v_mul_f32 v164, v242, v164
 v_mul_f32 v165, v242, v165
 v_mul_f32 v246, v164, v164
 v_mul_f32 v247, v165, v165
 v_fma_f32 v246, v246, s53, v245
 v_fma_f32 v247, v247, s53, v245
 v_mul_f32 v246, v246, v164
 v_mul_f32 v247, v247, v165
 v_exp_f32 v246, v246
 v_exp_f32 v247, v247
 v_add_f32 v246, 1.0, v246
 v_add_f32 v247, 1.0, v247
 v_rcp_f32 v246, v246
 v_rcp_f32 v247, v247
 v_mul_f32 v164, v246, v164
 v_mul_f32 v165, v247, v165
 v_cvt_pk_bf16_f32 v162, v164, v165
 v_mul_f32 v166, v242, v166
 v_mul_f32 v167, v242, v167
 v_mul_f32 v246, v166, v166
 v_mul_f32 v247, v167, v167
 v_fma_f32 v246, v246, s53, v245
 v_fma_f32 v247, v247, s53, v245
 v_mul_f32 v246, v246, v166
 v_mul_f32 v247, v247, v167
 v_exp_f32 v246, v246
 v_exp_f32 v247, v247
 v_add_f32 v246, 1.0, v246
 v_add_f32 v247, 1.0, v247
 v_rcp_f32 v246, v246
 v_rcp_f32 v247, v247
 v_mul_f32 v166, v246, v166
 v_mul_f32 v167, v247, v167
 v_cvt_pk_bf16_f32 v163, v166, v167
 buffer_store_dwordx4 v[160:163], v254, s[16:19], s7 offen offset:2048 sc1
 v_mul_f32 v168, v242, v168
 v_mul_f32 v169, v242, v169
 v_mul_f32 v246, v168, v168
 v_mul_f32 v247, v169, v169
 v_fma_f32 v246, v246, s53, v245
 v_fma_f32 v247, v247, s53, v245
 v_mul_f32 v246, v246, v168
 v_mul_f32 v247, v247, v169
 v_exp_f32 v246, v246
 v_exp_f32 v247, v247
 v_add_f32 v246, 1.0, v246
 v_add_f32 v247, 1.0, v247
 v_rcp_f32 v246, v246
 v_rcp_f32 v247, v247
 v_mul_f32 v168, v246, v168
 v_mul_f32 v169, v247, v169
 v_cvt_pk_bf16_f32 v168, v168, v169
 v_mul_f32 v170, v242, v170
 v_mul_f32 v171, v242, v171
 v_mul_f32 v246, v170, v170
 v_mul_f32 v247, v171, v171
 v_fma_f32 v246, v246, s53, v245
 v_fma_f32 v247, v247, s53, v245
 v_mul_f32 v246, v246, v170
 v_mul_f32 v247, v247, v171
 v_exp_f32 v246, v246
 v_exp_f32 v247, v247
 v_add_f32 v246, 1.0, v246
 v_add_f32 v247, 1.0, v247
 v_rcp_f32 v246, v246
 v_rcp_f32 v247, v247
 v_mul_f32 v170, v246, v170
 v_mul_f32 v171, v247, v171
 v_cvt_pk_bf16_f32 v169, v170, v171
 v_mul_f32 v172, v242, v172
 v_mul_f32 v173, v242, v173
 v_mul_f32 v246, v172, v172
 v_mul_f32 v247, v173, v173
 v_fma_f32 v246, v246, s53, v245
 v_fma_f32 v247, v247, s53, v245
 v_mul_f32 v246, v246, v172
 v_mul_f32 v247, v247, v173
 v_exp_f32 v246, v246
 v_exp_f32 v247, v247
 v_add_f32 v246, 1.0, v246
 v_add_f32 v247, 1.0, v247
 v_rcp_f32 v246, v246
 v_rcp_f32 v247, v247
 v_mul_f32 v172, v246, v172
 v_mul_f32 v173, v247, v173
 v_cvt_pk_bf16_f32 v170, v172, v173
 v_mul_f32 v174, v242, v174
 v_mul_f32 v175, v242, v175
 v_mul_f32 v246, v174, v174
 v_mul_f32 v247, v175, v175
 v_fma_f32 v246, v246, s53, v245
 v_fma_f32 v247, v247, s53, v245
 v_mul_f32 v246, v246, v174
 v_mul_f32 v247, v247, v175
 v_exp_f32 v246, v246
 v_exp_f32 v247, v247
 v_add_f32 v246, 1.0, v246
 v_add_f32 v247, 1.0, v247
 v_rcp_f32 v246, v246
 v_rcp_f32 v247, v247
 v_mul_f32 v174, v246, v174
 v_mul_f32 v175, v247, v175
 v_cvt_pk_bf16_f32 v171, v174, v175
 buffer_store_dwordx4 v[168:171], v254, s[16:19], s7 offen offset:3072 sc1
 v_and_b32 v0, 31, v255
 s_lshl_b32 s3, s24, 5
 v_add_u32 v0, s3, v0
 s_movk_i32 s4, 0x800
 s_mov_b32 s5, 36864
 v_mov_b32 v3, 0x40000000
 v_subrev_u32 v1, 1, v0
 v_cmp_gt_u32 vcc, s4, v1
 v_lshrrev_b32 v2, 5, v1
 v_mul_u32_u24 v2, s5, v2
 v_and_b32 v1, 31, v1
 v_lshl_add_u32 v2, v1, 4, v2
 v_lshl_add_u32 v2, v244, 9, v2
 v_cndmask_b32 v240, v3, v2, vcc
 v_subrev_u32 v1, -1, v0
 v_cmp_gt_u32 vcc, s4, v1
 v_lshrrev_b32 v2, 5, v1
 v_mul_u32_u24 v2, s5, v2
 v_and_b32 v1, 31, v1
 v_lshl_add_u32 v2, v1, 4, v2
 v_lshl_add_u32 v2, v244, 9, v2
 v_cndmask_b32 v241, v3, v2, vcc
 v_subrev_u32 v1, 2, v0
 v_cmp_gt_u32 vcc, s4, v1
 v_lshrrev_b32 v2, 5, v1
 v_mul_u32_u24 v2, s5, v2
 v_and_b32 v1, 31, v1
 v_lshl_add_u32 v2, v1, 4, v2
 v_lshl_add_u32 v2, v244, 9, v2
 v_cndmask_b32 v242, v3, v2, vcc
 v_subrev_u32 v1, -2, v0
 v_cmp_gt_u32 vcc, s4, v1
 v_lshrrev_b32 v2, 5, v1
 v_mul_u32_u24 v2, s5, v2
 v_and_b32 v1, 31, v1
 v_lshl_add_u32 v2, v1, 4, v2
 v_lshl_add_u32 v2, v244, 9, v2
 v_cndmask_b32 v243, v3, v2, vcc
 v_bfe_u32 v1, v255, 2, 2
 v_lshrrev_b32 v2, 5, v255
 v_lshl_add_u32 v2, v2, 2, v1
 v_lshlrev_b32 v232, 7, v2
 v_lshrrev_b32 v1, 1, v1
 v_lshl_add_u32 v232, v1, 6, v232
 v_bfe_u32 v1, v255, 4, 1
 v_lshl_add_u32 v232, v1, 5, v232
 v_and_b32 v1, 3, v255
 v_lshl_add_u32 v232, v1, 3, v232
 v_xor_b32 v233, 64, v232
 v_add_u32 v234, 49152, v232
 v_add_u32 v235, 49152, v233
 v_add_u32 v236, 98304, v232
 v_add_u32 v237, 98304, v233
 v_and_b32 v0, 31, v255
 v_lshlrev_b32 v1, 2, v244
 v_sub_u32 v0, v0, v1
 v_mov_b32 v1, 0x3f80
 v_mov_b32 v2, 1.0
 v_cmp_eq_u32 vcc, 0, v0
 v_cmp_eq_u32 s[54:55], 1, v0
 s_nop 0
 v_cndmask_b32 v192, 0, v1, vcc
 v_cndmask_b32 v192, v192, v2, s[54:55]
 v_cmp_eq_u32 vcc, 2, v0
 v_cmp_eq_u32 s[54:55], 3, v0
 s_nop 0
 v_cndmask_b32 v193, 0, v1, vcc
 v_cndmask_b32 v193, v193, v2, s[54:55]
 v_cmp_eq_u32 vcc, 8, v0
 v_cmp_eq_u32 s[54:55], 9, v0
 s_nop 0
 v_cndmask_b32 v194, 0, v1, vcc
 v_cndmask_b32 v194, v194, v2, s[54:55]
 v_cmp_eq_u32 vcc, 10, v0
 v_cmp_eq_u32 s[54:55], 11, v0
 s_nop 0
 v_cndmask_b32 v195, 0, v1, vcc
 v_cndmask_b32 v195, v195, v2, s[54:55]
 v_cmp_eq_u32 vcc, 16, v0
 v_cmp_eq_u32 s[54:55], 17, v0
 s_nop 0
 v_cndmask_b32 v196, 0, v1, vcc
 v_cndmask_b32 v196, v196, v2, s[54:55]
 v_cmp_eq_u32 vcc, 18, v0
 v_cmp_eq_u32 s[54:55], 19, v0
 s_nop 0
 v_cndmask_b32 v197, 0, v1, vcc
 v_cndmask_b32 v197, v197, v2, s[54:55]
 v_cmp_eq_u32 vcc, 24, v0
 v_cmp_eq_u32 s[54:55], 25, v0
 s_nop 0
 v_cndmask_b32 v198, 0, v1, vcc
 v_cndmask_b32 v198, v198, v2, s[54:55]
 v_cmp_eq_u32 vcc, 26, v0
 v_cmp_eq_u32 s[54:55], 27, v0
 s_nop 0
 v_cndmask_b32 v199, 0, v1, vcc
 v_cndmask_b32 v199, v199, v2, s[54:55]
 v_min_u32 v0, 2, v255
 s_add_u32 s3, s26, 15
 v_add_u32 v0, s3, v0
 v_and_b32 v0, 15, v0
 v_lshlrev_b32 v0, 7, v0
 v_add_u32 v0, 19128832, v0
 s_mul_i32 s3, s26, 128
 s_add_u32 s3, s3, 19128832
 v_lshl_add_u32 v2, v255, 7, s3
 v_mov_b32 v1, 0
 buffer_load_dword v4, v1, s[56:59], 0 offen sc1
 s_waitcnt vmcnt(0)
 s_barrier
 s_cmp_lg_u32 s29, 0
 s_cbranch_scc1 L_arr_h
 s_mov_b32 s38, 0x40000
L_gate_h:
 v_readfirstlane_b32 s3, v4
 s_cmp_eq_u32 s3, 1
 s_cbranch_scc1 L_open_h
 buffer_load_dword v4, v1, s[56:59], 0 offen sc1
 s_waitcnt vmcnt(0)
 s_sub_u32 s38, s38, 1
 s_cbranch_scc0 L_gate_h
L_open_h:
 v_mov_b32 v1, 1
 s_mov_b64 exec, 1
 buffer_atomic_add v1, v2, s[16:19], 0 offen sc1
 s_mov_b64 exec, -1
L_arr_h:
 s_add_u32 s91, s91, 1
 s_cmp_ge_u32 s91, 9
 s_cselect_b32 s91, 0, s91
 s_lshl_b32 s21, s91, 13
 s_add_u32 s21, s21, s30
 s_add_u32 m0, s21, 73728
 s_mul_i32 s21, s91, 73728
 s_add_u32 s21, s21, s25
 buffer_load_dwordx4 v238, s[60:63], s21 offen lds
 buffer_load_dwordx4 v239, s[60:63], s21 offen offset:1024 lds
 s_add_u32 s91, s91, 1
 s_cmp_ge_u32 s91, 9
 s_cselect_b32 s91, 0, s91
 s_lshl_b32 s21, s91, 13
 s_add_u32 s21, s21, s30
 s_add_u32 m0, s21, 73728
 s_mul_i32 s21, s91, 73728
 s_add_u32 s21, s21, s25
 buffer_load_dwordx4 v238, s[60:63], s21 offen lds
 buffer_load_dwordx4 v239, s[60:63], s21 offen offset:1024 lds
 s_add_u32 s91, s91, 1
 s_cmp_ge_u32 s91, 9
 s_cselect_b32 s91, 0, s91
 s_lshl_b32 s21, s91, 13
 s_add_u32 s21, s21, s30
 s_add_u32 m0, s21, 73728
 s_mul_i32 s21, s91, 73728
 s_add_u32 s21, s21, s25
 buffer_load_dwordx4 v238, s[60:63], s21 offen lds
 buffer_load_dwordx4 v239, s[60:63], s21 offen offset:1024 lds
 s_add_u32 s91, s91, 1
 s_cmp_ge_u32 s91, 9
 s_cselect_b32 s91, 0, s91
 s_lshl_b32 s21, s91, 13
 s_add_u32 s21, s21, s30
 s_add_u32 m0, s21, 73728
 s_mul_i32 s21, s91, 73728
 s_add_u32 s21, s21, s25
 buffer_load_dwordx4 v238, s[60:63], s21 offen lds
 buffer_load_dwordx4 v239, s[60:63], s21 offen offset:1024 lds
 s_add_u32 s91, s91, 1
 s_cmp_ge_u32 s91, 9
 s_cselect_b32 s91, 0, s91
 s_lshl_b32 s21, s91, 13
 s_add_u32 s21, s21, s30
 s_add_u32 m0, s21, 73728
 s_mul_i32 s21, s91, 73728
 s_add_u32 s21, s21, s25
 buffer_load_dwordx4 v238, s[60:63], s21 offen lds
 buffer_load_dwordx4 v239, s[60:63], s21 offen offset:1024 lds
 s_add_u32 s91, s91, 1
 s_cmp_ge_u32 s91, 9
 s_cselect_b32 s91, 0, s91
 s_lshl_b32 s21, s91, 13
 s_add_u32 s21, s21, s30
 s_add_u32 m0, s21, 73728
 s_mul_i32 s21, s91, 73728
 s_add_u32 s21, s21, s25
 buffer_load_dwordx4 v238, s[60:63], s21 offen lds
 buffer_load_dwordx4 v239, s[60:63], s21 offen offset:1024 lds
 s_add_u32 s91, s91, 1
 s_cmp_ge_u32 s91, 9
 s_cselect_b32 s91, 0, s91
 s_lshl_b32 s21, s91, 13
 s_add_u32 s21, s21, s30
 s_add_u32 m0, s21, 73728
 s_mul_i32 s21, s91, 73728
 s_add_u32 s21, s21, s25
 buffer_load_dwordx4 v238, s[60:63], s21 offen lds
 buffer_load_dwordx4 v239, s[60:63], s21 offen offset:1024 lds
 s_add_u32 s91, s91, 1
 s_cmp_ge_u32 s91, 9
 s_cselect_b32 s91, 0, s91
 s_lshl_b32 s21, s91, 13
 s_add_u32 s21, s21, s30
 s_add_u32 m0, s21, 73728
 s_mul_i32 s21, s91, 73728
 s_add_u32 s21, s21, s25
 buffer_load_dwordx4 v238, s[60:63], s21 offen lds
 buffer_load_dwordx4 v239, s[60:63], s21 offen offset:1024 lds
 s_add_u32 s91, s91, 1
 s_cmp_ge_u32 s91, 9
 s_cselect_b32 s91, 0, s91
 s_lshl_b32 s21, s91, 13
 s_add_u32 s21, s21, s30
 s_add_u32 m0, s21, 73728
 s_mul_i32 s21, s91, 73728
 s_add_u32 s21, s21, s25
 buffer_load_dwordx4 v238, s[60:63], s21 offen lds
 buffer_load_dwordx4 v239, s[60:63], s21 offen offset:1024 lds
 s_cmp_lg_u32 s29, 0
 s_cbranch_scc1 L1_pull
 s_cmp_lg_u32 s29, 0
 s_cbranch_scc1 L1_poll_ok
 s_mov_b32 s38, 0x100000
L1_poll:
 buffer_load_dword v5, v0, s[16:19], 0 offen sc1
 s_sub_u32 s38, s38, 1
 s_cbranch_scc1 L1_poll_ok
 s_waitcnt vmcnt(0)
 v_cmp_ne_u32 vcc, 9, v5
 s_cmp_lg_u64 vcc, 0
 s_cbranch_scc1 L1_poll
L1_poll_ok:
 s_waitcnt vmcnt(0)
 s_barrier
 s_mov_b32 s3, 7184896
 buffer_load_dwordx4 v[0:3], v240, s[16:19], s3 offen offset:0 sc1
 buffer_load_dwordx4 v[4:7], v240, s[16:19], s3 offen offset:1024 sc1
 buffer_load_dwordx4 v[8:11], v240, s[16:19], s3 offen offset:2048 sc1
 buffer_load_dwordx4 v[12:15], v240, s[16:19], s3 offen offset:3072 sc1
 s_mov_b32 s3, 7188992
 buffer_load_dwordx4 v[16:19], v240, s[16:19], s3 offen offset:0 sc1
 buffer_load_dwordx4 v[20:23], v240, s[16:19], s3 offen offset:1024 sc1
 buffer_load_dwordx4 v[24:27], v240, s[16:19], s3 offen offset:2048 sc1
 buffer_load_dwordx4 v[28:31], v240, s[16:19], s3 offen offset:3072 sc1
 s_mov_b32 s3, 7193088
 buffer_load_dwordx4 v[32:35], v240, s[16:19], s3 offen offset:0 sc1
 buffer_load_dwordx4 v[36:39], v241, s[16:19], s3 offen offset:1024 sc1
 buffer_load_dwordx4 v[40:43], v241, s[16:19], s3 offen offset:2048 sc1
 buffer_load_dwordx4 v[44:47], v241, s[16:19], s3 offen offset:3072 sc1
 ds_read_b64_tr_b16 v[208:209], v234 offset:24576
 ds_read_b64_tr_b16 v[210:211], v234 offset:25600
 ds_read_b64_tr_b16 v[212:213], v235 offset:24576
 ds_read_b64_tr_b16 v[214:215], v235 offset:25600
 ds_read_b64_tr_b16 v[216:217], v234 offset:26624
 ds_read_b64_tr_b16 v[218:219], v234 offset:27648
 ds_read_b64_tr_b16 v[220:221], v235 offset:26624
 ds_read_b64_tr_b16 v[222:223], v235 offset:27648
 s_waitcnt vmcnt(8)
 s_waitcnt lgkmcnt(4)
 v_mfma_f32_32x32x16_bf16 v[144:159], v[208:211], v[0:3], 0
 ds_read_b64_tr_b16 v[224:225], v234 offset:28672
 ds_read_b64_tr_b16 v[226:227], v234 offset:29696
 s_mov_b32 s3, 7197184
 buffer_load_dwordx4 v[48:51], v241, s[16:19], s3 offen offset:0 sc1
 v_mfma_f32_32x32x16_bf16 v[160:175], v[212:215], v[0:3], 0
 ds_read_b64_tr_b16 v[228:229], v235 offset:28672
 ds_read_b64_tr_b16 v[230:231], v235 offset:29696
 s_waitcnt lgkmcnt(4)
 v_mfma_f32_32x32x16_bf16 v[144:159], v[216:219], v[4:7], v[144:159]
 ds_read_b64_tr_b16 v[208:209], v234 offset:30720
 ds_read_b64_tr_b16 v[210:211], v234 offset:31744
 buffer_load_dwordx4 v[52:55], v241, s[16:19], s3 offen offset:1024 sc1
 v_mfma_f32_32x32x16_bf16 v[160:175], v[220:223], v[4:7], v[160:175]
 ds_read_b64_tr_b16 v[212:213], v235 offset:30720
 ds_read_b64_tr_b16 v[214:215], v235 offset:31744
 s_waitcnt lgkmcnt(4)
 v_mfma_f32_32x32x16_bf16 v[144:159], v[224:227], v[8:11], v[144:159]
 ds_read_b64_tr_b16 v[216:217], v234 offset:32768
 ds_read_b64_tr_b16 v[218:219], v234 offset:33792
 buffer_load_dwordx4 v[56:59], v241, s[16:19], s3 offen offset:2048 sc1
 v_mfma_f32_32x32x16_bf16 v[160:175], v[228:231], v[8:11], v[160:175]
 ds_read_b64_tr_b16 v[220:221], v235 offset:32768
 ds_read_b64_tr_b16 v[222:223], v235 offset:33792
 s_waitcnt lgkmcnt(4)
 v_mfma_f32_32x32x16_bf16 v[144:159], v[208:211], v[12:15], v[144:159]
 ds_read_b64_tr_b16 v[224:225], v234 offset:34816
 ds_read_b64_tr_b16 v[226:227], v234 offset:35840
 buffer_load_dwordx4 v[60:63], v241, s[16:19], s3 offen offset:3072 sc1
 v_mfma_f32_32x32x16_bf16 v[160:175], v[212:215], v[12:15], v[160:175]
 ds_read_b64_tr_b16 v[228:229], v235 offset:34816
 ds_read_b64_tr_b16 v[230:231], v235 offset:35840
 s_waitcnt vmcnt(8)
 s_waitcnt lgkmcnt(4)
 v_mfma_f32_32x32x16_bf16 v[144:159], v[216:219], v[16:19], v[144:159]
 ds_read_b64_tr_b16 v[208:209], v234 offset:36864
 ds_read_b64_tr_b16 v[210:211], v234 offset:37888
 s_mov_b32 s3, 7201280
 buffer_load_dwordx4 v[64:67], v241, s[16:19], s3 offen offset:0 sc1
 v_mfma_f32_32x32x16_bf16 v[160:175], v[220:223], v[16:19], v[160:175]
 ds_read_b64_tr_b16 v[212:213], v235 offset:36864
 ds_read_b64_tr_b16 v[214:215], v235 offset:37888
 s_waitcnt lgkmcnt(4)
 v_mfma_f32_32x32x16_bf16 v[144:159], v[224:227], v[20:23], v[144:159]
 ds_read_b64_tr_b16 v[216:217], v234 offset:38912
 ds_read_b64_tr_b16 v[218:219], v234 offset:39936
 buffer_load_dwordx4 v[68:71], v241, s[16:19], s3 offen offset:1024 sc1
 v_mfma_f32_32x32x16_bf16 v[160:175], v[228:231], v[20:23], v[160:175]
 ds_read_b64_tr_b16 v[220:221], v235 offset:38912
 ds_read_b64_tr_b16 v[222:223], v235 offset:39936
 s_waitcnt lgkmcnt(4)
 v_mfma_f32_32x32x16_bf16 v[144:159], v[208:211], v[24:27], v[144:159]
 ds_read_b64_tr_b16 v[224:225], v234 offset:40960
 ds_read_b64_tr_b16 v[226:227], v234 offset:41984
 buffer_load_dwordx4 v[72:75], v242, s[16:19], s3 offen offset:2048 sc1
 v_mfma_f32_32x32x16_bf16 v[160:175], v[212:215], v[24:27], v[160:175]
 ds_read_b64_tr_b16 v[228:229], v235 offset:40960
 ds_read_b64_tr_b16 v[230:231], v235 offset:41984
 s_waitcnt lgkmcnt(4)
 v_mfma_f32_32x32x16_bf16 v[144:159], v[216:219], v[28:31], v[144:159]
 ds_read_b64_tr_b16 v[208:209], v234 offset:43008
 ds_read_b64_tr_b16 v[210:211], v234 offset:44032
 buffer_load_dwordx4 v[76:79], v242, s[16:19], s3 offen offset:3072 sc1
 v_mfma_f32_32x32x16_bf16 v[160:175], v[220:223], v[28:31], v[160:175]
 ds_read_b64_tr_b16 v[212:213], v235 offset:43008
 ds_read_b64_tr_b16 v[214:215], v235 offset:44032
 s_waitcnt vmcnt(8)
 s_waitcnt lgkmcnt(4)
 v_mfma_f32_32x32x16_bf16 v[144:159], v[224:227], v[32:35], v[144:159]
 ds_read_b64_tr_b16 v[216:217], v234 offset:45056
 ds_read_b64_tr_b16 v[218:219], v234 offset:46080
 s_mov_b32 s3, 7205376
 buffer_load_dwordx4 v[80:83], v242, s[16:19], s3 offen offset:0 sc1
 v_mfma_f32_32x32x16_bf16 v[160:175], v[228:231], v[32:35], v[160:175]
 ds_read_b64_tr_b16 v[220:221], v235 offset:45056
 ds_read_b64_tr_b16 v[222:223], v235 offset:46080
 buffer_load_dwordx4 v[84:87], v242, s[16:19], s3 offen offset:1024 sc1
 s_waitcnt lgkmcnt(4)
 v_mfma_f32_32x32x16_bf16 v[144:159], v[208:211], v[36:39], v[144:159]
 ds_read_b64_tr_b16 v[224:225], v234 offset:47104
 ds_read_b64_tr_b16 v[226:227], v234 offset:48128
 v_mfma_f32_32x32x16_bf16 v[160:175], v[212:215], v[36:39], v[160:175]
 ds_read_b64_tr_b16 v[228:229], v235 offset:47104
 ds_read_b64_tr_b16 v[230:231], v235 offset:48128
 s_waitcnt lgkmcnt(4)
 v_mfma_f32_32x32x16_bf16 v[144:159], v[216:219], v[40:43], v[144:159]
 ds_read_b64_tr_b16 v[208:209], v236 offset:0
 ds_read_b64_tr_b16 v[210:211], v236 offset:1024
 buffer_load_dwordx4 v[88:91], v242, s[16:19], s3 offen offset:2048 sc1
 v_mfma_f32_32x32x16_bf16 v[160:175], v[220:223], v[40:43], v[160:175]
 ds_read_b64_tr_b16 v[212:213], v237 offset:0
 ds_read_b64_tr_b16 v[214:215], v237 offset:1024
 s_waitcnt lgkmcnt(4)
 v_mfma_f32_32x32x16_bf16 v[144:159], v[224:227], v[44:47], v[144:159]
 ds_read_b64_tr_b16 v[216:217], v236 offset:2048
 ds_read_b64_tr_b16 v[218:219], v236 offset:3072
 buffer_load_dwordx4 v[92:95], v242, s[16:19], s3 offen offset:3072 sc1
 v_mfma_f32_32x32x16_bf16 v[160:175], v[228:231], v[44:47], v[160:175]
 ds_read_b64_tr_b16 v[220:221], v237 offset:2048
 ds_read_b64_tr_b16 v[222:223], v237 offset:3072
 s_waitcnt vmcnt(8)
 s_waitcnt lgkmcnt(4)
 v_mfma_f32_32x32x16_bf16 v[144:159], v[208:211], v[48:51], v[144:159]
 ds_read_b64_tr_b16 v[224:225], v236 offset:4096
 ds_read_b64_tr_b16 v[226:227], v236 offset:5120
 s_mov_b32 s3, 7209472
 buffer_load_dwordx4 v[96:99], v242, s[16:19], s3 offen offset:0 sc1
 v_mfma_f32_32x32x16_bf16 v[160:175], v[212:215], v[48:51], v[160:175]
 ds_read_b64_tr_b16 v[228:229], v237 offset:4096
 ds_read_b64_tr_b16 v[230:231], v237 offset:5120
 s_waitcnt lgkmcnt(4)
 v_mfma_f32_32x32x16_bf16 v[144:159], v[216:219], v[52:55], v[144:159]
 ds_read_b64_tr_b16 v[208:209], v236 offset:6144
 ds_read_b64_tr_b16 v[210:211], v236 offset:7168
 buffer_load_dwordx4 v[100:103], v242, s[16:19], s3 offen offset:1024 sc1
 v_mfma_f32_32x32x16_bf16 v[160:175], v[220:223], v[52:55], v[160:175]
 ds_read_b64_tr_b16 v[212:213], v237 offset:6144
 ds_read_b64_tr_b16 v[214:215], v237 offset:7168
 s_waitcnt lgkmcnt(4)
 v_mfma_f32_32x32x16_bf16 v[144:159], v[224:227], v[56:59], v[144:159]
 ds_read_b64_tr_b16 v[216:217], v236 offset:8192
 ds_read_b64_tr_b16 v[218:219], v236 offset:9216
 buffer_load_dwordx4 v[104:107], v242, s[16:19], s3 offen offset:2048 sc1
 v_mfma_f32_32x32x16_bf16 v[160:175], v[228:231], v[56:59], v[160:175]
 ds_read_b64_tr_b16 v[220:221], v237 offset:8192
 ds_read_b64_tr_b16 v[222:223], v237 offset:9216
 s_waitcnt lgkmcnt(4)
 v_mfma_f32_32x32x16_bf16 v[144:159], v[208:211], v[60:63], v[144:159]
 ds_read_b64_tr_b16 v[224:225], v236 offset:10240
 ds_read_b64_tr_b16 v[226:227], v236 offset:11264
 buffer_load_dwordx4 v[108:111], v243, s[16:19], s3 offen offset:3072 sc1
 v_mfma_f32_32x32x16_bf16 v[160:175], v[212:215], v[60:63], v[160:175]
 ds_read_b64_tr_b16 v[228:229], v237 offset:10240
 ds_read_b64_tr_b16 v[230:231], v237 offset:11264
 s_waitcnt vmcnt(8)
 s_waitcnt lgkmcnt(4)
 v_mfma_f32_32x32x16_bf16 v[144:159], v[216:219], v[64:67], v[144:159]
 ds_read_b64_tr_b16 v[208:209], v236 offset:12288
 ds_read_b64_tr_b16 v[210:211], v236 offset:13312
 s_mov_b32 s3, 7213568
 buffer_load_dwordx4 v[112:115], v243, s[16:19], s3 offen offset:0 sc1
 v_mfma_f32_32x32x16_bf16 v[160:175], v[220:223], v[64:67], v[160:175]
 ds_read_b64_tr_b16 v[212:213], v237 offset:12288
 ds_read_b64_tr_b16 v[214:215], v237 offset:13312
 s_waitcnt lgkmcnt(4)
 v_mfma_f32_32x32x16_bf16 v[144:159], v[224:227], v[68:71], v[144:159]
 ds_read_b64_tr_b16 v[216:217], v236 offset:14336
 ds_read_b64_tr_b16 v[218:219], v236 offset:15360
 buffer_load_dwordx4 v[116:119], v243, s[16:19], s3 offen offset:1024 sc1
 v_mfma_f32_32x32x16_bf16 v[160:175], v[228:231], v[68:71], v[160:175]
 ds_read_b64_tr_b16 v[220:221], v237 offset:14336
 ds_read_b64_tr_b16 v[222:223], v237 offset:15360
 s_waitcnt lgkmcnt(4)
 v_mfma_f32_32x32x16_bf16 v[144:159], v[208:211], v[72:75], v[144:159]
 ds_read_b64_tr_b16 v[224:225], v236 offset:16384
 ds_read_b64_tr_b16 v[226:227], v236 offset:17408
 buffer_load_dwordx4 v[120:123], v243, s[16:19], s3 offen offset:2048 sc1
 v_mfma_f32_32x32x16_bf16 v[160:175], v[212:215], v[72:75], v[160:175]
 ds_read_b64_tr_b16 v[228:229], v237 offset:16384
 ds_read_b64_tr_b16 v[230:231], v237 offset:17408
 s_waitcnt lgkmcnt(4)
 v_mfma_f32_32x32x16_bf16 v[144:159], v[216:219], v[76:79], v[144:159]
 ds_read_b64_tr_b16 v[208:209], v236 offset:18432
 ds_read_b64_tr_b16 v[210:211], v236 offset:19456
 buffer_load_dwordx4 v[124:127], v243, s[16:19], s3 offen offset:3072 sc1
 v_mfma_f32_32x32x16_bf16 v[160:175], v[220:223], v[76:79], v[160:175]
 ds_read_b64_tr_b16 v[212:213], v237 offset:18432
 ds_read_b64_tr_b16 v[214:215], v237 offset:19456
 s_waitcnt vmcnt(8)
 s_waitcnt lgkmcnt(4)
 v_mfma_f32_32x32x16_bf16 v[144:159], v[224:227], v[80:83], v[144:159]
 ds_read_b64_tr_b16 v[216:217], v236 offset:20480
 ds_read_b64_tr_b16 v[218:219], v236 offset:21504
 s_mov_b32 s3, 7217664
 buffer_load_dwordx4 v[128:131], v243, s[16:19], s3 offen offset:0 sc1
 v_mfma_f32_32x32x16_bf16 v[160:175], v[228:231], v[80:83], v[160:175]
 ds_read_b64_tr_b16 v[220:221], v237 offset:20480
 ds_read_b64_tr_b16 v[222:223], v237 offset:21504
 buffer_load_dwordx4 v[132:135], v243, s[16:19], s3 offen offset:1024 sc1
 s_waitcnt lgkmcnt(4)
 v_mfma_f32_32x32x16_bf16 v[144:159], v[208:211], v[84:87], v[144:159]
 ds_read_b64_tr_b16 v[224:225], v236 offset:22528
 ds_read_b64_tr_b16 v[226:227], v236 offset:23552
 v_mfma_f32_32x32x16_bf16 v[160:175], v[212:215], v[84:87], v[160:175]
 ds_read_b64_tr_b16 v[228:229], v237 offset:22528
 ds_read_b64_tr_b16 v[230:231], v237 offset:23552
 s_waitcnt lgkmcnt(4)
 v_mfma_f32_32x32x16_bf16 v[144:159], v[216:219], v[88:91], v[144:159]
 ds_read_b64_tr_b16 v[208:209], v236 offset:24576
 ds_read_b64_tr_b16 v[210:211], v236 offset:25600
 buffer_load_dwordx4 v[136:139], v243, s[16:19], s3 offen offset:2048 sc1
 v_mfma_f32_32x32x16_bf16 v[160:175], v[220:223], v[88:91], v[160:175]
 ds_read_b64_tr_b16 v[212:213], v237 offset:24576
 ds_read_b64_tr_b16 v[214:215], v237 offset:25600
 s_waitcnt lgkmcnt(4)
 v_mfma_f32_32x32x16_bf16 v[144:159], v[224:227], v[92:95], v[144:159]
 ds_read_b64_tr_b16 v[216:217], v236 offset:26624
 ds_read_b64_tr_b16 v[218:219], v236 offset:27648
 buffer_load_dwordx4 v[140:143], v243, s[16:19], s3 offen offset:3072 sc1
 v_mfma_f32_32x32x16_bf16 v[160:175], v[228:231], v[92:95], v[160:175]
 ds_read_b64_tr_b16 v[220:221], v237 offset:26624
 ds_read_b64_tr_b16 v[222:223], v237 offset:27648
 s_waitcnt vmcnt(8)
 s_waitcnt lgkmcnt(4)
 v_mfma_f32_32x32x16_bf16 v[144:159], v[208:211], v[96:99], v[144:159]
 ds_read_b64_tr_b16 v[224:225], v236 offset:28672
 ds_read_b64_tr_b16 v[226:227], v236 offset:29696
 v_mfma_f32_32x32x16_bf16 v[160:175], v[212:215], v[96:99], v[160:175]
 ds_read_b64_tr_b16 v[228:229], v237 offset:28672
 ds_read_b64_tr_b16 v[230:231], v237 offset:29696
 s_waitcnt lgkmcnt(4)
 v_mfma_f32_32x32x16_bf16 v[144:159], v[216:219], v[100:103], v[144:159]
 ds_read_b64_tr_b16 v[208:209], v236 offset:30720
 ds_read_b64_tr_b16 v[210:211], v236 offset:31744
 v_mfma_f32_32x32x16_bf16 v[160:175], v[220:223], v[100:103], v[160:175]
 ds_read_b64_tr_b16 v[212:213], v237 offset:30720
 ds_read_b64_tr_b16 v[214:215], v237 offset:31744
 s_waitcnt lgkmcnt(4)
 v_mfma_f32_32x32x16_bf16 v[144:159], v[224:227], v[104:107], v[144:159]
 ds_read_b64_tr_b16 v[216:217], v236 offset:32768
 ds_read_b64_tr_b16 v[218:219], v236 offset:33792
 v_mfma_f32_32x32x16_bf16 v[160:175], v[228:231], v[104:107], v[160:175]
 ds_read_b64_tr_b16 v[220:221], v237 offset:32768
 ds_read_b64_tr_b16 v[222:223], v237 offset:33792
 s_waitcnt lgkmcnt(4)
 v_mfma_f32_32x32x16_bf16 v[144:159], v[208:211], v[108:111], v[144:159]
 ds_read_b64_tr_b16 v[224:225], v236 offset:34816
 ds_read_b64_tr_b16 v[226:227], v236 offset:35840
 v_mfma_f32_32x32x16_bf16 v[160:175], v[212:215], v[108:111], v[160:175]
 ds_read_b64_tr_b16 v[228:229], v237 offset:34816
 ds_read_b64_tr_b16 v[230:231], v237 offset:35840
 s_waitcnt vmcnt(4)
 s_waitcnt lgkmcnt(4)
 v_mfma_f32_32x32x16_bf16 v[144:159], v[216:219], v[112:115], v[144:159]
 ds_read_b64_tr_b16 v[208:209], v236 offset:36864
 ds_read_b64_tr_b16 v[210:211], v236 offset:37888
 v_mfma_f32_32x32x16_bf16 v[160:175], v[220:223], v[112:115], v[160:175]
 ds_read_b64_tr_b16 v[212:213], v237 offset:36864
 ds_read_b64_tr_b16 v[214:215], v237 offset:37888
 s_waitcnt lgkmcnt(4)
 v_mfma_f32_32x32x16_bf16 v[144:159], v[224:227], v[116:119], v[144:159]
 ds_read_b64_tr_b16 v[216:217], v236 offset:38912
 ds_read_b64_tr_b16 v[218:219], v236 offset:39936
 v_mfma_f32_32x32x16_bf16 v[160:175], v[228:231], v[116:119], v[160:175]
 ds_read_b64_tr_b16 v[220:221], v237 offset:38912
 ds_read_b64_tr_b16 v[222:223], v237 offset:39936
 s_waitcnt lgkmcnt(4)
 v_mfma_f32_32x32x16_bf16 v[144:159], v[208:211], v[120:123], v[144:159]
 ds_read_b64_tr_b16 v[224:225], v236 offset:40960
 ds_read_b64_tr_b16 v[226:227], v236 offset:41984
 v_mfma_f32_32x32x16_bf16 v[160:175], v[212:215], v[120:123], v[160:175]
 ds_read_b64_tr_b16 v[228:229], v237 offset:40960
 ds_read_b64_tr_b16 v[230:231], v237 offset:41984
 s_waitcnt lgkmcnt(4)
 v_mfma_f32_32x32x16_bf16 v[144:159], v[216:219], v[124:127], v[144:159]
 ds_read_b64_tr_b16 v[208:209], v236 offset:43008
 ds_read_b64_tr_b16 v[210:211], v236 offset:44032
 v_mfma_f32_32x32x16_bf16 v[160:175], v[220:223], v[124:127], v[160:175]
 ds_read_b64_tr_b16 v[212:213], v237 offset:43008
 ds_read_b64_tr_b16 v[214:215], v237 offset:44032
 s_waitcnt vmcnt(0)
 s_waitcnt lgkmcnt(4)
 v_mfma_f32_32x32x16_bf16 v[144:159], v[224:227], v[128:131], v[144:159]
 ds_read_b64_tr_b16 v[216:217], v236 offset:45056
 ds_read_b64_tr_b16 v[218:219], v236 offset:46080
 v_mfma_f32_32x32x16_bf16 v[160:175], v[228:231], v[128:131], v[160:175]
 ds_read_b64_tr_b16 v[220:221], v237 offset:45056
 ds_read_b64_tr_b16 v[222:223], v237 offset:46080
 s_waitcnt lgkmcnt(4)
 v_mfma_f32_32x32x16_bf16 v[144:159], v[208:211], v[132:135], v[144:159]
 ds_read_b64_tr_b16 v[224:225], v236 offset:47104
 ds_read_b64_tr_b16 v[226:227], v236 offset:48128
 v_mfma_f32_32x32x16_bf16 v[160:175], v[212:215], v[132:135], v[160:175]
 ds_read_b64_tr_b16 v[228:229], v237 offset:47104
 ds_read_b64_tr_b16 v[230:231], v237 offset:48128
 s_waitcnt lgkmcnt(4)
 v_mfma_f32_32x32x16_bf16 v[144:159], v[216:219], v[136:139], v[144:159]
 v_mfma_f32_32x32x16_bf16 v[160:175], v[220:223], v[136:139], v[160:175]
 s_waitcnt lgkmcnt(0)
 v_mfma_f32_32x32x16_bf16 v[144:159], v[224:227], v[140:143], v[144:159]
 v_mfma_f32_32x32x16_bf16 v[160:175], v[228:231], v[140:143], v[160:175]
 v_mfma_f32_32x32x16_bf16 v[144:159], v[192:195], v[176:179], v[144:159]
 v_mfma_f32_32x32x16_bf16 v[160:175], v[192:195], v[184:187], v[160:175]
 v_mfma_f32_32x32x16_bf16 v[144:159], v[196:199], v[180:183], v[144:159]
 v_mfma_f32_32x32x16_bf16 v[160:175], v[196:199], v[188:191], v[160:175]
 s_lshl_b32 s4, s25, 7
 s_lshl_b32 s5, s24, 8
 s_add_u32 s4, s4, s5
 s_add_u32 s4, s4, 18981376
 s_add_u32 s5, s52, 14262784
 v_lshlrev_b32 v246, 3, v255
 v_mov_b32 v247, 0x40000000
 v_cmp_gt_u32 vcc, 32, v255
 s_nop 4
 v_cndmask_b32 v246, v247, v246, vcc
 v_mov_b32 v248, v144
 v_mul_f32 v250, v144, v144
 v_mov_b32 v249, v145
 v_mul_f32 v251, v145, v145
 v_add_f32 v248, v248, v146
 v_fmac_f32 v250, v146, v146
 v_add_f32 v249, v249, v147
 v_fmac_f32 v251, v147, v147
 v_add_f32 v248, v248, v148
 v_fmac_f32 v250, v148, v148
 v_add_f32 v249, v249, v149
 v_fmac_f32 v251, v149, v149
 v_add_f32 v248, v248, v150
 v_fmac_f32 v250, v150, v150
 v_add_f32 v249, v249, v151
 v_fmac_f32 v251, v151, v151
 v_cvt_pk_bf16_f32 v144, v144, v145
 v_cvt_pk_bf16_f32 v145, v146, v147
 v_cvt_pk_bf16_f32 v146, v148, v149
 v_cvt_pk_bf16_f32 v147, v150, v151
 buffer_store_dwordx4 v[144:147], v254, s[16:19], s5 offen offset:0 sc1
 v_add_f32 v248, v248, v152
 v_fmac_f32 v250, v152, v152
 v_add_f32 v249, v249, v153
 v_fmac_f32 v251, v153, v153
 v_add_f32 v248, v248, v154
 v_fmac_f32 v250, v154, v154
 v_add_f32 v249, v249, v155
 v_fmac_f32 v251, v155, v155
 v_add_f32 v248, v248, v156
 v_fmac_f32 v250, v156, v156
 v_add_f32 v249, v249, v157
 v_fmac_f32 v251, v157, v157
 v_add_f32 v248, v248, v158
 v_fmac_f32 v250, v158, v158
 v_add_f32 v249, v249, v159
 v_fmac_f32 v251, v159, v159
 v_cvt_pk_bf16_f32 v152, v152, v153
 v_cvt_pk_bf16_f32 v153, v154, v155
 v_cvt_pk_bf16_f32 v154, v156, v157
 v_cvt_pk_bf16_f32 v155, v158, v159
 buffer_store_dwordx4 v[152:155], v254, s[16:19], s5 offen offset:1024 sc1
 v_add_f32 v248, v248, v160
 v_fmac_f32 v250, v160, v160
 v_add_f32 v249, v249, v161
 v_fmac_f32 v251, v161, v161
 v_add_f32 v248, v248, v162
 v_fmac_f32 v250, v162, v162
 v_add_f32 v249, v249, v163
 v_fmac_f32 v251, v163, v163
 v_add_f32 v248, v248, v164
 v_fmac_f32 v250, v164, v164
 v_add_f32 v249, v249, v165
 v_fmac_f32 v251, v165, v165
 v_add_f32 v248, v248, v166
 v_fmac_f32 v250, v166, v166
 v_add_f32 v249, v249, v167
 v_fmac_f32 v251, v167, v167
 v_cvt_pk_bf16_f32 v160, v160, v161
 v_cvt_pk_bf16_f32 v161, v162, v163
 v_cvt_pk_bf16_f32 v162, v164, v165
 v_cvt_pk_bf16_f32 v163, v166, v167
 buffer_store_dwordx4 v[160:163], v254, s[16:19], s5 offen offset:2048 sc1
 v_add_f32 v248, v248, v168
 v_fmac_f32 v250, v168, v168
 v_add_f32 v249, v249, v169
 v_fmac_f32 v251, v169, v169
 v_add_f32 v248, v248, v170
 v_fmac_f32 v250, v170, v170
 v_add_f32 v249, v249, v171
 v_fmac_f32 v251, v171, v171
 v_add_f32 v248, v248, v172
 v_fmac_f32 v250, v172, v172
 v_add_f32 v249, v249, v173
 v_fmac_f32 v251, v173, v173
 v_add_f32 v248, v248, v174
 v_fmac_f32 v250, v174, v174
 v_add_f32 v249, v249, v175
 v_fmac_f32 v251, v175, v175
 v_cvt_pk_bf16_f32 v168, v168, v169
 v_cvt_pk_bf16_f32 v169, v170, v171
 v_cvt_pk_bf16_f32 v170, v172, v173
 v_cvt_pk_bf16_f32 v171, v174, v175
 buffer_store_dwordx4 v[168:171], v254, s[16:19], s5 offen offset:3072 sc1
 v_add_f32 v248, v248, v249
 v_add_f32 v250, v250, v251
 v_mov_b32 v249, v248
 v_mov_b32 v251, v250
 s_nop 1
 v_permlane32_swap_b32 v248, v249
 v_permlane32_swap_b32 v250, v251
 v_add_f32 v248, v248, v249
 v_add_f32 v249, v250, v251
 buffer_store_dwordx2 v[248:249], v246, s[16:19], s4 offen sc1
 s_load_dwordx2 s[4:5], s[0:1], 48
 s_load_dwordx2 s[20:21], s[0:1], 56
 s_load_dwordx2 s[6:7], s[0:1], 80
 s_load_dwordx2 s[60:61], s[0:1], 16
 s_mul_i32 s3, s26, 128
 s_add_u32 s3, s3, 19130880
 v_lshl_add_u32 v2, v255, 7, s3
 v_mov_b32 v1, 0
 s_waitcnt vmcnt(0)
 s_barrier
 s_cmp_lg_u32 s29, 0
 s_cbranch_scc1 L_arr_x
 v_mov_b32 v1, 1
 s_mov_b64 exec, 1
 buffer_atomic_add v1, v2, s[16:19], 0 offen sc1
 s_mov_b64 exec, -1
L_arr_x:
 s_branch L_after_k1
L1_qdone:
 s_load_dwordx2 s[4:5], s[0:1], 48
 s_load_dwordx2 s[20:21], s[0:1], 56
 s_load_dwordx2 s[6:7], s[0:1], 80
 s_load_dwordx2 s[60:61], s[0:1], 16
 s_mul_i32 s3, s26, 1024
 s_add_u32 s3, s3, 19137024
 v_lshl_add_u32 v2, v255, 7, s3
 v_mov_b32 v1, 0
 buffer_load_dword v4, v1, s[56:59], 0 offen sc1
 s_waitcnt vmcnt(0)
 s_barrier
 s_cmp_lg_u32 s29, 0
 s_cbranch_scc1 L_arr_q
 s_mov_b32 s38, 0x40000
L_gate_q:
 v_readfirstlane_b32 s3, v4
 s_cmp_eq_u32 s3, 1
 s_cbranch_scc1 L_open_q
 buffer_load_dword v4, v1, s[56:59], 0 offen sc1
 s_waitcnt vmcnt(0)
 s_sub_u32 s38, s38, 1
 s_cbranch_scc0 L_gate_q
L_open_q:
 v_mov_b32 v1, 1
 s_mov_b64 exec, 255
 buffer_atomic_add v1, v2, s[16:19], 0 offen sc1
 s_mov_b64 exec, -1
L_arr_q:
 s_branch L_after_k1
L1_end:
 s_endpgm
L1_pull:
 v_subrev_u32 v4, 1024, v253
 s_lshr_b32 s3, s25, 7
 s_mul_i32 s4, s26, 9
 s_add_u32 s3, s3, s4
 s_mul_i32 s4, s3, 36864
 s_mul_i32 s5, s3, 4608
 s_mov_b32 s8, s100
 s_and_b32 s9, s101, 0xffff
 s_mov_b32 s10, 0xa2000
 s_mov_b32 s11, 0x20000
 buffer_load_dwordx4 v[248:251], v4, s[8:11], s5 offen
 buffer_load_dwordx4 v[248:251], v4, s[8:11], s5 offen offset:1536
 s_getpc_b64 s[100:101]
L1_pcw:
 s_add_u32 s100, s100, L_after_k1-L1_pcw
 s_addc_u32 s101, s101, 0
 s_lshr_b32 s3, s2, 3
 s_and_b32 s3, s3, 15
 s_lshl_b32 s3, s3, 12
 s_add_u32 s100, s100, s3
 s_addc_u32 s101, s101, 0
 global_load_dwordx4 v[248:251], v4, s[100:101]
 global_load_dwordx4 v[248:251], v4, s[100:101] offset:1024
 s_branch L1_poll_ok
L_after_k1:
 s_and_b32 s24, s2, 7
 s_lshr_b32 s25, s2, 3
 s_xor_b32 s25, s25, 16
 s_cmp_ge_u32 s25, 16
 s_cbranch_scc1 L3_att
 s_lshr_b32 s3, s24, 1
 s_lshl_b32 s3, s3, 2
 s_lshr_b32 s26, s25, 2
 s_add_u32 s3, s3, s26
 s_and_b32 s24, s24, 1
 s_lshl_b32 s24, s24, 2
 s_and_b32 s26, s25, 3
 s_add_u32 s24, s24, s26
 s_mov_b32 s25, s3
 s_lshl_b32 s31, s25, 2
 s_add_u32 s31, s31, s29
 s_lshl_b32 s30, s29, 11
 s_lshr_b32 s26, s25, 2
 s_mul_i32 s26, s26, 2
 s_mul_i32 s3, s26, 57
 s_lshr_b32 s3, s3, 9
 s_mul_i32 s3, s3, 9
 s_sub_u32 s26, s26, s3
 s_mul_i32 s27, s24, 1152
 s_add_u32 s39, s27, 1152
 s_lshl_b32 s34, s26, 7
 s_add_u32 s32, s27, s34
 s_lshl_b32 s28, s29, 4
 s_movk_i32 s22, 9216
 v_lshlrev_b32 v252, 4, v255
 s_mul_i32 s51, s31, 36864
 v_and_b32 v188, 31, v255
 v_lshlrev_b32 v188, 3, v188
 v_lshrrev_b32 v189, 5, v255
 v_lshl_add_u32 v188, v189, 14, v188
 v_lshl_add_u32 v189, v189, 30, v188
 s_lshl_b32 s53, s31, 8
 s_add_u32 s53, s53, 18981376
 v_lshrrev_b32 v250, 3, v255
 v_add_u32 v250, s28, v250
 v_mul_lo_u32 v246, v250, s22
 v_bfe_u32 v250, v255, 4, 1
 v_lshlrev_b32 v250, 2, v250
 v_and_b32 v247, 7, v255
 v_xor_b32 v250, v250, v247
 v_lshl_add_u32 v246, v250, 4, v246
 s_lshl_b32 s3, s22, 3
 s_sub_u32 s3, s3, 1024
 v_add_u32 v247, s3, v246
 s_waitcnt lgkmcnt(0)
 s_mov_b32 s8, s6
 s_and_b32 s9, s7, 0xffff
 s_mov_b32 s10, 0x2447200
 s_mov_b32 s11, 0x20000
 s_mov_b32 s12, s4
 s_and_b32 s13, s5, 0xffff
 s_mov_b32 s14, 0x510000
 s_mov_b32 s15, 0x20000
 s_add_u32 m0, s30, 0
 s_add_u32 s36, s32, 0
 buffer_load_dwordx4 v246, s[12:15], s36 offen lds
 buffer_load_dwordx4 v247, s[12:15], s36 offen offset:1024 lds
 s_add_u32 m0, s30, 8192
 s_add_u32 s36, s32, 589824
 buffer_load_dwordx4 v246, s[12:15], s36 offen lds
 buffer_load_dwordx4 v247, s[12:15], s36 offen offset:1024 lds
 s_add_u32 m0, s30, 16384
 s_add_u32 s36, s32, 1179648
 buffer_load_dwordx4 v246, s[12:15], s36 offen lds
 buffer_load_dwordx4 v247, s[12:15], s36 offen offset:1024 lds
 s_add_u32 m0, s30, 24576
 s_add_u32 s36, s32, 1769472
 buffer_load_dwordx4 v246, s[12:15], s36 offen lds
 buffer_load_dwordx4 v247, s[12:15], s36 offen offset:1024 lds
 s_add_u32 m0, s30, 32768
 s_add_u32 s36, s32, 2359296
 buffer_load_dwordx4 v246, s[12:15], s36 offen lds
 buffer_load_dwordx4 v247, s[12:15], s36 offen offset:1024 lds
 s_add_u32 m0, s30, 40960
 s_add_u32 s36, s32, 2949120
 buffer_load_dwordx4 v246, s[12:15], s36 offen lds
 buffer_load_dwordx4 v247, s[12:15], s36 offen offset:1024 lds
 s_add_u32 m0, s30, 49152
 s_add_u32 s36, s32, 3538944
 buffer_load_dwordx4 v246, s[12:15], s36 offen lds
 buffer_load_dwordx4 v247, s[12:15], s36 offen offset:1024 lds
 s_add_u32 m0, s30, 57344
 s_add_u32 s36, s32, 4128768
 buffer_load_dwordx4 v246, s[12:15], s36 offen lds
 buffer_load_dwordx4 v247, s[12:15], s36 offen offset:1024 lds
 s_add_u32 m0, s30, 65536
 s_add_u32 s36, s32, 4718592
 buffer_load_dwordx4 v246, s[12:15], s36 offen lds
 buffer_load_dwordx4 v247, s[12:15], s36 offen offset:1024 lds
 s_add_u32 m0, s30, 73728
 s_add_u32 s32, s32, 128
 s_cmp_ge_u32 s32, s39
 s_cselect_b32 s3, 1152, 0
 s_sub_u32 s32, s32, s3
 s_add_u32 s36, s32, 0
 buffer_load_dwordx4 v246, s[12:15], s36 offen lds
 buffer_load_dwordx4 v247, s[12:15], s36 offen offset:1024 lds
 s_add_u32 m0, s30, 81920
 s_add_u32 s36, s32, 589824
 buffer_load_dwordx4 v246, s[12:15], s36 offen lds
 buffer_load_dwordx4 v247, s[12:15], s36 offen offset:1024 lds
 s_add_u32 m0, s30, 90112
 s_add_u32 s36, s32, 1179648
 buffer_load_dwordx4 v246, s[12:15], s36 offen lds
 buffer_load_dwordx4 v247, s[12:15], s36 offen offset:1024 lds
 s_add_u32 m0, s30, 98304
 s_add_u32 s36, s32, 1769472
 buffer_load_dwordx4 v246, s[12:15], s36 offen lds
 buffer_load_dwordx4 v247, s[12:15], s36 offen offset:1024 lds
 s_add_u32 m0, s30, 106496
 s_add_u32 s36, s32, 2359296
 buffer_load_dwordx4 v246, s[12:15], s36 offen lds
 buffer_load_dwordx4 v247, s[12:15], s36 offen offset:1024 lds
 s_lshl_b32 s3, s25, 7
 s_add_u32 s3, s3, 19130880
 v_mov_b32 v0, s3
 s_cmp_lg_u32 s29, 0
 s_cbranch_scc1 L3_pollx_ok
 s_mov_b32 s38, 0x100000
L3_pollx:
 buffer_load_dword v1, v0, s[8:11], 0 offen sc1
 s_sub_u32 s38, s38, 1
 s_cbranch_scc1 L3_pollx_ok
 s_waitcnt vmcnt(0)
 v_cmp_ne_u32 vcc, 9, v1
 s_cmp_lg_u64 vcc, 0
 s_cbranch_scc1 L3_pollx
L3_pollx_ok:
 s_waitcnt vmcnt(0)
 s_barrier
 buffer_load_dwordx2 v[176:177], v188, s[8:11], s53 offen sc1
 s_add_u32 s53, s53, 32768
 buffer_load_dwordx2 v[178:179], v188, s[8:11], s53 offen sc1
 s_add_u32 s53, s53, 32768
 buffer_load_dwordx2 v[180:181], v188, s[8:11], s53 offen sc1
 s_add_u32 s53, s53, 32768
 buffer_load_dwordx2 v[182:183], v188, s[8:11], s53 offen sc1
 s_add_u32 s53, s53, 32768
 buffer_load_dwordx2 v[184:185], v189, s[8:11], s53 offen sc1
 s_add_u32 s53, s53, 32768
 s_add_u32 s52, s51, 14262784
 buffer_load_dwordx4 v[0:3], v252, s[8:11], s52 offen offset:0 sc1
 buffer_load_dwordx4 v[4:7], v252, s[8:11], s52 offen offset:1024 sc1
 buffer_load_dwordx4 v[8:11], v252, s[8:11], s52 offen offset:2048 sc1
 buffer_load_dwordx4 v[12:15], v252, s[8:11], s52 offen offset:3072 sc1
 s_mov_b32 s12, s4
 s_and_b32 s13, s5, 0xffff
 s_mov_b32 s14, 0x510000
 s_mov_b32 s15, 0x20000
 s_add_u32 s52, s51, 14266880
 buffer_load_dwordx4 v[16:19], v252, s[8:11], s52 offen offset:0 sc1
 buffer_load_dwordx4 v[20:23], v252, s[8:11], s52 offen offset:1024 sc1
 buffer_load_dwordx4 v[24:27], v252, s[8:11], s52 offen offset:2048 sc1
 buffer_load_dwordx4 v[28:31], v252, s[8:11], s52 offen offset:3072 sc1
 v_bfe_u32 v250, v255, 2, 2
 v_lshrrev_b32 v251, 5, v255
 v_lshl_add_u32 v251, v251, 2, v250
 v_lshlrev_b32 v240, 7, v251
 v_lshrrev_b32 v250, 1, v250
 v_lshl_add_u32 v240, v250, 6, v240
 v_bfe_u32 v250, v255, 4, 1
 v_lshl_add_u32 v240, v250, 5, v240
 v_and_b32 v250, 3, v255
 v_lshl_add_u32 v240, v250, 3, v240
 v_xor_b32 v241, 64, v240
 v_add_u32 v242, 49152, v240
 v_add_u32 v243, 49152, v241
 v_add_u32 v244, 98304, v240
 v_add_u32 v245, 98304, v241
 s_mov_b32 s16, s20
 s_and_b32 s17, s21, 0xffff
 s_mov_b32 s18, 0x510000
 s_mov_b32 s19, 0x20000
 s_waitcnt vmcnt(8)
 v_add_f32 v176, v176, v178
 v_add_f32 v177, v177, v179
 v_add_f32 v176, v176, v180
 v_add_f32 v177, v177, v181
 v_add_f32 v176, v176, v182
 v_add_f32 v177, v177, v183
 v_add_f32 v176, v176, v184
 v_add_f32 v177, v177, v185
 v_mov_b32 v178, v176
 v_mov_b32 v179, v177
 s_nop 1
 v_permlane32_swap_b32 v176, v178
 v_permlane32_swap_b32 v177, v179
 v_add_f32 v176, v176, v178
 v_add_f32 v177, v177, v179
 v_mul_f32 v254, 0xbae38e39, v176
 v_mul_f32 v177, 0x3ae38e39, v177
 v_fma_f32 v177, -v254, v254, v177
 v_max_f32 v177, 0, v177
 v_add_f32 v177, 0x3727c5ac, v177
 v_rsq_f32 v253, v177
 s_nop 0
 v_mul_f32 v249, 0xc0135761, v253
 v_mul_f32 v178, v253, v253
 v_mul_f32 v178, v178, v253
 v_mul_f32 v248, 0xbdd2d3e8, v178
 s_add_u32 s52, s51, 14270976
 buffer_load_dwordx4 v[32:35], v252, s[8:11], s52 offen offset:0 sc1
 s_waitcnt vmcnt(5)
 v_lshlrev_b32 v250, 16, v0
 v_and_b32 v251, 0xffff0000, v0
 v_add_f32 v250, v254, v250
 v_add_f32 v251, v254, v251
 v_cvt_pk_bf16_f32 v250, v250, v251
 v_accvgpr_write_b32 a0, v250
 v_lshlrev_b32 v250, 16, v1
 v_and_b32 v251, 0xffff0000, v1
 v_add_f32 v250, v254, v250
 v_add_f32 v251, v254, v251
 v_cvt_pk_bf16_f32 v250, v250, v251
 v_accvgpr_write_b32 a1, v250
 v_lshlrev_b32 v250, 16, v2
 v_and_b32 v251, 0xffff0000, v2
 v_add_f32 v250, v254, v250
 v_add_f32 v251, v254, v251
 v_cvt_pk_bf16_f32 v250, v250, v251
 v_accvgpr_write_b32 a2, v250
 v_lshlrev_b32 v250, 16, v3
 v_and_b32 v251, 0xffff0000, v3
 v_add_f32 v250, v254, v250
 v_add_f32 v251, v254, v251
 v_cvt_pk_bf16_f32 v250, v250, v251
 buffer_load_dwordx4 v[36:39], v252, s[8:11], s52 offen offset:1024 sc1
 v_accvgpr_write_b32 a3, v250
 v_lshlrev_b32 v250, 16, v4
 v_and_b32 v251, 0xffff0000, v4
 v_add_f32 v250, v254, v250
 v_add_f32 v251, v254, v251
 v_cvt_pk_bf16_f32 v250, v250, v251
 v_accvgpr_write_b32 a4, v250
 v_lshlrev_b32 v250, 16, v5
 v_and_b32 v251, 0xffff0000, v5
 v_add_f32 v250, v254, v250
 v_add_f32 v251, v254, v251
 v_cvt_pk_bf16_f32 v250, v250, v251
 v_accvgpr_write_b32 a5, v250
 v_lshlrev_b32 v250, 16, v6
 v_and_b32 v251, 0xffff0000, v6
 v_add_f32 v250, v254, v250
 v_add_f32 v251, v254, v251
 v_cvt_pk_bf16_f32 v250, v250, v251
 v_accvgpr_write_b32 a6, v250
 v_lshlrev_b32 v250, 16, v7
 v_and_b32 v251, 0xffff0000, v7
 v_add_f32 v250, v254, v250
 v_add_f32 v251, v254, v251
 v_cvt_pk_bf16_f32 v250, v250, v251
 buffer_load_dwordx4 v[40:43], v252, s[8:11], s52 offen offset:2048 sc1
 v_accvgpr_write_b32 a7, v250
 v_lshlrev_b32 v250, 16, v8
 v_and_b32 v251, 0xffff0000, v8
 v_add_f32 v250, v254, v250
 v_add_f32 v251, v254, v251
 v_cvt_pk_bf16_f32 v250, v250, v251
 v_accvgpr_write_b32 a8, v250
 v_lshlrev_b32 v250, 16, v9
 v_and_b32 v251, 0xffff0000, v9
 v_add_f32 v250, v254, v250
 v_add_f32 v251, v254, v251
 v_cvt_pk_bf16_f32 v250, v250, v251
 v_accvgpr_write_b32 a9, v250
 v_lshlrev_b32 v250, 16, v10
 v_and_b32 v251, 0xffff0000, v10
 v_add_f32 v250, v254, v250
 v_add_f32 v251, v254, v251
 v_cvt_pk_bf16_f32 v250, v250, v251
 v_accvgpr_write_b32 a10, v250
 v_lshlrev_b32 v250, 16, v11
 v_and_b32 v251, 0xffff0000, v11
 v_add_f32 v250, v254, v250
 v_add_f32 v251, v254, v251
 v_cvt_pk_bf16_f32 v250, v250, v251
 buffer_load_dwordx4 v[44:47], v252, s[8:11], s52 offen offset:3072 sc1
 v_accvgpr_write_b32 a11, v250
 v_lshlrev_b32 v250, 16, v12
 v_and_b32 v251, 0xffff0000, v12
 v_add_f32 v250, v254, v250
 v_add_f32 v251, v254, v251
 v_cvt_pk_bf16_f32 v250, v250, v251
 v_accvgpr_write_b32 a12, v250
 v_lshlrev_b32 v250, 16, v13
 v_and_b32 v251, 0xffff0000, v13
 v_add_f32 v250, v254, v250
 v_add_f32 v251, v254, v251
 v_cvt_pk_bf16_f32 v250, v250, v251
 v_accvgpr_write_b32 a13, v250
 v_lshlrev_b32 v250, 16, v14
 v_and_b32 v251, 0xffff0000, v14
 v_add_f32 v250, v254, v250
 v_add_f32 v251, v254, v251
 v_cvt_pk_bf16_f32 v250, v250, v251
 v_accvgpr_write_b32 a14, v250
 v_lshlrev_b32 v250, 16, v15
 v_and_b32 v251, 0xffff0000, v15
 v_add_f32 v250, v254, v250
 v_add_f32 v251, v254, v251
 v_cvt_pk_bf16_f32 v250, v250, v251
 v_accvgpr_write_b32 a15, v250
 s_waitcnt vmcnt(42)
 s_barrier
 ds_read_b64_tr_b16 v[208:209], v240 offset:0
 ds_read_b64_tr_b16 v[210:211], v240 offset:1024
 ds_read_b64_tr_b16 v[212:213], v241 offset:0
 ds_read_b64_tr_b16 v[214:215], v241 offset:1024
 ds_read_b64_tr_b16 v[216:217], v240 offset:2048
 ds_read_b64_tr_b16 v[218:219], v240 offset:3072
 ds_read_b64_tr_b16 v[220:221], v241 offset:2048
 ds_read_b64_tr_b16 v[222:223], v241 offset:3072
 ds_read_b64_tr_b16 v[224:225], v240 offset:4096
 ds_read_b64_tr_b16 v[226:227], v240 offset:5120
 ds_read_b64_tr_b16 v[228:229], v241 offset:4096
 ds_read_b64_tr_b16 v[230:231], v241 offset:5120
 s_waitcnt lgkmcnt(4)
 v_mfma_f32_32x32x16_bf16 v[144:159], v[208:211], a[0:3], 0
 ds_read_b64_tr_b16 v[232:233], v240 offset:6144
 ds_read_b64_tr_b16 v[234:235], v240 offset:7168
 s_add_u32 s52, s51, 14275072
 buffer_load_dwordx4 v[48:51], v252, s[8:11], s52 offen offset:0 sc1
 s_waitcnt vmcnt(5)
 v_lshlrev_b32 v250, 16, v16
 v_and_b32 v251, 0xffff0000, v16
 v_add_f32 v250, v254, v250
 v_add_f32 v251, v254, v251
 v_cvt_pk_bf16_f32 v250, v250, v251
 v_accvgpr_write_b32 a16, v250
 v_lshlrev_b32 v250, 16, v17
 v_and_b32 v251, 0xffff0000, v17
 v_add_f32 v250, v254, v250
 v_add_f32 v251, v254, v251
 v_cvt_pk_bf16_f32 v250, v250, v251
 v_accvgpr_write_b32 a17, v250
 v_lshlrev_b32 v250, 16, v18
 v_mfma_f32_32x32x16_bf16 v[160:175], v[212:215], a[0:3], 0
 ds_read_b64_tr_b16 v[236:237], v241 offset:6144
 ds_read_b64_tr_b16 v[238:239], v241 offset:7168
 v_and_b32 v251, 0xffff0000, v18
 v_add_f32 v250, v254, v250
 v_add_f32 v251, v254, v251
 v_cvt_pk_bf16_f32 v250, v250, v251
 v_accvgpr_write_b32 a18, v250
 v_lshlrev_b32 v250, 16, v19
 v_and_b32 v251, 0xffff0000, v19
 v_add_f32 v250, v254, v250
 v_add_f32 v251, v254, v251
 v_cvt_pk_bf16_f32 v250, v250, v251
 v_accvgpr_write_b32 a19, v250
 v_lshlrev_b32 v250, 16, v20
 v_and_b32 v251, 0xffff0000, v20
 v_add_f32 v250, v254, v250
 v_mfma_f32_32x32x16_bf16 v[144:159], v[216:219], a[4:7], v[144:159]
 ds_read_b64_tr_b16 v[208:209], v240 offset:8192
 ds_read_b64_tr_b16 v[210:211], v240 offset:9216
 buffer_load_dwordx4 v[52:55], v252, s[8:11], s52 offen offset:1024 sc1
 v_add_f32 v251, v254, v251
 v_cvt_pk_bf16_f32 v250, v250, v251
 v_accvgpr_write_b32 a20, v250
 v_lshlrev_b32 v250, 16, v21
 v_and_b32 v251, 0xffff0000, v21
 v_add_f32 v250, v254, v250
 v_add_f32 v251, v254, v251
 v_cvt_pk_bf16_f32 v250, v250, v251
 v_accvgpr_write_b32 a21, v250
 v_lshlrev_b32 v250, 16, v22
 v_and_b32 v251, 0xffff0000, v22
 v_add_f32 v250, v254, v250
 v_add_f32 v251, v254, v251
 v_cvt_pk_bf16_f32 v250, v250, v251
 v_mfma_f32_32x32x16_bf16 v[160:175], v[220:223], a[4:7], v[160:175]
 ds_read_b64_tr_b16 v[212:213], v241 offset:8192
 ds_read_b64_tr_b16 v[214:215], v241 offset:9216
 v_accvgpr_write_b32 a22, v250
 v_lshlrev_b32 v250, 16, v23
 v_and_b32 v251, 0xffff0000, v23
 v_add_f32 v250, v254, v250
 v_add_f32 v251, v254, v251
 v_cvt_pk_bf16_f32 v250, v250, v251
 v_accvgpr_write_b32 a23, v250
 v_lshlrev_b32 v250, 16, v24
 v_and_b32 v251, 0xffff0000, v24
 v_add_f32 v250, v254, v250
 v_add_f32 v251, v254, v251
 v_cvt_pk_bf16_f32 v250, v250, v251
 v_accvgpr_write_b32 a24, v250
 v_lshlrev_b32 v250, 16, v25
 s_waitcnt lgkmcnt(4)
 v_mfma_f32_32x32x16_bf16 v[144:159], v[224:227], a[8:11], v[144:159]
 ds_read_b64_tr_b16 v[216:217], v240 offset:10240
 ds_read_b64_tr_b16 v[218:219], v240 offset:11264
 buffer_load_dwordx4 v[56:59], v252, s[8:11], s52 offen offset:2048 sc1
 v_and_b32 v251, 0xffff0000, v25
 v_add_f32 v250, v254, v250
 v_add_f32 v251, v254, v251
 v_cvt_pk_bf16_f32 v250, v250, v251
 v_accvgpr_write_b32 a25, v250
 v_lshlrev_b32 v250, 16, v26
 v_and_b32 v251, 0xffff0000, v26
 v_add_f32 v250, v254, v250
 v_add_f32 v251, v254, v251
 v_cvt_pk_bf16_f32 v250, v250, v251
 v_accvgpr_write_b32 a26, v250
 v_lshlrev_b32 v250, 16, v27
 v_and_b32 v251, 0xffff0000, v27
 v_add_f32 v250, v254, v250
 v_mfma_f32_32x32x16_bf16 v[160:175], v[228:231], a[8:11], v[160:175]
 ds_read_b64_tr_b16 v[220:221], v241 offset:10240
 ds_read_b64_tr_b16 v[222:223], v241 offset:11264
 v_add_f32 v251, v254, v251
 v_cvt_pk_bf16_f32 v250, v250, v251
 v_accvgpr_write_b32 a27, v250
 v_lshlrev_b32 v250, 16, v28
 v_and_b32 v251, 0xffff0000, v28
 v_add_f32 v250, v254, v250
 v_add_f32 v251, v254, v251
 v_cvt_pk_bf16_f32 v250, v250, v251
 v_accvgpr_write_b32 a28, v250
 v_lshlrev_b32 v250, 16, v29
 v_and_b32 v251, 0xffff0000, v29
 v_add_f32 v250, v254, v250
 v_add_f32 v251, v254, v251
 v_cvt_pk_bf16_f32 v250, v250, v251
 v_mfma_f32_32x32x16_bf16 v[144:159], v[232:235], a[12:15], v[144:159]
 ds_read_b64_tr_b16 v[224:225], v240 offset:12288
 ds_read_b64_tr_b16 v[226:227], v240 offset:13312
 buffer_load_dwordx4 v[60:63], v252, s[8:11], s52 offen offset:3072 sc1
 v_accvgpr_write_b32 a29, v250
 v_lshlrev_b32 v250, 16, v30
 v_and_b32 v251, 0xffff0000, v30
 v_add_f32 v250, v254, v250
 v_add_f32 v251, v254, v251
 v_cvt_pk_bf16_f32 v250, v250, v251
 v_accvgpr_write_b32 a30, v250
 v_lshlrev_b32 v250, 16, v31
 v_and_b32 v251, 0xffff0000, v31
 v_add_f32 v250, v254, v250
 v_add_f32 v251, v254, v251
 v_cvt_pk_bf16_f32 v250, v250, v251
 v_accvgpr_write_b32 a31, v250
 v_mfma_f32_32x32x16_bf16 v[160:175], v[236:239], a[12:15], v[160:175]
 ds_read_b64_tr_b16 v[228:229], v241 offset:12288
 ds_read_b64_tr_b16 v[230:231], v241 offset:13312
 s_waitcnt lgkmcnt(4)
 v_mfma_f32_32x32x16_bf16 v[144:159], v[208:211], a[16:19], v[144:159]
 ds_read_b64_tr_b16 v[232:233], v240 offset:14336
 ds_read_b64_tr_b16 v[234:235], v240 offset:15360
 s_add_u32 s52, s51, 14279168
 buffer_load_dwordx4 v[64:67], v252, s[8:11], s52 offen offset:0 sc1
 s_waitcnt vmcnt(5)
 v_lshlrev_b32 v250, 16, v32
 v_and_b32 v251, 0xffff0000, v32
 v_add_f32 v250, v254, v250
 v_add_f32 v251, v254, v251
 v_cvt_pk_bf16_f32 v250, v250, v251
 v_accvgpr_write_b32 a32, v250
 v_lshlrev_b32 v250, 16, v33
 v_and_b32 v251, 0xffff0000, v33
 v_add_f32 v250, v254, v250
 v_add_f32 v251, v254, v251
 v_cvt_pk_bf16_f32 v250, v250, v251
 v_accvgpr_write_b32 a33, v250
 v_lshlrev_b32 v250, 16, v34
 v_and_b32 v251, 0xffff0000, v34
 v_add_f32 v250, v254, v250
 v_add_f32 v251, v254, v251
 v_mfma_f32_32x32x16_bf16 v[160:175], v[212:215], a[16:19], v[160:175]
 ds_read_b64_tr_b16 v[236:237], v241 offset:14336
 ds_read_b64_tr_b16 v[238:239], v241 offset:15360
 s_waitcnt vmcnt(45)
 s_barrier
 v_mfma_f32_32x32x16_bf16 v[144:159], v[216:219], a[20:23], v[144:159]
 ds_read_b64_tr_b16 v[208:209], v240 offset:16384
 ds_read_b64_tr_b16 v[210:211], v240 offset:17408
 buffer_load_dwordx4 v[68:71], v252, s[8:11], s52 offen offset:1024 sc1
 v_cvt_pk_bf16_f32 v250, v250, v251
 v_accvgpr_write_b32 a34, v250
 v_lshlrev_b32 v250, 16, v35
 v_and_b32 v251, 0xffff0000, v35
 v_add_f32 v250, v254, v250
 v_add_f32 v251, v254, v251
 v_cvt_pk_bf16_f32 v250, v250, v251
 v_accvgpr_write_b32 a35, v250
 v_lshlrev_b32 v250, 16, v36
 v_and_b32 v251, 0xffff0000, v36
 v_add_f32 v250, v254, v250
 v_add_f32 v251, v254, v251
 v_cvt_pk_bf16_f32 v250, v250, v251
 v_accvgpr_write_b32 a36, v250
 v_lshlrev_b32 v250, 16, v37
 v_and_b32 v251, 0xffff0000, v37
 v_mfma_f32_32x32x16_bf16 v[160:175], v[220:223], a[20:23], v[160:175]
 ds_read_b64_tr_b16 v[212:213], v241 offset:16384
 ds_read_b64_tr_b16 v[214:215], v241 offset:17408
 v_add_f32 v250, v254, v250
 v_add_f32 v251, v254, v251
 v_cvt_pk_bf16_f32 v250, v250, v251
 v_accvgpr_write_b32 a37, v250
 v_lshlrev_b32 v250, 16, v38
 v_and_b32 v251, 0xffff0000, v38
 v_add_f32 v250, v254, v250
 v_add_f32 v251, v254, v251
 v_cvt_pk_bf16_f32 v250, v250, v251
 v_accvgpr_write_b32 a38, v250
 v_lshlrev_b32 v250, 16, v39
 v_and_b32 v251, 0xffff0000, v39
 v_add_f32 v250, v254, v250
 v_add_f32 v251, v254, v251
 v_cvt_pk_bf16_f32 v250, v250, v251
 v_accvgpr_write_b32 a39, v250
 s_waitcnt lgkmcnt(4)
 v_mfma_f32_32x32x16_bf16 v[144:159], v[224:227], a[24:27], v[144:159]
 ds_read_b64_tr_b16 v[216:217], v240 offset:18432
 ds_read_b64_tr_b16 v[218:219], v240 offset:19456
 buffer_load_dwordx4 v[72:75], v252, s[8:11], s52 offen offset:2048 sc1
 v_lshlrev_b32 v250, 16, v40
 v_and_b32 v251, 0xffff0000, v40
 v_add_f32 v250, v254, v250
 v_add_f32 v251, v254, v251
 v_cvt_pk_bf16_f32 v250, v250, v251
 v_accvgpr_write_b32 a40, v250
 v_lshlrev_b32 v250, 16, v41
 v_and_b32 v251, 0xffff0000, v41
 v_add_f32 v250, v254, v250
 v_add_f32 v251, v254, v251
 v_cvt_pk_bf16_f32 v250, v250, v251
 v_accvgpr_write_b32 a41, v250
 v_lshlrev_b32 v250, 16, v42
 v_and_b32 v251, 0xffff0000, v42
 v_add_f32 v250, v254, v250
 v_add_f32 v251, v254, v251
 v_mfma_f32_32x32x16_bf16 v[160:175], v[228:231], a[24:27], v[160:175]
 ds_read_b64_tr_b16 v[220:221], v241 offset:18432
 ds_read_b64_tr_b16 v[222:223], v241 offset:19456
 v_cvt_pk_bf16_f32 v250, v250, v251
 v_accvgpr_write_b32 a42, v250
 v_lshlrev_b32 v250, 16, v43
 v_and_b32 v251, 0xffff0000, v43
 v_add_f32 v250, v254, v250
 v_add_f32 v251, v254, v251
 v_cvt_pk_bf16_f32 v250, v250, v251
 v_accvgpr_write_b32 a43, v250
 v_lshlrev_b32 v250, 16, v44
 v_and_b32 v251, 0xffff0000, v44
 v_add_f32 v250, v254, v250
 v_add_f32 v251, v254, v251
 v_cvt_pk_bf16_f32 v250, v250, v251
 v_accvgpr_write_b32 a44, v250
 v_lshlrev_b32 v250, 16, v45
 v_and_b32 v251, 0xffff0000, v45
 v_mfma_f32_32x32x16_bf16 v[144:159], v[232:235], a[28:31], v[144:159]
 ds_read_b64_tr_b16 v[224:225], v240 offset:20480
 ds_read_b64_tr_b16 v[226:227], v240 offset:21504
 buffer_load_dwordx4 v[76:79], v252, s[8:11], s52 offen offset:3072 sc1
 v_add_f32 v250, v254, v250
 v_add_f32 v251, v254, v251
 v_cvt_pk_bf16_f32 v250, v250, v251
 v_accvgpr_write_b32 a45, v250
 v_lshlrev_b32 v250, 16, v46
 v_and_b32 v251, 0xffff0000, v46
 v_add_f32 v250, v254, v250
 v_add_f32 v251, v254, v251
 v_cvt_pk_bf16_f32 v250, v250, v251
 v_accvgpr_write_b32 a46, v250
 v_lshlrev_b32 v250, 16, v47
 v_and_b32 v251, 0xffff0000, v47
 v_add_f32 v250, v254, v250
 v_add_f32 v251, v254, v251
 v_cvt_pk_bf16_f32 v250, v250, v251
 v_accvgpr_write_b32 a47, v250
 v_mfma_f32_32x32x16_bf16 v[160:175], v[236:239], a[28:31], v[160:175]
 ds_read_b64_tr_b16 v[228:229], v241 offset:20480
 ds_read_b64_tr_b16 v[230:231], v241 offset:21504
 s_waitcnt lgkmcnt(4)
 v_mfma_f32_32x32x16_bf16 v[144:159], v[208:211], a[32:35], v[144:159]
 ds_read_b64_tr_b16 v[232:233], v240 offset:22528
 ds_read_b64_tr_b16 v[234:235], v240 offset:23552
 s_add_u32 s52, s51, 14283264
 buffer_load_dwordx4 v[80:83], v252, s[8:11], s52 offen offset:0 sc1
 s_waitcnt vmcnt(5)
 v_lshlrev_b32 v250, 16, v48
 v_and_b32 v251, 0xffff0000, v48
 v_add_f32 v250, v254, v250
 v_add_f32 v251, v254, v251
 v_cvt_pk_bf16_f32 v250, v250, v251
 v_accvgpr_write_b32 a48, v250
 v_lshlrev_b32 v250, 16, v49
 v_and_b32 v251, 0xffff0000, v49
 v_add_f32 v250, v254, v250
 v_add_f32 v251, v254, v251
 v_cvt_pk_bf16_f32 v250, v250, v251
 v_accvgpr_write_b32 a49, v250
 v_lshlrev_b32 v250, 16, v50
 v_and_b32 v251, 0xffff0000, v50
 v_add_f32 v250, v254, v250
 v_add_f32 v251, v254, v251
 v_mfma_f32_32x32x16_bf16 v[160:175], v[212:215], a[32:35], v[160:175]
 ds_read_b64_tr_b16 v[236:237], v241 offset:22528
 ds_read_b64_tr_b16 v[238:239], v241 offset:23552
 s_waitcnt vmcnt(45)
 s_barrier
 v_mfma_f32_32x32x16_bf16 v[144:159], v[216:219], a[36:39], v[144:159]
 ds_read_b64_tr_b16 v[208:209], v240 offset:24576
 ds_read_b64_tr_b16 v[210:211], v240 offset:25600
 buffer_load_dwordx4 v[84:87], v252, s[8:11], s52 offen offset:1024 sc1
 v_cvt_pk_bf16_f32 v250, v250, v251
 v_accvgpr_write_b32 a50, v250
 v_lshlrev_b32 v250, 16, v51
 v_and_b32 v251, 0xffff0000, v51
 v_add_f32 v250, v254, v250
 v_add_f32 v251, v254, v251
 v_cvt_pk_bf16_f32 v250, v250, v251
 v_accvgpr_write_b32 a51, v250
 v_lshlrev_b32 v250, 16, v52
 v_and_b32 v251, 0xffff0000, v52
 v_add_f32 v250, v254, v250
 v_add_f32 v251, v254, v251
 v_cvt_pk_bf16_f32 v250, v250, v251
 v_accvgpr_write_b32 a52, v250
 v_lshlrev_b32 v250, 16, v53
 v_and_b32 v251, 0xffff0000, v53
 v_mfma_f32_32x32x16_bf16 v[160:175], v[220:223], a[36:39], v[160:175]
 ds_read_b64_tr_b16 v[212:213], v241 offset:24576
 ds_read_b64_tr_b16 v[214:215], v241 offset:25600
 v_add_f32 v250, v254, v250
 v_add_f32 v251, v254, v251
 v_cvt_pk_bf16_f32 v250, v250, v251
 v_accvgpr_write_b32 a53, v250
 v_lshlrev_b32 v250, 16, v54
 v_and_b32 v251, 0xffff0000, v54
 v_add_f32 v250, v254, v250
 v_add_f32 v251, v254, v251
 v_cvt_pk_bf16_f32 v250, v250, v251
 v_accvgpr_write_b32 a54, v250
 v_lshlrev_b32 v250, 16, v55
 v_and_b32 v251, 0xffff0000, v55
 v_add_f32 v250, v254, v250
 v_add_f32 v251, v254, v251
 v_cvt_pk_bf16_f32 v250, v250, v251
 v_accvgpr_write_b32 a55, v250
 s_waitcnt lgkmcnt(4)
 v_mfma_f32_32x32x16_bf16 v[144:159], v[224:227], a[40:43], v[144:159]
 ds_read_b64_tr_b16 v[216:217], v240 offset:26624
 ds_read_b64_tr_b16 v[218:219], v240 offset:27648
 buffer_load_dwordx4 v[88:91], v252, s[8:11], s52 offen offset:2048 sc1
 v_lshlrev_b32 v250, 16, v56
 v_and_b32 v251, 0xffff0000, v56
 v_add_f32 v250, v254, v250
 v_add_f32 v251, v254, v251
 v_cvt_pk_bf16_f32 v250, v250, v251
 v_accvgpr_write_b32 a56, v250
 v_lshlrev_b32 v250, 16, v57
 v_and_b32 v251, 0xffff0000, v57
 v_add_f32 v250, v254, v250
 v_add_f32 v251, v254, v251
 v_cvt_pk_bf16_f32 v250, v250, v251
 v_accvgpr_write_b32 a57, v250
 v_lshlrev_b32 v250, 16, v58
 v_and_b32 v251, 0xffff0000, v58
 v_add_f32 v250, v254, v250
 v_add_f32 v251, v254, v251
 v_mfma_f32_32x32x16_bf16 v[160:175], v[228:231], a[40:43], v[160:175]
 ds_read_b64_tr_b16 v[220:221], v241 offset:26624
 ds_read_b64_tr_b16 v[222:223], v241 offset:27648
 v_cvt_pk_bf16_f32 v250, v250, v251
 v_accvgpr_write_b32 a58, v250
 v_lshlrev_b32 v250, 16, v59
 v_and_b32 v251, 0xffff0000, v59
 v_add_f32 v250, v254, v250
 v_add_f32 v251, v254, v251
 v_cvt_pk_bf16_f32 v250, v250, v251
 v_accvgpr_write_b32 a59, v250
 v_lshlrev_b32 v250, 16, v60
 v_and_b32 v251, 0xffff0000, v60
 v_add_f32 v250, v254, v250
 v_add_f32 v251, v254, v251
 v_cvt_pk_bf16_f32 v250, v250, v251
 v_accvgpr_write_b32 a60, v250
 v_lshlrev_b32 v250, 16, v61
 v_and_b32 v251, 0xffff0000, v61
 v_mfma_f32_32x32x16_bf16 v[144:159], v[232:235], a[44:47], v[144:159]
 ds_read_b64_tr_b16 v[224:225], v240 offset:28672
 ds_read_b64_tr_b16 v[226:227], v240 offset:29696
 buffer_load_dwordx4 v[92:95], v252, s[8:11], s52 offen offset:3072 sc1
 v_add_f32 v250, v254, v250
 v_add_f32 v251, v254, v251
 v_cvt_pk_bf16_f32 v250, v250, v251
 v_accvgpr_write_b32 a61, v250
 v_lshlrev_b32 v250, 16, v62
 v_and_b32 v251, 0xffff0000, v62
 v_add_f32 v250, v254, v250
 v_add_f32 v251, v254, v251
 v_cvt_pk_bf16_f32 v250, v250, v251
 v_accvgpr_write_b32 a62, v250
 v_lshlrev_b32 v250, 16, v63
 v_and_b32 v251, 0xffff0000, v63
 v_add_f32 v250, v254, v250
 v_add_f32 v251, v254, v251
 v_cvt_pk_bf16_f32 v250, v250, v251
 v_accvgpr_write_b32 a63, v250
 v_mfma_f32_32x32x16_bf16 v[160:175], v[236:239], a[44:47], v[160:175]
 ds_read_b64_tr_b16 v[228:229], v241 offset:28672
 ds_read_b64_tr_b16 v[230:231], v241 offset:29696
 s_waitcnt lgkmcnt(4)
 v_mfma_f32_32x32x16_bf16 v[144:159], v[208:211], a[48:51], v[144:159]
 ds_read_b64_tr_b16 v[232:233], v240 offset:30720
 ds_read_b64_tr_b16 v[234:235], v240 offset:31744
 s_add_u32 s52, s51, 14287360
 buffer_load_dwordx4 v[96:99], v252, s[8:11], s52 offen offset:0 sc1
 s_waitcnt vmcnt(5)
 v_lshlrev_b32 v250, 16, v64
 v_and_b32 v251, 0xffff0000, v64
 v_add_f32 v250, v254, v250
 v_add_f32 v251, v254, v251
 v_cvt_pk_bf16_f32 v250, v250, v251
 v_accvgpr_write_b32 a64, v250
 v_lshlrev_b32 v250, 16, v65
 v_and_b32 v251, 0xffff0000, v65
 v_add_f32 v250, v254, v250
 v_add_f32 v251, v254, v251
 v_cvt_pk_bf16_f32 v250, v250, v251
 v_accvgpr_write_b32 a65, v250
 v_lshlrev_b32 v250, 16, v66
 v_and_b32 v251, 0xffff0000, v66
 v_add_f32 v250, v254, v250
 v_add_f32 v251, v254, v251
 v_mfma_f32_32x32x16_bf16 v[160:175], v[212:215], a[48:51], v[160:175]
 ds_read_b64_tr_b16 v[236:237], v241 offset:30720
 ds_read_b64_tr_b16 v[238:239], v241 offset:31744
 buffer_load_dwordx4 v[100:103], v252, s[8:11], s52 offen offset:1024 sc1
 v_cvt_pk_bf16_f32 v250, v250, v251
 v_accvgpr_write_b32 a66, v250
 v_lshlrev_b32 v250, 16, v67
 v_and_b32 v251, 0xffff0000, v67
 v_add_f32 v250, v254, v250
 v_add_f32 v251, v254, v251
 v_cvt_pk_bf16_f32 v250, v250, v251
 v_accvgpr_write_b32 a67, v250
 v_lshlrev_b32 v250, 16, v68
 v_and_b32 v251, 0xffff0000, v68
 v_add_f32 v250, v254, v250
 v_add_f32 v251, v254, v251
 v_cvt_pk_bf16_f32 v250, v250, v251
 v_accvgpr_write_b32 a68, v250
 v_lshlrev_b32 v250, 16, v69
 v_and_b32 v251, 0xffff0000, v69
 v_mfma_f32_32x32x16_bf16 v[144:159], v[216:219], a[52:55], v[144:159]
 ds_read_b64_tr_b16 v[208:209], v240 offset:32768
 ds_read_b64_tr_b16 v[210:211], v240 offset:33792
 v_add_f32 v250, v254, v250
 v_add_f32 v251, v254, v251
 v_cvt_pk_bf16_f32 v250, v250, v251
 v_accvgpr_write_b32 a69, v250
 v_lshlrev_b32 v250, 16, v70
 v_and_b32 v251, 0xffff0000, v70
 v_add_f32 v250, v254, v250
 v_add_f32 v251, v254, v251
 v_cvt_pk_bf16_f32 v250, v250, v251
 v_accvgpr_write_b32 a70, v250
 v_lshlrev_b32 v250, 16, v71
 v_and_b32 v251, 0xffff0000, v71
 v_add_f32 v250, v254, v250
 v_add_f32 v251, v254, v251
 v_cvt_pk_bf16_f32 v250, v250, v251
 v_accvgpr_write_b32 a71, v250
 v_mfma_f32_32x32x16_bf16 v[160:175], v[220:223], a[52:55], v[160:175]
 ds_read_b64_tr_b16 v[212:213], v241 offset:32768
 ds_read_b64_tr_b16 v[214:215], v241 offset:33792
 buffer_load_dwordx4 v[104:107], v252, s[8:11], s52 offen offset:2048 sc1
 v_lshlrev_b32 v250, 16, v72
 v_and_b32 v251, 0xffff0000, v72
 v_add_f32 v250, v254, v250
 v_add_f32 v251, v254, v251
 v_cvt_pk_bf16_f32 v250, v250, v251
 v_accvgpr_write_b32 a72, v250
 v_lshlrev_b32 v250, 16, v73
 v_and_b32 v251, 0xffff0000, v73
 v_add_f32 v250, v254, v250
 v_add_f32 v251, v254, v251
 v_cvt_pk_bf16_f32 v250, v250, v251
 v_accvgpr_write_b32 a73, v250
 v_lshlrev_b32 v250, 16, v74
 v_and_b32 v251, 0xffff0000, v74
 v_add_f32 v250, v254, v250
 v_add_f32 v251, v254, v251
 s_waitcnt lgkmcnt(4)
 v_mfma_f32_32x32x16_bf16 v[144:159], v[224:227], a[56:59], v[144:159]
 ds_read_b64_tr_b16 v[216:217], v240 offset:34816
 ds_read_b64_tr_b16 v[218:219], v240 offset:35840
 v_cvt_pk_bf16_f32 v250, v250, v251
 v_accvgpr_write_b32 a74, v250
 v_lshlrev_b32 v250, 16, v75
 v_and_b32 v251, 0xffff0000, v75
 v_add_f32 v250, v254, v250
 v_add_f32 v251, v254, v251
 v_cvt_pk_bf16_f32 v250, v250, v251
 v_accvgpr_write_b32 a75, v250
 v_lshlrev_b32 v250, 16, v76
 v_and_b32 v251, 0xffff0000, v76
 v_add_f32 v250, v254, v250
 v_add_f32 v251, v254, v251
 v_cvt_pk_bf16_f32 v250, v250, v251
 v_accvgpr_write_b32 a76, v250
 v_lshlrev_b32 v250, 16, v77
 v_and_b32 v251, 0xffff0000, v77
 v_mfma_f32_32x32x16_bf16 v[160:175], v[228:231], a[56:59], v[160:175]
 ds_read_b64_tr_b16 v[220:221], v241 offset:34816
 ds_read_b64_tr_b16 v[222:223], v241 offset:35840
 s_waitcnt vmcnt(43)
 s_barrier
 v_mfma_f32_32x32x16_bf16 v[144:159], v[232:235], a[60:63], v[144:159]
 ds_read_b64_tr_b16 v[224:225], v240 offset:36864
 ds_read_b64_tr_b16 v[226:227], v240 offset:37888
 buffer_load_dwordx4 v[108:111], v252, s[8:11], s52 offen offset:3072 sc1
 v_add_f32 v250, v254, v250
 v_add_f32 v251, v254, v251
 v_cvt_pk_bf16_f32 v250, v250, v251
 v_accvgpr_write_b32 a77, v250
 v_lshlrev_b32 v250, 16, v78
 v_and_b32 v251, 0xffff0000, v78
 v_add_f32 v250, v254, v250
 v_add_f32 v251, v254, v251
 v_cvt_pk_bf16_f32 v250, v250, v251
 v_accvgpr_write_b32 a78, v250
 v_lshlrev_b32 v250, 16, v79
 v_and_b32 v251, 0xffff0000, v79
 v_add_f32 v250, v254, v250
 v_add_f32 v251, v254, v251
 v_cvt_pk_bf16_f32 v250, v250, v251
 v_accvgpr_write_b32 a79, v250
 v_mfma_f32_32x32x16_bf16 v[160:175], v[236:239], a[60:63], v[160:175]
 ds_read_b64_tr_b16 v[228:229], v241 offset:36864
 ds_read_b64_tr_b16 v[230:231], v241 offset:37888
 s_waitcnt lgkmcnt(4)
 v_mfma_f32_32x32x16_bf16 v[144:159], v[208:211], a[64:67], v[144:159]
 ds_read_b64_tr_b16 v[232:233], v240 offset:38912
 ds_read_b64_tr_b16 v[234:235], v240 offset:39936
 s_add_u32 s52, s51, 14291456
 buffer_load_dwordx4 v[112:115], v252, s[8:11], s52 offen offset:0 sc1
 s_waitcnt vmcnt(5)
 v_lshlrev_b32 v250, 16, v80
 v_and_b32 v251, 0xffff0000, v80
 v_add_f32 v250, v254, v250
 v_add_f32 v251, v254, v251
 v_cvt_pk_bf16_f32 v250, v250, v251
 v_accvgpr_write_b32 a80, v250
 v_lshlrev_b32 v250, 16, v81
 v_and_b32 v251, 0xffff0000, v81
 v_add_f32 v250, v254, v250
 v_add_f32 v251, v254, v251
 v_cvt_pk_bf16_f32 v250, v250, v251
 v_accvgpr_write_b32 a81, v250
 v_lshlrev_b32 v250, 16, v82
 v_mfma_f32_32x32x16_bf16 v[160:175], v[212:215], a[64:67], v[160:175]
 ds_read_b64_tr_b16 v[236:237], v241 offset:38912
 ds_read_b64_tr_b16 v[238:239], v241 offset:39936
 v_and_b32 v251, 0xffff0000, v82
 v_add_f32 v250, v254, v250
 v_add_f32 v251, v254, v251
 v_cvt_pk_bf16_f32 v250, v250, v251
 v_accvgpr_write_b32 a82, v250
 v_lshlrev_b32 v250, 16, v83
 v_and_b32 v251, 0xffff0000, v83
 v_add_f32 v250, v254, v250
 v_add_f32 v251, v254, v251
 v_cvt_pk_bf16_f32 v250, v250, v251
 v_accvgpr_write_b32 a83, v250
 v_lshlrev_b32 v250, 16, v84
 v_and_b32 v251, 0xffff0000, v84
 v_add_f32 v250, v254, v250
 v_mfma_f32_32x32x16_bf16 v[144:159], v[216:219], a[68:71], v[144:159]
 ds_read_b64_tr_b16 v[208:209], v240 offset:40960
 ds_read_b64_tr_b16 v[210:211], v240 offset:41984
 buffer_load_dwordx4 v[116:119], v252, s[8:11], s52 offen offset:1024 sc1
 v_add_f32 v251, v254, v251
 v_cvt_pk_bf16_f32 v250, v250, v251
 v_accvgpr_write_b32 a84, v250
 v_lshlrev_b32 v250, 16, v85
 v_and_b32 v251, 0xffff0000, v85
 v_add_f32 v250, v254, v250
 v_add_f32 v251, v254, v251
 v_cvt_pk_bf16_f32 v250, v250, v251
 v_accvgpr_write_b32 a85, v250
 v_lshlrev_b32 v250, 16, v86
 v_and_b32 v251, 0xffff0000, v86
 v_add_f32 v250, v254, v250
 v_add_f32 v251, v254, v251
 v_cvt_pk_bf16_f32 v250, v250, v251
 v_mfma_f32_32x32x16_bf16 v[160:175], v[220:223], a[68:71], v[160:175]
 ds_read_b64_tr_b16 v[212:213], v241 offset:40960
 ds_read_b64_tr_b16 v[214:215], v241 offset:41984
 v_accvgpr_write_b32 a86, v250
 v_lshlrev_b32 v250, 16, v87
 v_and_b32 v251, 0xffff0000, v87
 v_add_f32 v250, v254, v250
 v_add_f32 v251, v254, v251
 v_cvt_pk_bf16_f32 v250, v250, v251
 v_accvgpr_write_b32 a87, v250
 v_lshlrev_b32 v250, 16, v88
 v_and_b32 v251, 0xffff0000, v88
 v_add_f32 v250, v254, v250
 v_add_f32 v251, v254, v251
 v_cvt_pk_bf16_f32 v250, v250, v251
 v_accvgpr_write_b32 a88, v250
 v_lshlrev_b32 v250, 16, v89
 s_waitcnt lgkmcnt(4)
 v_mfma_f32_32x32x16_bf16 v[144:159], v[224:227], a[72:75], v[144:159]
 ds_read_b64_tr_b16 v[216:217], v240 offset:43008
 ds_read_b64_tr_b16 v[218:219], v240 offset:44032
 buffer_load_dwordx4 v[120:123], v252, s[8:11], s52 offen offset:2048 sc1
 v_and_b32 v251, 0xffff0000, v89
 v_add_f32 v250, v254, v250
 v_add_f32 v251, v254, v251
 v_cvt_pk_bf16_f32 v250, v250, v251
 v_accvgpr_write_b32 a89, v250
 v_lshlrev_b32 v250, 16, v90
 v_and_b32 v251, 0xffff0000, v90
 v_add_f32 v250, v254, v250
 v_add_f32 v251, v254, v251
 v_cvt_pk_bf16_f32 v250, v250, v251
 v_accvgpr_write_b32 a90, v250
 v_lshlrev_b32 v250, 16, v91
 v_and_b32 v251, 0xffff0000, v91
 v_add_f32 v250, v254, v250
 v_mfma_f32_32x32x16_bf16 v[160:175], v[228:231], a[72:75], v[160:175]
 ds_read_b64_tr_b16 v[220:221], v241 offset:43008
 ds_read_b64_tr_b16 v[222:223], v241 offset:44032
 v_add_f32 v251, v254, v251
 v_cvt_pk_bf16_f32 v250, v250, v251
 v_accvgpr_write_b32 a91, v250
 v_lshlrev_b32 v250, 16, v92
 v_and_b32 v251, 0xffff0000, v92
 v_add_f32 v250, v254, v250
 v_add_f32 v251, v254, v251
 v_cvt_pk_bf16_f32 v250, v250, v251
 v_accvgpr_write_b32 a92, v250
 v_lshlrev_b32 v250, 16, v93
 v_and_b32 v251, 0xffff0000, v93
 v_add_f32 v250, v254, v250
 v_add_f32 v251, v254, v251
 v_cvt_pk_bf16_f32 v250, v250, v251
 v_mfma_f32_32x32x16_bf16 v[144:159], v[232:235], a[76:79], v[144:159]
 ds_read_b64_tr_b16 v[224:225], v240 offset:45056
 ds_read_b64_tr_b16 v[226:227], v240 offset:46080
 buffer_load_dwordx4 v[124:127], v252, s[8:11], s52 offen offset:3072 sc1
 v_accvgpr_write_b32 a93, v250
 v_lshlrev_b32 v250, 16, v94
 v_and_b32 v251, 0xffff0000, v94
 v_add_f32 v250, v254, v250
 v_add_f32 v251, v254, v251
 v_cvt_pk_bf16_f32 v250, v250, v251
 v_accvgpr_write_b32 a94, v250
 v_lshlrev_b32 v250, 16, v95
 v_and_b32 v251, 0xffff0000, v95
 v_add_f32 v250, v254, v250
 v_add_f32 v251, v254, v251
 v_cvt_pk_bf16_f32 v250, v250, v251
 v_accvgpr_write_b32 a95, v250
 v_mfma_f32_32x32x16_bf16 v[160:175], v[236:239], a[76:79], v[160:175]
 ds_read_b64_tr_b16 v[228:229], v241 offset:45056
 ds_read_b64_tr_b16 v[230:231], v241 offset:46080
 s_waitcnt lgkmcnt(4)
 v_mfma_f32_32x32x16_bf16 v[144:159], v[208:211], a[80:83], v[144:159]
 ds_read_b64_tr_b16 v[232:233], v240 offset:47104
 ds_read_b64_tr_b16 v[234:235], v240 offset:48128
 s_add_u32 s52, s51, 14295552
 buffer_load_dwordx4 v[128:131], v252, s[8:11], s52 offen offset:0 sc1
 s_waitcnt vmcnt(5)
 v_lshlrev_b32 v250, 16, v96
 v_and_b32 v251, 0xffff0000, v96
 v_add_f32 v250, v254, v250
 v_add_f32 v251, v254, v251
 v_cvt_pk_bf16_f32 v250, v250, v251
 v_accvgpr_write_b32 a96, v250
 v_lshlrev_b32 v250, 16, v97
 v_and_b32 v251, 0xffff0000, v97
 v_add_f32 v250, v254, v250
 v_add_f32 v251, v254, v251
 v_cvt_pk_bf16_f32 v250, v250, v251
 v_accvgpr_write_b32 a97, v250
 v_lshlrev_b32 v250, 16, v98
 v_mfma_f32_32x32x16_bf16 v[160:175], v[212:215], a[80:83], v[160:175]
 ds_read_b64_tr_b16 v[236:237], v241 offset:47104
 ds_read_b64_tr_b16 v[238:239], v241 offset:48128
 v_and_b32 v251, 0xffff0000, v98
 v_add_f32 v250, v254, v250
 v_add_f32 v251, v254, v251
 v_cvt_pk_bf16_f32 v250, v250, v251
 v_accvgpr_write_b32 a98, v250
 v_lshlrev_b32 v250, 16, v99
 v_and_b32 v251, 0xffff0000, v99
 v_add_f32 v250, v254, v250
 v_add_f32 v251, v254, v251
 v_cvt_pk_bf16_f32 v250, v250, v251
 v_accvgpr_write_b32 a99, v250
 v_lshlrev_b32 v250, 16, v100
 v_and_b32 v251, 0xffff0000, v100
 v_add_f32 v250, v254, v250
 v_mfma_f32_32x32x16_bf16 v[144:159], v[216:219], a[84:87], v[144:159]
 ds_read_b64_tr_b16 v[208:209], v242 offset:0
 ds_read_b64_tr_b16 v[210:211], v242 offset:1024
 buffer_load_dwordx4 v[132:135], v252, s[8:11], s52 offen offset:1024 sc1
 v_add_f32 v251, v254, v251
 v_cvt_pk_bf16_f32 v250, v250, v251
 v_accvgpr_write_b32 a100, v250
 v_lshlrev_b32 v250, 16, v101
 v_and_b32 v251, 0xffff0000, v101
 v_add_f32 v250, v254, v250
 v_add_f32 v251, v254, v251
 v_cvt_pk_bf16_f32 v250, v250, v251
 v_accvgpr_write_b32 a101, v250
 v_lshlrev_b32 v250, 16, v102
 v_and_b32 v251, 0xffff0000, v102
 v_add_f32 v250, v254, v250
 v_add_f32 v251, v254, v251
 v_cvt_pk_bf16_f32 v250, v250, v251
 v_mfma_f32_32x32x16_bf16 v[160:175], v[220:223], a[84:87], v[160:175]
 ds_read_b64_tr_b16 v[212:213], v243 offset:0
 ds_read_b64_tr_b16 v[214:215], v243 offset:1024
 v_accvgpr_write_b32 a102, v250
 v_lshlrev_b32 v250, 16, v103
 v_and_b32 v251, 0xffff0000, v103
 v_add_f32 v250, v254, v250
 v_add_f32 v251, v254, v251
 v_cvt_pk_bf16_f32 v250, v250, v251
 v_accvgpr_write_b32 a103, v250
 v_lshlrev_b32 v250, 16, v104
 v_and_b32 v251, 0xffff0000, v104
 v_add_f32 v250, v254, v250
 v_add_f32 v251, v254, v251
 v_cvt_pk_bf16_f32 v250, v250, v251
 v_accvgpr_write_b32 a104, v250
 v_lshlrev_b32 v250, 16, v105
 s_waitcnt lgkmcnt(4)
 v_mfma_f32_32x32x16_bf16 v[144:159], v[224:227], a[88:91], v[144:159]
 ds_read_b64_tr_b16 v[216:217], v242 offset:2048
 ds_read_b64_tr_b16 v[218:219], v242 offset:3072
 buffer_load_dwordx4 v[136:139], v252, s[8:11], s52 offen offset:2048 sc1
 v_and_b32 v251, 0xffff0000, v105
 v_add_f32 v250, v254, v250
 v_add_f32 v251, v254, v251
 v_cvt_pk_bf16_f32 v250, v250, v251
 v_accvgpr_write_b32 a105, v250
 v_lshlrev_b32 v250, 16, v106
 v_and_b32 v251, 0xffff0000, v106
 v_add_f32 v250, v254, v250
 v_add_f32 v251, v254, v251
 v_cvt_pk_bf16_f32 v250, v250, v251
 v_accvgpr_write_b32 a106, v250
 v_lshlrev_b32 v250, 16, v107
 v_and_b32 v251, 0xffff0000, v107
 v_add_f32 v250, v254, v250
 v_mfma_f32_32x32x16_bf16 v[160:175], v[228:231], a[88:91], v[160:175]
 ds_read_b64_tr_b16 v[220:221], v243 offset:2048
 ds_read_b64_tr_b16 v[222:223], v243 offset:3072
 v_add_f32 v251, v254, v251
 v_cvt_pk_bf16_f32 v250, v250, v251
 v_accvgpr_write_b32 a107, v250
 v_lshlrev_b32 v250, 16, v108
 v_and_b32 v251, 0xffff0000, v108
 v_add_f32 v250, v254, v250
 v_add_f32 v251, v254, v251
 v_cvt_pk_bf16_f32 v250, v250, v251
 v_accvgpr_write_b32 a108, v250
 v_lshlrev_b32 v250, 16, v109
 v_and_b32 v251, 0xffff0000, v109
 v_add_f32 v250, v254, v250
 v_add_f32 v251, v254, v251
 v_cvt_pk_bf16_f32 v250, v250, v251
 v_mfma_f32_32x32x16_bf16 v[144:159], v[232:235], a[92:95], v[144:159]
 ds_read_b64_tr_b16 v[224:225], v242 offset:4096
 ds_read_b64_tr_b16 v[226:227], v242 offset:5120
 buffer_load_dwordx4 v[140:143], v252, s[8:11], s52 offen offset:3072 sc1
 v_accvgpr_write_b32 a109, v250
 v_lshlrev_b32 v250, 16, v110
 v_and_b32 v251, 0xffff0000, v110
 v_add_f32 v250, v254, v250
 v_add_f32 v251, v254, v251
 v_cvt_pk_bf16_f32 v250, v250, v251
 v_accvgpr_write_b32 a110, v250
 v_lshlrev_b32 v250, 16, v111
 v_and_b32 v251, 0xffff0000, v111
 v_add_f32 v250, v254, v250
 v_add_f32 v251, v254, v251
 v_cvt_pk_bf16_f32 v250, v250, v251
 v_accvgpr_write_b32 a111, v250
 v_mfma_f32_32x32x16_bf16 v[160:175], v[236:239], a[92:95], v[160:175]
 ds_read_b64_tr_b16 v[228:229], v243 offset:4096
 ds_read_b64_tr_b16 v[230:231], v243 offset:5120
 s_waitcnt lgkmcnt(4)
 v_mfma_f32_32x32x16_bf16 v[144:159], v[208:211], a[96:99], v[144:159]
 ds_read_b64_tr_b16 v[232:233], v242 offset:6144
 ds_read_b64_tr_b16 v[234:235], v242 offset:7168
 s_waitcnt vmcnt(4)
 v_lshlrev_b32 v250, 16, v112
 v_and_b32 v251, 0xffff0000, v112
 v_add_f32 v250, v254, v250
 v_add_f32 v251, v254, v251
 v_cvt_pk_bf16_f32 v250, v250, v251
 v_accvgpr_write_b32 a112, v250
 v_lshlrev_b32 v250, 16, v113
 v_and_b32 v251, 0xffff0000, v113
 v_add_f32 v250, v254, v250
 v_add_f32 v251, v254, v251
 v_cvt_pk_bf16_f32 v250, v250, v251
 v_accvgpr_write_b32 a113, v250
 v_lshlrev_b32 v250, 16, v114
 v_mfma_f32_32x32x16_bf16 v[160:175], v[212:215], a[96:99], v[160:175]
 ds_read_b64_tr_b16 v[236:237], v243 offset:6144
 ds_read_b64_tr_b16 v[238:239], v243 offset:7168
 v_and_b32 v251, 0xffff0000, v114
 v_add_f32 v250, v254, v250
 v_add_f32 v251, v254, v251
 v_cvt_pk_bf16_f32 v250, v250, v251
 v_accvgpr_write_b32 a114, v250
 v_lshlrev_b32 v250, 16, v115
 v_and_b32 v251, 0xffff0000, v115
 v_add_f32 v250, v254, v250
 v_add_f32 v251, v254, v251
 v_cvt_pk_bf16_f32 v250, v250, v251
 v_accvgpr_write_b32 a115, v250
 v_lshlrev_b32 v250, 16, v116
 v_and_b32 v251, 0xffff0000, v116
 v_add_f32 v250, v254, v250
 v_mfma_f32_32x32x16_bf16 v[144:159], v[216:219], a[100:103], v[144:159]
 ds_read_b64_tr_b16 v[208:209], v242 offset:8192
 ds_read_b64_tr_b16 v[210:211], v242 offset:9216
 v_add_f32 v251, v254, v251
 v_cvt_pk_bf16_f32 v250, v250, v251
 v_accvgpr_write_b32 a116, v250
 v_lshlrev_b32 v250, 16, v117
 v_and_b32 v251, 0xffff0000, v117
 v_add_f32 v250, v254, v250
 v_add_f32 v251, v254, v251
 v_cvt_pk_bf16_f32 v250, v250, v251
 v_accvgpr_write_b32 a117, v250
 v_lshlrev_b32 v250, 16, v118
 v_and_b32 v251, 0xffff0000, v118
 v_add_f32 v250, v254, v250
 v_add_f32 v251, v254, v251
 v_cvt_pk_bf16_f32 v250, v250, v251
 v_mfma_f32_32x32x16_bf16 v[160:175], v[220:223], a[100:103], v[160:175]
 ds_read_b64_tr_b16 v[212:213], v243 offset:8192
 ds_read_b64_tr_b16 v[214:215], v243 offset:9216
 v_accvgpr_write_b32 a118, v250
 v_lshlrev_b32 v250, 16, v119
 v_and_b32 v251, 0xffff0000, v119
 v_add_f32 v250, v254, v250
 v_add_f32 v251, v254, v251
 v_cvt_pk_bf16_f32 v250, v250, v251
 v_accvgpr_write_b32 a119, v250
 v_lshlrev_b32 v250, 16, v120
 v_and_b32 v251, 0xffff0000, v120
 v_add_f32 v250, v254, v250
 v_add_f32 v251, v254, v251
 v_cvt_pk_bf16_f32 v250, v250, v251
 v_accvgpr_write_b32 a120, v250
 v_lshlrev_b32 v250, 16, v121
 s_waitcnt lgkmcnt(4)
 v_mfma_f32_32x32x16_bf16 v[144:159], v[224:227], a[104:107], v[144:159]
 ds_read_b64_tr_b16 v[216:217], v242 offset:10240
 ds_read_b64_tr_b16 v[218:219], v242 offset:11264
 v_and_b32 v251, 0xffff0000, v121
 v_add_f32 v250, v254, v250
 v_add_f32 v251, v254, v251
 v_cvt_pk_bf16_f32 v250, v250, v251
 v_accvgpr_write_b32 a121, v250
 v_lshlrev_b32 v250, 16, v122
 v_and_b32 v251, 0xffff0000, v122
 v_add_f32 v250, v254, v250
 v_add_f32 v251, v254, v251
 v_cvt_pk_bf16_f32 v250, v250, v251
 v_accvgpr_write_b32 a122, v250
 v_lshlrev_b32 v250, 16, v123
 v_and_b32 v251, 0xffff0000, v123
 v_add_f32 v250, v254, v250
 v_mfma_f32_32x32x16_bf16 v[160:175], v[228:231], a[104:107], v[160:175]
 ds_read_b64_tr_b16 v[220:221], v243 offset:10240
 ds_read_b64_tr_b16 v[222:223], v243 offset:11264
 v_add_f32 v251, v254, v251
 v_cvt_pk_bf16_f32 v250, v250, v251
 v_accvgpr_write_b32 a123, v250
 v_lshlrev_b32 v250, 16, v124
 v_and_b32 v251, 0xffff0000, v124
 v_add_f32 v250, v254, v250
 v_add_f32 v251, v254, v251
 v_cvt_pk_bf16_f32 v250, v250, v251
 v_accvgpr_write_b32 a124, v250
 v_lshlrev_b32 v250, 16, v125
 v_and_b32 v251, 0xffff0000, v125
 v_add_f32 v250, v254, v250
 v_add_f32 v251, v254, v251
 v_cvt_pk_bf16_f32 v250, v250, v251
 v_mfma_f32_32x32x16_bf16 v[144:159], v[232:235], a[108:111], v[144:159]
 ds_read_b64_tr_b16 v[224:225], v242 offset:12288
 ds_read_b64_tr_b16 v[226:227], v242 offset:13312
 v_accvgpr_write_b32 a125, v250
 v_lshlrev_b32 v250, 16, v126
 v_and_b32 v251, 0xffff0000, v126
 v_add_f32 v250, v254, v250
 v_add_f32 v251, v254, v251
 v_cvt_pk_bf16_f32 v250, v250, v251
 v_accvgpr_write_b32 a126, v250
 v_lshlrev_b32 v250, 16, v127
 v_and_b32 v251, 0xffff0000, v127
 v_add_f32 v250, v254, v250
 v_add_f32 v251, v254, v251
 v_cvt_pk_bf16_f32 v250, v250, v251
 v_accvgpr_write_b32 a127, v250
 v_mfma_f32_32x32x16_bf16 v[160:175], v[236:239], a[108:111], v[160:175]
 ds_read_b64_tr_b16 v[228:229], v243 offset:12288
 ds_read_b64_tr_b16 v[230:231], v243 offset:13312
 s_waitcnt lgkmcnt(4)
 v_mfma_f32_32x32x16_bf16 v[144:159], v[208:211], a[112:115], v[144:159]
 ds_read_b64_tr_b16 v[232:233], v242 offset:14336
 ds_read_b64_tr_b16 v[234:235], v242 offset:15360
 s_waitcnt vmcnt(0)
 v_lshlrev_b32 v250, 16, v128
 v_and_b32 v251, 0xffff0000, v128
 v_add_f32 v250, v254, v250
 v_add_f32 v251, v254, v251
 v_cvt_pk_bf16_f32 v250, v250, v251
 v_accvgpr_write_b32 a128, v250
 v_lshlrev_b32 v250, 16, v129
 v_and_b32 v251, 0xffff0000, v129
 v_add_f32 v250, v254, v250
 v_add_f32 v251, v254, v251
 v_cvt_pk_bf16_f32 v250, v250, v251
 v_accvgpr_write_b32 a129, v250
 v_lshlrev_b32 v250, 16, v130
 v_mfma_f32_32x32x16_bf16 v[160:175], v[212:215], a[112:115], v[160:175]
 ds_read_b64_tr_b16 v[236:237], v243 offset:14336
 ds_read_b64_tr_b16 v[238:239], v243 offset:15360
 v_and_b32 v251, 0xffff0000, v130
 v_add_f32 v250, v254, v250
 v_add_f32 v251, v254, v251
 v_cvt_pk_bf16_f32 v250, v250, v251
 v_accvgpr_write_b32 a130, v250
 v_lshlrev_b32 v250, 16, v131
 v_and_b32 v251, 0xffff0000, v131
 v_add_f32 v250, v254, v250
 v_add_f32 v251, v254, v251
 v_cvt_pk_bf16_f32 v250, v250, v251
 v_accvgpr_write_b32 a131, v250
 v_lshlrev_b32 v250, 16, v132
 v_and_b32 v251, 0xffff0000, v132
 v_add_f32 v250, v254, v250
 v_mfma_f32_32x32x16_bf16 v[144:159], v[216:219], a[116:119], v[144:159]
 ds_read_b64_tr_b16 v[208:209], v242 offset:16384
 ds_read_b64_tr_b16 v[210:211], v242 offset:17408
 v_add_f32 v251, v254, v251
 v_cvt_pk_bf16_f32 v250, v250, v251
 v_accvgpr_write_b32 a132, v250
 v_lshlrev_b32 v250, 16, v133
 v_and_b32 v251, 0xffff0000, v133
 v_add_f32 v250, v254, v250
 v_add_f32 v251, v254, v251
 v_cvt_pk_bf16_f32 v250, v250, v251
 v_accvgpr_write_b32 a133, v250
 v_lshlrev_b32 v250, 16, v134
 v_and_b32 v251, 0xffff0000, v134
 v_add_f32 v250, v254, v250
 v_add_f32 v251, v254, v251
 v_cvt_pk_bf16_f32 v250, v250, v251
 v_mfma_f32_32x32x16_bf16 v[160:175], v[220:223], a[116:119], v[160:175]
 ds_read_b64_tr_b16 v[212:213], v243 offset:16384
 ds_read_b64_tr_b16 v[214:215], v243 offset:17408
 v_accvgpr_write_b32 a134, v250
 v_lshlrev_b32 v250, 16, v135
 v_and_b32 v251, 0xffff0000, v135
 v_add_f32 v250, v254, v250
 v_add_f32 v251, v254, v251
 v_cvt_pk_bf16_f32 v250, v250, v251
 v_accvgpr_write_b32 a135, v250
 v_lshlrev_b32 v250, 16, v136
 v_and_b32 v251, 0xffff0000, v136
 v_add_f32 v250, v254, v250
 v_add_f32 v251, v254, v251
 v_cvt_pk_bf16_f32 v250, v250, v251
 v_accvgpr_write_b32 a136, v250
 v_lshlrev_b32 v250, 16, v137
 s_waitcnt lgkmcnt(4)
 v_mfma_f32_32x32x16_bf16 v[144:159], v[224:227], a[120:123], v[144:159]
 ds_read_b64_tr_b16 v[216:217], v242 offset:18432
 ds_read_b64_tr_b16 v[218:219], v242 offset:19456
 v_and_b32 v251, 0xffff0000, v137
 v_add_f32 v250, v254, v250
 v_add_f32 v251, v254, v251
 v_cvt_pk_bf16_f32 v250, v250, v251
 v_accvgpr_write_b32 a137, v250
 v_lshlrev_b32 v250, 16, v138
 v_and_b32 v251, 0xffff0000, v138
 v_add_f32 v250, v254, v250
 v_add_f32 v251, v254, v251
 v_cvt_pk_bf16_f32 v250, v250, v251
 v_accvgpr_write_b32 a138, v250
 v_lshlrev_b32 v250, 16, v139
 v_and_b32 v251, 0xffff0000, v139
 v_add_f32 v250, v254, v250
 s_mul_i32 s27, s24, 663552
 v_mfma_f32_32x32x16_bf16 v[160:175], v[228:231], a[120:123], v[160:175]
 ds_read_b64_tr_b16 v[220:221], v243 offset:18432
 ds_read_b64_tr_b16 v[222:223], v243 offset:19456
 v_add_f32 v251, v254, v251
 v_cvt_pk_bf16_f32 v250, v250, v251
 v_accvgpr_write_b32 a139, v250
 v_lshlrev_b32 v250, 16, v140
 v_and_b32 v251, 0xffff0000, v140
 v_add_f32 v250, v254, v250
 v_add_f32 v251, v254, v251
 v_cvt_pk_bf16_f32 v250, v250, v251
 v_accvgpr_write_b32 a140, v250
 v_lshlrev_b32 v250, 16, v141
 v_and_b32 v251, 0xffff0000, v141
 v_add_f32 v250, v254, v250
 v_add_f32 v251, v254, v251
 v_cvt_pk_bf16_f32 v250, v250, v251
 s_add_u32 s4, s26, 0
 s_cmp_ge_u32 s4, 9
 s_cselect_b32 s5, 9, 0
 s_sub_u32 s4, s4, s5
 s_mul_i32 s4, s4, 73728
 s_add_u32 s40, s4, s27
 v_mfma_f32_32x32x16_bf16 v[144:159], v[232:235], a[124:127], v[144:159]
 ds_read_b64_tr_b16 v[224:225], v242 offset:20480
 ds_read_b64_tr_b16 v[226:227], v242 offset:21504
 v_accvgpr_write_b32 a141, v250
 v_lshlrev_b32 v250, 16, v142
 v_and_b32 v251, 0xffff0000, v142
 v_add_f32 v250, v254, v250
 v_add_f32 v251, v254, v251
 v_cvt_pk_bf16_f32 v250, v250, v251
 v_accvgpr_write_b32 a142, v250
 v_lshlrev_b32 v250, 16, v143
 v_and_b32 v251, 0xffff0000, v143
 v_add_f32 v250, v254, v250
 v_add_f32 v251, v254, v251
 v_cvt_pk_bf16_f32 v250, v250, v251
 v_accvgpr_write_b32 a143, v250
 s_add_u32 s4, s26, 1
 s_cmp_ge_u32 s4, 9
 s_cselect_b32 s5, 9, 0
 s_sub_u32 s4, s4, s5
 s_mul_i32 s4, s4, 73728
 s_add_u32 s41, s4, s27
 v_mfma_f32_32x32x16_bf16 v[160:175], v[236:239], a[124:127], v[160:175]
 ds_read_b64_tr_b16 v[228:229], v243 offset:20480
 ds_read_b64_tr_b16 v[230:231], v243 offset:21504
 s_add_u32 s4, s26, 2
 s_cmp_ge_u32 s4, 9
 s_cselect_b32 s5, 9, 0
 s_sub_u32 s4, s4, s5
 s_mul_i32 s4, s4, 73728
 s_add_u32 s42, s4, s27
 s_waitcnt lgkmcnt(4)
 v_mfma_f32_32x32x16_bf16 v[144:159], v[208:211], a[128:131], v[144:159]
 ds_read_b64_tr_b16 v[232:233], v242 offset:22528
 ds_read_b64_tr_b16 v[234:235], v242 offset:23552
 s_add_u32 s4, s26, 3
 s_cmp_ge_u32 s4, 9
 s_cselect_b32 s5, 9, 0
 s_sub_u32 s4, s4, s5
 s_mul_i32 s4, s4, 73728
 s_add_u32 s43, s4, s27
 v_mfma_f32_32x32x16_bf16 v[160:175], v[212:215], a[128:131], v[160:175]
 ds_read_b64_tr_b16 v[236:237], v243 offset:22528
 ds_read_b64_tr_b16 v[238:239], v243 offset:23552
 s_waitcnt vmcnt(42)
 s_barrier
 v_mfma_f32_32x32x16_bf16 v[144:159], v[216:219], a[132:135], v[144:159]
 ds_read_b64_tr_b16 v[208:209], v242 offset:24576
 ds_read_b64_tr_b16 v[210:211], v242 offset:25600
 s_add_u32 m0, s30, 114688
 s_add_u32 s36, s32, 2949120
 buffer_load_dwordx4 v246, s[12:15], s36 offen lds
 s_add_u32 s4, s26, 4
 s_cmp_ge_u32 s4, 9
 s_cselect_b32 s5, 9, 0
 s_sub_u32 s4, s4, s5
 s_mul_i32 s4, s4, 73728
 s_add_u32 s44, s4, s27
 v_mfma_f32_32x32x16_bf16 v[160:175], v[220:223], a[132:135], v[160:175]
 ds_read_b64_tr_b16 v[212:213], v243 offset:24576
 ds_read_b64_tr_b16 v[214:215], v243 offset:25600
 s_add_u32 s4, s26, 5
 s_cmp_ge_u32 s4, 9
 s_cselect_b32 s5, 9, 0
 s_sub_u32 s4, s4, s5
 s_mul_i32 s4, s4, 73728
 s_add_u32 s45, s4, s27
 s_waitcnt lgkmcnt(4)
 v_mfma_f32_32x32x16_bf16 v[144:159], v[224:227], a[136:139], v[144:159]
 ds_read_b64_tr_b16 v[216:217], v242 offset:26624
 ds_read_b64_tr_b16 v[218:219], v242 offset:27648
 s_add_u32 s4, s26, 6
 s_cmp_ge_u32 s4, 9
 s_cselect_b32 s5, 9, 0
 s_sub_u32 s4, s4, s5
 s_mul_i32 s4, s4, 73728
 s_add_u32 s46, s4, s27
 v_mfma_f32_32x32x16_bf16 v[160:175], v[228:231], a[136:139], v[160:175]
 ds_read_b64_tr_b16 v[220:221], v243 offset:26624
 ds_read_b64_tr_b16 v[222:223], v243 offset:27648
 buffer_load_dwordx4 v247, s[12:15], s36 offen offset:1024 lds
 s_add_u32 s4, s26, 7
 s_cmp_ge_u32 s4, 9
 s_cselect_b32 s5, 9, 0
 s_sub_u32 s4, s4, s5
 s_mul_i32 s4, s4, 73728
 s_add_u32 s47, s4, s27
 v_mfma_f32_32x32x16_bf16 v[144:159], v[232:235], a[140:143], v[144:159]
 ds_read_b64_tr_b16 v[224:225], v242 offset:28672
 ds_read_b64_tr_b16 v[226:227], v242 offset:29696
 s_add_u32 s4, s26, 8
 s_cmp_ge_u32 s4, 9
 s_cselect_b32 s5, 9, 0
 s_sub_u32 s4, s4, s5
 s_mul_i32 s4, s4, 73728
 s_add_u32 s48, s4, s27
 v_mfma_f32_32x32x16_bf16 v[160:175], v[236:239], a[140:143], v[160:175]
 ds_read_b64_tr_b16 v[228:229], v243 offset:28672
 ds_read_b64_tr_b16 v[230:231], v243 offset:29696
 s_mul_i32 s4, s24, 2359296
 s_add_u32 s4, s4, s51
 s_add_u32 s4, s4, 19165696
 s_add_u32 s50, s4, 36864
 s_lshl_b32 s5, s26, 12
 s_add_u32 s35, s4, s5
 s_mov_b32 s37, 4
 s_waitcnt lgkmcnt(4)
 v_mfma_f32_32x32x16_bf16 v[176:191], v[208:211], a[0:3], 0
 ds_read_b64_tr_b16 v[232:233], v242 offset:30720
 ds_read_b64_tr_b16 v[234:235], v242 offset:31744
 s_add_u32 m0, s30, 122880
 s_add_u32 s36, s32, 3538944
 buffer_load_dwordx4 v246, s[12:15], s36 offen lds
 v_mfma_f32_32x32x16_bf16 v[192:207], v[212:215], a[0:3], 0
 ds_read_b64_tr_b16 v[236:237], v243 offset:30720
 ds_read_b64_tr_b16 v[238:239], v243 offset:31744
 v_mfma_f32_32x32x16_bf16 v[176:191], v[216:219], a[4:7], v[176:191]
 ds_read_b64_tr_b16 v[208:209], v242 offset:32768
 ds_read_b64_tr_b16 v[210:211], v242 offset:33792
 v_mfma_f32_32x32x16_bf16 v[192:207], v[220:223], a[4:7], v[192:207]
 ds_read_b64_tr_b16 v[212:213], v243 offset:32768
 ds_read_b64_tr_b16 v[214:215], v243 offset:33792
 buffer_load_dwordx4 v247, s[12:15], s36 offen offset:1024 lds
 s_waitcnt lgkmcnt(4)
 v_mfma_f32_32x32x16_bf16 v[176:191], v[224:227], a[8:11], v[176:191]
 ds_read_b64_tr_b16 v[216:217], v242 offset:34816
 ds_read_b64_tr_b16 v[218:219], v242 offset:35840
 v_mul_f32 v250, v144, v144
 v_mul_f32 v251, v145, v145
 v_fma_f32 v250, v250, v248, v249
 v_fma_f32 v251, v251, v248, v249
 v_mfma_f32_32x32x16_bf16 v[192:207], v[228:231], a[8:11], v[192:207]
 ds_read_b64_tr_b16 v[220:221], v243 offset:34816
 ds_read_b64_tr_b16 v[222:223], v243 offset:35840
 v_mul_f32 v250, v250, v144
 v_mul_f32 v251, v251, v145
 v_exp_f32 v250, v250
 v_mfma_f32_32x32x16_bf16 v[176:191], v[232:235], a[12:15], v[176:191]
 ds_read_b64_tr_b16 v[224:225], v242 offset:36864
 ds_read_b64_tr_b16 v[226:227], v242 offset:37888
 s_add_u32 m0, s30, 131072
 s_add_u32 s36, s32, 4128768
 buffer_load_dwordx4 v246, s[12:15], s36 offen lds
 v_exp_f32 v251, v251
 v_add_f32 v250, 1.0, v250
 v_add_f32 v251, 1.0, v251
 v_rcp_f32 v250, v250
 v_mfma_f32_32x32x16_bf16 v[192:207], v[236:239], a[12:15], v[192:207]
 ds_read_b64_tr_b16 v[228:229], v243 offset:36864
 ds_read_b64_tr_b16 v[230:231], v243 offset:37888
 v_rcp_f32 v251, v251
 v_mul_f32 v144, v250, v144
 v_mul_f32 v145, v251, v145
 v_cvt_pk_bf16_f32 v0, v144, v145
 s_waitcnt lgkmcnt(4)
 v_mfma_f32_32x32x16_bf16 v[176:191], v[208:211], a[16:19], v[176:191]
 ds_read_b64_tr_b16 v[232:233], v242 offset:38912
 ds_read_b64_tr_b16 v[234:235], v242 offset:39936
 v_mul_f32 v250, v146, v146
 v_mul_f32 v251, v147, v147
 v_fma_f32 v250, v250, v248, v249
 v_mfma_f32_32x32x16_bf16 v[192:207], v[212:215], a[16:19], v[192:207]
 ds_read_b64_tr_b16 v[236:237], v243 offset:38912
 ds_read_b64_tr_b16 v[238:239], v243 offset:39936
 buffer_load_dwordx4 v247, s[12:15], s36 offen offset:1024 lds
 v_fma_f32 v251, v251, v248, v249
 v_mul_f32 v250, v250, v146
 v_mul_f32 v251, v251, v147
 v_mfma_f32_32x32x16_bf16 v[176:191], v[216:219], a[20:23], v[176:191]
 ds_read_b64_tr_b16 v[208:209], v242 offset:40960
 ds_read_b64_tr_b16 v[210:211], v242 offset:41984
 v_exp_f32 v250, v250
 v_exp_f32 v251, v251
 v_add_f32 v250, 1.0, v250
 v_add_f32 v251, 1.0, v251
 v_rcp_f32 v250, v250
 v_mfma_f32_32x32x16_bf16 v[192:207], v[220:223], a[20:23], v[192:207]
 ds_read_b64_tr_b16 v[212:213], v243 offset:40960
 ds_read_b64_tr_b16 v[214:215], v243 offset:41984
 v_rcp_f32 v251, v251
 v_mul_f32 v146, v250, v146
 v_mul_f32 v147, v251, v147
 v_cvt_pk_bf16_f32 v1, v146, v147
 s_waitcnt lgkmcnt(4)
 v_mfma_f32_32x32x16_bf16 v[176:191], v[224:227], a[24:27], v[176:191]
 ds_read_b64_tr_b16 v[216:217], v242 offset:43008
 ds_read_b64_tr_b16 v[218:219], v242 offset:44032
 s_add_u32 m0, s30, 139264
 s_add_u32 s36, s32, 4718592
 buffer_load_dwordx4 v246, s[12:15], s36 offen lds
 v_mul_f32 v250, v148, v148
 v_mul_f32 v251, v149, v149
 v_fma_f32 v250, v250, v248, v249
 v_mfma_f32_32x32x16_bf16 v[192:207], v[228:231], a[24:27], v[192:207]
 ds_read_b64_tr_b16 v[220:221], v243 offset:43008
 ds_read_b64_tr_b16 v[222:223], v243 offset:44032
 v_fma_f32 v251, v251, v248, v249
 v_mul_f32 v250, v250, v148
 v_mul_f32 v251, v251, v149
 v_mfma_f32_32x32x16_bf16 v[176:191], v[232:235], a[28:31], v[176:191]
 ds_read_b64_tr_b16 v[224:225], v242 offset:45056
 ds_read_b64_tr_b16 v[226:227], v242 offset:46080
 v_exp_f32 v250, v250
 v_exp_f32 v251, v251
 v_add_f32 v250, 1.0, v250
 v_add_f32 v251, 1.0, v251
 v_mfma_f32_32x32x16_bf16 v[192:207], v[236:239], a[28:31], v[192:207]
 ds_read_b64_tr_b16 v[228:229], v243 offset:45056
 ds_read_b64_tr_b16 v[230:231], v243 offset:46080
 buffer_load_dwordx4 v247, s[12:15], s36 offen offset:1024 lds
 v_rcp_f32 v250, v250
 v_rcp_f32 v251, v251
 v_mul_f32 v148, v250, v148
 v_mul_f32 v149, v251, v149
 s_waitcnt lgkmcnt(4)
 v_mfma_f32_32x32x16_bf16 v[176:191], v[208:211], a[32:35], v[176:191]
 ds_read_b64_tr_b16 v[232:233], v242 offset:47104
 ds_read_b64_tr_b16 v[234:235], v242 offset:48128
 v_cvt_pk_bf16_f32 v2, v148, v149
 v_mul_f32 v250, v150, v150
 v_mul_f32 v251, v151, v151
 v_mfma_f32_32x32x16_bf16 v[192:207], v[212:215], a[32:35], v[192:207]
 ds_read_b64_tr_b16 v[236:237], v243 offset:47104
 ds_read_b64_tr_b16 v[238:239], v243 offset:48128
 v_fma_f32 v250, v250, v248, v249
 v_fma_f32 v251, v251, v248, v249
 v_mul_f32 v250, v250, v150
 v_mul_f32 v251, v251, v151
 v_mfma_f32_32x32x16_bf16 v[176:191], v[216:219], a[36:39], v[176:191]
 ds_read_b64_tr_b16 v[208:209], v244 offset:0
 ds_read_b64_tr_b16 v[210:211], v244 offset:1024
 s_add_u32 m0, s30, 0
 s_add_u32 s32, s32, 128
 s_cmp_ge_u32 s32, s39
 s_cselect_b32 s3, 1152, 0
 s_sub_u32 s32, s32, s3
 s_add_u32 s36, s32, 0
 buffer_load_dwordx4 v246, s[12:15], s36 offen lds
 v_exp_f32 v250, v250
 v_exp_f32 v251, v251
 v_add_f32 v250, 1.0, v250
 v_add_f32 v251, 1.0, v251
 v_mfma_f32_32x32x16_bf16 v[192:207], v[220:223], a[36:39], v[192:207]
 ds_read_b64_tr_b16 v[212:213], v245 offset:0
 ds_read_b64_tr_b16 v[214:215], v245 offset:1024
 v_rcp_f32 v250, v250
 v_rcp_f32 v251, v251
 v_mul_f32 v150, v250, v150
 v_mul_f32 v151, v251, v151
 s_waitcnt lgkmcnt(4)
 v_mfma_f32_32x32x16_bf16 v[176:191], v[224:227], a[40:43], v[176:191]
 ds_read_b64_tr_b16 v[216:217], v244 offset:2048
 ds_read_b64_tr_b16 v[218:219], v244 offset:3072
 v_cvt_pk_bf16_f32 v3, v150, v151
 v_mul_f32 v250, v152, v152
 v_mul_f32 v251, v153, v153
 v_mfma_f32_32x32x16_bf16 v[192:207], v[228:231], a[40:43], v[192:207]
 ds_read_b64_tr_b16 v[220:221], v245 offset:2048
 ds_read_b64_tr_b16 v[222:223], v245 offset:3072
 buffer_load_dwordx4 v247, s[12:15], s36 offen offset:1024 lds
 v_fma_f32 v250, v250, v248, v249
 v_fma_f32 v251, v251, v248, v249
 v_mul_f32 v250, v250, v152
 v_mfma_f32_32x32x16_bf16 v[176:191], v[232:235], a[44:47], v[176:191]
 ds_read_b64_tr_b16 v[224:225], v244 offset:4096
 ds_read_b64_tr_b16 v[226:227], v244 offset:5120
 v_mul_f32 v251, v251, v153
 v_exp_f32 v250, v250
 v_exp_f32 v251, v251
 v_add_f32 v250, 1.0, v250
 v_mfma_f32_32x32x16_bf16 v[192:207], v[236:239], a[44:47], v[192:207]
 ds_read_b64_tr_b16 v[228:229], v245 offset:4096
 ds_read_b64_tr_b16 v[230:231], v245 offset:5120
 v_add_f32 v251, 1.0, v251
 v_rcp_f32 v250, v250
 v_rcp_f32 v251, v251
 v_mul_f32 v152, v250, v152
 v_mul_f32 v153, v251, v153
 s_waitcnt lgkmcnt(4)
 v_mfma_f32_32x32x16_bf16 v[176:191], v[208:211], a[48:51], v[176:191]
 ds_read_b64_tr_b16 v[232:233], v244 offset:6144
 ds_read_b64_tr_b16 v[234:235], v244 offset:7168
 s_add_u32 m0, s30, 8192
 s_add_u32 s36, s32, 589824
 buffer_load_dwordx4 v246, s[12:15], s36 offen lds
 v_cvt_pk_bf16_f32 v4, v152, v153
 v_mul_f32 v250, v154, v154
 v_mul_f32 v251, v155, v155
 v_mfma_f32_32x32x16_bf16 v[192:207], v[212:215], a[48:51], v[192:207]
 ds_read_b64_tr_b16 v[236:237], v245 offset:6144
 ds_read_b64_tr_b16 v[238:239], v245 offset:7168
 v_fma_f32 v250, v250, v248, v249
 v_fma_f32 v251, v251, v248, v249
 v_mul_f32 v250, v250, v154
 v_mfma_f32_32x32x16_bf16 v[176:191], v[216:219], a[52:55], v[176:191]
 ds_read_b64_tr_b16 v[208:209], v244 offset:8192
 ds_read_b64_tr_b16 v[210:211], v244 offset:9216
 v_mul_f32 v251, v251, v155
 v_exp_f32 v250, v250
 v_exp_f32 v251, v251
 v_add_f32 v250, 1.0, v250
 v_mfma_f32_32x32x16_bf16 v[192:207], v[220:223], a[52:55], v[192:207]
 ds_read_b64_tr_b16 v[212:213], v245 offset:8192
 ds_read_b64_tr_b16 v[214:215], v245 offset:9216
 buffer_load_dwordx4 v247, s[12:15], s36 offen offset:1024 lds
 v_add_f32 v251, 1.0, v251
 v_rcp_f32 v250, v250
 v_rcp_f32 v251, v251
 v_mul_f32 v154, v250, v154
 s_waitcnt lgkmcnt(4)
 v_mfma_f32_32x32x16_bf16 v[176:191], v[224:227], a[56:59], v[176:191]
 ds_read_b64_tr_b16 v[216:217], v244 offset:10240
 ds_read_b64_tr_b16 v[218:219], v244 offset:11264
 v_mul_f32 v155, v251, v155
 v_cvt_pk_bf16_f32 v5, v154, v155
 v_mul_f32 v250, v156, v156
 v_mfma_f32_32x32x16_bf16 v[192:207], v[228:231], a[56:59], v[192:207]
 ds_read_b64_tr_b16 v[220:221], v245 offset:10240
 ds_read_b64_tr_b16 v[222:223], v245 offset:11264
 s_waitcnt vmcnt(4)
 s_barrier
 v_mfma_f32_32x32x16_bf16 v[176:191], v[232:235], a[60:63], v[176:191]
 ds_read_b64_tr_b16 v[224:225], v244 offset:12288
 ds_read_b64_tr_b16 v[226:227], v244 offset:13312
 s_add_u32 m0, s30, 16384
 s_add_u32 s36, s32, 1179648
 buffer_load_dwordx4 v246, s[12:15], s36 offen lds
 v_mul_f32 v251, v157, v157
 v_fma_f32 v250, v250, v248, v249
 v_fma_f32 v251, v251, v248, v249
 v_mfma_f32_32x32x16_bf16 v[192:207], v[236:239], a[60:63], v[192:207]
 ds_read_b64_tr_b16 v[228:229], v245 offset:12288
 ds_read_b64_tr_b16 v[230:231], v245 offset:13312
 v_mul_f32 v250, v250, v156
 v_mul_f32 v251, v251, v157
 v_exp_f32 v250, v250
 v_exp_f32 v251, v251
 v_add_f32 v250, 1.0, v250
 s_waitcnt lgkmcnt(4)
 v_mfma_f32_32x32x16_bf16 v[176:191], v[208:211], a[64:67], v[176:191]
 ds_read_b64_tr_b16 v[232:233], v244 offset:14336
 ds_read_b64_tr_b16 v[234:235], v244 offset:15360
 v_add_f32 v251, 1.0, v251
 v_rcp_f32 v250, v250
 v_rcp_f32 v251, v251
 v_mul_f32 v156, v250, v156
 v_mfma_f32_32x32x16_bf16 v[192:207], v[212:215], a[64:67], v[192:207]
 ds_read_b64_tr_b16 v[236:237], v245 offset:14336
 ds_read_b64_tr_b16 v[238:239], v245 offset:15360
 buffer_load_dwordx4 v247, s[12:15], s36 offen offset:1024 lds
 v_mul_f32 v157, v251, v157
 v_cvt_pk_bf16_f32 v6, v156, v157
 v_mul_f32 v250, v158, v158
 v_mfma_f32_32x32x16_bf16 v[176:191], v[216:219], a[68:71], v[176:191]
 ds_read_b64_tr_b16 v[208:209], v244 offset:16384
 ds_read_b64_tr_b16 v[210:211], v244 offset:17408
 v_mul_f32 v251, v159, v159
 v_fma_f32 v250, v250, v248, v249
 v_fma_f32 v251, v251, v248, v249
 v_mfma_f32_32x32x16_bf16 v[192:207], v[220:223], a[68:71], v[192:207]
 ds_read_b64_tr_b16 v[212:213], v245 offset:16384
 ds_read_b64_tr_b16 v[214:215], v245 offset:17408
 v_mul_f32 v250, v250, v158
 v_mul_f32 v251, v251, v159
 v_exp_f32 v250, v250
 s_waitcnt lgkmcnt(4)
 v_mfma_f32_32x32x16_bf16 v[176:191], v[224:227], a[72:75], v[176:191]
 ds_read_b64_tr_b16 v[216:217], v244 offset:18432
 ds_read_b64_tr_b16 v[218:219], v244 offset:19456
 s_add_u32 m0, s30, 24576
 s_add_u32 s36, s32, 1769472
 buffer_load_dwordx4 v246, s[12:15], s36 offen lds
 v_exp_f32 v251, v251
 v_add_f32 v250, 1.0, v250
 v_add_f32 v251, 1.0, v251
 v_rcp_f32 v250, v250
 v_mfma_f32_32x32x16_bf16 v[192:207], v[228:231], a[72:75], v[192:207]
 ds_read_b64_tr_b16 v[220:221], v245 offset:18432
 ds_read_b64_tr_b16 v[222:223], v245 offset:19456
 v_rcp_f32 v251, v251
 v_mul_f32 v158, v250, v158
 v_mul_f32 v159, v251, v159
 v_cvt_pk_bf16_f32 v7, v158, v159
 v_mfma_f32_32x32x16_bf16 v[176:191], v[232:235], a[76:79], v[176:191]
 ds_read_b64_tr_b16 v[224:225], v244 offset:20480
 ds_read_b64_tr_b16 v[226:227], v244 offset:21504
 v_mul_f32 v250, v160, v160
 v_mul_f32 v251, v161, v161
 v_fma_f32 v250, v250, v248, v249
 v_fma_f32 v251, v251, v248, v249
 v_mfma_f32_32x32x16_bf16 v[192:207], v[236:239], a[76:79], v[192:207]
 ds_read_b64_tr_b16 v[228:229], v245 offset:20480
 ds_read_b64_tr_b16 v[230:231], v245 offset:21504
 buffer_load_dwordx4 v247, s[12:15], s36 offen offset:1024 lds
 v_mul_f32 v250, v250, v160
 v_mul_f32 v251, v251, v161
 v_exp_f32 v250, v250
 s_waitcnt lgkmcnt(4)
 v_mfma_f32_32x32x16_bf16 v[176:191], v[208:211], a[80:83], v[176:191]
 ds_read_b64_tr_b16 v[232:233], v244 offset:22528
 ds_read_b64_tr_b16 v[234:235], v244 offset:23552
 v_exp_f32 v251, v251
 v_add_f32 v250, 1.0, v250
 v_add_f32 v251, 1.0, v251
 v_rcp_f32 v250, v250
 v_mfma_f32_32x32x16_bf16 v[192:207], v[212:215], a[80:83], v[192:207]
 ds_read_b64_tr_b16 v[236:237], v245 offset:22528
 ds_read_b64_tr_b16 v[238:239], v245 offset:23552
 v_rcp_f32 v251, v251
 v_mul_f32 v160, v250, v160
 v_mul_f32 v161, v251, v161
 v_cvt_pk_bf16_f32 v8, v160, v161
 v_mfma_f32_32x32x16_bf16 v[176:191], v[216:219], a[84:87], v[176:191]
 ds_read_b64_tr_b16 v[208:209], v244 offset:24576
 ds_read_b64_tr_b16 v[210:211], v244 offset:25600
 s_add_u32 m0, s30, 32768
 s_add_u32 s36, s32, 2359296
 buffer_load_dwordx4 v246, s[12:15], s36 offen lds
 v_mul_f32 v250, v162, v162
 v_mul_f32 v251, v163, v163
 v_fma_f32 v250, v250, v248, v249
 v_mfma_f32_32x32x16_bf16 v[192:207], v[220:223], a[84:87], v[192:207]
 ds_read_b64_tr_b16 v[212:213], v245 offset:24576
 ds_read_b64_tr_b16 v[214:215], v245 offset:25600
 v_fma_f32 v251, v251, v248, v249
 v_mul_f32 v250, v250, v162
 v_mul_f32 v251, v251, v163
 s_waitcnt lgkmcnt(4)
 v_mfma_f32_32x32x16_bf16 v[176:191], v[224:227], a[88:91], v[176:191]
 ds_read_b64_tr_b16 v[216:217], v244 offset:26624
 ds_read_b64_tr_b16 v[218:219], v244 offset:27648
 v_exp_f32 v250, v250
 v_exp_f32 v251, v251
 v_add_f32 v250, 1.0, v250
 v_add_f32 v251, 1.0, v251
 v_rcp_f32 v250, v250
 v_mfma_f32_32x32x16_bf16 v[192:207], v[228:231], a[88:91], v[192:207]
 ds_read_b64_tr_b16 v[220:221], v245 offset:26624
 ds_read_b64_tr_b16 v[222:223], v245 offset:27648
 buffer_load_dwordx4 v247, s[12:15], s36 offen offset:1024 lds
 v_rcp_f32 v251, v251
 v_mul_f32 v162, v250, v162
 v_mul_f32 v163, v251, v163
 v_cvt_pk_bf16_f32 v9, v162, v163
 v_mfma_f32_32x32x16_bf16 v[176:191], v[232:235], a[92:95], v[176:191]
 ds_read_b64_tr_b16 v[224:225], v244 offset:28672
 ds_read_b64_tr_b16 v[226:227], v244 offset:29696
 v_mul_f32 v250, v164, v164
 v_mul_f32 v251, v165, v165
 v_fma_f32 v250, v250, v248, v249
 v_mfma_f32_32x32x16_bf16 v[192:207], v[236:239], a[92:95], v[192:207]
 ds_read_b64_tr_b16 v[228:229], v245 offset:28672
 ds_read_b64_tr_b16 v[230:231], v245 offset:29696
 v_fma_f32 v251, v251, v248, v249
 v_mul_f32 v250, v250, v164
 v_mul_f32 v251, v251, v165
 s_waitcnt lgkmcnt(4)
 v_mfma_f32_32x32x16_bf16 v[176:191], v[208:211], a[96:99], v[176:191]
 ds_read_b64_tr_b16 v[232:233], v244 offset:30720
 ds_read_b64_tr_b16 v[234:235], v244 offset:31744
 s_add_u32 m0, s30, 40960
 s_add_u32 s36, s32, 2949120
 buffer_load_dwordx4 v246, s[12:15], s36 offen lds
 v_exp_f32 v250, v250
 v_exp_f32 v251, v251
 v_add_f32 v250, 1.0, v250
 v_add_f32 v251, 1.0, v251
 v_mfma_f32_32x32x16_bf16 v[192:207], v[212:215], a[96:99], v[192:207]
 ds_read_b64_tr_b16 v[236:237], v245 offset:30720
 ds_read_b64_tr_b16 v[238:239], v245 offset:31744
 v_rcp_f32 v250, v250
 v_rcp_f32 v251, v251
 v_mul_f32 v164, v250, v164
 v_mul_f32 v165, v251, v165
 v_mfma_f32_32x32x16_bf16 v[176:191], v[216:219], a[100:103], v[176:191]
 ds_read_b64_tr_b16 v[208:209], v244 offset:32768
 ds_read_b64_tr_b16 v[210:211], v244 offset:33792
 v_cvt_pk_bf16_f32 v10, v164, v165
 v_mul_f32 v250, v166, v166
 v_mul_f32 v251, v167, v167
 v_mfma_f32_32x32x16_bf16 v[192:207], v[220:223], a[100:103], v[192:207]
 ds_read_b64_tr_b16 v[212:213], v245 offset:32768
 ds_read_b64_tr_b16 v[214:215], v245 offset:33792
 buffer_load_dwordx4 v247, s[12:15], s36 offen offset:1024 lds
 v_fma_f32 v250, v250, v248, v249
 v_fma_f32 v251, v251, v248, v249
 v_mul_f32 v250, v250, v166
 v_mul_f32 v251, v251, v167
 s_waitcnt lgkmcnt(4)
 v_mfma_f32_32x32x16_bf16 v[176:191], v[224:227], a[104:107], v[176:191]
 ds_read_b64_tr_b16 v[216:217], v244 offset:34816
 ds_read_b64_tr_b16 v[218:219], v244 offset:35840
 v_exp_f32 v250, v250
 v_exp_f32 v251, v251
 v_add_f32 v250, 1.0, v250
 v_add_f32 v251, 1.0, v251
 v_mfma_f32_32x32x16_bf16 v[192:207], v[228:231], a[104:107], v[192:207]
 ds_read_b64_tr_b16 v[220:221], v245 offset:34816
 ds_read_b64_tr_b16 v[222:223], v245 offset:35840
 v_rcp_f32 v250, v250
 v_rcp_f32 v251, v251
 v_mul_f32 v166, v250, v166
 v_mul_f32 v167, v251, v167
 v_mfma_f32_32x32x16_bf16 v[176:191], v[232:235], a[108:111], v[176:191]
 ds_read_b64_tr_b16 v[224:225], v244 offset:36864
 ds_read_b64_tr_b16 v[226:227], v244 offset:37888
 s_add_u32 m0, s30, 49152
 s_add_u32 s36, s32, 3538944
 buffer_load_dwordx4 v246, s[12:15], s36 offen lds
 v_cvt_pk_bf16_f32 v11, v166, v167
 v_mul_f32 v250, v168, v168
 v_mul_f32 v251, v169, v169
 v_mfma_f32_32x32x16_bf16 v[192:207], v[236:239], a[108:111], v[192:207]
 ds_read_b64_tr_b16 v[228:229], v245 offset:36864
 ds_read_b64_tr_b16 v[230:231], v245 offset:37888
 v_fma_f32 v250, v250, v248, v249
 v_fma_f32 v251, v251, v248, v249
 v_mul_f32 v250, v250, v168
 s_waitcnt lgkmcnt(4)
 v_mfma_f32_32x32x16_bf16 v[176:191], v[208:211], a[112:115], v[176:191]
 ds_read_b64_tr_b16 v[232:233], v244 offset:38912
 ds_read_b64_tr_b16 v[234:235], v244 offset:39936
 v_mul_f32 v251, v251, v169
 v_exp_f32 v250, v250
 v_exp_f32 v251, v251
 v_add_f32 v250, 1.0, v250
 v_mfma_f32_32x32x16_bf16 v[192:207], v[212:215], a[112:115], v[192:207]
 ds_read_b64_tr_b16 v[236:237], v245 offset:38912
 ds_read_b64_tr_b16 v[238:239], v245 offset:39936
 buffer_load_dwordx4 v247, s[12:15], s36 offen offset:1024 lds
 v_add_f32 v251, 1.0, v251
 v_rcp_f32 v250, v250
 v_rcp_f32 v251, v251
 v_mul_f32 v168, v250, v168
 v_mul_f32 v169, v251, v169
 v_mfma_f32_32x32x16_bf16 v[176:191], v[216:219], a[116:119], v[176:191]
 ds_read_b64_tr_b16 v[208:209], v244 offset:40960
 ds_read_b64_tr_b16 v[210:211], v244 offset:41984
 v_cvt_pk_bf16_f32 v12, v168, v169
 v_mul_f32 v250, v170, v170
 v_mul_f32 v251, v171, v171
 v_mfma_f32_32x32x16_bf16 v[192:207], v[220:223], a[116:119], v[192:207]
 ds_read_b64_tr_b16 v[212:213], v245 offset:40960
 ds_read_b64_tr_b16 v[214:215], v245 offset:41984
 v_fma_f32 v250, v250, v248, v249
 v_fma_f32 v251, v251, v248, v249
 v_mul_f32 v250, v250, v170
 s_waitcnt lgkmcnt(4)
 v_mfma_f32_32x32x16_bf16 v[176:191], v[224:227], a[120:123], v[176:191]
 ds_read_b64_tr_b16 v[216:217], v244 offset:43008
 ds_read_b64_tr_b16 v[218:219], v244 offset:44032
 s_add_u32 m0, s30, 57344
 s_add_u32 s36, s32, 4128768
 buffer_load_dwordx4 v246, s[12:15], s36 offen lds
 v_mul_f32 v251, v251, v171
 v_exp_f32 v250, v250
 v_exp_f32 v251, v251
 v_add_f32 v250, 1.0, v250
 v_mfma_f32_32x32x16_bf16 v[192:207], v[228:231], a[120:123], v[192:207]
 ds_read_b64_tr_b16 v[220:221], v245 offset:43008
 ds_read_b64_tr_b16 v[222:223], v245 offset:44032
 v_add_f32 v251, 1.0, v251
 v_rcp_f32 v250, v250
 v_rcp_f32 v251, v251
 v_mul_f32 v170, v250, v170
 v_mfma_f32_32x32x16_bf16 v[176:191], v[232:235], a[124:127], v[176:191]
 ds_read_b64_tr_b16 v[224:225], v244 offset:45056
 ds_read_b64_tr_b16 v[226:227], v244 offset:46080
 v_mul_f32 v171, v251, v171
 v_cvt_pk_bf16_f32 v13, v170, v171
 v_mul_f32 v250, v172, v172
 v_mfma_f32_32x32x16_bf16 v[192:207], v[236:239], a[124:127], v[192:207]
 ds_read_b64_tr_b16 v[228:229], v245 offset:45056
 ds_read_b64_tr_b16 v[230:231], v245 offset:46080
 buffer_load_dwordx4 v247, s[12:15], s36 offen offset:1024 lds
 v_mul_f32 v251, v173, v173
 v_fma_f32 v250, v250, v248, v249
 v_fma_f32 v251, v251, v248, v249
 s_waitcnt lgkmcnt(4)
 v_mfma_f32_32x32x16_bf16 v[176:191], v[208:211], a[128:131], v[176:191]
 ds_read_b64_tr_b16 v[232:233], v244 offset:47104
 ds_read_b64_tr_b16 v[234:235], v244 offset:48128
 v_mul_f32 v250, v250, v172
 v_mul_f32 v251, v251, v173
 v_exp_f32 v250, v250
 v_exp_f32 v251, v251
 v_add_f32 v250, 1.0, v250
 v_mfma_f32_32x32x16_bf16 v[192:207], v[212:215], a[128:131], v[192:207]
 ds_read_b64_tr_b16 v[236:237], v245 offset:47104
 ds_read_b64_tr_b16 v[238:239], v245 offset:48128
 s_waitcnt vmcnt(6)
 s_barrier
 v_mfma_f32_32x32x16_bf16 v[176:191], v[216:219], a[132:135], v[176:191]
 ds_read_b64_tr_b16 v[208:209], v240 offset:0
 ds_read_b64_tr_b16 v[210:211], v240 offset:1024
 s_add_u32 m0, s30, 65536
 s_add_u32 s36, s32, 4718592
 buffer_load_dwordx4 v246, s[12:15], s36 offen lds
 v_add_f32 v251, 1.0, v251
 v_rcp_f32 v250, v250
 v_rcp_f32 v251, v251
 v_mul_f32 v172, v250, v172
 v_mfma_f32_32x32x16_bf16 v[192:207], v[220:223], a[132:135], v[192:207]
 ds_read_b64_tr_b16 v[212:213], v241 offset:0
 ds_read_b64_tr_b16 v[214:215], v241 offset:1024
 v_mul_f32 v173, v251, v173
 v_cvt_pk_bf16_f32 v14, v172, v173
 v_mul_f32 v250, v174, v174
 s_waitcnt lgkmcnt(4)
 v_mfma_f32_32x32x16_bf16 v[176:191], v[224:227], a[136:139], v[176:191]
 ds_read_b64_tr_b16 v[216:217], v240 offset:2048
 ds_read_b64_tr_b16 v[218:219], v240 offset:3072
 v_mul_f32 v251, v175, v175
 v_fma_f32 v250, v250, v248, v249
 v_fma_f32 v251, v251, v248, v249
 v_mfma_f32_32x32x16_bf16 v[192:207], v[228:231], a[136:139], v[192:207]
 ds_read_b64_tr_b16 v[220:221], v241 offset:2048
 ds_read_b64_tr_b16 v[222:223], v241 offset:3072
 buffer_load_dwordx4 v247, s[12:15], s36 offen offset:1024 lds
 v_mul_f32 v250, v250, v174
 v_mul_f32 v251, v251, v175
 v_exp_f32 v250, v250
 v_mfma_f32_32x32x16_bf16 v[176:191], v[232:235], a[140:143], v[176:191]
 ds_read_b64_tr_b16 v[224:225], v240 offset:4096
 ds_read_b64_tr_b16 v[226:227], v240 offset:5120
 v_exp_f32 v251, v251
 v_add_f32 v250, 1.0, v250
 v_add_f32 v251, 1.0, v251
 v_rcp_f32 v250, v250
 v_mfma_f32_32x32x16_bf16 v[192:207], v[236:239], a[140:143], v[192:207]
 ds_read_b64_tr_b16 v[228:229], v241 offset:4096
 ds_read_b64_tr_b16 v[230:231], v241 offset:5120
 v_rcp_f32 v251, v251
 v_mul_f32 v174, v250, v174
 v_mul_f32 v175, v251, v175
 v_cvt_pk_bf16_f32 v15, v174, v175
 s_waitcnt lgkmcnt(4)
 v_mfma_f32_32x32x16_bf16 v[144:159], v[208:211], a[0:3], 0
 ds_read_b64_tr_b16 v[232:233], v240 offset:6144
 ds_read_b64_tr_b16 v[234:235], v240 offset:7168
 s_add_u32 m0, s30, 73728
 s_add_u32 s32, s32, 128
 s_cmp_ge_u32 s32, s39
 s_cselect_b32 s3, 1152, 0
 s_sub_u32 s32, s32, s3
 s_add_u32 s36, s32, 0
 buffer_load_dwordx4 v246, s[12:15], s36 offen lds
 v_mfma_f32_32x32x16_bf16 v[160:175], v[212:215], a[0:3], 0
 ds_read_b64_tr_b16 v[236:237], v241 offset:6144
 ds_read_b64_tr_b16 v[238:239], v241 offset:7168
 v_mfma_f32_32x32x16_bf16 v[144:159], v[216:219], a[4:7], v[144:159]
 ds_read_b64_tr_b16 v[208:209], v240 offset:8192
 ds_read_b64_tr_b16 v[210:211], v240 offset:9216
 v_mfma_f32_32x32x16_bf16 v[160:175], v[220:223], a[4:7], v[160:175]
 ds_read_b64_tr_b16 v[212:213], v241 offset:8192
 ds_read_b64_tr_b16 v[214:215], v241 offset:9216
 buffer_load_dwordx4 v247, s[12:15], s36 offen offset:1024 lds
 s_waitcnt lgkmcnt(4)
 v_mfma_f32_32x32x16_bf16 v[144:159], v[224:227], a[8:11], v[144:159]
 ds_read_b64_tr_b16 v[216:217], v240 offset:10240
 ds_read_b64_tr_b16 v[218:219], v240 offset:11264
 v_mul_f32 v250, v176, v176
 v_mul_f32 v251, v177, v177
 v_fma_f32 v250, v250, v248, v249
 v_fma_f32 v251, v251, v248, v249
 v_mfma_f32_32x32x16_bf16 v[160:175], v[228:231], a[8:11], v[160:175]
 ds_read_b64_tr_b16 v[220:221], v241 offset:10240
 ds_read_b64_tr_b16 v[222:223], v241 offset:11264
 v_mul_f32 v250, v250, v176
 v_mul_f32 v251, v251, v177
 v_exp_f32 v250, v250
 v_mfma_f32_32x32x16_bf16 v[144:159], v[232:235], a[12:15], v[144:159]
 ds_read_b64_tr_b16 v[224:225], v240 offset:12288
 ds_read_b64_tr_b16 v[226:227], v240 offset:13312
 s_add_u32 m0, s30, 81920
 s_add_u32 s36, s32, 589824
 buffer_load_dwordx4 v246, s[12:15], s36 offen lds
 v_exp_f32 v251, v251
 v_add_f32 v250, 1.0, v250
 v_add_f32 v251, 1.0, v251
 v_rcp_f32 v250, v250
 v_mfma_f32_32x32x16_bf16 v[160:175], v[236:239], a[12:15], v[160:175]
 ds_read_b64_tr_b16 v[228:229], v241 offset:12288
 ds_read_b64_tr_b16 v[230:231], v241 offset:13312
 v_rcp_f32 v251, v251
 v_mul_f32 v176, v250, v176
 v_mul_f32 v177, v251, v177
 v_cvt_pk_bf16_f32 v16, v176, v177
 s_waitcnt lgkmcnt(4)
 v_mfma_f32_32x32x16_bf16 v[144:159], v[208:211], a[16:19], v[144:159]
 ds_read_b64_tr_b16 v[232:233], v240 offset:14336
 ds_read_b64_tr_b16 v[234:235], v240 offset:15360
 v_mul_f32 v250, v178, v178
 v_mul_f32 v251, v179, v179
 v_fma_f32 v250, v250, v248, v249
 v_mfma_f32_32x32x16_bf16 v[160:175], v[212:215], a[16:19], v[160:175]
 ds_read_b64_tr_b16 v[236:237], v241 offset:14336
 ds_read_b64_tr_b16 v[238:239], v241 offset:15360
 buffer_load_dwordx4 v247, s[12:15], s36 offen offset:1024 lds
 v_fma_f32 v251, v251, v248, v249
 v_mul_f32 v250, v250, v178
 v_mul_f32 v251, v251, v179
 v_mfma_f32_32x32x16_bf16 v[144:159], v[216:219], a[20:23], v[144:159]
 ds_read_b64_tr_b16 v[208:209], v240 offset:16384
 ds_read_b64_tr_b16 v[210:211], v240 offset:17408
 v_exp_f32 v250, v250
 v_exp_f32 v251, v251
 v_add_f32 v250, 1.0, v250
 v_add_f32 v251, 1.0, v251
 v_rcp_f32 v250, v250
 v_mfma_f32_32x32x16_bf16 v[160:175], v[220:223], a[20:23], v[160:175]
 ds_read_b64_tr_b16 v[212:213], v241 offset:16384
 ds_read_b64_tr_b16 v[214:215], v241 offset:17408
 v_rcp_f32 v251, v251
 v_mul_f32 v178, v250, v178
 v_mul_f32 v179, v251, v179
 v_cvt_pk_bf16_f32 v17, v178, v179
 s_waitcnt lgkmcnt(4)
 v_mfma_f32_32x32x16_bf16 v[144:159], v[224:227], a[24:27], v[144:159]
 ds_read_b64_tr_b16 v[216:217], v240 offset:18432
 ds_read_b64_tr_b16 v[218:219], v240 offset:19456
 s_add_u32 m0, s30, 90112
 s_add_u32 s36, s32, 1179648
 buffer_load_dwordx4 v246, s[12:15], s36 offen lds
 v_mul_f32 v250, v180, v180
 v_mul_f32 v251, v181, v181
 v_fma_f32 v250, v250, v248, v249
 v_mfma_f32_32x32x16_bf16 v[160:175], v[228:231], a[24:27], v[160:175]
 ds_read_b64_tr_b16 v[220:221], v241 offset:18432
 ds_read_b64_tr_b16 v[222:223], v241 offset:19456
 v_fma_f32 v251, v251, v248, v249
 v_mul_f32 v250, v250, v180
 v_mul_f32 v251, v251, v181
 v_mfma_f32_32x32x16_bf16 v[144:159], v[232:235], a[28:31], v[144:159]
 ds_read_b64_tr_b16 v[224:225], v240 offset:20480
 ds_read_b64_tr_b16 v[226:227], v240 offset:21504
 v_exp_f32 v250, v250
 v_exp_f32 v251, v251
 v_add_f32 v250, 1.0, v250
 v_add_f32 v251, 1.0, v251
 v_mfma_f32_32x32x16_bf16 v[160:175], v[236:239], a[28:31], v[160:175]
 ds_read_b64_tr_b16 v[228:229], v241 offset:20480
 ds_read_b64_tr_b16 v[230:231], v241 offset:21504
 buffer_load_dwordx4 v247, s[12:15], s36 offen offset:1024 lds
 v_rcp_f32 v250, v250
 v_rcp_f32 v251, v251
 v_mul_f32 v180, v250, v180
 v_mul_f32 v181, v251, v181
 s_waitcnt lgkmcnt(4)
 v_mfma_f32_32x32x16_bf16 v[144:159], v[208:211], a[32:35], v[144:159]
 ds_read_b64_tr_b16 v[232:233], v240 offset:22528
 ds_read_b64_tr_b16 v[234:235], v240 offset:23552
 v_cvt_pk_bf16_f32 v18, v180, v181
 v_mul_f32 v250, v182, v182
 v_mul_f32 v251, v183, v183
 v_mfma_f32_32x32x16_bf16 v[160:175], v[212:215], a[32:35], v[160:175]
 ds_read_b64_tr_b16 v[236:237], v241 offset:22528
 ds_read_b64_tr_b16 v[238:239], v241 offset:23552
 v_fma_f32 v250, v250, v248, v249
 v_fma_f32 v251, v251, v248, v249
 v_mul_f32 v250, v250, v182
 v_mul_f32 v251, v251, v183
 v_mfma_f32_32x32x16_bf16 v[144:159], v[216:219], a[36:39], v[144:159]
 ds_read_b64_tr_b16 v[208:209], v240 offset:24576
 ds_read_b64_tr_b16 v[210:211], v240 offset:25600
 v_exp_f32 v250, v250
 v_exp_f32 v251, v251
 v_add_f32 v250, 1.0, v250
 v_add_f32 v251, 1.0, v251
 v_mfma_f32_32x32x16_bf16 v[160:175], v[220:223], a[36:39], v[160:175]
 ds_read_b64_tr_b16 v[212:213], v241 offset:24576
 ds_read_b64_tr_b16 v[214:215], v241 offset:25600
 v_rcp_f32 v250, v250
 v_rcp_f32 v251, v251
 v_mul_f32 v182, v250, v182
 v_mul_f32 v183, v251, v183
 s_waitcnt lgkmcnt(4)
 v_mfma_f32_32x32x16_bf16 v[144:159], v[224:227], a[40:43], v[144:159]
 ds_read_b64_tr_b16 v[216:217], v240 offset:26624
 ds_read_b64_tr_b16 v[218:219], v240 offset:27648
 s_add_u32 m0, s30, 98304
 s_add_u32 s36, s32, 1769472
 buffer_load_dwordx4 v246, s[12:15], s36 offen lds
 v_cvt_pk_bf16_f32 v19, v182, v183
 v_mul_f32 v250, v184, v184
 v_mul_f32 v251, v185, v185
 v_mfma_f32_32x32x16_bf16 v[160:175], v[228:231], a[40:43], v[160:175]
 ds_read_b64_tr_b16 v[220:221], v241 offset:26624
 ds_read_b64_tr_b16 v[222:223], v241 offset:27648
 v_fma_f32 v250, v250, v248, v249
 v_fma_f32 v251, v251, v248, v249
 v_mul_f32 v250, v250, v184
 v_mfma_f32_32x32x16_bf16 v[144:159], v[232:235], a[44:47], v[144:159]
 ds_read_b64_tr_b16 v[224:225], v240 offset:28672
 ds_read_b64_tr_b16 v[226:227], v240 offset:29696
 v_mul_f32 v251, v251, v185
 v_exp_f32 v250, v250
 v_exp_f32 v251, v251
 v_add_f32 v250, 1.0, v250
 v_mfma_f32_32x32x16_bf16 v[160:175], v[236:239], a[44:47], v[160:175]
 ds_read_b64_tr_b16 v[228:229], v241 offset:28672
 ds_read_b64_tr_b16 v[230:231], v241 offset:29696
 v_add_f32 v251, 1.0, v251
 v_rcp_f32 v250, v250
 v_rcp_f32 v251, v251
 v_mul_f32 v184, v250, v184
 v_mul_f32 v185, v251, v185
 s_waitcnt lgkmcnt(4)
 v_mfma_f32_32x32x16_bf16 v[144:159], v[208:211], a[48:51], v[144:159]
 ds_read_b64_tr_b16 v[232:233], v240 offset:30720
 ds_read_b64_tr_b16 v[234:235], v240 offset:31744
 buffer_load_dwordx4 v247, s[12:15], s36 offen offset:1024 lds
 v_cvt_pk_bf16_f32 v20, v184, v185
 v_mul_f32 v250, v186, v186
 v_mul_f32 v251, v187, v187
 v_mfma_f32_32x32x16_bf16 v[160:175], v[212:215], a[48:51], v[160:175]
 ds_read_b64_tr_b16 v[236:237], v241 offset:30720
 ds_read_b64_tr_b16 v[238:239], v241 offset:31744
 v_fma_f32 v250, v250, v248, v249
 v_fma_f32 v251, v251, v248, v249
 v_mul_f32 v250, v250, v186
 v_mfma_f32_32x32x16_bf16 v[144:159], v[216:219], a[52:55], v[144:159]
 ds_read_b64_tr_b16 v[208:209], v240 offset:32768
 ds_read_b64_tr_b16 v[210:211], v240 offset:33792
 v_mul_f32 v251, v251, v187
 v_exp_f32 v250, v250
 v_exp_f32 v251, v251
 v_add_f32 v250, 1.0, v250
 v_mfma_f32_32x32x16_bf16 v[160:175], v[220:223], a[52:55], v[160:175]
 ds_read_b64_tr_b16 v[212:213], v241 offset:32768
 ds_read_b64_tr_b16 v[214:215], v241 offset:33792
 v_add_f32 v251, 1.0, v251
 v_rcp_f32 v250, v250
 v_rcp_f32 v251, v251
 v_mul_f32 v186, v250, v186
 s_waitcnt lgkmcnt(4)
 v_mfma_f32_32x32x16_bf16 v[144:159], v[224:227], a[56:59], v[144:159]
 ds_read_b64_tr_b16 v[216:217], v240 offset:34816
 ds_read_b64_tr_b16 v[218:219], v240 offset:35840
 s_add_u32 m0, s30, 106496
 s_add_u32 s36, s32, 2359296
 buffer_load_dwordx4 v246, s[12:15], s36 offen lds
 v_mul_f32 v187, v251, v187
 v_cvt_pk_bf16_f32 v21, v186, v187
 v_mul_f32 v250, v188, v188
 v_mfma_f32_32x32x16_bf16 v[160:175], v[228:231], a[56:59], v[160:175]
 ds_read_b64_tr_b16 v[220:221], v241 offset:34816
 ds_read_b64_tr_b16 v[222:223], v241 offset:35840
 s_waitcnt vmcnt(9)
 s_barrier
 v_mfma_f32_32x32x16_bf16 v[144:159], v[232:235], a[60:63], v[144:159]
 ds_read_b64_tr_b16 v[224:225], v240 offset:36864
 ds_read_b64_tr_b16 v[226:227], v240 offset:37888
 v_mul_f32 v251, v189, v189
 v_fma_f32 v250, v250, v248, v249
 v_fma_f32 v251, v251, v248, v249
 v_mfma_f32_32x32x16_bf16 v[160:175], v[236:239], a[60:63], v[160:175]
 ds_read_b64_tr_b16 v[228:229], v241 offset:36864
 ds_read_b64_tr_b16 v[230:231], v241 offset:37888
 v_mul_f32 v250, v250, v188
 v_mul_f32 v251, v251, v189
 v_exp_f32 v250, v250
 v_exp_f32 v251, v251
 v_add_f32 v250, 1.0, v250
 s_waitcnt lgkmcnt(4)
 v_mfma_f32_32x32x16_bf16 v[144:159], v[208:211], a[64:67], v[144:159]
 ds_read_b64_tr_b16 v[232:233], v240 offset:38912
 ds_read_b64_tr_b16 v[234:235], v240 offset:39936
 buffer_load_dwordx4 v247, s[12:15], s36 offen offset:1024 lds
 v_add_f32 v251, 1.0, v251
 v_rcp_f32 v250, v250
 v_rcp_f32 v251, v251
 v_mul_f32 v188, v250, v188
 v_mfma_f32_32x32x16_bf16 v[160:175], v[212:215], a[64:67], v[160:175]
 ds_read_b64_tr_b16 v[236:237], v241 offset:38912
 ds_read_b64_tr_b16 v[238:239], v241 offset:39936
 v_mul_f32 v189, v251, v189
 v_cvt_pk_bf16_f32 v22, v188, v189
 v_mul_f32 v250, v190, v190
 v_mfma_f32_32x32x16_bf16 v[144:159], v[216:219], a[68:71], v[144:159]
 ds_read_b64_tr_b16 v[208:209], v240 offset:40960
 ds_read_b64_tr_b16 v[210:211], v240 offset:41984
 v_mul_f32 v251, v191, v191
 v_fma_f32 v250, v250, v248, v249
 v_fma_f32 v251, v251, v248, v249
 v_mfma_f32_32x32x16_bf16 v[160:175], v[220:223], a[68:71], v[160:175]
 ds_read_b64_tr_b16 v[212:213], v241 offset:40960
 ds_read_b64_tr_b16 v[214:215], v241 offset:41984
 v_mul_f32 v250, v250, v190
 v_mul_f32 v251, v251, v191
 v_exp_f32 v250, v250
 s_waitcnt lgkmcnt(4)
 v_mfma_f32_32x32x16_bf16 v[144:159], v[224:227], a[72:75], v[144:159]
 ds_read_b64_tr_b16 v[216:217], v240 offset:43008
 ds_read_b64_tr_b16 v[218:219], v240 offset:44032
 s_add_u32 m0, s30, 114688
 s_add_u32 s36, s32, 2949120
 buffer_load_dwordx4 v246, s[12:15], s36 offen lds
 v_exp_f32 v251, v251
 v_add_f32 v250, 1.0, v250
 v_add_f32 v251, 1.0, v251
 v_rcp_f32 v250, v250
 v_mfma_f32_32x32x16_bf16 v[160:175], v[228:231], a[72:75], v[160:175]
 ds_read_b64_tr_b16 v[220:221], v241 offset:43008
 ds_read_b64_tr_b16 v[222:223], v241 offset:44032
 v_rcp_f32 v251, v251
 v_mul_f32 v190, v250, v190
 v_mul_f32 v191, v251, v191
 v_cvt_pk_bf16_f32 v23, v190, v191
 v_mfma_f32_32x32x16_bf16 v[144:159], v[232:235], a[76:79], v[144:159]
 ds_read_b64_tr_b16 v[224:225], v240 offset:45056
 ds_read_b64_tr_b16 v[226:227], v240 offset:46080
 v_mul_f32 v250, v192, v192
 v_mul_f32 v251, v193, v193
 v_fma_f32 v250, v250, v248, v249
 v_fma_f32 v251, v251, v248, v249
 v_mfma_f32_32x32x16_bf16 v[160:175], v[236:239], a[76:79], v[160:175]
 ds_read_b64_tr_b16 v[228:229], v241 offset:45056
 ds_read_b64_tr_b16 v[230:231], v241 offset:46080
 v_mul_f32 v250, v250, v192
 v_mul_f32 v251, v251, v193
 v_exp_f32 v250, v250
 s_waitcnt lgkmcnt(4)
 v_mfma_f32_32x32x16_bf16 v[144:159], v[208:211], a[80:83], v[144:159]
 ds_read_b64_tr_b16 v[232:233], v240 offset:47104
 ds_read_b64_tr_b16 v[234:235], v240 offset:48128
 buffer_load_dwordx4 v247, s[12:15], s36 offen offset:1024 lds
 v_exp_f32 v251, v251
 v_add_f32 v250, 1.0, v250
 v_add_f32 v251, 1.0, v251
 v_rcp_f32 v250, v250
 v_mfma_f32_32x32x16_bf16 v[160:175], v[212:215], a[80:83], v[160:175]
 ds_read_b64_tr_b16 v[236:237], v241 offset:47104
 ds_read_b64_tr_b16 v[238:239], v241 offset:48128
 v_rcp_f32 v251, v251
 v_mul_f32 v192, v250, v192
 v_mul_f32 v193, v251, v193
 v_cvt_pk_bf16_f32 v24, v192, v193
 v_mfma_f32_32x32x16_bf16 v[144:159], v[216:219], a[84:87], v[144:159]
 ds_read_b64_tr_b16 v[208:209], v242 offset:0
 ds_read_b64_tr_b16 v[210:211], v242 offset:1024
 v_mul_f32 v250, v194, v194
 v_mul_f32 v251, v195, v195
 v_fma_f32 v250, v250, v248, v249
 v_mfma_f32_32x32x16_bf16 v[160:175], v[220:223], a[84:87], v[160:175]
 ds_read_b64_tr_b16 v[212:213], v243 offset:0
 ds_read_b64_tr_b16 v[214:215], v243 offset:1024
 v_fma_f32 v251, v251, v248, v249
 v_mul_f32 v250, v250, v194
 v_mul_f32 v251, v251, v195
 s_waitcnt lgkmcnt(4)
 v_mfma_f32_32x32x16_bf16 v[144:159], v[224:227], a[88:91], v[144:159]
 ds_read_b64_tr_b16 v[216:217], v242 offset:2048
 ds_read_b64_tr_b16 v[218:219], v242 offset:3072
 s_add_u32 m0, s30, 122880
 s_add_u32 s36, s32, 3538944
 buffer_load_dwordx4 v246, s[12:15], s36 offen lds
 v_exp_f32 v250, v250
 v_exp_f32 v251, v251
 v_add_f32 v250, 1.0, v250
 v_add_f32 v251, 1.0, v251
 v_rcp_f32 v250, v250
 v_mfma_f32_32x32x16_bf16 v[160:175], v[228:231], a[88:91], v[160:175]
 ds_read_b64_tr_b16 v[220:221], v243 offset:2048
 ds_read_b64_tr_b16 v[222:223], v243 offset:3072
 v_rcp_f32 v251, v251
 v_mul_f32 v194, v250, v194
 v_mul_f32 v195, v251, v195
 v_cvt_pk_bf16_f32 v25, v194, v195
 v_mfma_f32_32x32x16_bf16 v[144:159], v[232:235], a[92:95], v[144:159]
 ds_read_b64_tr_b16 v[224:225], v242 offset:4096
 ds_read_b64_tr_b16 v[226:227], v242 offset:5120
 v_mul_f32 v250, v196, v196
 v_mul_f32 v251, v197, v197
 v_fma_f32 v250, v250, v248, v249
 v_mfma_f32_32x32x16_bf16 v[160:175], v[236:239], a[92:95], v[160:175]
 ds_read_b64_tr_b16 v[228:229], v243 offset:4096
 ds_read_b64_tr_b16 v[230:231], v243 offset:5120
 v_fma_f32 v251, v251, v248, v249
 v_mul_f32 v250, v250, v196
 v_mul_f32 v251, v251, v197
 s_waitcnt lgkmcnt(4)
 v_mfma_f32_32x32x16_bf16 v[144:159], v[208:211], a[96:99], v[144:159]
 ds_read_b64_tr_b16 v[232:233], v242 offset:6144
 ds_read_b64_tr_b16 v[234:235], v242 offset:7168
 buffer_load_dwordx4 v247, s[12:15], s36 offen offset:1024 lds
 v_exp_f32 v250, v250
 v_exp_f32 v251, v251
 v_add_f32 v250, 1.0, v250
 v_add_f32 v251, 1.0, v251
 v_mfma_f32_32x32x16_bf16 v[160:175], v[212:215], a[96:99], v[160:175]
 ds_read_b64_tr_b16 v[236:237], v243 offset:6144
 ds_read_b64_tr_b16 v[238:239], v243 offset:7168
 v_rcp_f32 v250, v250
 v_rcp_f32 v251, v251
 v_mul_f32 v196, v250, v196
 v_mul_f32 v197, v251, v197
 v_mfma_f32_32x32x16_bf16 v[144:159], v[216:219], a[100:103], v[144:159]
 ds_read_b64_tr_b16 v[208:209], v242 offset:8192
 ds_read_b64_tr_b16 v[210:211], v242 offset:9216
 v_cvt_pk_bf16_f32 v26, v196, v197
 v_mul_f32 v250, v198, v198
 v_mul_f32 v251, v199, v199
 v_mfma_f32_32x32x16_bf16 v[160:175], v[220:223], a[100:103], v[160:175]
 ds_read_b64_tr_b16 v[212:213], v243 offset:8192
 ds_read_b64_tr_b16 v[214:215], v243 offset:9216
 v_fma_f32 v250, v250, v248, v249
 v_fma_f32 v251, v251, v248, v249
 v_mul_f32 v250, v250, v198
 v_mul_f32 v251, v251, v199
 s_waitcnt lgkmcnt(4)
 v_mfma_f32_32x32x16_bf16 v[144:159], v[224:227], a[104:107], v[144:159]
 ds_read_b64_tr_b16 v[216:217], v242 offset:10240
 ds_read_b64_tr_b16 v[218:219], v242 offset:11264
 s_add_u32 m0, s30, 131072
 s_add_u32 s36, s32, 4128768
 buffer_load_dwordx4 v246, s[12:15], s36 offen lds
 v_exp_f32 v250, v250
 v_exp_f32 v251, v251
 v_add_f32 v250, 1.0, v250
 v_add_f32 v251, 1.0, v251
 v_mfma_f32_32x32x16_bf16 v[160:175], v[228:231], a[104:107], v[160:175]
 ds_read_b64_tr_b16 v[220:221], v243 offset:10240
 ds_read_b64_tr_b16 v[222:223], v243 offset:11264
 v_rcp_f32 v250, v250
 v_rcp_f32 v251, v251
 v_mul_f32 v198, v250, v198
 v_mul_f32 v199, v251, v199
 v_mfma_f32_32x32x16_bf16 v[144:159], v[232:235], a[108:111], v[144:159]
 ds_read_b64_tr_b16 v[224:225], v242 offset:12288
 ds_read_b64_tr_b16 v[226:227], v242 offset:13312
 v_cvt_pk_bf16_f32 v27, v198, v199
 v_mul_f32 v250, v200, v200
 v_mul_f32 v251, v201, v201
 v_mfma_f32_32x32x16_bf16 v[160:175], v[236:239], a[108:111], v[160:175]
 ds_read_b64_tr_b16 v[228:229], v243 offset:12288
 ds_read_b64_tr_b16 v[230:231], v243 offset:13312
 v_fma_f32 v250, v250, v248, v249
 v_fma_f32 v251, v251, v248, v249
 v_mul_f32 v250, v250, v200
 s_waitcnt lgkmcnt(4)
 v_mfma_f32_32x32x16_bf16 v[144:159], v[208:211], a[112:115], v[144:159]
 ds_read_b64_tr_b16 v[232:233], v242 offset:14336
 ds_read_b64_tr_b16 v[234:235], v242 offset:15360
 buffer_load_dwordx4 v247, s[12:15], s36 offen offset:1024 lds
 v_mul_f32 v251, v251, v201
 v_exp_f32 v250, v250
 v_exp_f32 v251, v251
 v_add_f32 v250, 1.0, v250
 v_mfma_f32_32x32x16_bf16 v[160:175], v[212:215], a[112:115], v[160:175]
 ds_read_b64_tr_b16 v[236:237], v243 offset:14336
 ds_read_b64_tr_b16 v[238:239], v243 offset:15360
 v_add_f32 v251, 1.0, v251
 v_rcp_f32 v250, v250
 v_rcp_f32 v251, v251
 v_mul_f32 v200, v250, v200
 v_mul_f32 v201, v251, v201
 v_mfma_f32_32x32x16_bf16 v[144:159], v[216:219], a[116:119], v[144:159]
 ds_read_b64_tr_b16 v[208:209], v242 offset:16384
 ds_read_b64_tr_b16 v[210:211], v242 offset:17408
 v_cvt_pk_bf16_f32 v28, v200, v201
 v_mul_f32 v250, v202, v202
 v_mul_f32 v251, v203, v203
 v_mfma_f32_32x32x16_bf16 v[160:175], v[220:223], a[116:119], v[160:175]
 ds_read_b64_tr_b16 v[212:213], v243 offset:16384
 ds_read_b64_tr_b16 v[214:215], v243 offset:17408
 v_fma_f32 v250, v250, v248, v249
 v_fma_f32 v251, v251, v248, v249
 v_mul_f32 v250, v250, v202
 s_waitcnt lgkmcnt(4)
 v_mfma_f32_32x32x16_bf16 v[144:159], v[224:227], a[120:123], v[144:159]
 ds_read_b64_tr_b16 v[216:217], v242 offset:18432
 ds_read_b64_tr_b16 v[218:219], v242 offset:19456
 s_add_u32 m0, s30, 139264
 s_add_u32 s36, s32, 4718592
 buffer_load_dwordx4 v246, s[12:15], s36 offen lds
 v_mul_f32 v251, v251, v203
 v_exp_f32 v250, v250
 v_exp_f32 v251, v251
 v_add_f32 v250, 1.0, v250
 v_mfma_f32_32x32x16_bf16 v[160:175], v[228:231], a[120:123], v[160:175]
 ds_read_b64_tr_b16 v[220:221], v243 offset:18432
 ds_read_b64_tr_b16 v[222:223], v243 offset:19456
 v_add_f32 v251, 1.0, v251
 v_rcp_f32 v250, v250
 v_rcp_f32 v251, v251
 v_mul_f32 v202, v250, v202
 v_mfma_f32_32x32x16_bf16 v[144:159], v[232:235], a[124:127], v[144:159]
 ds_read_b64_tr_b16 v[224:225], v242 offset:20480
 ds_read_b64_tr_b16 v[226:227], v242 offset:21504
 v_mul_f32 v203, v251, v203
 v_cvt_pk_bf16_f32 v29, v202, v203
 v_mul_f32 v250, v204, v204
 v_mfma_f32_32x32x16_bf16 v[160:175], v[236:239], a[124:127], v[160:175]
 ds_read_b64_tr_b16 v[228:229], v243 offset:20480
 ds_read_b64_tr_b16 v[230:231], v243 offset:21504
 v_mul_f32 v251, v205, v205
 v_fma_f32 v250, v250, v248, v249
 v_fma_f32 v251, v251, v248, v249
 s_waitcnt lgkmcnt(4)
 v_mfma_f32_32x32x16_bf16 v[144:159], v[208:211], a[128:131], v[144:159]
 ds_read_b64_tr_b16 v[232:233], v242 offset:22528
 ds_read_b64_tr_b16 v[234:235], v242 offset:23552
 buffer_load_dwordx4 v247, s[12:15], s36 offen offset:1024 lds
 v_mul_f32 v250, v250, v204
 v_mul_f32 v251, v251, v205
 v_exp_f32 v250, v250
 v_exp_f32 v251, v251
 v_add_f32 v250, 1.0, v250
 v_mfma_f32_32x32x16_bf16 v[160:175], v[212:215], a[128:131], v[160:175]
 ds_read_b64_tr_b16 v[236:237], v243 offset:22528
 ds_read_b64_tr_b16 v[238:239], v243 offset:23552
 s_waitcnt vmcnt(8)
 s_barrier
 v_mfma_f32_32x32x16_bf16 v[144:159], v[216:219], a[132:135], v[144:159]
 ds_read_b64_tr_b16 v[208:209], v242 offset:24576
 ds_read_b64_tr_b16 v[210:211], v242 offset:25600
 v_add_f32 v251, 1.0, v251
 v_rcp_f32 v250, v250
 v_rcp_f32 v251, v251
 v_mul_f32 v204, v250, v204
 v_mfma_f32_32x32x16_bf16 v[160:175], v[220:223], a[132:135], v[160:175]
 ds_read_b64_tr_b16 v[212:213], v243 offset:24576
 ds_read_b64_tr_b16 v[214:215], v243 offset:25600
 v_mul_f32 v205, v251, v205
 v_cvt_pk_bf16_f32 v30, v204, v205
 v_mul_f32 v250, v206, v206
 s_waitcnt lgkmcnt(4)
 v_mfma_f32_32x32x16_bf16 v[144:159], v[224:227], a[136:139], v[144:159]
 ds_read_b64_tr_b16 v[216:217], v242 offset:26624
 ds_read_b64_tr_b16 v[218:219], v242 offset:27648
 s_add_u32 m0, s30, 0
 s_add_u32 s32, s32, 128
 s_cmp_ge_u32 s32, s39
 s_cselect_b32 s3, 1152, 0
 s_sub_u32 s32, s32, s3
 s_add_u32 s36, s32, 0
 buffer_load_dwordx4 v246, s[12:15], s36 offen lds
 v_mul_f32 v251, v207, v207
 v_fma_f32 v250, v250, v248, v249
 v_fma_f32 v251, v251, v248, v249
 v_mfma_f32_32x32x16_bf16 v[160:175], v[228:231], a[136:139], v[160:175]
 ds_read_b64_tr_b16 v[220:221], v243 offset:26624
 ds_read_b64_tr_b16 v[222:223], v243 offset:27648
 v_mul_f32 v250, v250, v206
 v_mul_f32 v251, v251, v207
 v_exp_f32 v250, v250
 v_mfma_f32_32x32x16_bf16 v[144:159], v[232:235], a[140:143], v[144:159]
 ds_read_b64_tr_b16 v[224:225], v242 offset:28672
 ds_read_b64_tr_b16 v[226:227], v242 offset:29696
 v_exp_f32 v251, v251
 v_add_f32 v250, 1.0, v250
 v_add_f32 v251, 1.0, v251
 v_rcp_f32 v250, v250
 v_mfma_f32_32x32x16_bf16 v[160:175], v[236:239], a[140:143], v[160:175]
 ds_read_b64_tr_b16 v[228:229], v243 offset:28672
 ds_read_b64_tr_b16 v[230:231], v243 offset:29696
 v_rcp_f32 v251, v251
 v_mul_f32 v206, v250, v206
 v_mul_f32 v207, v251, v207
 v_cvt_pk_bf16_f32 v31, v206, v207
 s_waitcnt lgkmcnt(4)
 v_mfma_f32_32x32x16_bf16 v[176:191], v[208:211], a[0:3], 0
 ds_read_b64_tr_b16 v[232:233], v242 offset:30720
 ds_read_b64_tr_b16 v[234:235], v242 offset:31744
 buffer_load_dwordx4 v247, s[12:15], s36 offen offset:1024 lds
 v_mfma_f32_32x32x16_bf16 v[192:207], v[212:215], a[0:3], 0
 ds_read_b64_tr_b16 v[236:237], v243 offset:30720
 ds_read_b64_tr_b16 v[238:239], v243 offset:31744
 v_mfma_f32_32x32x16_bf16 v[176:191], v[216:219], a[4:7], v[176:191]
 ds_read_b64_tr_b16 v[208:209], v242 offset:32768
 ds_read_b64_tr_b16 v[210:211], v242 offset:33792
 v_mfma_f32_32x32x16_bf16 v[192:207], v[220:223], a[4:7], v[192:207]
 ds_read_b64_tr_b16 v[212:213], v243 offset:32768
 ds_read_b64_tr_b16 v[214:215], v243 offset:33792
 s_waitcnt lgkmcnt(4)
 v_mfma_f32_32x32x16_bf16 v[176:191], v[224:227], a[8:11], v[176:191]
 ds_read_b64_tr_b16 v[216:217], v242 offset:34816
 ds_read_b64_tr_b16 v[218:219], v242 offset:35840
 s_add_u32 m0, s30, 8192
 s_add_u32 s36, s32, 589824
 buffer_load_dwordx4 v246, s[12:15], s36 offen lds
 v_mul_f32 v250, v144, v144
 v_mul_f32 v251, v145, v145
 v_fma_f32 v250, v250, v248, v249
 v_fma_f32 v251, v251, v248, v249
 v_mfma_f32_32x32x16_bf16 v[192:207], v[228:231], a[8:11], v[192:207]
 ds_read_b64_tr_b16 v[220:221], v243 offset:34816
 ds_read_b64_tr_b16 v[222:223], v243 offset:35840
 v_mul_f32 v250, v250, v144
 v_mul_f32 v251, v251, v145
 v_exp_f32 v250, v250
 v_mfma_f32_32x32x16_bf16 v[176:191], v[232:235], a[12:15], v[176:191]
 ds_read_b64_tr_b16 v[224:225], v242 offset:36864
 ds_read_b64_tr_b16 v[226:227], v242 offset:37888
 v_exp_f32 v251, v251
 v_add_f32 v250, 1.0, v250
 v_add_f32 v251, 1.0, v251
 v_rcp_f32 v250, v250
 v_mfma_f32_32x32x16_bf16 v[192:207], v[236:239], a[12:15], v[192:207]
 ds_read_b64_tr_b16 v[228:229], v243 offset:36864
 ds_read_b64_tr_b16 v[230:231], v243 offset:37888
 v_rcp_f32 v251, v251
 v_mul_f32 v144, v250, v144
 v_mul_f32 v145, v251, v145
 v_cvt_pk_bf16_f32 v32, v144, v145
 s_waitcnt lgkmcnt(4)
 v_mfma_f32_32x32x16_bf16 v[176:191], v[208:211], a[16:19], v[176:191]
 ds_read_b64_tr_b16 v[232:233], v242 offset:38912
 ds_read_b64_tr_b16 v[234:235], v242 offset:39936
 buffer_load_dwordx4 v247, s[12:15], s36 offen offset:1024 lds
 v_mul_f32 v250, v146, v146
 v_mul_f32 v251, v147, v147
 v_fma_f32 v250, v250, v248, v249
 v_mfma_f32_32x32x16_bf16 v[192:207], v[212:215], a[16:19], v[192:207]
 ds_read_b64_tr_b16 v[236:237], v243 offset:38912
 ds_read_b64_tr_b16 v[238:239], v243 offset:39936
 v_fma_f32 v251, v251, v248, v249
 v_mul_f32 v250, v250, v146
 v_mul_f32 v251, v251, v147
 v_mfma_f32_32x32x16_bf16 v[176:191], v[216:219], a[20:23], v[176:191]
 ds_read_b64_tr_b16 v[208:209], v242 offset:40960
 ds_read_b64_tr_b16 v[210:211], v242 offset:41984
 v_exp_f32 v250, v250
 v_exp_f32 v251, v251
 v_add_f32 v250, 1.0, v250
 v_add_f32 v251, 1.0, v251
 v_rcp_f32 v250, v250
 v_mfma_f32_32x32x16_bf16 v[192:207], v[220:223], a[20:23], v[192:207]
 ds_read_b64_tr_b16 v[212:213], v243 offset:40960
 ds_read_b64_tr_b16 v[214:215], v243 offset:41984
 v_rcp_f32 v251, v251
 v_mul_f32 v146, v250, v146
 v_mul_f32 v147, v251, v147
 v_cvt_pk_bf16_f32 v33, v146, v147
 s_waitcnt lgkmcnt(4)
 v_mfma_f32_32x32x16_bf16 v[176:191], v[224:227], a[24:27], v[176:191]
 ds_read_b64_tr_b16 v[216:217], v242 offset:43008
 ds_read_b64_tr_b16 v[218:219], v242 offset:44032
 s_add_u32 m0, s30, 16384
 s_add_u32 s36, s32, 1179648
 buffer_load_dwordx4 v246, s[12:15], s36 offen lds
 v_mul_f32 v250, v148, v148
 v_mul_f32 v251, v149, v149
 v_fma_f32 v250, v250, v248, v249
 v_mfma_f32_32x32x16_bf16 v[192:207], v[228:231], a[24:27], v[192:207]
 ds_read_b64_tr_b16 v[220:221], v243 offset:43008
 ds_read_b64_tr_b16 v[222:223], v243 offset:44032
 v_fma_f32 v251, v251, v248, v249
 v_mul_f32 v250, v250, v148
 v_mul_f32 v251, v251, v149
 v_mfma_f32_32x32x16_bf16 v[176:191], v[232:235], a[28:31], v[176:191]
 ds_read_b64_tr_b16 v[224:225], v242 offset:45056
 ds_read_b64_tr_b16 v[226:227], v242 offset:46080
 v_exp_f32 v250, v250
 v_exp_f32 v251, v251
 v_add_f32 v250, 1.0, v250
 v_add_f32 v251, 1.0, v251
 v_mfma_f32_32x32x16_bf16 v[192:207], v[236:239], a[28:31], v[192:207]
 ds_read_b64_tr_b16 v[228:229], v243 offset:45056
 ds_read_b64_tr_b16 v[230:231], v243 offset:46080
 v_rcp_f32 v250, v250
 v_rcp_f32 v251, v251
 v_mul_f32 v148, v250, v148
 v_mul_f32 v149, v251, v149
 s_waitcnt lgkmcnt(4)
 v_mfma_f32_32x32x16_bf16 v[176:191], v[208:211], a[32:35], v[176:191]
 ds_read_b64_tr_b16 v[232:233], v242 offset:47104
 ds_read_b64_tr_b16 v[234:235], v242 offset:48128
 buffer_load_dwordx4 v247, s[12:15], s36 offen offset:1024 lds
 v_cvt_pk_bf16_f32 v34, v148, v149
 v_mul_f32 v250, v150, v150
 v_mul_f32 v251, v151, v151
 v_mfma_f32_32x32x16_bf16 v[192:207], v[212:215], a[32:35], v[192:207]
 ds_read_b64_tr_b16 v[236:237], v243 offset:47104
 ds_read_b64_tr_b16 v[238:239], v243 offset:48128
 v_fma_f32 v250, v250, v248, v249
 v_fma_f32 v251, v251, v248, v249
 v_mul_f32 v250, v250, v150
 v_mul_f32 v251, v251, v151
 v_mfma_f32_32x32x16_bf16 v[176:191], v[216:219], a[36:39], v[176:191]
 ds_read_b64_tr_b16 v[208:209], v244 offset:0
 ds_read_b64_tr_b16 v[210:211], v244 offset:1024
 v_exp_f32 v250, v250
 v_exp_f32 v251, v251
 v_add_f32 v250, 1.0, v250
 v_add_f32 v251, 1.0, v251
 v_mfma_f32_32x32x16_bf16 v[192:207], v[220:223], a[36:39], v[192:207]
 ds_read_b64_tr_b16 v[212:213], v245 offset:0
 ds_read_b64_tr_b16 v[214:215], v245 offset:1024
 v_rcp_f32 v250, v250
 v_rcp_f32 v251, v251
 v_mul_f32 v150, v250, v150
 v_mul_f32 v151, v251, v151
 s_waitcnt lgkmcnt(4)
 v_mfma_f32_32x32x16_bf16 v[176:191], v[224:227], a[40:43], v[176:191]
 ds_read_b64_tr_b16 v[216:217], v244 offset:2048
 ds_read_b64_tr_b16 v[218:219], v244 offset:3072
 s_add_u32 m0, s30, 24576
 s_add_u32 s36, s32, 1769472
 buffer_load_dwordx4 v246, s[12:15], s36 offen lds
 v_cvt_pk_bf16_f32 v35, v150, v151
 v_mul_f32 v250, v152, v152
 v_mul_f32 v251, v153, v153
 v_mfma_f32_32x32x16_bf16 v[192:207], v[228:231], a[40:43], v[192:207]
 ds_read_b64_tr_b16 v[220:221], v245 offset:2048
 ds_read_b64_tr_b16 v[222:223], v245 offset:3072
 v_fma_f32 v250, v250, v248, v249
 v_fma_f32 v251, v251, v248, v249
 v_mul_f32 v250, v250, v152
 v_mfma_f32_32x32x16_bf16 v[176:191], v[232:235], a[44:47], v[176:191]
 ds_read_b64_tr_b16 v[224:225], v244 offset:4096
 ds_read_b64_tr_b16 v[226:227], v244 offset:5120
 v_mul_f32 v251, v251, v153
 v_exp_f32 v250, v250
 v_exp_f32 v251, v251
 v_add_f32 v250, 1.0, v250
 v_mfma_f32_32x32x16_bf16 v[192:207], v[236:239], a[44:47], v[192:207]
 ds_read_b64_tr_b16 v[228:229], v245 offset:4096
 ds_read_b64_tr_b16 v[230:231], v245 offset:5120
 v_add_f32 v251, 1.0, v251
 v_rcp_f32 v250, v250
 v_rcp_f32 v251, v251
 v_mul_f32 v152, v250, v152
 v_mul_f32 v153, v251, v153
 s_waitcnt lgkmcnt(4)
 v_mfma_f32_32x32x16_bf16 v[176:191], v[208:211], a[48:51], v[176:191]
 ds_read_b64_tr_b16 v[232:233], v244 offset:6144
 ds_read_b64_tr_b16 v[234:235], v244 offset:7168
 buffer_load_dwordx4 v247, s[12:15], s36 offen offset:1024 lds
 v_cvt_pk_bf16_f32 v36, v152, v153
 v_mul_f32 v250, v154, v154
 v_mul_f32 v251, v155, v155
 v_mfma_f32_32x32x16_bf16 v[192:207], v[212:215], a[48:51], v[192:207]
 ds_read_b64_tr_b16 v[236:237], v245 offset:6144
 ds_read_b64_tr_b16 v[238:239], v245 offset:7168
 v_fma_f32 v250, v250, v248, v249
 v_fma_f32 v251, v251, v248, v249
 v_mul_f32 v250, v250, v154
 v_mfma_f32_32x32x16_bf16 v[176:191], v[216:219], a[52:55], v[176:191]
 ds_read_b64_tr_b16 v[208:209], v244 offset:8192
 ds_read_b64_tr_b16 v[210:211], v244 offset:9216
 v_mul_f32 v251, v251, v155
 v_exp_f32 v250, v250
 v_exp_f32 v251, v251
 v_add_f32 v250, 1.0, v250
 v_mfma_f32_32x32x16_bf16 v[192:207], v[220:223], a[52:55], v[192:207]
 ds_read_b64_tr_b16 v[212:213], v245 offset:8192
 ds_read_b64_tr_b16 v[214:215], v245 offset:9216
 v_add_f32 v251, 1.0, v251
 v_rcp_f32 v250, v250
 v_rcp_f32 v251, v251
 v_mul_f32 v154, v250, v154
 s_waitcnt lgkmcnt(4)
 v_mfma_f32_32x32x16_bf16 v[176:191], v[224:227], a[56:59], v[176:191]
 ds_read_b64_tr_b16 v[216:217], v244 offset:10240
 ds_read_b64_tr_b16 v[218:219], v244 offset:11264
 s_add_u32 m0, s30, 32768
 s_add_u32 s36, s32, 2359296
 buffer_load_dwordx4 v246, s[12:15], s36 offen lds
 v_mul_f32 v155, v251, v155
 v_cvt_pk_bf16_f32 v37, v154, v155
 v_mul_f32 v250, v156, v156
 v_mfma_f32_32x32x16_bf16 v[192:207], v[228:231], a[56:59], v[192:207]
 ds_read_b64_tr_b16 v[220:221], v245 offset:10240
 ds_read_b64_tr_b16 v[222:223], v245 offset:11264
 s_waitcnt vmcnt(9)
 s_barrier
 v_mfma_f32_32x32x16_bf16 v[176:191], v[232:235], a[60:63], v[176:191]
 ds_read_b64_tr_b16 v[224:225], v244 offset:12288
 ds_read_b64_tr_b16 v[226:227], v244 offset:13312
 v_mul_f32 v251, v157, v157
 v_fma_f32 v250, v250, v248, v249
 v_fma_f32 v251, v251, v248, v249
 v_mfma_f32_32x32x16_bf16 v[192:207], v[236:239], a[60:63], v[192:207]
 ds_read_b64_tr_b16 v[228:229], v245 offset:12288
 ds_read_b64_tr_b16 v[230:231], v245 offset:13312
 v_mul_f32 v250, v250, v156
 v_mul_f32 v251, v251, v157
 v_exp_f32 v250, v250
 v_exp_f32 v251, v251
 v_add_f32 v250, 1.0, v250
 s_waitcnt lgkmcnt(4)
 v_mfma_f32_32x32x16_bf16 v[176:191], v[208:211], a[64:67], v[176:191]
 ds_read_b64_tr_b16 v[232:233], v244 offset:14336
 ds_read_b64_tr_b16 v[234:235], v244 offset:15360
 buffer_load_dwordx4 v247, s[12:15], s36 offen offset:1024 lds
 v_add_f32 v251, 1.0, v251
 v_rcp_f32 v250, v250
 v_rcp_f32 v251, v251
 v_mul_f32 v156, v250, v156
 v_mfma_f32_32x32x16_bf16 v[192:207], v[212:215], a[64:67], v[192:207]
 ds_read_b64_tr_b16 v[236:237], v245 offset:14336
 ds_read_b64_tr_b16 v[238:239], v245 offset:15360
 v_mul_f32 v157, v251, v157
 v_cvt_pk_bf16_f32 v38, v156, v157
 v_mul_f32 v250, v158, v158
 v_mfma_f32_32x32x16_bf16 v[176:191], v[216:219], a[68:71], v[176:191]
 ds_read_b64_tr_b16 v[208:209], v244 offset:16384
 ds_read_b64_tr_b16 v[210:211], v244 offset:17408
 v_mul_f32 v251, v159, v159
 v_fma_f32 v250, v250, v248, v249
 v_fma_f32 v251, v251, v248, v249
 v_mfma_f32_32x32x16_bf16 v[192:207], v[220:223], a[68:71], v[192:207]
 ds_read_b64_tr_b16 v[212:213], v245 offset:16384
 ds_read_b64_tr_b16 v[214:215], v245 offset:17408
 v_mul_f32 v250, v250, v158
 v_mul_f32 v251, v251, v159
 v_exp_f32 v250, v250
 s_waitcnt lgkmcnt(4)
 v_mfma_f32_32x32x16_bf16 v[176:191], v[224:227], a[72:75], v[176:191]
 ds_read_b64_tr_b16 v[216:217], v244 offset:18432
 ds_read_b64_tr_b16 v[218:219], v244 offset:19456
 s_add_u32 m0, s30, 40960
 s_add_u32 s36, s32, 2949120
 buffer_load_dwordx4 v246, s[12:15], s36 offen lds
 v_exp_f32 v251, v251
 v_add_f32 v250, 1.0, v250
 v_add_f32 v251, 1.0, v251
 v_rcp_f32 v250, v250
 v_mfma_f32_32x32x16_bf16 v[192:207], v[228:231], a[72:75], v[192:207]
 ds_read_b64_tr_b16 v[220:221], v245 offset:18432
 ds_read_b64_tr_b16 v[222:223], v245 offset:19456
 v_rcp_f32 v251, v251
 v_mul_f32 v158, v250, v158
 v_mul_f32 v159, v251, v159
 v_cvt_pk_bf16_f32 v39, v158, v159
 v_mfma_f32_32x32x16_bf16 v[176:191], v[232:235], a[76:79], v[176:191]
 ds_read_b64_tr_b16 v[224:225], v244 offset:20480
 ds_read_b64_tr_b16 v[226:227], v244 offset:21504
 v_mul_f32 v250, v160, v160
 v_mul_f32 v251, v161, v161
 v_fma_f32 v250, v250, v248, v249
 v_fma_f32 v251, v251, v248, v249
 v_mfma_f32_32x32x16_bf16 v[192:207], v[236:239], a[76:79], v[192:207]
 ds_read_b64_tr_b16 v[228:229], v245 offset:20480
 ds_read_b64_tr_b16 v[230:231], v245 offset:21504
 v_mul_f32 v250, v250, v160
 v_mul_f32 v251, v251, v161
 v_exp_f32 v250, v250
 s_waitcnt lgkmcnt(4)
 v_mfma_f32_32x32x16_bf16 v[176:191], v[208:211], a[80:83], v[176:191]
 ds_read_b64_tr_b16 v[232:233], v244 offset:22528
 ds_read_b64_tr_b16 v[234:235], v244 offset:23552
 buffer_load_dwordx4 v247, s[12:15], s36 offen offset:1024 lds
 v_exp_f32 v251, v251
 v_add_f32 v250, 1.0, v250
 v_add_f32 v251, 1.0, v251
 v_rcp_f32 v250, v250
 v_mfma_f32_32x32x16_bf16 v[192:207], v[212:215], a[80:83], v[192:207]
 ds_read_b64_tr_b16 v[236:237], v245 offset:22528
 ds_read_b64_tr_b16 v[238:239], v245 offset:23552
 v_rcp_f32 v251, v251
 v_mul_f32 v160, v250, v160
 v_mul_f32 v161, v251, v161
 v_cvt_pk_bf16_f32 v40, v160, v161
 v_mfma_f32_32x32x16_bf16 v[176:191], v[216:219], a[84:87], v[176:191]
 ds_read_b64_tr_b16 v[208:209], v244 offset:24576
 ds_read_b64_tr_b16 v[210:211], v244 offset:25600
 v_mul_f32 v250, v162, v162
 v_mul_f32 v251, v163, v163
 v_fma_f32 v250, v250, v248, v249
 v_mfma_f32_32x32x16_bf16 v[192:207], v[220:223], a[84:87], v[192:207]
 ds_read_b64_tr_b16 v[212:213], v245 offset:24576
 ds_read_b64_tr_b16 v[214:215], v245 offset:25600
 v_fma_f32 v251, v251, v248, v249
 v_mul_f32 v250, v250, v162
 v_mul_f32 v251, v251, v163
 s_waitcnt lgkmcnt(4)
 v_mfma_f32_32x32x16_bf16 v[176:191], v[224:227], a[88:91], v[176:191]
 ds_read_b64_tr_b16 v[216:217], v244 offset:26624
 ds_read_b64_tr_b16 v[218:219], v244 offset:27648
 s_add_u32 m0, s30, 49152
 s_add_u32 s36, s32, 3538944
 buffer_load_dwordx4 v246, s[12:15], s36 offen lds
 v_exp_f32 v250, v250
 v_exp_f32 v251, v251
 v_add_f32 v250, 1.0, v250
 v_add_f32 v251, 1.0, v251
 v_rcp_f32 v250, v250
 v_mfma_f32_32x32x16_bf16 v[192:207], v[228:231], a[88:91], v[192:207]
 ds_read_b64_tr_b16 v[220:221], v245 offset:26624
 ds_read_b64_tr_b16 v[222:223], v245 offset:27648
 v_rcp_f32 v251, v251
 v_mul_f32 v162, v250, v162
 v_mul_f32 v163, v251, v163
 v_cvt_pk_bf16_f32 v41, v162, v163
 v_mfma_f32_32x32x16_bf16 v[176:191], v[232:235], a[92:95], v[176:191]
 ds_read_b64_tr_b16 v[224:225], v244 offset:28672
 ds_read_b64_tr_b16 v[226:227], v244 offset:29696
 v_mul_f32 v250, v164, v164
 v_mul_f32 v251, v165, v165
 v_fma_f32 v250, v250, v248, v249
 v_mfma_f32_32x32x16_bf16 v[192:207], v[236:239], a[92:95], v[192:207]
 ds_read_b64_tr_b16 v[228:229], v245 offset:28672
 ds_read_b64_tr_b16 v[230:231], v245 offset:29696
 v_fma_f32 v251, v251, v248, v249
 v_mul_f32 v250, v250, v164
 v_mul_f32 v251, v251, v165
 s_waitcnt lgkmcnt(4)
 v_mfma_f32_32x32x16_bf16 v[176:191], v[208:211], a[96:99], v[176:191]
 ds_read_b64_tr_b16 v[232:233], v244 offset:30720
 ds_read_b64_tr_b16 v[234:235], v244 offset:31744
 buffer_load_dwordx4 v247, s[12:15], s36 offen offset:1024 lds
 v_exp_f32 v250, v250
 v_exp_f32 v251, v251
 v_add_f32 v250, 1.0, v250
 v_add_f32 v251, 1.0, v251
 v_mfma_f32_32x32x16_bf16 v[192:207], v[212:215], a[96:99], v[192:207]
 ds_read_b64_tr_b16 v[236:237], v245 offset:30720
 ds_read_b64_tr_b16 v[238:239], v245 offset:31744
 v_rcp_f32 v250, v250
 v_rcp_f32 v251, v251
 v_mul_f32 v164, v250, v164
 v_mul_f32 v165, v251, v165
 v_mfma_f32_32x32x16_bf16 v[176:191], v[216:219], a[100:103], v[176:191]
 ds_read_b64_tr_b16 v[208:209], v244 offset:32768
 ds_read_b64_tr_b16 v[210:211], v244 offset:33792
 v_cvt_pk_bf16_f32 v42, v164, v165
 v_mul_f32 v250, v166, v166
 v_mul_f32 v251, v167, v167
 v_mfma_f32_32x32x16_bf16 v[192:207], v[220:223], a[100:103], v[192:207]
 ds_read_b64_tr_b16 v[212:213], v245 offset:32768
 ds_read_b64_tr_b16 v[214:215], v245 offset:33792
 v_fma_f32 v250, v250, v248, v249
 v_fma_f32 v251, v251, v248, v249
 v_mul_f32 v250, v250, v166
 v_mul_f32 v251, v251, v167
 s_waitcnt lgkmcnt(4)
 v_mfma_f32_32x32x16_bf16 v[176:191], v[224:227], a[104:107], v[176:191]
 ds_read_b64_tr_b16 v[216:217], v244 offset:34816
 ds_read_b64_tr_b16 v[218:219], v244 offset:35840
 s_add_u32 m0, s30, 57344
 s_add_u32 s36, s32, 4128768
 buffer_load_dwordx4 v246, s[12:15], s36 offen lds
 v_exp_f32 v250, v250
 v_exp_f32 v251, v251
 v_add_f32 v250, 1.0, v250
 v_add_f32 v251, 1.0, v251
 v_mfma_f32_32x32x16_bf16 v[192:207], v[228:231], a[104:107], v[192:207]
 ds_read_b64_tr_b16 v[220:221], v245 offset:34816
 ds_read_b64_tr_b16 v[222:223], v245 offset:35840
 v_rcp_f32 v250, v250
 v_rcp_f32 v251, v251
 v_mul_f32 v166, v250, v166
 v_mul_f32 v167, v251, v167
 v_mfma_f32_32x32x16_bf16 v[176:191], v[232:235], a[108:111], v[176:191]
 ds_read_b64_tr_b16 v[224:225], v244 offset:36864
 ds_read_b64_tr_b16 v[226:227], v244 offset:37888
 v_cvt_pk_bf16_f32 v43, v166, v167
 v_mul_f32 v250, v168, v168
 v_mul_f32 v251, v169, v169
 v_mfma_f32_32x32x16_bf16 v[192:207], v[236:239], a[108:111], v[192:207]
 ds_read_b64_tr_b16 v[228:229], v245 offset:36864
 ds_read_b64_tr_b16 v[230:231], v245 offset:37888
 v_fma_f32 v250, v250, v248, v249
 v_fma_f32 v251, v251, v248, v249
 v_mul_f32 v250, v250, v168
 s_waitcnt lgkmcnt(4)
 v_mfma_f32_32x32x16_bf16 v[176:191], v[208:211], a[112:115], v[176:191]
 ds_read_b64_tr_b16 v[232:233], v244 offset:38912
 ds_read_b64_tr_b16 v[234:235], v244 offset:39936
 buffer_load_dwordx4 v247, s[12:15], s36 offen offset:1024 lds
 v_mul_f32 v251, v251, v169
 v_exp_f32 v250, v250
 v_exp_f32 v251, v251
 v_add_f32 v250, 1.0, v250
 v_mfma_f32_32x32x16_bf16 v[192:207], v[212:215], a[112:115], v[192:207]
 ds_read_b64_tr_b16 v[236:237], v245 offset:38912
 ds_read_b64_tr_b16 v[238:239], v245 offset:39936
 v_add_f32 v251, 1.0, v251
 v_rcp_f32 v250, v250
 v_rcp_f32 v251, v251
 v_mul_f32 v168, v250, v168
 v_mul_f32 v169, v251, v169
 v_mfma_f32_32x32x16_bf16 v[176:191], v[216:219], a[116:119], v[176:191]
 ds_read_b64_tr_b16 v[208:209], v244 offset:40960
 ds_read_b64_tr_b16 v[210:211], v244 offset:41984
 v_cvt_pk_bf16_f32 v44, v168, v169
 v_mul_f32 v250, v170, v170
 v_mul_f32 v251, v171, v171
 v_mfma_f32_32x32x16_bf16 v[192:207], v[220:223], a[116:119], v[192:207]
 ds_read_b64_tr_b16 v[212:213], v245 offset:40960
 ds_read_b64_tr_b16 v[214:215], v245 offset:41984
 v_fma_f32 v250, v250, v248, v249
 v_fma_f32 v251, v251, v248, v249
 v_mul_f32 v250, v250, v170
 s_waitcnt lgkmcnt(4)
 v_mfma_f32_32x32x16_bf16 v[176:191], v[224:227], a[120:123], v[176:191]
 ds_read_b64_tr_b16 v[216:217], v244 offset:43008
 ds_read_b64_tr_b16 v[218:219], v244 offset:44032
 s_add_u32 m0, s30, 65536
 s_add_u32 s36, s32, 4718592
 buffer_load_dwordx4 v246, s[12:15], s36 offen lds
 v_mul_f32 v251, v251, v171
 v_exp_f32 v250, v250
 v_exp_f32 v251, v251
 v_add_f32 v250, 1.0, v250
 v_mfma_f32_32x32x16_bf16 v[192:207], v[228:231], a[120:123], v[192:207]
 ds_read_b64_tr_b16 v[220:221], v245 offset:43008
 ds_read_b64_tr_b16 v[222:223], v245 offset:44032
 v_add_f32 v251, 1.0, v251
 v_rcp_f32 v250, v250
 v_rcp_f32 v251, v251
 v_mul_f32 v170, v250, v170
 v_mfma_f32_32x32x16_bf16 v[176:191], v[232:235], a[124:127], v[176:191]
 ds_read_b64_tr_b16 v[224:225], v244 offset:45056
 ds_read_b64_tr_b16 v[226:227], v244 offset:46080
 v_mul_f32 v171, v251, v171
 v_cvt_pk_bf16_f32 v45, v170, v171
 v_mul_f32 v250, v172, v172
 v_mfma_f32_32x32x16_bf16 v[192:207], v[236:239], a[124:127], v[192:207]
 ds_read_b64_tr_b16 v[228:229], v245 offset:45056
 ds_read_b64_tr_b16 v[230:231], v245 offset:46080
 v_mul_f32 v251, v173, v173
 v_fma_f32 v250, v250, v248, v249
 v_fma_f32 v251, v251, v248, v249
 s_waitcnt lgkmcnt(4)
 v_mfma_f32_32x32x16_bf16 v[176:191], v[208:211], a[128:131], v[176:191]
 ds_read_b64_tr_b16 v[232:233], v244 offset:47104
 ds_read_b64_tr_b16 v[234:235], v244 offset:48128
 buffer_load_dwordx4 v247, s[12:15], s36 offen offset:1024 lds
 v_mul_f32 v250, v250, v172
 v_mul_f32 v251, v251, v173
 v_exp_f32 v250, v250
 v_exp_f32 v251, v251
 v_add_f32 v250, 1.0, v250
 v_mfma_f32_32x32x16_bf16 v[192:207], v[212:215], a[128:131], v[192:207]
 ds_read_b64_tr_b16 v[236:237], v245 offset:47104
 ds_read_b64_tr_b16 v[238:239], v245 offset:48128
 s_waitcnt vmcnt(8)
 s_barrier
 v_mfma_f32_32x32x16_bf16 v[176:191], v[216:219], a[132:135], v[176:191]
 ds_read_b64_tr_b16 v[208:209], v240 offset:0
 ds_read_b64_tr_b16 v[210:211], v240 offset:1024
 v_add_f32 v251, 1.0, v251
 v_rcp_f32 v250, v250
 v_rcp_f32 v251, v251
 v_mul_f32 v172, v250, v172
 v_mfma_f32_32x32x16_bf16 v[192:207], v[220:223], a[132:135], v[192:207]
 ds_read_b64_tr_b16 v[212:213], v241 offset:0
 ds_read_b64_tr_b16 v[214:215], v241 offset:1024
 v_mul_f32 v173, v251, v173
 v_cvt_pk_bf16_f32 v46, v172, v173
 v_mul_f32 v250, v174, v174
 s_waitcnt lgkmcnt(4)
 v_mfma_f32_32x32x16_bf16 v[176:191], v[224:227], a[136:139], v[176:191]
 ds_read_b64_tr_b16 v[216:217], v240 offset:2048
 ds_read_b64_tr_b16 v[218:219], v240 offset:3072
 s_add_u32 m0, s30, 73728
 s_add_u32 s32, s32, 128
 s_cmp_ge_u32 s32, s39
 s_cselect_b32 s3, 1152, 0
 s_sub_u32 s32, s32, s3
 s_add_u32 s36, s32, 0
 buffer_load_dwordx4 v246, s[12:15], s36 offen lds
 v_mul_f32 v251, v175, v175
 v_fma_f32 v250, v250, v248, v249
 v_fma_f32 v251, v251, v248, v249
 v_mfma_f32_32x32x16_bf16 v[192:207], v[228:231], a[136:139], v[192:207]
 ds_read_b64_tr_b16 v[220:221], v241 offset:2048
 ds_read_b64_tr_b16 v[222:223], v241 offset:3072
 v_mul_f32 v250, v250, v174
 v_mul_f32 v251, v251, v175
 v_exp_f32 v250, v250
 v_mfma_f32_32x32x16_bf16 v[176:191], v[232:235], a[140:143], v[176:191]
 ds_read_b64_tr_b16 v[224:225], v240 offset:4096
 ds_read_b64_tr_b16 v[226:227], v240 offset:5120
 v_exp_f32 v251, v251
 v_add_f32 v250, 1.0, v250
 v_add_f32 v251, 1.0, v251
 v_rcp_f32 v250, v250
 v_mfma_f32_32x32x16_bf16 v[192:207], v[236:239], a[140:143], v[192:207]
 ds_read_b64_tr_b16 v[228:229], v241 offset:4096
 ds_read_b64_tr_b16 v[230:231], v241 offset:5120
 v_rcp_f32 v251, v251
 v_mul_f32 v174, v250, v174
 v_mul_f32 v175, v251, v175
 v_cvt_pk_bf16_f32 v47, v174, v175
 s_waitcnt lgkmcnt(4)
 v_mfma_f32_32x32x16_bf16 v[144:159], v[208:211], a[0:3], 0
 ds_read_b64_tr_b16 v[232:233], v240 offset:6144
 ds_read_b64_tr_b16 v[234:235], v240 offset:7168
 buffer_load_dwordx4 v247, s[12:15], s36 offen offset:1024 lds
 v_mfma_f32_32x32x16_bf16 v[160:175], v[212:215], a[0:3], 0
 ds_read_b64_tr_b16 v[236:237], v241 offset:6144
 ds_read_b64_tr_b16 v[238:239], v241 offset:7168
 v_mfma_f32_32x32x16_bf16 v[144:159], v[216:219], a[4:7], v[144:159]
 ds_read_b64_tr_b16 v[208:209], v240 offset:8192
 ds_read_b64_tr_b16 v[210:211], v240 offset:9216
 v_mfma_f32_32x32x16_bf16 v[160:175], v[220:223], a[4:7], v[160:175]
 ds_read_b64_tr_b16 v[212:213], v241 offset:8192
 ds_read_b64_tr_b16 v[214:215], v241 offset:9216
 s_waitcnt lgkmcnt(4)
 v_mfma_f32_32x32x16_bf16 v[144:159], v[224:227], a[8:11], v[144:159]
 ds_read_b64_tr_b16 v[216:217], v240 offset:10240
 ds_read_b64_tr_b16 v[218:219], v240 offset:11264
 s_add_u32 m0, s30, 81920
 s_add_u32 s36, s32, 589824
 buffer_load_dwordx4 v246, s[12:15], s36 offen lds
 v_mul_f32 v250, v176, v176
 v_mul_f32 v251, v177, v177
 v_fma_f32 v250, v250, v248, v249
 v_fma_f32 v251, v251, v248, v249
 v_mfma_f32_32x32x16_bf16 v[160:175], v[228:231], a[8:11], v[160:175]
 ds_read_b64_tr_b16 v[220:221], v241 offset:10240
 ds_read_b64_tr_b16 v[222:223], v241 offset:11264
 v_mul_f32 v250, v250, v176
 v_mul_f32 v251, v251, v177
 v_exp_f32 v250, v250
 v_mfma_f32_32x32x16_bf16 v[144:159], v[232:235], a[12:15], v[144:159]
 ds_read_b64_tr_b16 v[224:225], v240 offset:12288
 ds_read_b64_tr_b16 v[226:227], v240 offset:13312
 v_exp_f32 v251, v251
 v_add_f32 v250, 1.0, v250
 v_add_f32 v251, 1.0, v251
 v_rcp_f32 v250, v250
 v_mfma_f32_32x32x16_bf16 v[160:175], v[236:239], a[12:15], v[160:175]
 ds_read_b64_tr_b16 v[228:229], v241 offset:12288
 ds_read_b64_tr_b16 v[230:231], v241 offset:13312
 v_rcp_f32 v251, v251
 v_mul_f32 v176, v250, v176
 v_mul_f32 v177, v251, v177
 v_cvt_pk_bf16_f32 v48, v176, v177
 s_waitcnt lgkmcnt(4)
 v_mfma_f32_32x32x16_bf16 v[144:159], v[208:211], a[16:19], v[144:159]
 ds_read_b64_tr_b16 v[232:233], v240 offset:14336
 ds_read_b64_tr_b16 v[234:235], v240 offset:15360
 buffer_load_dwordx4 v247, s[12:15], s36 offen offset:1024 lds
 v_mul_f32 v250, v178, v178
 v_mul_f32 v251, v179, v179
 v_fma_f32 v250, v250, v248, v249
 v_mfma_f32_32x32x16_bf16 v[160:175], v[212:215], a[16:19], v[160:175]
 ds_read_b64_tr_b16 v[236:237], v241 offset:14336
 ds_read_b64_tr_b16 v[238:239], v241 offset:15360
 v_fma_f32 v251, v251, v248, v249
 v_mul_f32 v250, v250, v178
 v_mul_f32 v251, v251, v179
 v_mfma_f32_32x32x16_bf16 v[144:159], v[216:219], a[20:23], v[144:159]
 ds_read_b64_tr_b16 v[208:209], v240 offset:16384
 ds_read_b64_tr_b16 v[210:211], v240 offset:17408
 v_exp_f32 v250, v250
 v_exp_f32 v251, v251
 v_add_f32 v250, 1.0, v250
 v_add_f32 v251, 1.0, v251
 v_rcp_f32 v250, v250
 v_mfma_f32_32x32x16_bf16 v[160:175], v[220:223], a[20:23], v[160:175]
 ds_read_b64_tr_b16 v[212:213], v241 offset:16384
 ds_read_b64_tr_b16 v[214:215], v241 offset:17408
 v_rcp_f32 v251, v251
 v_mul_f32 v178, v250, v178
 v_mul_f32 v179, v251, v179
 v_cvt_pk_bf16_f32 v49, v178, v179
 s_waitcnt lgkmcnt(4)
 v_mfma_f32_32x32x16_bf16 v[144:159], v[224:227], a[24:27], v[144:159]
 ds_read_b64_tr_b16 v[216:217], v240 offset:18432
 ds_read_b64_tr_b16 v[218:219], v240 offset:19456
 s_add_u32 m0, s30, 90112
 s_add_u32 s36, s32, 1179648
 buffer_load_dwordx4 v246, s[12:15], s36 offen lds
 v_mul_f32 v250, v180, v180
 v_mul_f32 v251, v181, v181
 v_fma_f32 v250, v250, v248, v249
 v_mfma_f32_32x32x16_bf16 v[160:175], v[228:231], a[24:27], v[160:175]
 ds_read_b64_tr_b16 v[220:221], v241 offset:18432
 ds_read_b64_tr_b16 v[222:223], v241 offset:19456
 v_fma_f32 v251, v251, v248, v249
 v_mul_f32 v250, v250, v180
 v_mul_f32 v251, v251, v181
 v_mfma_f32_32x32x16_bf16 v[144:159], v[232:235], a[28:31], v[144:159]
 ds_read_b64_tr_b16 v[224:225], v240 offset:20480
 ds_read_b64_tr_b16 v[226:227], v240 offset:21504
 v_exp_f32 v250, v250
 v_exp_f32 v251, v251
 v_add_f32 v250, 1.0, v250
 v_add_f32 v251, 1.0, v251
 v_mfma_f32_32x32x16_bf16 v[160:175], v[236:239], a[28:31], v[160:175]
 ds_read_b64_tr_b16 v[228:229], v241 offset:20480
 ds_read_b64_tr_b16 v[230:231], v241 offset:21504
 v_rcp_f32 v250, v250
 v_rcp_f32 v251, v251
 v_mul_f32 v180, v250, v180
 v_mul_f32 v181, v251, v181
 s_waitcnt lgkmcnt(4)
 v_mfma_f32_32x32x16_bf16 v[144:159], v[208:211], a[32:35], v[144:159]
 ds_read_b64_tr_b16 v[232:233], v240 offset:22528
 ds_read_b64_tr_b16 v[234:235], v240 offset:23552
 buffer_load_dwordx4 v247, s[12:15], s36 offen offset:1024 lds
 v_cvt_pk_bf16_f32 v50, v180, v181
 v_mul_f32 v250, v182, v182
 v_mul_f32 v251, v183, v183
 v_mfma_f32_32x32x16_bf16 v[160:175], v[212:215], a[32:35], v[160:175]
 ds_read_b64_tr_b16 v[236:237], v241 offset:22528
 ds_read_b64_tr_b16 v[238:239], v241 offset:23552
 v_fma_f32 v250, v250, v248, v249
 v_fma_f32 v251, v251, v248, v249
 v_mul_f32 v250, v250, v182
 v_mul_f32 v251, v251, v183
 v_mfma_f32_32x32x16_bf16 v[144:159], v[216:219], a[36:39], v[144:159]
 ds_read_b64_tr_b16 v[208:209], v240 offset:24576
 ds_read_b64_tr_b16 v[210:211], v240 offset:25600
 v_exp_f32 v250, v250
 v_exp_f32 v251, v251
 v_add_f32 v250, 1.0, v250
 v_add_f32 v251, 1.0, v251
 v_mfma_f32_32x32x16_bf16 v[160:175], v[220:223], a[36:39], v[160:175]
 ds_read_b64_tr_b16 v[212:213], v241 offset:24576
 ds_read_b64_tr_b16 v[214:215], v241 offset:25600
 v_rcp_f32 v250, v250
 v_rcp_f32 v251, v251
 v_mul_f32 v182, v250, v182
 v_mul_f32 v183, v251, v183
 s_waitcnt lgkmcnt(4)
 v_mfma_f32_32x32x16_bf16 v[144:159], v[224:227], a[40:43], v[144:159]
 ds_read_b64_tr_b16 v[216:217], v240 offset:26624
 ds_read_b64_tr_b16 v[218:219], v240 offset:27648
 s_add_u32 m0, s30, 98304
 s_add_u32 s36, s32, 1769472
 buffer_load_dwordx4 v246, s[12:15], s36 offen lds
 v_cvt_pk_bf16_f32 v51, v182, v183
 v_mul_f32 v250, v184, v184
 v_mul_f32 v251, v185, v185
 v_mfma_f32_32x32x16_bf16 v[160:175], v[228:231], a[40:43], v[160:175]
 ds_read_b64_tr_b16 v[220:221], v241 offset:26624
 ds_read_b64_tr_b16 v[222:223], v241 offset:27648
 v_fma_f32 v250, v250, v248, v249
 v_fma_f32 v251, v251, v248, v249
 v_mul_f32 v250, v250, v184
 v_mfma_f32_32x32x16_bf16 v[144:159], v[232:235], a[44:47], v[144:159]
 ds_read_b64_tr_b16 v[224:225], v240 offset:28672
 ds_read_b64_tr_b16 v[226:227], v240 offset:29696
 v_mul_f32 v251, v251, v185
 v_exp_f32 v250, v250
 v_exp_f32 v251, v251
 v_add_f32 v250, 1.0, v250
 v_mfma_f32_32x32x16_bf16 v[160:175], v[236:239], a[44:47], v[160:175]
 ds_read_b64_tr_b16 v[228:229], v241 offset:28672
 ds_read_b64_tr_b16 v[230:231], v241 offset:29696
 v_add_f32 v251, 1.0, v251
 v_rcp_f32 v250, v250
 v_rcp_f32 v251, v251
 v_mul_f32 v184, v250, v184
 v_mul_f32 v185, v251, v185
 s_waitcnt lgkmcnt(4)
 v_mfma_f32_32x32x16_bf16 v[144:159], v[208:211], a[48:51], v[144:159]
 ds_read_b64_tr_b16 v[232:233], v240 offset:30720
 ds_read_b64_tr_b16 v[234:235], v240 offset:31744
 buffer_load_dwordx4 v247, s[12:15], s36 offen offset:1024 lds
 v_cvt_pk_bf16_f32 v52, v184, v185
 v_mul_f32 v250, v186, v186
 v_mul_f32 v251, v187, v187
 v_mfma_f32_32x32x16_bf16 v[160:175], v[212:215], a[48:51], v[160:175]
 ds_read_b64_tr_b16 v[236:237], v241 offset:30720
 ds_read_b64_tr_b16 v[238:239], v241 offset:31744
 v_fma_f32 v250, v250, v248, v249
 v_fma_f32 v251, v251, v248, v249
 v_mul_f32 v250, v250, v186
 v_mfma_f32_32x32x16_bf16 v[144:159], v[216:219], a[52:55], v[144:159]
 ds_read_b64_tr_b16 v[208:209], v240 offset:32768
 ds_read_b64_tr_b16 v[210:211], v240 offset:33792
 v_mul_f32 v251, v251, v187
 v_exp_f32 v250, v250
 v_exp_f32 v251, v251
 v_add_f32 v250, 1.0, v250
 v_mfma_f32_32x32x16_bf16 v[160:175], v[220:223], a[52:55], v[160:175]
 ds_read_b64_tr_b16 v[212:213], v241 offset:32768
 ds_read_b64_tr_b16 v[214:215], v241 offset:33792
 v_add_f32 v251, 1.0, v251
 v_rcp_f32 v250, v250
 v_rcp_f32 v251, v251
 v_mul_f32 v186, v250, v186
 s_waitcnt lgkmcnt(4)
 v_mfma_f32_32x32x16_bf16 v[144:159], v[224:227], a[56:59], v[144:159]
 ds_read_b64_tr_b16 v[216:217], v240 offset:34816
 ds_read_b64_tr_b16 v[218:219], v240 offset:35840
 s_add_u32 m0, s30, 106496
 s_add_u32 s36, s32, 2359296
 buffer_load_dwordx4 v246, s[12:15], s36 offen lds
 v_mul_f32 v187, v251, v187
 v_cvt_pk_bf16_f32 v53, v186, v187
 v_mul_f32 v250, v188, v188
 v_mfma_f32_32x32x16_bf16 v[160:175], v[228:231], a[56:59], v[160:175]
 ds_read_b64_tr_b16 v[220:221], v241 offset:34816
 ds_read_b64_tr_b16 v[222:223], v241 offset:35840
 s_waitcnt vmcnt(9)
 s_barrier
 v_mfma_f32_32x32x16_bf16 v[144:159], v[232:235], a[60:63], v[144:159]
 ds_read_b64_tr_b16 v[224:225], v240 offset:36864
 ds_read_b64_tr_b16 v[226:227], v240 offset:37888
 v_mul_f32 v251, v189, v189
 v_fma_f32 v250, v250, v248, v249
 v_fma_f32 v251, v251, v248, v249
 v_mfma_f32_32x32x16_bf16 v[160:175], v[236:239], a[60:63], v[160:175]
 ds_read_b64_tr_b16 v[228:229], v241 offset:36864
 ds_read_b64_tr_b16 v[230:231], v241 offset:37888
 v_mul_f32 v250, v250, v188
 v_mul_f32 v251, v251, v189
 v_exp_f32 v250, v250
 v_exp_f32 v251, v251
 v_add_f32 v250, 1.0, v250
 s_waitcnt lgkmcnt(4)
 v_mfma_f32_32x32x16_bf16 v[144:159], v[208:211], a[64:67], v[144:159]
 ds_read_b64_tr_b16 v[232:233], v240 offset:38912
 ds_read_b64_tr_b16 v[234:235], v240 offset:39936
 buffer_load_dwordx4 v247, s[12:15], s36 offen offset:1024 lds
 v_add_f32 v251, 1.0, v251
 v_rcp_f32 v250, v250
 v_rcp_f32 v251, v251
 v_mul_f32 v188, v250, v188
 v_mfma_f32_32x32x16_bf16 v[160:175], v[212:215], a[64:67], v[160:175]
 ds_read_b64_tr_b16 v[236:237], v241 offset:38912
 ds_read_b64_tr_b16 v[238:239], v241 offset:39936
 v_mul_f32 v189, v251, v189
 v_cvt_pk_bf16_f32 v54, v188, v189
 v_mul_f32 v250, v190, v190
 v_mfma_f32_32x32x16_bf16 v[144:159], v[216:219], a[68:71], v[144:159]
 ds_read_b64_tr_b16 v[208:209], v240 offset:40960
 ds_read_b64_tr_b16 v[210:211], v240 offset:41984
 v_mul_f32 v251, v191, v191
 v_fma_f32 v250, v250, v248, v249
 v_fma_f32 v251, v251, v248, v249
 v_mfma_f32_32x32x16_bf16 v[160:175], v[220:223], a[68:71], v[160:175]
 ds_read_b64_tr_b16 v[212:213], v241 offset:40960
 ds_read_b64_tr_b16 v[214:215], v241 offset:41984
 v_mul_f32 v250, v250, v190
 v_mul_f32 v251, v251, v191
 v_exp_f32 v250, v250
 s_waitcnt lgkmcnt(4)
 v_mfma_f32_32x32x16_bf16 v[144:159], v[224:227], a[72:75], v[144:159]
 ds_read_b64_tr_b16 v[216:217], v240 offset:43008
 ds_read_b64_tr_b16 v[218:219], v240 offset:44032
 s_add_u32 m0, s30, 114688
 s_add_u32 s36, s32, 2949120
 buffer_load_dwordx4 v246, s[12:15], s36 offen lds
 v_exp_f32 v251, v251
 v_add_f32 v250, 1.0, v250
 v_add_f32 v251, 1.0, v251
 v_rcp_f32 v250, v250
 v_mfma_f32_32x32x16_bf16 v[160:175], v[228:231], a[72:75], v[160:175]
 ds_read_b64_tr_b16 v[220:221], v241 offset:43008
 ds_read_b64_tr_b16 v[222:223], v241 offset:44032
 v_rcp_f32 v251, v251
 v_mul_f32 v190, v250, v190
 v_mul_f32 v191, v251, v191
 v_cvt_pk_bf16_f32 v55, v190, v191
 v_mfma_f32_32x32x16_bf16 v[144:159], v[232:235], a[76:79], v[144:159]
 ds_read_b64_tr_b16 v[224:225], v240 offset:45056
 ds_read_b64_tr_b16 v[226:227], v240 offset:46080
 v_mul_f32 v250, v192, v192
 v_mul_f32 v251, v193, v193
 v_fma_f32 v250, v250, v248, v249
 v_fma_f32 v251, v251, v248, v249
 v_mfma_f32_32x32x16_bf16 v[160:175], v[236:239], a[76:79], v[160:175]
 ds_read_b64_tr_b16 v[228:229], v241 offset:45056
 ds_read_b64_tr_b16 v[230:231], v241 offset:46080
 v_mul_f32 v250, v250, v192
 v_mul_f32 v251, v251, v193
 v_exp_f32 v250, v250
 s_waitcnt lgkmcnt(4)
 v_mfma_f32_32x32x16_bf16 v[144:159], v[208:211], a[80:83], v[144:159]
 ds_read_b64_tr_b16 v[232:233], v240 offset:47104
 ds_read_b64_tr_b16 v[234:235], v240 offset:48128
 buffer_load_dwordx4 v247, s[12:15], s36 offen offset:1024 lds
 v_exp_f32 v251, v251
 v_add_f32 v250, 1.0, v250
 v_add_f32 v251, 1.0, v251
 v_rcp_f32 v250, v250
 v_mfma_f32_32x32x16_bf16 v[160:175], v[212:215], a[80:83], v[160:175]
 ds_read_b64_tr_b16 v[236:237], v241 offset:47104
 ds_read_b64_tr_b16 v[238:239], v241 offset:48128
 v_rcp_f32 v251, v251
 v_mul_f32 v192, v250, v192
 v_mul_f32 v193, v251, v193
 v_cvt_pk_bf16_f32 v56, v192, v193
 v_mfma_f32_32x32x16_bf16 v[144:159], v[216:219], a[84:87], v[144:159]
 ds_read_b64_tr_b16 v[208:209], v242 offset:0
 ds_read_b64_tr_b16 v[210:211], v242 offset:1024
 v_mul_f32 v250, v194, v194
 v_mul_f32 v251, v195, v195
 v_fma_f32 v250, v250, v248, v249
 v_mfma_f32_32x32x16_bf16 v[160:175], v[220:223], a[84:87], v[160:175]
 ds_read_b64_tr_b16 v[212:213], v243 offset:0
 ds_read_b64_tr_b16 v[214:215], v243 offset:1024
 v_fma_f32 v251, v251, v248, v249
 v_mul_f32 v250, v250, v194
 v_mul_f32 v251, v251, v195
 s_waitcnt lgkmcnt(4)
 v_mfma_f32_32x32x16_bf16 v[144:159], v[224:227], a[88:91], v[144:159]
 ds_read_b64_tr_b16 v[216:217], v242 offset:2048
 ds_read_b64_tr_b16 v[218:219], v242 offset:3072
 s_add_u32 m0, s30, 122880
 s_add_u32 s36, s32, 3538944
 buffer_load_dwordx4 v246, s[12:15], s36 offen lds
 v_exp_f32 v250, v250
 v_exp_f32 v251, v251
 v_add_f32 v250, 1.0, v250
 v_add_f32 v251, 1.0, v251
 v_rcp_f32 v250, v250
 v_mfma_f32_32x32x16_bf16 v[160:175], v[228:231], a[88:91], v[160:175]
 ds_read_b64_tr_b16 v[220:221], v243 offset:2048
 ds_read_b64_tr_b16 v[222:223], v243 offset:3072
 v_rcp_f32 v251, v251
 v_mul_f32 v194, v250, v194
 v_mul_f32 v195, v251, v195
 v_cvt_pk_bf16_f32 v57, v194, v195
 v_mfma_f32_32x32x16_bf16 v[144:159], v[232:235], a[92:95], v[144:159]
 ds_read_b64_tr_b16 v[224:225], v242 offset:4096
 ds_read_b64_tr_b16 v[226:227], v242 offset:5120
 v_mul_f32 v250, v196, v196
 v_mul_f32 v251, v197, v197
 v_fma_f32 v250, v250, v248, v249
 v_mfma_f32_32x32x16_bf16 v[160:175], v[236:239], a[92:95], v[160:175]
 ds_read_b64_tr_b16 v[228:229], v243 offset:4096
 ds_read_b64_tr_b16 v[230:231], v243 offset:5120
 v_fma_f32 v251, v251, v248, v249
 v_mul_f32 v250, v250, v196
 v_mul_f32 v251, v251, v197
 s_waitcnt lgkmcnt(4)
 v_mfma_f32_32x32x16_bf16 v[144:159], v[208:211], a[96:99], v[144:159]
 ds_read_b64_tr_b16 v[232:233], v242 offset:6144
 ds_read_b64_tr_b16 v[234:235], v242 offset:7168
 buffer_load_dwordx4 v247, s[12:15], s36 offen offset:1024 lds
 v_exp_f32 v250, v250
 v_exp_f32 v251, v251
 v_add_f32 v250, 1.0, v250
 v_add_f32 v251, 1.0, v251
 v_mfma_f32_32x32x16_bf16 v[160:175], v[212:215], a[96:99], v[160:175]
 ds_read_b64_tr_b16 v[236:237], v243 offset:6144
 ds_read_b64_tr_b16 v[238:239], v243 offset:7168
 v_rcp_f32 v250, v250
 v_rcp_f32 v251, v251
 v_mul_f32 v196, v250, v196
 v_mul_f32 v197, v251, v197
 v_mfma_f32_32x32x16_bf16 v[144:159], v[216:219], a[100:103], v[144:159]
 ds_read_b64_tr_b16 v[208:209], v242 offset:8192
 ds_read_b64_tr_b16 v[210:211], v242 offset:9216
 v_cvt_pk_bf16_f32 v58, v196, v197
 v_mul_f32 v250, v198, v198
 v_mul_f32 v251, v199, v199
 v_mfma_f32_32x32x16_bf16 v[160:175], v[220:223], a[100:103], v[160:175]
 ds_read_b64_tr_b16 v[212:213], v243 offset:8192
 ds_read_b64_tr_b16 v[214:215], v243 offset:9216
 v_fma_f32 v250, v250, v248, v249
 v_fma_f32 v251, v251, v248, v249
 v_mul_f32 v250, v250, v198
 v_mul_f32 v251, v251, v199
 s_waitcnt lgkmcnt(4)
 v_mfma_f32_32x32x16_bf16 v[144:159], v[224:227], a[104:107], v[144:159]
 ds_read_b64_tr_b16 v[216:217], v242 offset:10240
 ds_read_b64_tr_b16 v[218:219], v242 offset:11264
 s_add_u32 m0, s30, 131072
 s_add_u32 s36, s32, 4128768
 buffer_load_dwordx4 v246, s[12:15], s36 offen lds
 v_exp_f32 v250, v250
 v_exp_f32 v251, v251
 v_add_f32 v250, 1.0, v250
 v_add_f32 v251, 1.0, v251
 v_mfma_f32_32x32x16_bf16 v[160:175], v[228:231], a[104:107], v[160:175]
 ds_read_b64_tr_b16 v[220:221], v243 offset:10240
 ds_read_b64_tr_b16 v[222:223], v243 offset:11264
 v_rcp_f32 v250, v250
 v_rcp_f32 v251, v251
 v_mul_f32 v198, v250, v198
 v_mul_f32 v199, v251, v199
 v_mfma_f32_32x32x16_bf16 v[144:159], v[232:235], a[108:111], v[144:159]
 ds_read_b64_tr_b16 v[224:225], v242 offset:12288
 ds_read_b64_tr_b16 v[226:227], v242 offset:13312
 v_cvt_pk_bf16_f32 v59, v198, v199
 v_mul_f32 v250, v200, v200
 v_mul_f32 v251, v201, v201
 v_mfma_f32_32x32x16_bf16 v[160:175], v[236:239], a[108:111], v[160:175]
 ds_read_b64_tr_b16 v[228:229], v243 offset:12288
 ds_read_b64_tr_b16 v[230:231], v243 offset:13312
 v_fma_f32 v250, v250, v248, v249
 v_fma_f32 v251, v251, v248, v249
 v_mul_f32 v250, v250, v200
 s_waitcnt lgkmcnt(4)
 v_mfma_f32_32x32x16_bf16 v[144:159], v[208:211], a[112:115], v[144:159]
 ds_read_b64_tr_b16 v[232:233], v242 offset:14336
 ds_read_b64_tr_b16 v[234:235], v242 offset:15360
 buffer_load_dwordx4 v247, s[12:15], s36 offen offset:1024 lds
 v_mul_f32 v251, v251, v201
 v_exp_f32 v250, v250
 v_exp_f32 v251, v251
 v_add_f32 v250, 1.0, v250
 v_mfma_f32_32x32x16_bf16 v[160:175], v[212:215], a[112:115], v[160:175]
 ds_read_b64_tr_b16 v[236:237], v243 offset:14336
 ds_read_b64_tr_b16 v[238:239], v243 offset:15360
 v_add_f32 v251, 1.0, v251
 v_rcp_f32 v250, v250
 v_rcp_f32 v251, v251
 v_mul_f32 v200, v250, v200
 v_mul_f32 v201, v251, v201
 v_mfma_f32_32x32x16_bf16 v[144:159], v[216:219], a[116:119], v[144:159]
 ds_read_b64_tr_b16 v[208:209], v242 offset:16384
 ds_read_b64_tr_b16 v[210:211], v242 offset:17408
 v_cvt_pk_bf16_f32 v60, v200, v201
 v_mul_f32 v250, v202, v202
 v_mul_f32 v251, v203, v203
 v_mfma_f32_32x32x16_bf16 v[160:175], v[220:223], a[116:119], v[160:175]
 ds_read_b64_tr_b16 v[212:213], v243 offset:16384
 ds_read_b64_tr_b16 v[214:215], v243 offset:17408
 v_fma_f32 v250, v250, v248, v249
 v_fma_f32 v251, v251, v248, v249
 v_mul_f32 v250, v250, v202
 s_waitcnt lgkmcnt(4)
 v_mfma_f32_32x32x16_bf16 v[144:159], v[224:227], a[120:123], v[144:159]
 ds_read_b64_tr_b16 v[216:217], v242 offset:18432
 ds_read_b64_tr_b16 v[218:219], v242 offset:19456
 s_add_u32 m0, s30, 139264
 s_add_u32 s36, s32, 4718592
 buffer_load_dwordx4 v246, s[12:15], s36 offen lds
 v_mul_f32 v251, v251, v203
 v_exp_f32 v250, v250
 v_exp_f32 v251, v251
 v_add_f32 v250, 1.0, v250
 v_mfma_f32_32x32x16_bf16 v[160:175], v[228:231], a[120:123], v[160:175]
 ds_read_b64_tr_b16 v[220:221], v243 offset:18432
 ds_read_b64_tr_b16 v[222:223], v243 offset:19456
 v_add_f32 v251, 1.0, v251
 v_rcp_f32 v250, v250
 v_rcp_f32 v251, v251
 v_mul_f32 v202, v250, v202
 v_mfma_f32_32x32x16_bf16 v[144:159], v[232:235], a[124:127], v[144:159]
 ds_read_b64_tr_b16 v[224:225], v242 offset:20480
 ds_read_b64_tr_b16 v[226:227], v242 offset:21504
 v_mul_f32 v203, v251, v203
 v_cvt_pk_bf16_f32 v61, v202, v203
 v_mul_f32 v250, v204, v204
 v_mfma_f32_32x32x16_bf16 v[160:175], v[236:239], a[124:127], v[160:175]
 ds_read_b64_tr_b16 v[228:229], v243 offset:20480
 ds_read_b64_tr_b16 v[230:231], v243 offset:21504
 v_mul_f32 v251, v205, v205
 v_fma_f32 v250, v250, v248, v249
 v_fma_f32 v251, v251, v248, v249
 s_waitcnt lgkmcnt(4)
 v_mfma_f32_32x32x16_bf16 v[144:159], v[208:211], a[128:131], v[144:159]
 ds_read_b64_tr_b16 v[232:233], v242 offset:22528
 ds_read_b64_tr_b16 v[234:235], v242 offset:23552
 buffer_load_dwordx4 v247, s[12:15], s36 offen offset:1024 lds
 v_mul_f32 v250, v250, v204
 v_mul_f32 v251, v251, v205
 v_exp_f32 v250, v250
 v_exp_f32 v251, v251
 v_add_f32 v250, 1.0, v250
 v_mfma_f32_32x32x16_bf16 v[160:175], v[212:215], a[128:131], v[160:175]
 ds_read_b64_tr_b16 v[236:237], v243 offset:22528
 ds_read_b64_tr_b16 v[238:239], v243 offset:23552
 s_waitcnt vmcnt(8)
 s_barrier
 v_mfma_f32_32x32x16_bf16 v[144:159], v[216:219], a[132:135], v[144:159]
 ds_read_b64_tr_b16 v[208:209], v242 offset:24576
 ds_read_b64_tr_b16 v[210:211], v242 offset:25600
 v_add_f32 v251, 1.0, v251
 v_rcp_f32 v250, v250
 v_rcp_f32 v251, v251
 v_mul_f32 v204, v250, v204
 v_mfma_f32_32x32x16_bf16 v[160:175], v[220:223], a[132:135], v[160:175]
 ds_read_b64_tr_b16 v[212:213], v243 offset:24576
 ds_read_b64_tr_b16 v[214:215], v243 offset:25600
 v_mul_f32 v205, v251, v205
 v_cvt_pk_bf16_f32 v62, v204, v205
 v_mul_f32 v250, v206, v206
 s_waitcnt lgkmcnt(4)
 v_mfma_f32_32x32x16_bf16 v[144:159], v[224:227], a[136:139], v[144:159]
 ds_read_b64_tr_b16 v[216:217], v242 offset:26624
 ds_read_b64_tr_b16 v[218:219], v242 offset:27648
 s_add_u32 m0, s30, 0
 s_add_u32 s32, s32, 128
 s_cmp_ge_u32 s32, s39
 s_cselect_b32 s3, 1152, 0
 s_sub_u32 s32, s32, s3
 s_add_u32 s36, s32, 0
 buffer_load_dwordx4 v246, s[12:15], s36 offen lds
 v_mul_f32 v251, v207, v207
 v_fma_f32 v250, v250, v248, v249
 v_fma_f32 v251, v251, v248, v249
 v_mfma_f32_32x32x16_bf16 v[160:175], v[228:231], a[136:139], v[160:175]
 ds_read_b64_tr_b16 v[220:221], v243 offset:26624
 ds_read_b64_tr_b16 v[222:223], v243 offset:27648
 v_mul_f32 v250, v250, v206
 v_mul_f32 v251, v251, v207
 v_exp_f32 v250, v250
 v_mfma_f32_32x32x16_bf16 v[144:159], v[232:235], a[140:143], v[144:159]
 ds_read_b64_tr_b16 v[224:225], v242 offset:28672
 ds_read_b64_tr_b16 v[226:227], v242 offset:29696
 v_exp_f32 v251, v251
 v_add_f32 v250, 1.0, v250
 v_add_f32 v251, 1.0, v251
 v_rcp_f32 v250, v250
 v_mfma_f32_32x32x16_bf16 v[160:175], v[236:239], a[140:143], v[160:175]
 ds_read_b64_tr_b16 v[228:229], v243 offset:28672
 ds_read_b64_tr_b16 v[230:231], v243 offset:29696
 v_rcp_f32 v251, v251
 v_mul_f32 v206, v250, v206
 v_mul_f32 v207, v251, v207
 v_cvt_pk_bf16_f32 v63, v206, v207
 s_waitcnt lgkmcnt(4)
 v_mfma_f32_32x32x16_bf16 v[176:191], v[208:211], a[0:3], 0
 ds_read_b64_tr_b16 v[232:233], v242 offset:30720
 ds_read_b64_tr_b16 v[234:235], v242 offset:31744
 buffer_load_dwordx4 v247, s[12:15], s36 offen offset:1024 lds
 v_mfma_f32_32x32x16_bf16 v[192:207], v[212:215], a[0:3], 0
 ds_read_b64_tr_b16 v[236:237], v243 offset:30720
 ds_read_b64_tr_b16 v[238:239], v243 offset:31744
 v_mfma_f32_32x32x16_bf16 v[176:191], v[216:219], a[4:7], v[176:191]
 ds_read_b64_tr_b16 v[208:209], v242 offset:32768
 ds_read_b64_tr_b16 v[210:211], v242 offset:33792
 v_mfma_f32_32x32x16_bf16 v[192:207], v[220:223], a[4:7], v[192:207]
 ds_read_b64_tr_b16 v[212:213], v243 offset:32768
 ds_read_b64_tr_b16 v[214:215], v243 offset:33792
 s_waitcnt lgkmcnt(4)
 v_mfma_f32_32x32x16_bf16 v[176:191], v[224:227], a[8:11], v[176:191]
 ds_read_b64_tr_b16 v[216:217], v242 offset:34816
 ds_read_b64_tr_b16 v[218:219], v242 offset:35840
 s_add_u32 m0, s30, 8192
 s_add_u32 s36, s32, 589824
 buffer_load_dwordx4 v246, s[12:15], s36 offen lds
 v_mul_f32 v250, v144, v144
 v_mul_f32 v251, v145, v145
 v_fma_f32 v250, v250, v248, v249
 v_fma_f32 v251, v251, v248, v249
 v_mfma_f32_32x32x16_bf16 v[192:207], v[228:231], a[8:11], v[192:207]
 ds_read_b64_tr_b16 v[220:221], v243 offset:34816
 ds_read_b64_tr_b16 v[222:223], v243 offset:35840
 v_mul_f32 v250, v250, v144
 v_mul_f32 v251, v251, v145
 v_exp_f32 v250, v250
 v_mfma_f32_32x32x16_bf16 v[176:191], v[232:235], a[12:15], v[176:191]
 ds_read_b64_tr_b16 v[224:225], v242 offset:36864
 ds_read_b64_tr_b16 v[226:227], v242 offset:37888
 v_exp_f32 v251, v251
 v_add_f32 v250, 1.0, v250
 v_add_f32 v251, 1.0, v251
 v_rcp_f32 v250, v250
 v_mfma_f32_32x32x16_bf16 v[192:207], v[236:239], a[12:15], v[192:207]
 ds_read_b64_tr_b16 v[228:229], v243 offset:36864
 ds_read_b64_tr_b16 v[230:231], v243 offset:37888
 v_rcp_f32 v251, v251
 v_mul_f32 v144, v250, v144
 v_mul_f32 v145, v251, v145
 v_cvt_pk_bf16_f32 v64, v144, v145
 s_waitcnt lgkmcnt(4)
 v_mfma_f32_32x32x16_bf16 v[176:191], v[208:211], a[16:19], v[176:191]
 ds_read_b64_tr_b16 v[232:233], v242 offset:38912
 ds_read_b64_tr_b16 v[234:235], v242 offset:39936
 buffer_load_dwordx4 v247, s[12:15], s36 offen offset:1024 lds
 v_mul_f32 v250, v146, v146
 v_mul_f32 v251, v147, v147
 v_fma_f32 v250, v250, v248, v249
 v_mfma_f32_32x32x16_bf16 v[192:207], v[212:215], a[16:19], v[192:207]
 ds_read_b64_tr_b16 v[236:237], v243 offset:38912
 ds_read_b64_tr_b16 v[238:239], v243 offset:39936
 v_fma_f32 v251, v251, v248, v249
 v_mul_f32 v250, v250, v146
 v_mul_f32 v251, v251, v147
 v_mfma_f32_32x32x16_bf16 v[176:191], v[216:219], a[20:23], v[176:191]
 ds_read_b64_tr_b16 v[208:209], v242 offset:40960
 ds_read_b64_tr_b16 v[210:211], v242 offset:41984
 v_exp_f32 v250, v250
 v_exp_f32 v251, v251
 v_add_f32 v250, 1.0, v250
 v_add_f32 v251, 1.0, v251
 v_rcp_f32 v250, v250
 v_mfma_f32_32x32x16_bf16 v[192:207], v[220:223], a[20:23], v[192:207]
 ds_read_b64_tr_b16 v[212:213], v243 offset:40960
 ds_read_b64_tr_b16 v[214:215], v243 offset:41984
 v_rcp_f32 v251, v251
 v_mul_f32 v146, v250, v146
 v_mul_f32 v147, v251, v147
 v_cvt_pk_bf16_f32 v65, v146, v147
 s_waitcnt lgkmcnt(4)
 v_mfma_f32_32x32x16_bf16 v[176:191], v[224:227], a[24:27], v[176:191]
 ds_read_b64_tr_b16 v[216:217], v242 offset:43008
 ds_read_b64_tr_b16 v[218:219], v242 offset:44032
 s_add_u32 m0, s30, 16384
 s_add_u32 s36, s32, 1179648
 buffer_load_dwordx4 v246, s[12:15], s36 offen lds
 v_mul_f32 v250, v148, v148
 v_mul_f32 v251, v149, v149
 v_fma_f32 v250, v250, v248, v249
 v_mfma_f32_32x32x16_bf16 v[192:207], v[228:231], a[24:27], v[192:207]
 ds_read_b64_tr_b16 v[220:221], v243 offset:43008
 ds_read_b64_tr_b16 v[222:223], v243 offset:44032
 v_fma_f32 v251, v251, v248, v249
 v_mul_f32 v250, v250, v148
 v_mul_f32 v251, v251, v149
 v_mfma_f32_32x32x16_bf16 v[176:191], v[232:235], a[28:31], v[176:191]
 ds_read_b64_tr_b16 v[224:225], v242 offset:45056
 ds_read_b64_tr_b16 v[226:227], v242 offset:46080
 v_exp_f32 v250, v250
 v_exp_f32 v251, v251
 v_add_f32 v250, 1.0, v250
 v_add_f32 v251, 1.0, v251
 v_mfma_f32_32x32x16_bf16 v[192:207], v[236:239], a[28:31], v[192:207]
 ds_read_b64_tr_b16 v[228:229], v243 offset:45056
 ds_read_b64_tr_b16 v[230:231], v243 offset:46080
 v_rcp_f32 v250, v250
 v_rcp_f32 v251, v251
 v_mul_f32 v148, v250, v148
 v_mul_f32 v149, v251, v149
 s_waitcnt lgkmcnt(4)
 v_mfma_f32_32x32x16_bf16 v[176:191], v[208:211], a[32:35], v[176:191]
 ds_read_b64_tr_b16 v[232:233], v242 offset:47104
 ds_read_b64_tr_b16 v[234:235], v242 offset:48128
 buffer_load_dwordx4 v247, s[12:15], s36 offen offset:1024 lds
 v_cvt_pk_bf16_f32 v66, v148, v149
 v_mul_f32 v250, v150, v150
 v_mul_f32 v251, v151, v151
 v_mfma_f32_32x32x16_bf16 v[192:207], v[212:215], a[32:35], v[192:207]
 ds_read_b64_tr_b16 v[236:237], v243 offset:47104
 ds_read_b64_tr_b16 v[238:239], v243 offset:48128
 v_fma_f32 v250, v250, v248, v249
 v_fma_f32 v251, v251, v248, v249
 v_mul_f32 v250, v250, v150
 v_mul_f32 v251, v251, v151
 v_mfma_f32_32x32x16_bf16 v[176:191], v[216:219], a[36:39], v[176:191]
 ds_read_b64_tr_b16 v[208:209], v244 offset:0
 ds_read_b64_tr_b16 v[210:211], v244 offset:1024
 v_exp_f32 v250, v250
 v_exp_f32 v251, v251
 v_add_f32 v250, 1.0, v250
 v_add_f32 v251, 1.0, v251
 v_mfma_f32_32x32x16_bf16 v[192:207], v[220:223], a[36:39], v[192:207]
 ds_read_b64_tr_b16 v[212:213], v245 offset:0
 ds_read_b64_tr_b16 v[214:215], v245 offset:1024
 v_rcp_f32 v250, v250
 v_rcp_f32 v251, v251
 v_mul_f32 v150, v250, v150
 v_mul_f32 v151, v251, v151
 s_waitcnt lgkmcnt(4)
 v_mfma_f32_32x32x16_bf16 v[176:191], v[224:227], a[40:43], v[176:191]
 ds_read_b64_tr_b16 v[216:217], v244 offset:2048
 ds_read_b64_tr_b16 v[218:219], v244 offset:3072
 s_add_u32 m0, s30, 24576
 s_add_u32 s36, s32, 1769472
 buffer_load_dwordx4 v246, s[12:15], s36 offen lds
 v_cvt_pk_bf16_f32 v67, v150, v151
 v_mul_f32 v250, v152, v152
 v_mul_f32 v251, v153, v153
 v_mfma_f32_32x32x16_bf16 v[192:207], v[228:231], a[40:43], v[192:207]
 ds_read_b64_tr_b16 v[220:221], v245 offset:2048
 ds_read_b64_tr_b16 v[222:223], v245 offset:3072
 v_fma_f32 v250, v250, v248, v249
 v_fma_f32 v251, v251, v248, v249
 v_mul_f32 v250, v250, v152
 v_mfma_f32_32x32x16_bf16 v[176:191], v[232:235], a[44:47], v[176:191]
 ds_read_b64_tr_b16 v[224:225], v244 offset:4096
 ds_read_b64_tr_b16 v[226:227], v244 offset:5120
 v_mul_f32 v251, v251, v153
 v_exp_f32 v250, v250
 v_exp_f32 v251, v251
 v_add_f32 v250, 1.0, v250
 v_mfma_f32_32x32x16_bf16 v[192:207], v[236:239], a[44:47], v[192:207]
 ds_read_b64_tr_b16 v[228:229], v245 offset:4096
 ds_read_b64_tr_b16 v[230:231], v245 offset:5120
 v_add_f32 v251, 1.0, v251
 v_rcp_f32 v250, v250
 v_rcp_f32 v251, v251
 v_mul_f32 v152, v250, v152
 v_mul_f32 v153, v251, v153
 s_waitcnt lgkmcnt(4)
 v_mfma_f32_32x32x16_bf16 v[176:191], v[208:211], a[48:51], v[176:191]
 ds_read_b64_tr_b16 v[232:233], v244 offset:6144
 ds_read_b64_tr_b16 v[234:235], v244 offset:7168
 buffer_load_dwordx4 v247, s[12:15], s36 offen offset:1024 lds
 v_cvt_pk_bf16_f32 v68, v152, v153
 v_mul_f32 v250, v154, v154
 v_mul_f32 v251, v155, v155
 v_mfma_f32_32x32x16_bf16 v[192:207], v[212:215], a[48:51], v[192:207]
 ds_read_b64_tr_b16 v[236:237], v245 offset:6144
 ds_read_b64_tr_b16 v[238:239], v245 offset:7168
 v_fma_f32 v250, v250, v248, v249
 v_fma_f32 v251, v251, v248, v249
 v_mul_f32 v250, v250, v154
 v_mfma_f32_32x32x16_bf16 v[176:191], v[216:219], a[52:55], v[176:191]
 ds_read_b64_tr_b16 v[208:209], v244 offset:8192
 ds_read_b64_tr_b16 v[210:211], v244 offset:9216
 v_mul_f32 v251, v251, v155
 v_exp_f32 v250, v250
 v_exp_f32 v251, v251
 v_add_f32 v250, 1.0, v250
 v_mfma_f32_32x32x16_bf16 v[192:207], v[220:223], a[52:55], v[192:207]
 ds_read_b64_tr_b16 v[212:213], v245 offset:8192
 ds_read_b64_tr_b16 v[214:215], v245 offset:9216
 v_add_f32 v251, 1.0, v251
 v_rcp_f32 v250, v250
 v_rcp_f32 v251, v251
 v_mul_f32 v154, v250, v154
 s_waitcnt lgkmcnt(4)
 v_mfma_f32_32x32x16_bf16 v[176:191], v[224:227], a[56:59], v[176:191]
 ds_read_b64_tr_b16 v[216:217], v244 offset:10240
 ds_read_b64_tr_b16 v[218:219], v244 offset:11264
 s_add_u32 m0, s30, 32768
 s_add_u32 s36, s32, 2359296
 buffer_load_dwordx4 v246, s[12:15], s36 offen lds
 v_mul_f32 v155, v251, v155
 v_cvt_pk_bf16_f32 v69, v154, v155
 v_mul_f32 v250, v156, v156
 v_mfma_f32_32x32x16_bf16 v[192:207], v[228:231], a[56:59], v[192:207]
 ds_read_b64_tr_b16 v[220:221], v245 offset:10240
 ds_read_b64_tr_b16 v[222:223], v245 offset:11264
 s_waitcnt vmcnt(9)
 s_barrier
 v_mfma_f32_32x32x16_bf16 v[176:191], v[232:235], a[60:63], v[176:191]
 ds_read_b64_tr_b16 v[224:225], v244 offset:12288
 ds_read_b64_tr_b16 v[226:227], v244 offset:13312
 v_mul_f32 v251, v157, v157
 v_fma_f32 v250, v250, v248, v249
 v_fma_f32 v251, v251, v248, v249
 v_mfma_f32_32x32x16_bf16 v[192:207], v[236:239], a[60:63], v[192:207]
 ds_read_b64_tr_b16 v[228:229], v245 offset:12288
 ds_read_b64_tr_b16 v[230:231], v245 offset:13312
 v_mul_f32 v250, v250, v156
 v_mul_f32 v251, v251, v157
 v_exp_f32 v250, v250
 v_exp_f32 v251, v251
 v_add_f32 v250, 1.0, v250
 s_waitcnt lgkmcnt(4)
 v_mfma_f32_32x32x16_bf16 v[176:191], v[208:211], a[64:67], v[176:191]
 ds_read_b64_tr_b16 v[232:233], v244 offset:14336
 ds_read_b64_tr_b16 v[234:235], v244 offset:15360
 buffer_load_dwordx4 v247, s[12:15], s36 offen offset:1024 lds
 v_add_f32 v251, 1.0, v251
 v_rcp_f32 v250, v250
 v_rcp_f32 v251, v251
 v_mul_f32 v156, v250, v156
 v_mfma_f32_32x32x16_bf16 v[192:207], v[212:215], a[64:67], v[192:207]
 ds_read_b64_tr_b16 v[236:237], v245 offset:14336
 ds_read_b64_tr_b16 v[238:239], v245 offset:15360
 v_mul_f32 v157, v251, v157
 v_cvt_pk_bf16_f32 v70, v156, v157
 v_mul_f32 v250, v158, v158
 v_mfma_f32_32x32x16_bf16 v[176:191], v[216:219], a[68:71], v[176:191]
 ds_read_b64_tr_b16 v[208:209], v244 offset:16384
 ds_read_b64_tr_b16 v[210:211], v244 offset:17408
 v_mul_f32 v251, v159, v159
 v_fma_f32 v250, v250, v248, v249
 v_fma_f32 v251, v251, v248, v249
 v_mfma_f32_32x32x16_bf16 v[192:207], v[220:223], a[68:71], v[192:207]
 ds_read_b64_tr_b16 v[212:213], v245 offset:16384
 ds_read_b64_tr_b16 v[214:215], v245 offset:17408
 v_mul_f32 v250, v250, v158
 v_mul_f32 v251, v251, v159
 v_exp_f32 v250, v250
 s_waitcnt lgkmcnt(4)
 v_mfma_f32_32x32x16_bf16 v[176:191], v[224:227], a[72:75], v[176:191]
 ds_read_b64_tr_b16 v[216:217], v244 offset:18432
 ds_read_b64_tr_b16 v[218:219], v244 offset:19456
 s_add_u32 m0, s30, 40960
 s_add_u32 s36, s32, 2949120
 buffer_load_dwordx4 v246, s[12:15], s36 offen lds
 v_exp_f32 v251, v251
 v_add_f32 v250, 1.0, v250
 v_add_f32 v251, 1.0, v251
 v_rcp_f32 v250, v250
 v_mfma_f32_32x32x16_bf16 v[192:207], v[228:231], a[72:75], v[192:207]
 ds_read_b64_tr_b16 v[220:221], v245 offset:18432
 ds_read_b64_tr_b16 v[222:223], v245 offset:19456
 v_rcp_f32 v251, v251
 v_mul_f32 v158, v250, v158
 v_mul_f32 v159, v251, v159
 v_cvt_pk_bf16_f32 v71, v158, v159
 v_mfma_f32_32x32x16_bf16 v[176:191], v[232:235], a[76:79], v[176:191]
 ds_read_b64_tr_b16 v[224:225], v244 offset:20480
 ds_read_b64_tr_b16 v[226:227], v244 offset:21504
 v_mul_f32 v250, v160, v160
 v_mul_f32 v251, v161, v161
 v_fma_f32 v250, v250, v248, v249
 v_fma_f32 v251, v251, v248, v249
 v_mfma_f32_32x32x16_bf16 v[192:207], v[236:239], a[76:79], v[192:207]
 ds_read_b64_tr_b16 v[228:229], v245 offset:20480
 ds_read_b64_tr_b16 v[230:231], v245 offset:21504
 v_mul_f32 v250, v250, v160
 v_mul_f32 v251, v251, v161
 v_exp_f32 v250, v250
 s_waitcnt lgkmcnt(4)
 v_mfma_f32_32x32x16_bf16 v[176:191], v[208:211], a[80:83], v[176:191]
 ds_read_b64_tr_b16 v[232:233], v244 offset:22528
 ds_read_b64_tr_b16 v[234:235], v244 offset:23552
 buffer_load_dwordx4 v247, s[12:15], s36 offen offset:1024 lds
 v_exp_f32 v251, v251
 v_add_f32 v250, 1.0, v250
 v_add_f32 v251, 1.0, v251
 v_rcp_f32 v250, v250
 v_mfma_f32_32x32x16_bf16 v[192:207], v[212:215], a[80:83], v[192:207]
 ds_read_b64_tr_b16 v[236:237], v245 offset:22528
 ds_read_b64_tr_b16 v[238:239], v245 offset:23552
 v_rcp_f32 v251, v251
 v_mul_f32 v160, v250, v160
 v_mul_f32 v161, v251, v161
 v_cvt_pk_bf16_f32 v72, v160, v161
 v_mfma_f32_32x32x16_bf16 v[176:191], v[216:219], a[84:87], v[176:191]
 ds_read_b64_tr_b16 v[208:209], v244 offset:24576
 ds_read_b64_tr_b16 v[210:211], v244 offset:25600
 v_mul_f32 v250, v162, v162
 v_mul_f32 v251, v163, v163
 v_fma_f32 v250, v250, v248, v249
 v_mfma_f32_32x32x16_bf16 v[192:207], v[220:223], a[84:87], v[192:207]
 ds_read_b64_tr_b16 v[212:213], v245 offset:24576
 ds_read_b64_tr_b16 v[214:215], v245 offset:25600
 v_fma_f32 v251, v251, v248, v249
 v_mul_f32 v250, v250, v162
 v_mul_f32 v251, v251, v163
 s_waitcnt lgkmcnt(4)
 v_mfma_f32_32x32x16_bf16 v[176:191], v[224:227], a[88:91], v[176:191]
 ds_read_b64_tr_b16 v[216:217], v244 offset:26624
 ds_read_b64_tr_b16 v[218:219], v244 offset:27648
 s_add_u32 m0, s30, 49152
 s_add_u32 s36, s32, 3538944
 buffer_load_dwordx4 v246, s[12:15], s36 offen lds
 v_exp_f32 v250, v250
 v_exp_f32 v251, v251
 v_add_f32 v250, 1.0, v250
 v_add_f32 v251, 1.0, v251
 v_rcp_f32 v250, v250
 v_mfma_f32_32x32x16_bf16 v[192:207], v[228:231], a[88:91], v[192:207]
 ds_read_b64_tr_b16 v[220:221], v245 offset:26624
 ds_read_b64_tr_b16 v[222:223], v245 offset:27648
 v_rcp_f32 v251, v251
 v_mul_f32 v162, v250, v162
 v_mul_f32 v163, v251, v163
 v_cvt_pk_bf16_f32 v73, v162, v163
 v_mfma_f32_32x32x16_bf16 v[176:191], v[232:235], a[92:95], v[176:191]
 ds_read_b64_tr_b16 v[224:225], v244 offset:28672
 ds_read_b64_tr_b16 v[226:227], v244 offset:29696
 v_mul_f32 v250, v164, v164
 v_mul_f32 v251, v165, v165
 v_fma_f32 v250, v250, v248, v249
 v_mfma_f32_32x32x16_bf16 v[192:207], v[236:239], a[92:95], v[192:207]
 ds_read_b64_tr_b16 v[228:229], v245 offset:28672
 ds_read_b64_tr_b16 v[230:231], v245 offset:29696
 v_fma_f32 v251, v251, v248, v249
 v_mul_f32 v250, v250, v164
 v_mul_f32 v251, v251, v165
 s_waitcnt lgkmcnt(4)
 v_mfma_f32_32x32x16_bf16 v[176:191], v[208:211], a[96:99], v[176:191]
 ds_read_b64_tr_b16 v[232:233], v244 offset:30720
 ds_read_b64_tr_b16 v[234:235], v244 offset:31744
 buffer_load_dwordx4 v247, s[12:15], s36 offen offset:1024 lds
 v_exp_f32 v250, v250
 v_exp_f32 v251, v251
 v_add_f32 v250, 1.0, v250
 v_add_f32 v251, 1.0, v251
 v_mfma_f32_32x32x16_bf16 v[192:207], v[212:215], a[96:99], v[192:207]
 ds_read_b64_tr_b16 v[236:237], v245 offset:30720
 ds_read_b64_tr_b16 v[238:239], v245 offset:31744
 v_rcp_f32 v250, v250
 v_rcp_f32 v251, v251
 v_mul_f32 v164, v250, v164
 v_mul_f32 v165, v251, v165
 v_mfma_f32_32x32x16_bf16 v[176:191], v[216:219], a[100:103], v[176:191]
 ds_read_b64_tr_b16 v[208:209], v244 offset:32768
 ds_read_b64_tr_b16 v[210:211], v244 offset:33792
 v_cvt_pk_bf16_f32 v74, v164, v165
 v_mul_f32 v250, v166, v166
 v_mul_f32 v251, v167, v167
 v_mfma_f32_32x32x16_bf16 v[192:207], v[220:223], a[100:103], v[192:207]
 ds_read_b64_tr_b16 v[212:213], v245 offset:32768
 ds_read_b64_tr_b16 v[214:215], v245 offset:33792
 v_fma_f32 v250, v250, v248, v249
 v_fma_f32 v251, v251, v248, v249
 v_mul_f32 v250, v250, v166
 v_mul_f32 v251, v251, v167
 s_waitcnt lgkmcnt(4)
 v_mfma_f32_32x32x16_bf16 v[176:191], v[224:227], a[104:107], v[176:191]
 ds_read_b64_tr_b16 v[216:217], v244 offset:34816
 ds_read_b64_tr_b16 v[218:219], v244 offset:35840
 s_add_u32 m0, s30, 57344
 s_add_u32 s36, s32, 4128768
 buffer_load_dwordx4 v246, s[12:15], s36 offen lds
 v_exp_f32 v250, v250
 v_exp_f32 v251, v251
 v_add_f32 v250, 1.0, v250
 v_add_f32 v251, 1.0, v251
 v_mfma_f32_32x32x16_bf16 v[192:207], v[228:231], a[104:107], v[192:207]
 ds_read_b64_tr_b16 v[220:221], v245 offset:34816
 ds_read_b64_tr_b16 v[222:223], v245 offset:35840
 v_rcp_f32 v250, v250
 v_rcp_f32 v251, v251
 v_mul_f32 v166, v250, v166
 v_mul_f32 v167, v251, v167
 v_mfma_f32_32x32x16_bf16 v[176:191], v[232:235], a[108:111], v[176:191]
 ds_read_b64_tr_b16 v[224:225], v244 offset:36864
 ds_read_b64_tr_b16 v[226:227], v244 offset:37888
 v_cvt_pk_bf16_f32 v75, v166, v167
 v_mul_f32 v250, v168, v168
 v_mul_f32 v251, v169, v169
 v_mfma_f32_32x32x16_bf16 v[192:207], v[236:239], a[108:111], v[192:207]
 ds_read_b64_tr_b16 v[228:229], v245 offset:36864
 ds_read_b64_tr_b16 v[230:231], v245 offset:37888
 v_fma_f32 v250, v250, v248, v249
 v_fma_f32 v251, v251, v248, v249
 v_mul_f32 v250, v250, v168
 s_waitcnt lgkmcnt(4)
 v_mfma_f32_32x32x16_bf16 v[176:191], v[208:211], a[112:115], v[176:191]
 ds_read_b64_tr_b16 v[232:233], v244 offset:38912
 ds_read_b64_tr_b16 v[234:235], v244 offset:39936
 buffer_load_dwordx4 v247, s[12:15], s36 offen offset:1024 lds
 v_mul_f32 v251, v251, v169
 v_exp_f32 v250, v250
 v_exp_f32 v251, v251
 v_add_f32 v250, 1.0, v250
 v_mfma_f32_32x32x16_bf16 v[192:207], v[212:215], a[112:115], v[192:207]
 ds_read_b64_tr_b16 v[236:237], v245 offset:38912
 ds_read_b64_tr_b16 v[238:239], v245 offset:39936
 v_add_f32 v251, 1.0, v251
 v_rcp_f32 v250, v250
 v_rcp_f32 v251, v251
 v_mul_f32 v168, v250, v168
 v_mul_f32 v169, v251, v169
 v_mfma_f32_32x32x16_bf16 v[176:191], v[216:219], a[116:119], v[176:191]
 ds_read_b64_tr_b16 v[208:209], v244 offset:40960
 ds_read_b64_tr_b16 v[210:211], v244 offset:41984
 v_cvt_pk_bf16_f32 v76, v168, v169
 v_mul_f32 v250, v170, v170
 v_mul_f32 v251, v171, v171
 v_mfma_f32_32x32x16_bf16 v[192:207], v[220:223], a[116:119], v[192:207]
 ds_read_b64_tr_b16 v[212:213], v245 offset:40960
 ds_read_b64_tr_b16 v[214:215], v245 offset:41984
 v_fma_f32 v250, v250, v248, v249
 v_fma_f32 v251, v251, v248, v249
 v_mul_f32 v250, v250, v170
 s_waitcnt lgkmcnt(4)
 v_mfma_f32_32x32x16_bf16 v[176:191], v[224:227], a[120:123], v[176:191]
 ds_read_b64_tr_b16 v[216:217], v244 offset:43008
 ds_read_b64_tr_b16 v[218:219], v244 offset:44032
 s_add_u32 m0, s30, 65536
 s_add_u32 s36, s32, 4718592
 buffer_load_dwordx4 v246, s[12:15], s36 offen lds
 v_mul_f32 v251, v251, v171
 v_exp_f32 v250, v250
 v_exp_f32 v251, v251
 v_add_f32 v250, 1.0, v250
 v_mfma_f32_32x32x16_bf16 v[192:207], v[228:231], a[120:123], v[192:207]
 ds_read_b64_tr_b16 v[220:221], v245 offset:43008
 ds_read_b64_tr_b16 v[222:223], v245 offset:44032
 v_add_f32 v251, 1.0, v251
 v_rcp_f32 v250, v250
 v_rcp_f32 v251, v251
 v_mul_f32 v170, v250, v170
 v_mfma_f32_32x32x16_bf16 v[176:191], v[232:235], a[124:127], v[176:191]
 ds_read_b64_tr_b16 v[224:225], v244 offset:45056
 ds_read_b64_tr_b16 v[226:227], v244 offset:46080
 v_mul_f32 v171, v251, v171
 v_cvt_pk_bf16_f32 v77, v170, v171
 v_mul_f32 v250, v172, v172
 v_mfma_f32_32x32x16_bf16 v[192:207], v[236:239], a[124:127], v[192:207]
 ds_read_b64_tr_b16 v[228:229], v245 offset:45056
 ds_read_b64_tr_b16 v[230:231], v245 offset:46080
 v_mul_f32 v251, v173, v173
 v_fma_f32 v250, v250, v248, v249
 v_fma_f32 v251, v251, v248, v249
 s_waitcnt lgkmcnt(4)
 v_mfma_f32_32x32x16_bf16 v[176:191], v[208:211], a[128:131], v[176:191]
 ds_read_b64_tr_b16 v[232:233], v244 offset:47104
 ds_read_b64_tr_b16 v[234:235], v244 offset:48128
 buffer_load_dwordx4 v247, s[12:15], s36 offen offset:1024 lds
 v_mul_f32 v250, v250, v172
 v_mul_f32 v251, v251, v173
 v_exp_f32 v250, v250
 v_exp_f32 v251, v251
 v_add_f32 v250, 1.0, v250
 v_mfma_f32_32x32x16_bf16 v[192:207], v[212:215], a[128:131], v[192:207]
 ds_read_b64_tr_b16 v[236:237], v245 offset:47104
 ds_read_b64_tr_b16 v[238:239], v245 offset:48128
 s_waitcnt vmcnt(8)
 s_barrier
 v_mfma_f32_32x32x16_bf16 v[176:191], v[216:219], a[132:135], v[176:191]
 ds_read_b64_tr_b16 v[208:209], v240 offset:0
 ds_read_b64_tr_b16 v[210:211], v240 offset:1024
 v_add_f32 v251, 1.0, v251
 v_rcp_f32 v250, v250
 v_rcp_f32 v251, v251
 v_mul_f32 v172, v250, v172
 v_mfma_f32_32x32x16_bf16 v[192:207], v[220:223], a[132:135], v[192:207]
 ds_read_b64_tr_b16 v[212:213], v241 offset:0
 ds_read_b64_tr_b16 v[214:215], v241 offset:1024
 v_mul_f32 v173, v251, v173
 v_cvt_pk_bf16_f32 v78, v172, v173
 v_mul_f32 v250, v174, v174
 s_waitcnt lgkmcnt(4)
 v_mfma_f32_32x32x16_bf16 v[176:191], v[224:227], a[136:139], v[176:191]
 ds_read_b64_tr_b16 v[216:217], v240 offset:2048
 ds_read_b64_tr_b16 v[218:219], v240 offset:3072
 s_add_u32 m0, s30, 73728
 s_add_u32 s32, s32, 128
 s_cmp_ge_u32 s32, s39
 s_cselect_b32 s3, 1152, 0
 s_sub_u32 s32, s32, s3
 s_add_u32 s36, s32, 0
 buffer_load_dwordx4 v246, s[12:15], s36 offen lds
 v_mul_f32 v251, v175, v175
 v_fma_f32 v250, v250, v248, v249
 v_fma_f32 v251, v251, v248, v249
 v_mfma_f32_32x32x16_bf16 v[192:207], v[228:231], a[136:139], v[192:207]
 ds_read_b64_tr_b16 v[220:221], v241 offset:2048
 ds_read_b64_tr_b16 v[222:223], v241 offset:3072
 v_mul_f32 v250, v250, v174
 v_mul_f32 v251, v251, v175
 v_exp_f32 v250, v250
 v_mfma_f32_32x32x16_bf16 v[176:191], v[232:235], a[140:143], v[176:191]
 ds_read_b64_tr_b16 v[224:225], v240 offset:4096
 ds_read_b64_tr_b16 v[226:227], v240 offset:5120
 v_exp_f32 v251, v251
 v_add_f32 v250, 1.0, v250
 v_add_f32 v251, 1.0, v251
 v_rcp_f32 v250, v250
 v_mfma_f32_32x32x16_bf16 v[192:207], v[236:239], a[140:143], v[192:207]
 ds_read_b64_tr_b16 v[228:229], v241 offset:4096
 ds_read_b64_tr_b16 v[230:231], v241 offset:5120
 v_rcp_f32 v251, v251
 v_mul_f32 v174, v250, v174
 v_mul_f32 v175, v251, v175
 v_cvt_pk_bf16_f32 v79, v174, v175
 s_waitcnt lgkmcnt(4)
 v_mfma_f32_32x32x16_bf16 v[144:159], v[208:211], a[0:3], 0
 ds_read_b64_tr_b16 v[232:233], v240 offset:6144
 ds_read_b64_tr_b16 v[234:235], v240 offset:7168
 buffer_load_dwordx4 v247, s[12:15], s36 offen offset:1024 lds
 v_mfma_f32_32x32x16_bf16 v[160:175], v[212:215], a[0:3], 0
 ds_read_b64_tr_b16 v[236:237], v241 offset:6144
 ds_read_b64_tr_b16 v[238:239], v241 offset:7168
 v_mfma_f32_32x32x16_bf16 v[144:159], v[216:219], a[4:7], v[144:159]
 ds_read_b64_tr_b16 v[208:209], v240 offset:8192
 ds_read_b64_tr_b16 v[210:211], v240 offset:9216
 v_mfma_f32_32x32x16_bf16 v[160:175], v[220:223], a[4:7], v[160:175]
 ds_read_b64_tr_b16 v[212:213], v241 offset:8192
 ds_read_b64_tr_b16 v[214:215], v241 offset:9216
 s_waitcnt lgkmcnt(4)
 v_mfma_f32_32x32x16_bf16 v[144:159], v[224:227], a[8:11], v[144:159]
 ds_read_b64_tr_b16 v[216:217], v240 offset:10240
 ds_read_b64_tr_b16 v[218:219], v240 offset:11264
 s_add_u32 m0, s30, 81920
 s_add_u32 s36, s32, 589824
 buffer_load_dwordx4 v246, s[12:15], s36 offen lds
 v_mul_f32 v250, v176, v176
 v_mul_f32 v251, v177, v177
 v_fma_f32 v250, v250, v248, v249
 v_fma_f32 v251, v251, v248, v249
 v_mfma_f32_32x32x16_bf16 v[160:175], v[228:231], a[8:11], v[160:175]
 ds_read_b64_tr_b16 v[220:221], v241 offset:10240
 ds_read_b64_tr_b16 v[222:223], v241 offset:11264
 v_mul_f32 v250, v250, v176
 v_mul_f32 v251, v251, v177
 v_exp_f32 v250, v250
 v_mfma_f32_32x32x16_bf16 v[144:159], v[232:235], a[12:15], v[144:159]
 ds_read_b64_tr_b16 v[224:225], v240 offset:12288
 ds_read_b64_tr_b16 v[226:227], v240 offset:13312
 v_exp_f32 v251, v251
 v_add_f32 v250, 1.0, v250
 v_add_f32 v251, 1.0, v251
 v_rcp_f32 v250, v250
 v_mfma_f32_32x32x16_bf16 v[160:175], v[236:239], a[12:15], v[160:175]
 ds_read_b64_tr_b16 v[228:229], v241 offset:12288
 ds_read_b64_tr_b16 v[230:231], v241 offset:13312
 v_rcp_f32 v251, v251
 v_mul_f32 v176, v250, v176
 v_mul_f32 v177, v251, v177
 v_cvt_pk_bf16_f32 v80, v176, v177
 s_waitcnt lgkmcnt(4)
 v_mfma_f32_32x32x16_bf16 v[144:159], v[208:211], a[16:19], v[144:159]
 ds_read_b64_tr_b16 v[232:233], v240 offset:14336
 ds_read_b64_tr_b16 v[234:235], v240 offset:15360
 buffer_load_dwordx4 v247, s[12:15], s36 offen offset:1024 lds
 v_mul_f32 v250, v178, v178
 v_mul_f32 v251, v179, v179
 v_fma_f32 v250, v250, v248, v249
 v_mfma_f32_32x32x16_bf16 v[160:175], v[212:215], a[16:19], v[160:175]
 ds_read_b64_tr_b16 v[236:237], v241 offset:14336
 ds_read_b64_tr_b16 v[238:239], v241 offset:15360
 v_fma_f32 v251, v251, v248, v249
 v_mul_f32 v250, v250, v178
 v_mul_f32 v251, v251, v179
 v_mfma_f32_32x32x16_bf16 v[144:159], v[216:219], a[20:23], v[144:159]
 ds_read_b64_tr_b16 v[208:209], v240 offset:16384
 ds_read_b64_tr_b16 v[210:211], v240 offset:17408
 v_exp_f32 v250, v250
 v_exp_f32 v251, v251
 v_add_f32 v250, 1.0, v250
 v_add_f32 v251, 1.0, v251
 v_rcp_f32 v250, v250
 v_mfma_f32_32x32x16_bf16 v[160:175], v[220:223], a[20:23], v[160:175]
 ds_read_b64_tr_b16 v[212:213], v241 offset:16384
 ds_read_b64_tr_b16 v[214:215], v241 offset:17408
 v_rcp_f32 v251, v251
 v_mul_f32 v178, v250, v178
 v_mul_f32 v179, v251, v179
 v_cvt_pk_bf16_f32 v81, v178, v179
 s_waitcnt lgkmcnt(4)
 v_mfma_f32_32x32x16_bf16 v[144:159], v[224:227], a[24:27], v[144:159]
 ds_read_b64_tr_b16 v[216:217], v240 offset:18432
 ds_read_b64_tr_b16 v[218:219], v240 offset:19456
 s_add_u32 m0, s30, 90112
 s_add_u32 s36, s32, 1179648
 buffer_load_dwordx4 v246, s[12:15], s36 offen lds
 v_mul_f32 v250, v180, v180
 v_mul_f32 v251, v181, v181
 v_fma_f32 v250, v250, v248, v249
 v_mfma_f32_32x32x16_bf16 v[160:175], v[228:231], a[24:27], v[160:175]
 ds_read_b64_tr_b16 v[220:221], v241 offset:18432
 ds_read_b64_tr_b16 v[222:223], v241 offset:19456
 v_fma_f32 v251, v251, v248, v249
 v_mul_f32 v250, v250, v180
 v_mul_f32 v251, v251, v181
 v_mfma_f32_32x32x16_bf16 v[144:159], v[232:235], a[28:31], v[144:159]
 ds_read_b64_tr_b16 v[224:225], v240 offset:20480
 ds_read_b64_tr_b16 v[226:227], v240 offset:21504
 v_exp_f32 v250, v250
 v_exp_f32 v251, v251
 v_add_f32 v250, 1.0, v250
 v_add_f32 v251, 1.0, v251
 v_mfma_f32_32x32x16_bf16 v[160:175], v[236:239], a[28:31], v[160:175]
 ds_read_b64_tr_b16 v[228:229], v241 offset:20480
 ds_read_b64_tr_b16 v[230:231], v241 offset:21504
 v_rcp_f32 v250, v250
 v_rcp_f32 v251, v251
 v_mul_f32 v180, v250, v180
 v_mul_f32 v181, v251, v181
 s_waitcnt lgkmcnt(4)
 v_mfma_f32_32x32x16_bf16 v[144:159], v[208:211], a[32:35], v[144:159]
 ds_read_b64_tr_b16 v[232:233], v240 offset:22528
 ds_read_b64_tr_b16 v[234:235], v240 offset:23552
 buffer_load_dwordx4 v247, s[12:15], s36 offen offset:1024 lds
 v_cvt_pk_bf16_f32 v82, v180, v181
 v_mul_f32 v250, v182, v182
 v_mul_f32 v251, v183, v183
 v_mfma_f32_32x32x16_bf16 v[160:175], v[212:215], a[32:35], v[160:175]
 ds_read_b64_tr_b16 v[236:237], v241 offset:22528
 ds_read_b64_tr_b16 v[238:239], v241 offset:23552
 v_fma_f32 v250, v250, v248, v249
 v_fma_f32 v251, v251, v248, v249
 v_mul_f32 v250, v250, v182
 v_mul_f32 v251, v251, v183
 v_mfma_f32_32x32x16_bf16 v[144:159], v[216:219], a[36:39], v[144:159]
 ds_read_b64_tr_b16 v[208:209], v240 offset:24576
 ds_read_b64_tr_b16 v[210:211], v240 offset:25600
 v_exp_f32 v250, v250
 v_exp_f32 v251, v251
 v_add_f32 v250, 1.0, v250
 v_add_f32 v251, 1.0, v251
 v_mfma_f32_32x32x16_bf16 v[160:175], v[220:223], a[36:39], v[160:175]
 ds_read_b64_tr_b16 v[212:213], v241 offset:24576
 ds_read_b64_tr_b16 v[214:215], v241 offset:25600
 v_rcp_f32 v250, v250
 v_rcp_f32 v251, v251
 v_mul_f32 v182, v250, v182
 v_mul_f32 v183, v251, v183
 s_waitcnt lgkmcnt(4)
 v_mfma_f32_32x32x16_bf16 v[144:159], v[224:227], a[40:43], v[144:159]
 ds_read_b64_tr_b16 v[216:217], v240 offset:26624
 ds_read_b64_tr_b16 v[218:219], v240 offset:27648
 s_add_u32 m0, s30, 98304
 s_add_u32 s36, s32, 1769472
 buffer_load_dwordx4 v246, s[12:15], s36 offen lds
 v_cvt_pk_bf16_f32 v83, v182, v183
 v_mul_f32 v250, v184, v184
 v_mul_f32 v251, v185, v185
 v_mfma_f32_32x32x16_bf16 v[160:175], v[228:231], a[40:43], v[160:175]
 ds_read_b64_tr_b16 v[220:221], v241 offset:26624
 ds_read_b64_tr_b16 v[222:223], v241 offset:27648
 v_fma_f32 v250, v250, v248, v249
 v_fma_f32 v251, v251, v248, v249
 v_mul_f32 v250, v250, v184
 v_mfma_f32_32x32x16_bf16 v[144:159], v[232:235], a[44:47], v[144:159]
 ds_read_b64_tr_b16 v[224:225], v240 offset:28672
 ds_read_b64_tr_b16 v[226:227], v240 offset:29696
 v_mul_f32 v251, v251, v185
 v_exp_f32 v250, v250
 v_exp_f32 v251, v251
 v_add_f32 v250, 1.0, v250
 v_mfma_f32_32x32x16_bf16 v[160:175], v[236:239], a[44:47], v[160:175]
 ds_read_b64_tr_b16 v[228:229], v241 offset:28672
 ds_read_b64_tr_b16 v[230:231], v241 offset:29696
 v_add_f32 v251, 1.0, v251
 v_rcp_f32 v250, v250
 v_rcp_f32 v251, v251
 v_mul_f32 v184, v250, v184
 v_mul_f32 v185, v251, v185
 s_waitcnt lgkmcnt(4)
 v_mfma_f32_32x32x16_bf16 v[144:159], v[208:211], a[48:51], v[144:159]
 ds_read_b64_tr_b16 v[232:233], v240 offset:30720
 ds_read_b64_tr_b16 v[234:235], v240 offset:31744
 buffer_load_dwordx4 v247, s[12:15], s36 offen offset:1024 lds
 v_cvt_pk_bf16_f32 v84, v184, v185
 v_mul_f32 v250, v186, v186
 v_mul_f32 v251, v187, v187
 v_mfma_f32_32x32x16_bf16 v[160:175], v[212:215], a[48:51], v[160:175]
 ds_read_b64_tr_b16 v[236:237], v241 offset:30720
 ds_read_b64_tr_b16 v[238:239], v241 offset:31744
 v_fma_f32 v250, v250, v248, v249
 v_fma_f32 v251, v251, v248, v249
 v_mul_f32 v250, v250, v186
 v_mfma_f32_32x32x16_bf16 v[144:159], v[216:219], a[52:55], v[144:159]
 ds_read_b64_tr_b16 v[208:209], v240 offset:32768
 ds_read_b64_tr_b16 v[210:211], v240 offset:33792
 v_mul_f32 v251, v251, v187
 v_exp_f32 v250, v250
 v_exp_f32 v251, v251
 v_add_f32 v250, 1.0, v250
 v_mfma_f32_32x32x16_bf16 v[160:175], v[220:223], a[52:55], v[160:175]
 ds_read_b64_tr_b16 v[212:213], v241 offset:32768
 ds_read_b64_tr_b16 v[214:215], v241 offset:33792
 v_add_f32 v251, 1.0, v251
 v_rcp_f32 v250, v250
 v_rcp_f32 v251, v251
 v_mul_f32 v186, v250, v186
 s_waitcnt lgkmcnt(4)
 v_mfma_f32_32x32x16_bf16 v[144:159], v[224:227], a[56:59], v[144:159]
 ds_read_b64_tr_b16 v[216:217], v240 offset:34816
 ds_read_b64_tr_b16 v[218:219], v240 offset:35840
 s_add_u32 m0, s30, 106496
 s_add_u32 s36, s32, 2359296
 buffer_load_dwordx4 v246, s[12:15], s36 offen lds
 v_mul_f32 v187, v251, v187
 v_cvt_pk_bf16_f32 v85, v186, v187
 v_mul_f32 v250, v188, v188
 v_mfma_f32_32x32x16_bf16 v[160:175], v[228:231], a[56:59], v[160:175]
 ds_read_b64_tr_b16 v[220:221], v241 offset:34816
 ds_read_b64_tr_b16 v[222:223], v241 offset:35840
 s_waitcnt vmcnt(9)
 s_barrier
 v_mfma_f32_32x32x16_bf16 v[144:159], v[232:235], a[60:63], v[144:159]
 ds_read_b64_tr_b16 v[224:225], v240 offset:36864
 ds_read_b64_tr_b16 v[226:227], v240 offset:37888
 v_mul_f32 v251, v189, v189
 v_fma_f32 v250, v250, v248, v249
 v_fma_f32 v251, v251, v248, v249
 v_mfma_f32_32x32x16_bf16 v[160:175], v[236:239], a[60:63], v[160:175]
 ds_read_b64_tr_b16 v[228:229], v241 offset:36864
 ds_read_b64_tr_b16 v[230:231], v241 offset:37888
 v_mul_f32 v250, v250, v188
 v_mul_f32 v251, v251, v189
 v_exp_f32 v250, v250
 v_exp_f32 v251, v251
 v_add_f32 v250, 1.0, v250
 s_waitcnt lgkmcnt(4)
 v_mfma_f32_32x32x16_bf16 v[144:159], v[208:211], a[64:67], v[144:159]
 ds_read_b64_tr_b16 v[232:233], v240 offset:38912
 ds_read_b64_tr_b16 v[234:235], v240 offset:39936
 buffer_load_dwordx4 v247, s[12:15], s36 offen offset:1024 lds
 v_add_f32 v251, 1.0, v251
 v_rcp_f32 v250, v250
 v_rcp_f32 v251, v251
 v_mul_f32 v188, v250, v188
 v_mfma_f32_32x32x16_bf16 v[160:175], v[212:215], a[64:67], v[160:175]
 ds_read_b64_tr_b16 v[236:237], v241 offset:38912
 ds_read_b64_tr_b16 v[238:239], v241 offset:39936
 v_mul_f32 v189, v251, v189
 v_cvt_pk_bf16_f32 v86, v188, v189
 v_mul_f32 v250, v190, v190
 v_mfma_f32_32x32x16_bf16 v[144:159], v[216:219], a[68:71], v[144:159]
 ds_read_b64_tr_b16 v[208:209], v240 offset:40960
 ds_read_b64_tr_b16 v[210:211], v240 offset:41984
 v_mul_f32 v251, v191, v191
 v_fma_f32 v250, v250, v248, v249
 v_fma_f32 v251, v251, v248, v249
 v_mfma_f32_32x32x16_bf16 v[160:175], v[220:223], a[68:71], v[160:175]
 ds_read_b64_tr_b16 v[212:213], v241 offset:40960
 ds_read_b64_tr_b16 v[214:215], v241 offset:41984
 v_mul_f32 v250, v250, v190
 v_mul_f32 v251, v251, v191
 v_exp_f32 v250, v250
 s_waitcnt lgkmcnt(4)
 v_mfma_f32_32x32x16_bf16 v[144:159], v[224:227], a[72:75], v[144:159]
 ds_read_b64_tr_b16 v[216:217], v240 offset:43008
 ds_read_b64_tr_b16 v[218:219], v240 offset:44032
 s_add_u32 m0, s30, 114688
 s_add_u32 s36, s32, 2949120
 buffer_load_dwordx4 v246, s[12:15], s36 offen lds
 v_exp_f32 v251, v251
 v_add_f32 v250, 1.0, v250
 v_add_f32 v251, 1.0, v251
 v_rcp_f32 v250, v250
 v_mfma_f32_32x32x16_bf16 v[160:175], v[228:231], a[72:75], v[160:175]
 ds_read_b64_tr_b16 v[220:221], v241 offset:43008
 ds_read_b64_tr_b16 v[222:223], v241 offset:44032
 v_rcp_f32 v251, v251
 v_mul_f32 v190, v250, v190
 v_mul_f32 v191, v251, v191
 v_cvt_pk_bf16_f32 v87, v190, v191
 v_mfma_f32_32x32x16_bf16 v[144:159], v[232:235], a[76:79], v[144:159]
 ds_read_b64_tr_b16 v[224:225], v240 offset:45056
 ds_read_b64_tr_b16 v[226:227], v240 offset:46080
 v_mul_f32 v250, v192, v192
 v_mul_f32 v251, v193, v193
 v_fma_f32 v250, v250, v248, v249
 v_fma_f32 v251, v251, v248, v249
 v_mfma_f32_32x32x16_bf16 v[160:175], v[236:239], a[76:79], v[160:175]
 ds_read_b64_tr_b16 v[228:229], v241 offset:45056
 ds_read_b64_tr_b16 v[230:231], v241 offset:46080
 v_mul_f32 v250, v250, v192
 v_mul_f32 v251, v251, v193
 v_exp_f32 v250, v250
 s_waitcnt lgkmcnt(4)
 v_mfma_f32_32x32x16_bf16 v[144:159], v[208:211], a[80:83], v[144:159]
 ds_read_b64_tr_b16 v[232:233], v240 offset:47104
 ds_read_b64_tr_b16 v[234:235], v240 offset:48128
 buffer_load_dwordx4 v247, s[12:15], s36 offen offset:1024 lds
 v_exp_f32 v251, v251
 v_add_f32 v250, 1.0, v250
 v_add_f32 v251, 1.0, v251
 v_rcp_f32 v250, v250
 v_mfma_f32_32x32x16_bf16 v[160:175], v[212:215], a[80:83], v[160:175]
 ds_read_b64_tr_b16 v[236:237], v241 offset:47104
 ds_read_b64_tr_b16 v[238:239], v241 offset:48128
 v_rcp_f32 v251, v251
 v_mul_f32 v192, v250, v192
 v_mul_f32 v193, v251, v193
 v_cvt_pk_bf16_f32 v88, v192, v193
 v_mfma_f32_32x32x16_bf16 v[144:159], v[216:219], a[84:87], v[144:159]
 ds_read_b64_tr_b16 v[208:209], v242 offset:0
 ds_read_b64_tr_b16 v[210:211], v242 offset:1024
 v_mul_f32 v250, v194, v194
 v_mul_f32 v251, v195, v195
 v_fma_f32 v250, v250, v248, v249
 v_mfma_f32_32x32x16_bf16 v[160:175], v[220:223], a[84:87], v[160:175]
 ds_read_b64_tr_b16 v[212:213], v243 offset:0
 ds_read_b64_tr_b16 v[214:215], v243 offset:1024
 v_fma_f32 v251, v251, v248, v249
 v_mul_f32 v250, v250, v194
 v_mul_f32 v251, v251, v195
 s_waitcnt lgkmcnt(4)
 v_mfma_f32_32x32x16_bf16 v[144:159], v[224:227], a[88:91], v[144:159]
 ds_read_b64_tr_b16 v[216:217], v242 offset:2048
 ds_read_b64_tr_b16 v[218:219], v242 offset:3072
 s_add_u32 m0, s30, 122880
 s_add_u32 s36, s32, 3538944
 buffer_load_dwordx4 v246, s[12:15], s36 offen lds
 v_exp_f32 v250, v250
 v_exp_f32 v251, v251
 v_add_f32 v250, 1.0, v250
 v_add_f32 v251, 1.0, v251
 v_rcp_f32 v250, v250
 v_mfma_f32_32x32x16_bf16 v[160:175], v[228:231], a[88:91], v[160:175]
 ds_read_b64_tr_b16 v[220:221], v243 offset:2048
 ds_read_b64_tr_b16 v[222:223], v243 offset:3072
 v_rcp_f32 v251, v251
 v_mul_f32 v194, v250, v194
 v_mul_f32 v195, v251, v195
 v_cvt_pk_bf16_f32 v89, v194, v195
 v_mfma_f32_32x32x16_bf16 v[144:159], v[232:235], a[92:95], v[144:159]
 ds_read_b64_tr_b16 v[224:225], v242 offset:4096
 ds_read_b64_tr_b16 v[226:227], v242 offset:5120
 v_mul_f32 v250, v196, v196
 v_mul_f32 v251, v197, v197
 v_fma_f32 v250, v250, v248, v249
 v_mfma_f32_32x32x16_bf16 v[160:175], v[236:239], a[92:95], v[160:175]
 ds_read_b64_tr_b16 v[228:229], v243 offset:4096
 ds_read_b64_tr_b16 v[230:231], v243 offset:5120
 v_fma_f32 v251, v251, v248, v249
 v_mul_f32 v250, v250, v196
 v_mul_f32 v251, v251, v197
 s_waitcnt lgkmcnt(4)
 v_mfma_f32_32x32x16_bf16 v[144:159], v[208:211], a[96:99], v[144:159]
 ds_read_b64_tr_b16 v[232:233], v242 offset:6144
 ds_read_b64_tr_b16 v[234:235], v242 offset:7168
 buffer_load_dwordx4 v247, s[12:15], s36 offen offset:1024 lds
 v_exp_f32 v250, v250
 v_exp_f32 v251, v251
 v_add_f32 v250, 1.0, v250
 v_add_f32 v251, 1.0, v251
 v_mfma_f32_32x32x16_bf16 v[160:175], v[212:215], a[96:99], v[160:175]
 ds_read_b64_tr_b16 v[236:237], v243 offset:6144
 ds_read_b64_tr_b16 v[238:239], v243 offset:7168
 v_rcp_f32 v250, v250
 v_rcp_f32 v251, v251
 v_mul_f32 v196, v250, v196
 v_mul_f32 v197, v251, v197
 v_mfma_f32_32x32x16_bf16 v[144:159], v[216:219], a[100:103], v[144:159]
 ds_read_b64_tr_b16 v[208:209], v242 offset:8192
 ds_read_b64_tr_b16 v[210:211], v242 offset:9216
 v_cvt_pk_bf16_f32 v90, v196, v197
 v_mul_f32 v250, v198, v198
 v_mul_f32 v251, v199, v199
 v_mfma_f32_32x32x16_bf16 v[160:175], v[220:223], a[100:103], v[160:175]
 ds_read_b64_tr_b16 v[212:213], v243 offset:8192
 ds_read_b64_tr_b16 v[214:215], v243 offset:9216
 v_fma_f32 v250, v250, v248, v249
 v_fma_f32 v251, v251, v248, v249
 v_mul_f32 v250, v250, v198
 v_mul_f32 v251, v251, v199
 s_waitcnt lgkmcnt(4)
 v_mfma_f32_32x32x16_bf16 v[144:159], v[224:227], a[104:107], v[144:159]
 ds_read_b64_tr_b16 v[216:217], v242 offset:10240
 ds_read_b64_tr_b16 v[218:219], v242 offset:11264
 s_add_u32 m0, s30, 131072
 s_add_u32 s36, s32, 4128768
 buffer_load_dwordx4 v246, s[12:15], s36 offen lds
 v_exp_f32 v250, v250
 v_exp_f32 v251, v251
 v_add_f32 v250, 1.0, v250
 v_add_f32 v251, 1.0, v251
 v_mfma_f32_32x32x16_bf16 v[160:175], v[228:231], a[104:107], v[160:175]
 ds_read_b64_tr_b16 v[220:221], v243 offset:10240
 ds_read_b64_tr_b16 v[222:223], v243 offset:11264
 v_rcp_f32 v250, v250
 v_rcp_f32 v251, v251
 v_mul_f32 v198, v250, v198
 v_mul_f32 v199, v251, v199
 v_mfma_f32_32x32x16_bf16 v[144:159], v[232:235], a[108:111], v[144:159]
 ds_read_b64_tr_b16 v[224:225], v242 offset:12288
 ds_read_b64_tr_b16 v[226:227], v242 offset:13312
 v_cvt_pk_bf16_f32 v91, v198, v199
 v_mul_f32 v250, v200, v200
 v_mul_f32 v251, v201, v201
 v_mfma_f32_32x32x16_bf16 v[160:175], v[236:239], a[108:111], v[160:175]
 ds_read_b64_tr_b16 v[228:229], v243 offset:12288
 ds_read_b64_tr_b16 v[230:231], v243 offset:13312
 v_fma_f32 v250, v250, v248, v249
 v_fma_f32 v251, v251, v248, v249
 v_mul_f32 v250, v250, v200
 s_waitcnt lgkmcnt(4)
 v_mfma_f32_32x32x16_bf16 v[144:159], v[208:211], a[112:115], v[144:159]
 ds_read_b64_tr_b16 v[232:233], v242 offset:14336
 ds_read_b64_tr_b16 v[234:235], v242 offset:15360
 buffer_load_dwordx4 v247, s[12:15], s36 offen offset:1024 lds
 v_mul_f32 v251, v251, v201
 v_exp_f32 v250, v250
 v_exp_f32 v251, v251
 v_add_f32 v250, 1.0, v250
 v_mfma_f32_32x32x16_bf16 v[160:175], v[212:215], a[112:115], v[160:175]
 ds_read_b64_tr_b16 v[236:237], v243 offset:14336
 ds_read_b64_tr_b16 v[238:239], v243 offset:15360
 v_add_f32 v251, 1.0, v251
 v_rcp_f32 v250, v250
 v_rcp_f32 v251, v251
 v_mul_f32 v200, v250, v200
 v_mul_f32 v201, v251, v201
 v_mfma_f32_32x32x16_bf16 v[144:159], v[216:219], a[116:119], v[144:159]
 ds_read_b64_tr_b16 v[208:209], v242 offset:16384
 ds_read_b64_tr_b16 v[210:211], v242 offset:17408
 v_cvt_pk_bf16_f32 v92, v200, v201
 v_mul_f32 v250, v202, v202
 v_mul_f32 v251, v203, v203
 v_mfma_f32_32x32x16_bf16 v[160:175], v[220:223], a[116:119], v[160:175]
 ds_read_b64_tr_b16 v[212:213], v243 offset:16384
 ds_read_b64_tr_b16 v[214:215], v243 offset:17408
 v_fma_f32 v250, v250, v248, v249
 v_fma_f32 v251, v251, v248, v249
 v_mul_f32 v250, v250, v202
 s_waitcnt lgkmcnt(4)
 v_mfma_f32_32x32x16_bf16 v[144:159], v[224:227], a[120:123], v[144:159]
 ds_read_b64_tr_b16 v[216:217], v242 offset:18432
 ds_read_b64_tr_b16 v[218:219], v242 offset:19456
 s_add_u32 m0, s30, 139264
 s_add_u32 s36, s32, 4718592
 buffer_load_dwordx4 v246, s[12:15], s36 offen lds
 v_mul_f32 v251, v251, v203
 v_exp_f32 v250, v250
 v_exp_f32 v251, v251
 v_add_f32 v250, 1.0, v250
 v_mfma_f32_32x32x16_bf16 v[160:175], v[228:231], a[120:123], v[160:175]
 ds_read_b64_tr_b16 v[220:221], v243 offset:18432
 ds_read_b64_tr_b16 v[222:223], v243 offset:19456
 v_add_f32 v251, 1.0, v251
 v_rcp_f32 v250, v250
 v_rcp_f32 v251, v251
 v_mul_f32 v202, v250, v202
 v_mfma_f32_32x32x16_bf16 v[144:159], v[232:235], a[124:127], v[144:159]
 ds_read_b64_tr_b16 v[224:225], v242 offset:20480
 ds_read_b64_tr_b16 v[226:227], v242 offset:21504
 v_mul_f32 v203, v251, v203
 v_cvt_pk_bf16_f32 v93, v202, v203
 v_mul_f32 v250, v204, v204
 v_mfma_f32_32x32x16_bf16 v[160:175], v[236:239], a[124:127], v[160:175]
 ds_read_b64_tr_b16 v[228:229], v243 offset:20480
 ds_read_b64_tr_b16 v[230:231], v243 offset:21504
 v_mul_f32 v251, v205, v205
 v_fma_f32 v250, v250, v248, v249
 v_fma_f32 v251, v251, v248, v249
 s_waitcnt lgkmcnt(4)
 v_mfma_f32_32x32x16_bf16 v[144:159], v[208:211], a[128:131], v[144:159]
 ds_read_b64_tr_b16 v[232:233], v242 offset:22528
 ds_read_b64_tr_b16 v[234:235], v242 offset:23552
 buffer_load_dwordx4 v247, s[12:15], s36 offen offset:1024 lds
 v_mul_f32 v250, v250, v204
 v_mul_f32 v251, v251, v205
 v_exp_f32 v250, v250
 v_exp_f32 v251, v251
 v_add_f32 v250, 1.0, v250
 v_mfma_f32_32x32x16_bf16 v[160:175], v[212:215], a[128:131], v[160:175]
 ds_read_b64_tr_b16 v[236:237], v243 offset:22528
 ds_read_b64_tr_b16 v[238:239], v243 offset:23552
 s_waitcnt vmcnt(8)
 s_barrier
 v_mfma_f32_32x32x16_bf16 v[144:159], v[216:219], a[132:135], v[144:159]
 ds_read_b64_tr_b16 v[208:209], v242 offset:24576
 ds_read_b64_tr_b16 v[210:211], v242 offset:25600
 v_add_f32 v251, 1.0, v251
 v_rcp_f32 v250, v250
 v_rcp_f32 v251, v251
 v_mul_f32 v204, v250, v204
 v_mfma_f32_32x32x16_bf16 v[160:175], v[220:223], a[132:135], v[160:175]
 ds_read_b64_tr_b16 v[212:213], v243 offset:24576
 ds_read_b64_tr_b16 v[214:215], v243 offset:25600
 v_mul_f32 v205, v251, v205
 v_cvt_pk_bf16_f32 v94, v204, v205
 v_mul_f32 v250, v206, v206
 s_waitcnt lgkmcnt(4)
 v_mfma_f32_32x32x16_bf16 v[144:159], v[224:227], a[136:139], v[144:159]
 ds_read_b64_tr_b16 v[216:217], v242 offset:26624
 ds_read_b64_tr_b16 v[218:219], v242 offset:27648
 s_add_u32 m0, s30, 0
 s_add_u32 s32, s32, 128
 s_cmp_ge_u32 s32, s39
 s_cselect_b32 s3, 1152, 0
 s_sub_u32 s32, s32, s3
 s_add_u32 s36, s32, 0
 buffer_load_dwordx4 v246, s[12:15], s36 offen lds
 v_mul_f32 v251, v207, v207
 v_fma_f32 v250, v250, v248, v249
 v_fma_f32 v251, v251, v248, v249
 v_mfma_f32_32x32x16_bf16 v[160:175], v[228:231], a[136:139], v[160:175]
 ds_read_b64_tr_b16 v[220:221], v243 offset:26624
 ds_read_b64_tr_b16 v[222:223], v243 offset:27648
 v_mul_f32 v250, v250, v206
 v_mul_f32 v251, v251, v207
 v_exp_f32 v250, v250
 v_mfma_f32_32x32x16_bf16 v[144:159], v[232:235], a[140:143], v[144:159]
 ds_read_b64_tr_b16 v[224:225], v242 offset:28672
 ds_read_b64_tr_b16 v[226:227], v242 offset:29696
 v_exp_f32 v251, v251
 v_add_f32 v250, 1.0, v250
 v_add_f32 v251, 1.0, v251
 v_rcp_f32 v250, v250
 v_mfma_f32_32x32x16_bf16 v[160:175], v[236:239], a[140:143], v[160:175]
 ds_read_b64_tr_b16 v[228:229], v243 offset:28672
 ds_read_b64_tr_b16 v[230:231], v243 offset:29696
 v_rcp_f32 v251, v251
 v_mul_f32 v206, v250, v206
 v_mul_f32 v207, v251, v207
 v_cvt_pk_bf16_f32 v95, v206, v207
 s_waitcnt lgkmcnt(4)
 v_mfma_f32_32x32x16_bf16 v[176:191], v[208:211], a[0:3], 0
 ds_read_b64_tr_b16 v[232:233], v242 offset:30720
 ds_read_b64_tr_b16 v[234:235], v242 offset:31744
 buffer_load_dwordx4 v247, s[12:15], s36 offen offset:1024 lds
 v_mfma_f32_32x32x16_bf16 v[192:207], v[212:215], a[0:3], 0
 ds_read_b64_tr_b16 v[236:237], v243 offset:30720
 ds_read_b64_tr_b16 v[238:239], v243 offset:31744
 v_mfma_f32_32x32x16_bf16 v[176:191], v[216:219], a[4:7], v[176:191]
 ds_read_b64_tr_b16 v[208:209], v242 offset:32768
 ds_read_b64_tr_b16 v[210:211], v242 offset:33792
 v_mfma_f32_32x32x16_bf16 v[192:207], v[220:223], a[4:7], v[192:207]
 ds_read_b64_tr_b16 v[212:213], v243 offset:32768
 ds_read_b64_tr_b16 v[214:215], v243 offset:33792
 s_waitcnt lgkmcnt(4)
 v_mfma_f32_32x32x16_bf16 v[176:191], v[224:227], a[8:11], v[176:191]
 ds_read_b64_tr_b16 v[216:217], v242 offset:34816
 ds_read_b64_tr_b16 v[218:219], v242 offset:35840
 s_add_u32 m0, s30, 8192
 s_add_u32 s36, s32, 589824
 buffer_load_dwordx4 v246, s[12:15], s36 offen lds
 v_mul_f32 v250, v144, v144
 v_mul_f32 v251, v145, v145
 v_fma_f32 v250, v250, v248, v249
 v_fma_f32 v251, v251, v248, v249
 v_mfma_f32_32x32x16_bf16 v[192:207], v[228:231], a[8:11], v[192:207]
 ds_read_b64_tr_b16 v[220:221], v243 offset:34816
 ds_read_b64_tr_b16 v[222:223], v243 offset:35840
 v_mul_f32 v250, v250, v144
 v_mul_f32 v251, v251, v145
 v_exp_f32 v250, v250
 v_mfma_f32_32x32x16_bf16 v[176:191], v[232:235], a[12:15], v[176:191]
 ds_read_b64_tr_b16 v[224:225], v242 offset:36864
 ds_read_b64_tr_b16 v[226:227], v242 offset:37888
 v_exp_f32 v251, v251
 v_add_f32 v250, 1.0, v250
 v_add_f32 v251, 1.0, v251
 v_rcp_f32 v250, v250
 v_mfma_f32_32x32x16_bf16 v[192:207], v[236:239], a[12:15], v[192:207]
 ds_read_b64_tr_b16 v[228:229], v243 offset:36864
 ds_read_b64_tr_b16 v[230:231], v243 offset:37888
 v_rcp_f32 v251, v251
 v_mul_f32 v144, v250, v144
 v_mul_f32 v145, v251, v145
 v_cvt_pk_bf16_f32 v96, v144, v145
 s_waitcnt lgkmcnt(4)
 v_mfma_f32_32x32x16_bf16 v[176:191], v[208:211], a[16:19], v[176:191]
 ds_read_b64_tr_b16 v[232:233], v242 offset:38912
 ds_read_b64_tr_b16 v[234:235], v242 offset:39936
 buffer_load_dwordx4 v247, s[12:15], s36 offen offset:1024 lds
 v_mul_f32 v250, v146, v146
 v_mul_f32 v251, v147, v147
 v_fma_f32 v250, v250, v248, v249
 v_mfma_f32_32x32x16_bf16 v[192:207], v[212:215], a[16:19], v[192:207]
 ds_read_b64_tr_b16 v[236:237], v243 offset:38912
 ds_read_b64_tr_b16 v[238:239], v243 offset:39936
 v_fma_f32 v251, v251, v248, v249
 v_mul_f32 v250, v250, v146
 v_mul_f32 v251, v251, v147
 v_mfma_f32_32x32x16_bf16 v[176:191], v[216:219], a[20:23], v[176:191]
 ds_read_b64_tr_b16 v[208:209], v242 offset:40960
 ds_read_b64_tr_b16 v[210:211], v242 offset:41984
 v_exp_f32 v250, v250
 v_exp_f32 v251, v251
 v_add_f32 v250, 1.0, v250
 v_add_f32 v251, 1.0, v251
 v_rcp_f32 v250, v250
 v_mfma_f32_32x32x16_bf16 v[192:207], v[220:223], a[20:23], v[192:207]
 ds_read_b64_tr_b16 v[212:213], v243 offset:40960
 ds_read_b64_tr_b16 v[214:215], v243 offset:41984
 v_rcp_f32 v251, v251
 v_mul_f32 v146, v250, v146
 v_mul_f32 v147, v251, v147
 v_cvt_pk_bf16_f32 v97, v146, v147
 s_waitcnt lgkmcnt(4)
 v_mfma_f32_32x32x16_bf16 v[176:191], v[224:227], a[24:27], v[176:191]
 ds_read_b64_tr_b16 v[216:217], v242 offset:43008
 ds_read_b64_tr_b16 v[218:219], v242 offset:44032
 s_add_u32 m0, s30, 16384
 s_add_u32 s36, s32, 1179648
 buffer_load_dwordx4 v246, s[12:15], s36 offen lds
 v_mul_f32 v250, v148, v148
 v_mul_f32 v251, v149, v149
 v_fma_f32 v250, v250, v248, v249
 v_mfma_f32_32x32x16_bf16 v[192:207], v[228:231], a[24:27], v[192:207]
 ds_read_b64_tr_b16 v[220:221], v243 offset:43008
 ds_read_b64_tr_b16 v[222:223], v243 offset:44032
 v_fma_f32 v251, v251, v248, v249
 v_mul_f32 v250, v250, v148
 v_mul_f32 v251, v251, v149
 v_mfma_f32_32x32x16_bf16 v[176:191], v[232:235], a[28:31], v[176:191]
 ds_read_b64_tr_b16 v[224:225], v242 offset:45056
 ds_read_b64_tr_b16 v[226:227], v242 offset:46080
 v_exp_f32 v250, v250
 v_exp_f32 v251, v251
 v_add_f32 v250, 1.0, v250
 v_add_f32 v251, 1.0, v251
 v_mfma_f32_32x32x16_bf16 v[192:207], v[236:239], a[28:31], v[192:207]
 ds_read_b64_tr_b16 v[228:229], v243 offset:45056
 ds_read_b64_tr_b16 v[230:231], v243 offset:46080
 v_rcp_f32 v250, v250
 v_rcp_f32 v251, v251
 v_mul_f32 v148, v250, v148
 v_mul_f32 v149, v251, v149
 s_waitcnt lgkmcnt(4)
 v_mfma_f32_32x32x16_bf16 v[176:191], v[208:211], a[32:35], v[176:191]
 ds_read_b64_tr_b16 v[232:233], v242 offset:47104
 ds_read_b64_tr_b16 v[234:235], v242 offset:48128
 buffer_load_dwordx4 v247, s[12:15], s36 offen offset:1024 lds
 v_cvt_pk_bf16_f32 v98, v148, v149
 v_mul_f32 v250, v150, v150
 v_mul_f32 v251, v151, v151
 v_mfma_f32_32x32x16_bf16 v[192:207], v[212:215], a[32:35], v[192:207]
 ds_read_b64_tr_b16 v[236:237], v243 offset:47104
 ds_read_b64_tr_b16 v[238:239], v243 offset:48128
 v_fma_f32 v250, v250, v248, v249
 v_fma_f32 v251, v251, v248, v249
 v_mul_f32 v250, v250, v150
 v_mul_f32 v251, v251, v151
 v_mfma_f32_32x32x16_bf16 v[176:191], v[216:219], a[36:39], v[176:191]
 ds_read_b64_tr_b16 v[208:209], v244 offset:0
 ds_read_b64_tr_b16 v[210:211], v244 offset:1024
 v_exp_f32 v250, v250
 v_exp_f32 v251, v251
 v_add_f32 v250, 1.0, v250
 v_add_f32 v251, 1.0, v251
 v_mfma_f32_32x32x16_bf16 v[192:207], v[220:223], a[36:39], v[192:207]
 ds_read_b64_tr_b16 v[212:213], v245 offset:0
 ds_read_b64_tr_b16 v[214:215], v245 offset:1024
 v_rcp_f32 v250, v250
 v_rcp_f32 v251, v251
 v_mul_f32 v150, v250, v150
 v_mul_f32 v151, v251, v151
 s_waitcnt lgkmcnt(4)
 v_mfma_f32_32x32x16_bf16 v[176:191], v[224:227], a[40:43], v[176:191]
 ds_read_b64_tr_b16 v[216:217], v244 offset:2048
 ds_read_b64_tr_b16 v[218:219], v244 offset:3072
 s_add_u32 m0, s30, 24576
 s_add_u32 s36, s32, 1769472
 buffer_load_dwordx4 v246, s[12:15], s36 offen lds
 v_cvt_pk_bf16_f32 v99, v150, v151
 v_mul_f32 v250, v152, v152
 v_mul_f32 v251, v153, v153
 v_mfma_f32_32x32x16_bf16 v[192:207], v[228:231], a[40:43], v[192:207]
 ds_read_b64_tr_b16 v[220:221], v245 offset:2048
 ds_read_b64_tr_b16 v[222:223], v245 offset:3072
 v_fma_f32 v250, v250, v248, v249
 v_fma_f32 v251, v251, v248, v249
 v_mul_f32 v250, v250, v152
 v_mfma_f32_32x32x16_bf16 v[176:191], v[232:235], a[44:47], v[176:191]
 ds_read_b64_tr_b16 v[224:225], v244 offset:4096
 ds_read_b64_tr_b16 v[226:227], v244 offset:5120
 v_mul_f32 v251, v251, v153
 v_exp_f32 v250, v250
 v_exp_f32 v251, v251
 v_add_f32 v250, 1.0, v250
 v_mfma_f32_32x32x16_bf16 v[192:207], v[236:239], a[44:47], v[192:207]
 ds_read_b64_tr_b16 v[228:229], v245 offset:4096
 ds_read_b64_tr_b16 v[230:231], v245 offset:5120
 v_add_f32 v251, 1.0, v251
 v_rcp_f32 v250, v250
 v_rcp_f32 v251, v251
 v_mul_f32 v152, v250, v152
 v_mul_f32 v153, v251, v153
 s_waitcnt lgkmcnt(4)
 v_mfma_f32_32x32x16_bf16 v[176:191], v[208:211], a[48:51], v[176:191]
 ds_read_b64_tr_b16 v[232:233], v244 offset:6144
 ds_read_b64_tr_b16 v[234:235], v244 offset:7168
 buffer_load_dwordx4 v247, s[12:15], s36 offen offset:1024 lds
 v_cvt_pk_bf16_f32 v100, v152, v153
 v_mul_f32 v250, v154, v154
 v_mul_f32 v251, v155, v155
 v_mfma_f32_32x32x16_bf16 v[192:207], v[212:215], a[48:51], v[192:207]
 ds_read_b64_tr_b16 v[236:237], v245 offset:6144
 ds_read_b64_tr_b16 v[238:239], v245 offset:7168
 v_fma_f32 v250, v250, v248, v249
 v_fma_f32 v251, v251, v248, v249
 v_mul_f32 v250, v250, v154
 v_mfma_f32_32x32x16_bf16 v[176:191], v[216:219], a[52:55], v[176:191]
 ds_read_b64_tr_b16 v[208:209], v244 offset:8192
 ds_read_b64_tr_b16 v[210:211], v244 offset:9216
 v_mul_f32 v251, v251, v155
 v_exp_f32 v250, v250
 v_exp_f32 v251, v251
 v_add_f32 v250, 1.0, v250
 v_mfma_f32_32x32x16_bf16 v[192:207], v[220:223], a[52:55], v[192:207]
 ds_read_b64_tr_b16 v[212:213], v245 offset:8192
 ds_read_b64_tr_b16 v[214:215], v245 offset:9216
 v_add_f32 v251, 1.0, v251
 v_rcp_f32 v250, v250
 v_rcp_f32 v251, v251
 v_mul_f32 v154, v250, v154
 s_waitcnt lgkmcnt(4)
 v_mfma_f32_32x32x16_bf16 v[176:191], v[224:227], a[56:59], v[176:191]
 ds_read_b64_tr_b16 v[216:217], v244 offset:10240
 ds_read_b64_tr_b16 v[218:219], v244 offset:11264
 s_add_u32 m0, s30, 32768
 s_add_u32 s36, s32, 2359296
 buffer_load_dwordx4 v246, s[12:15], s36 offen lds
 v_mul_f32 v155, v251, v155
 v_cvt_pk_bf16_f32 v101, v154, v155
 v_mul_f32 v250, v156, v156
 v_mfma_f32_32x32x16_bf16 v[192:207], v[228:231], a[56:59], v[192:207]
 ds_read_b64_tr_b16 v[220:221], v245 offset:10240
 ds_read_b64_tr_b16 v[222:223], v245 offset:11264
 s_waitcnt vmcnt(9)
 s_barrier
 v_mfma_f32_32x32x16_bf16 v[176:191], v[232:235], a[60:63], v[176:191]
 ds_read_b64_tr_b16 v[224:225], v244 offset:12288
 ds_read_b64_tr_b16 v[226:227], v244 offset:13312
 v_mul_f32 v251, v157, v157
 v_fma_f32 v250, v250, v248, v249
 v_fma_f32 v251, v251, v248, v249
 v_mfma_f32_32x32x16_bf16 v[192:207], v[236:239], a[60:63], v[192:207]
 ds_read_b64_tr_b16 v[228:229], v245 offset:12288
 ds_read_b64_tr_b16 v[230:231], v245 offset:13312
 v_mul_f32 v250, v250, v156
 v_mul_f32 v251, v251, v157
 v_exp_f32 v250, v250
 v_exp_f32 v251, v251
 v_add_f32 v250, 1.0, v250
 s_waitcnt lgkmcnt(4)
 v_mfma_f32_32x32x16_bf16 v[176:191], v[208:211], a[64:67], v[176:191]
 ds_read_b64_tr_b16 v[232:233], v244 offset:14336
 ds_read_b64_tr_b16 v[234:235], v244 offset:15360
 buffer_load_dwordx4 v247, s[12:15], s36 offen offset:1024 lds
 v_add_f32 v251, 1.0, v251
 v_rcp_f32 v250, v250
 v_rcp_f32 v251, v251
 v_mul_f32 v156, v250, v156
 v_mfma_f32_32x32x16_bf16 v[192:207], v[212:215], a[64:67], v[192:207]
 ds_read_b64_tr_b16 v[236:237], v245 offset:14336
 ds_read_b64_tr_b16 v[238:239], v245 offset:15360
 v_mul_f32 v157, v251, v157
 v_cvt_pk_bf16_f32 v102, v156, v157
 v_mul_f32 v250, v158, v158
 v_mfma_f32_32x32x16_bf16 v[176:191], v[216:219], a[68:71], v[176:191]
 ds_read_b64_tr_b16 v[208:209], v244 offset:16384
 ds_read_b64_tr_b16 v[210:211], v244 offset:17408
 v_mul_f32 v251, v159, v159
 v_fma_f32 v250, v250, v248, v249
 v_fma_f32 v251, v251, v248, v249
 v_mfma_f32_32x32x16_bf16 v[192:207], v[220:223], a[68:71], v[192:207]
 ds_read_b64_tr_b16 v[212:213], v245 offset:16384
 ds_read_b64_tr_b16 v[214:215], v245 offset:17408
 v_mul_f32 v250, v250, v158
 v_mul_f32 v251, v251, v159
 v_exp_f32 v250, v250
 s_waitcnt lgkmcnt(4)
 v_mfma_f32_32x32x16_bf16 v[176:191], v[224:227], a[72:75], v[176:191]
 ds_read_b64_tr_b16 v[216:217], v244 offset:18432
 ds_read_b64_tr_b16 v[218:219], v244 offset:19456
 s_add_u32 m0, s30, 40960
 s_add_u32 s36, s32, 2949120
 buffer_load_dwordx4 v246, s[12:15], s36 offen lds
 v_exp_f32 v251, v251
 v_add_f32 v250, 1.0, v250
 v_add_f32 v251, 1.0, v251
 v_rcp_f32 v250, v250
 v_mfma_f32_32x32x16_bf16 v[192:207], v[228:231], a[72:75], v[192:207]
 ds_read_b64_tr_b16 v[220:221], v245 offset:18432
 ds_read_b64_tr_b16 v[222:223], v245 offset:19456
 v_rcp_f32 v251, v251
 v_mul_f32 v158, v250, v158
 v_mul_f32 v159, v251, v159
 v_cvt_pk_bf16_f32 v103, v158, v159
 v_mfma_f32_32x32x16_bf16 v[176:191], v[232:235], a[76:79], v[176:191]
 ds_read_b64_tr_b16 v[224:225], v244 offset:20480
 ds_read_b64_tr_b16 v[226:227], v244 offset:21504
 v_mul_f32 v250, v160, v160
 v_mul_f32 v251, v161, v161
 v_fma_f32 v250, v250, v248, v249
 v_fma_f32 v251, v251, v248, v249
 v_mfma_f32_32x32x16_bf16 v[192:207], v[236:239], a[76:79], v[192:207]
 ds_read_b64_tr_b16 v[228:229], v245 offset:20480
 ds_read_b64_tr_b16 v[230:231], v245 offset:21504
 v_mul_f32 v250, v250, v160
 v_mul_f32 v251, v251, v161
 v_exp_f32 v250, v250
 s_waitcnt lgkmcnt(4)
 v_mfma_f32_32x32x16_bf16 v[176:191], v[208:211], a[80:83], v[176:191]
 ds_read_b64_tr_b16 v[232:233], v244 offset:22528
 ds_read_b64_tr_b16 v[234:235], v244 offset:23552
 buffer_load_dwordx4 v247, s[12:15], s36 offen offset:1024 lds
 v_exp_f32 v251, v251
 v_add_f32 v250, 1.0, v250
 v_add_f32 v251, 1.0, v251
 v_rcp_f32 v250, v250
 v_mfma_f32_32x32x16_bf16 v[192:207], v[212:215], a[80:83], v[192:207]
 ds_read_b64_tr_b16 v[236:237], v245 offset:22528
 ds_read_b64_tr_b16 v[238:239], v245 offset:23552
 v_rcp_f32 v251, v251
 v_mul_f32 v160, v250, v160
 v_mul_f32 v161, v251, v161
 v_cvt_pk_bf16_f32 v104, v160, v161
 v_mfma_f32_32x32x16_bf16 v[176:191], v[216:219], a[84:87], v[176:191]
 ds_read_b64_tr_b16 v[208:209], v244 offset:24576
 ds_read_b64_tr_b16 v[210:211], v244 offset:25600
 v_mul_f32 v250, v162, v162
 v_mul_f32 v251, v163, v163
 v_fma_f32 v250, v250, v248, v249
 v_mfma_f32_32x32x16_bf16 v[192:207], v[220:223], a[84:87], v[192:207]
 ds_read_b64_tr_b16 v[212:213], v245 offset:24576
 ds_read_b64_tr_b16 v[214:215], v245 offset:25600
 v_fma_f32 v251, v251, v248, v249
 v_mul_f32 v250, v250, v162
 v_mul_f32 v251, v251, v163
 s_waitcnt lgkmcnt(4)
 v_mfma_f32_32x32x16_bf16 v[176:191], v[224:227], a[88:91], v[176:191]
 ds_read_b64_tr_b16 v[216:217], v244 offset:26624
 ds_read_b64_tr_b16 v[218:219], v244 offset:27648
 s_add_u32 m0, s30, 49152
 s_add_u32 s36, s32, 3538944
 buffer_load_dwordx4 v246, s[12:15], s36 offen lds
 v_exp_f32 v250, v250
 v_exp_f32 v251, v251
 v_add_f32 v250, 1.0, v250
 v_add_f32 v251, 1.0, v251
 v_rcp_f32 v250, v250
 v_mfma_f32_32x32x16_bf16 v[192:207], v[228:231], a[88:91], v[192:207]
 ds_read_b64_tr_b16 v[220:221], v245 offset:26624
 ds_read_b64_tr_b16 v[222:223], v245 offset:27648
 v_rcp_f32 v251, v251
 v_mul_f32 v162, v250, v162
 v_mul_f32 v163, v251, v163
 v_cvt_pk_bf16_f32 v105, v162, v163
 v_mfma_f32_32x32x16_bf16 v[176:191], v[232:235], a[92:95], v[176:191]
 ds_read_b64_tr_b16 v[224:225], v244 offset:28672
 ds_read_b64_tr_b16 v[226:227], v244 offset:29696
 v_mul_f32 v250, v164, v164
 v_mul_f32 v251, v165, v165
 v_fma_f32 v250, v250, v248, v249
 v_mfma_f32_32x32x16_bf16 v[192:207], v[236:239], a[92:95], v[192:207]
 ds_read_b64_tr_b16 v[228:229], v245 offset:28672
 ds_read_b64_tr_b16 v[230:231], v245 offset:29696
 v_fma_f32 v251, v251, v248, v249
 v_mul_f32 v250, v250, v164
 v_mul_f32 v251, v251, v165
 s_waitcnt lgkmcnt(4)
 v_mfma_f32_32x32x16_bf16 v[176:191], v[208:211], a[96:99], v[176:191]
 ds_read_b64_tr_b16 v[232:233], v244 offset:30720
 ds_read_b64_tr_b16 v[234:235], v244 offset:31744
 buffer_load_dwordx4 v247, s[12:15], s36 offen offset:1024 lds
 v_exp_f32 v250, v250
 v_exp_f32 v251, v251
 v_add_f32 v250, 1.0, v250
 v_add_f32 v251, 1.0, v251
 v_mfma_f32_32x32x16_bf16 v[192:207], v[212:215], a[96:99], v[192:207]
 ds_read_b64_tr_b16 v[236:237], v245 offset:30720
 ds_read_b64_tr_b16 v[238:239], v245 offset:31744
 v_rcp_f32 v250, v250
 v_rcp_f32 v251, v251
 v_mul_f32 v164, v250, v164
 v_mul_f32 v165, v251, v165
 v_mfma_f32_32x32x16_bf16 v[176:191], v[216:219], a[100:103], v[176:191]
 ds_read_b64_tr_b16 v[208:209], v244 offset:32768
 ds_read_b64_tr_b16 v[210:211], v244 offset:33792
 v_cvt_pk_bf16_f32 v106, v164, v165
 v_mul_f32 v250, v166, v166
 v_mul_f32 v251, v167, v167
 v_mfma_f32_32x32x16_bf16 v[192:207], v[220:223], a[100:103], v[192:207]
 ds_read_b64_tr_b16 v[212:213], v245 offset:32768
 ds_read_b64_tr_b16 v[214:215], v245 offset:33792
 v_fma_f32 v250, v250, v248, v249
 v_fma_f32 v251, v251, v248, v249
 v_mul_f32 v250, v250, v166
 v_mul_f32 v251, v251, v167
 s_waitcnt lgkmcnt(4)
 v_mfma_f32_32x32x16_bf16 v[176:191], v[224:227], a[104:107], v[176:191]
 ds_read_b64_tr_b16 v[216:217], v244 offset:34816
 ds_read_b64_tr_b16 v[218:219], v244 offset:35840
 s_add_u32 m0, s30, 57344
 s_add_u32 s36, s32, 4128768
 buffer_load_dwordx4 v246, s[12:15], s36 offen lds
 v_exp_f32 v250, v250
 v_exp_f32 v251, v251
 v_add_f32 v250, 1.0, v250
 v_add_f32 v251, 1.0, v251
 v_mfma_f32_32x32x16_bf16 v[192:207], v[228:231], a[104:107], v[192:207]
 ds_read_b64_tr_b16 v[220:221], v245 offset:34816
 ds_read_b64_tr_b16 v[222:223], v245 offset:35840
 v_rcp_f32 v250, v250
 v_rcp_f32 v251, v251
 v_mul_f32 v166, v250, v166
 v_mul_f32 v167, v251, v167
 v_mfma_f32_32x32x16_bf16 v[176:191], v[232:235], a[108:111], v[176:191]
 ds_read_b64_tr_b16 v[224:225], v244 offset:36864
 ds_read_b64_tr_b16 v[226:227], v244 offset:37888
 v_cvt_pk_bf16_f32 v107, v166, v167
 v_mul_f32 v250, v168, v168
 v_mul_f32 v251, v169, v169
 v_mfma_f32_32x32x16_bf16 v[192:207], v[236:239], a[108:111], v[192:207]
 ds_read_b64_tr_b16 v[228:229], v245 offset:36864
 ds_read_b64_tr_b16 v[230:231], v245 offset:37888
 v_fma_f32 v250, v250, v248, v249
 v_fma_f32 v251, v251, v248, v249
 v_mul_f32 v250, v250, v168
 s_waitcnt lgkmcnt(4)
 v_mfma_f32_32x32x16_bf16 v[176:191], v[208:211], a[112:115], v[176:191]
 ds_read_b64_tr_b16 v[232:233], v244 offset:38912
 ds_read_b64_tr_b16 v[234:235], v244 offset:39936
 buffer_load_dwordx4 v247, s[12:15], s36 offen offset:1024 lds
 v_mul_f32 v251, v251, v169
 v_exp_f32 v250, v250
 v_exp_f32 v251, v251
 v_add_f32 v250, 1.0, v250
 v_mfma_f32_32x32x16_bf16 v[192:207], v[212:215], a[112:115], v[192:207]
 ds_read_b64_tr_b16 v[236:237], v245 offset:38912
 ds_read_b64_tr_b16 v[238:239], v245 offset:39936
 v_add_f32 v251, 1.0, v251
 v_rcp_f32 v250, v250
 v_rcp_f32 v251, v251
 v_mul_f32 v168, v250, v168
 v_mul_f32 v169, v251, v169
 v_mfma_f32_32x32x16_bf16 v[176:191], v[216:219], a[116:119], v[176:191]
 ds_read_b64_tr_b16 v[208:209], v244 offset:40960
 ds_read_b64_tr_b16 v[210:211], v244 offset:41984
 v_cvt_pk_bf16_f32 v108, v168, v169
 v_mul_f32 v250, v170, v170
 v_mul_f32 v251, v171, v171
 v_mfma_f32_32x32x16_bf16 v[192:207], v[220:223], a[116:119], v[192:207]
 ds_read_b64_tr_b16 v[212:213], v245 offset:40960
 ds_read_b64_tr_b16 v[214:215], v245 offset:41984
 v_fma_f32 v250, v250, v248, v249
 v_fma_f32 v251, v251, v248, v249
 v_mul_f32 v250, v250, v170
 s_waitcnt lgkmcnt(4)
 v_mfma_f32_32x32x16_bf16 v[176:191], v[224:227], a[120:123], v[176:191]
 ds_read_b64_tr_b16 v[216:217], v244 offset:43008
 ds_read_b64_tr_b16 v[218:219], v244 offset:44032
 s_add_u32 m0, s30, 65536
 s_add_u32 s36, s32, 4718592
 buffer_load_dwordx4 v246, s[12:15], s36 offen lds
 v_mul_f32 v251, v251, v171
 v_exp_f32 v250, v250
 v_exp_f32 v251, v251
 v_add_f32 v250, 1.0, v250
 v_mfma_f32_32x32x16_bf16 v[192:207], v[228:231], a[120:123], v[192:207]
 ds_read_b64_tr_b16 v[220:221], v245 offset:43008
 ds_read_b64_tr_b16 v[222:223], v245 offset:44032
 v_add_f32 v251, 1.0, v251
 v_rcp_f32 v250, v250
 v_rcp_f32 v251, v251
 v_mul_f32 v170, v250, v170
 v_mfma_f32_32x32x16_bf16 v[176:191], v[232:235], a[124:127], v[176:191]
 ds_read_b64_tr_b16 v[224:225], v244 offset:45056
 ds_read_b64_tr_b16 v[226:227], v244 offset:46080
 v_mul_f32 v171, v251, v171
 v_cvt_pk_bf16_f32 v109, v170, v171
 v_mul_f32 v250, v172, v172
 v_mfma_f32_32x32x16_bf16 v[192:207], v[236:239], a[124:127], v[192:207]
 ds_read_b64_tr_b16 v[228:229], v245 offset:45056
 ds_read_b64_tr_b16 v[230:231], v245 offset:46080
 v_mul_f32 v251, v173, v173
 v_fma_f32 v250, v250, v248, v249
 v_fma_f32 v251, v251, v248, v249
 s_waitcnt lgkmcnt(4)
 v_mfma_f32_32x32x16_bf16 v[176:191], v[208:211], a[128:131], v[176:191]
 ds_read_b64_tr_b16 v[232:233], v244 offset:47104
 ds_read_b64_tr_b16 v[234:235], v244 offset:48128
 buffer_load_dwordx4 v247, s[12:15], s36 offen offset:1024 lds
 v_mul_f32 v250, v250, v172
 v_mul_f32 v251, v251, v173
 v_exp_f32 v250, v250
 v_exp_f32 v251, v251
 v_add_f32 v250, 1.0, v250
 v_mfma_f32_32x32x16_bf16 v[192:207], v[212:215], a[128:131], v[192:207]
 ds_read_b64_tr_b16 v[236:237], v245 offset:47104
 ds_read_b64_tr_b16 v[238:239], v245 offset:48128
 s_waitcnt vmcnt(8)
 s_barrier
 v_mfma_f32_32x32x16_bf16 v[176:191], v[216:219], a[132:135], v[176:191]
 ds_read_b64_tr_b16 v[208:209], v240 offset:0
 ds_read_b64_tr_b16 v[210:211], v240 offset:1024
 v_add_f32 v251, 1.0, v251
 v_rcp_f32 v250, v250
 v_rcp_f32 v251, v251
 v_mul_f32 v172, v250, v172
 v_mfma_f32_32x32x16_bf16 v[192:207], v[220:223], a[132:135], v[192:207]
 ds_read_b64_tr_b16 v[212:213], v241 offset:0
 ds_read_b64_tr_b16 v[214:215], v241 offset:1024
 v_mul_f32 v173, v251, v173
 v_cvt_pk_bf16_f32 v110, v172, v173
 v_mul_f32 v250, v174, v174
 s_waitcnt lgkmcnt(4)
 v_mfma_f32_32x32x16_bf16 v[176:191], v[224:227], a[136:139], v[176:191]
 ds_read_b64_tr_b16 v[216:217], v240 offset:2048
 ds_read_b64_tr_b16 v[218:219], v240 offset:3072
 s_add_u32 m0, s30, 73728
 v_and_b32 v247, 127, v246
 v_lshrrev_b32 v246, 7, v246
 v_lshl_add_u32 v246, v246, 4, v247
 v_add_u32 v247, 8192, v246
 s_add_u32 s36, s40, s34
 buffer_load_dwordx4 v246, s[16:19], s36 offen lds
 v_mul_f32 v251, v175, v175
 v_fma_f32 v250, v250, v248, v249
 v_fma_f32 v251, v251, v248, v249
 v_mfma_f32_32x32x16_bf16 v[192:207], v[228:231], a[136:139], v[192:207]
 ds_read_b64_tr_b16 v[220:221], v241 offset:2048
 ds_read_b64_tr_b16 v[222:223], v241 offset:3072
 v_mul_f32 v250, v250, v174
 v_mul_f32 v251, v251, v175
 v_exp_f32 v250, v250
 v_mfma_f32_32x32x16_bf16 v[176:191], v[232:235], a[140:143], v[176:191]
 ds_read_b64_tr_b16 v[224:225], v240 offset:4096
 ds_read_b64_tr_b16 v[226:227], v240 offset:5120
 v_exp_f32 v251, v251
 v_add_f32 v250, 1.0, v250
 v_add_f32 v251, 1.0, v251
 v_rcp_f32 v250, v250
 v_mfma_f32_32x32x16_bf16 v[192:207], v[236:239], a[140:143], v[192:207]
 ds_read_b64_tr_b16 v[228:229], v241 offset:4096
 ds_read_b64_tr_b16 v[230:231], v241 offset:5120
 v_rcp_f32 v251, v251
 v_mul_f32 v174, v250, v174
 v_mul_f32 v175, v251, v175
 v_cvt_pk_bf16_f32 v111, v174, v175
 s_waitcnt lgkmcnt(4)
 v_mfma_f32_32x32x16_bf16 v[144:159], v[208:211], a[0:3], 0
 ds_read_b64_tr_b16 v[232:233], v240 offset:6144
 ds_read_b64_tr_b16 v[234:235], v240 offset:7168
 buffer_load_dwordx4 v247, s[16:19], s36 offen offset:1024 lds
 v_mfma_f32_32x32x16_bf16 v[160:175], v[212:215], a[0:3], 0
 ds_read_b64_tr_b16 v[236:237], v241 offset:6144
 ds_read_b64_tr_b16 v[238:239], v241 offset:7168
 v_mfma_f32_32x32x16_bf16 v[144:159], v[216:219], a[4:7], v[144:159]
 ds_read_b64_tr_b16 v[208:209], v240 offset:8192
 ds_read_b64_tr_b16 v[210:211], v240 offset:9216
 v_mfma_f32_32x32x16_bf16 v[160:175], v[220:223], a[4:7], v[160:175]
 ds_read_b64_tr_b16 v[212:213], v241 offset:8192
 ds_read_b64_tr_b16 v[214:215], v241 offset:9216
 s_waitcnt lgkmcnt(4)
 v_mfma_f32_32x32x16_bf16 v[144:159], v[224:227], a[8:11], v[144:159]
 ds_read_b64_tr_b16 v[216:217], v240 offset:10240
 ds_read_b64_tr_b16 v[218:219], v240 offset:11264
 s_add_u32 m0, s30, 81920
 s_add_u32 s36, s41, s34
 buffer_load_dwordx4 v246, s[16:19], s36 offen lds
 v_mul_f32 v250, v176, v176
 v_mul_f32 v251, v177, v177
 v_fma_f32 v250, v250, v248, v249
 v_fma_f32 v251, v251, v248, v249
 v_mfma_f32_32x32x16_bf16 v[160:175], v[228:231], a[8:11], v[160:175]
 ds_read_b64_tr_b16 v[220:221], v241 offset:10240
 ds_read_b64_tr_b16 v[222:223], v241 offset:11264
 v_mul_f32 v250, v250, v176
 v_mul_f32 v251, v251, v177
 v_exp_f32 v250, v250
 v_mfma_f32_32x32x16_bf16 v[144:159], v[232:235], a[12:15], v[144:159]
 ds_read_b64_tr_b16 v[224:225], v240 offset:12288
 ds_read_b64_tr_b16 v[226:227], v240 offset:13312
 v_exp_f32 v251, v251
 v_add_f32 v250, 1.0, v250
 v_add_f32 v251, 1.0, v251
 v_rcp_f32 v250, v250
 v_mfma_f32_32x32x16_bf16 v[160:175], v[236:239], a[12:15], v[160:175]
 ds_read_b64_tr_b16 v[228:229], v241 offset:12288
 ds_read_b64_tr_b16 v[230:231], v241 offset:13312
 v_rcp_f32 v251, v251
 v_mul_f32 v176, v250, v176
 v_mul_f32 v177, v251, v177
 v_cvt_pk_bf16_f32 v112, v176, v177
 s_waitcnt lgkmcnt(4)
 v_mfma_f32_32x32x16_bf16 v[144:159], v[208:211], a[16:19], v[144:159]
 ds_read_b64_tr_b16 v[232:233], v240 offset:14336
 ds_read_b64_tr_b16 v[234:235], v240 offset:15360
 buffer_load_dwordx4 v247, s[16:19], s36 offen offset:1024 lds
 v_mul_f32 v250, v178, v178
 v_mul_f32 v251, v179, v179
 v_fma_f32 v250, v250, v248, v249
 v_mfma_f32_32x32x16_bf16 v[160:175], v[212:215], a[16:19], v[160:175]
 ds_read_b64_tr_b16 v[236:237], v241 offset:14336
 ds_read_b64_tr_b16 v[238:239], v241 offset:15360
 v_fma_f32 v251, v251, v248, v249
 v_mul_f32 v250, v250, v178
 v_mul_f32 v251, v251, v179
 v_mfma_f32_32x32x16_bf16 v[144:159], v[216:219], a[20:23], v[144:159]
 ds_read_b64_tr_b16 v[208:209], v240 offset:16384
 ds_read_b64_tr_b16 v[210:211], v240 offset:17408
 v_exp_f32 v250, v250
 v_exp_f32 v251, v251
 v_add_f32 v250, 1.0, v250
 v_add_f32 v251, 1.0, v251
 v_rcp_f32 v250, v250
 v_mfma_f32_32x32x16_bf16 v[160:175], v[220:223], a[20:23], v[160:175]
 ds_read_b64_tr_b16 v[212:213], v241 offset:16384
 ds_read_b64_tr_b16 v[214:215], v241 offset:17408
 v_rcp_f32 v251, v251
 v_mul_f32 v178, v250, v178
 v_mul_f32 v179, v251, v179
 v_cvt_pk_bf16_f32 v113, v178, v179
 s_waitcnt lgkmcnt(4)
 v_mfma_f32_32x32x16_bf16 v[144:159], v[224:227], a[24:27], v[144:159]
 ds_read_b64_tr_b16 v[216:217], v240 offset:18432
 ds_read_b64_tr_b16 v[218:219], v240 offset:19456
 s_add_u32 m0, s30, 90112
 s_add_u32 s36, s42, s34
 buffer_load_dwordx4 v246, s[16:19], s36 offen lds
 v_mul_f32 v250, v180, v180
 v_mul_f32 v251, v181, v181
 v_fma_f32 v250, v250, v248, v249
 v_mfma_f32_32x32x16_bf16 v[160:175], v[228:231], a[24:27], v[160:175]
 ds_read_b64_tr_b16 v[220:221], v241 offset:18432
 ds_read_b64_tr_b16 v[222:223], v241 offset:19456
 v_fma_f32 v251, v251, v248, v249
 v_mul_f32 v250, v250, v180
 v_mul_f32 v251, v251, v181
 v_mfma_f32_32x32x16_bf16 v[144:159], v[232:235], a[28:31], v[144:159]
 ds_read_b64_tr_b16 v[224:225], v240 offset:20480
 ds_read_b64_tr_b16 v[226:227], v240 offset:21504
 v_exp_f32 v250, v250
 v_exp_f32 v251, v251
 v_add_f32 v250, 1.0, v250
 v_add_f32 v251, 1.0, v251
 v_mfma_f32_32x32x16_bf16 v[160:175], v[236:239], a[28:31], v[160:175]
 ds_read_b64_tr_b16 v[228:229], v241 offset:20480
 ds_read_b64_tr_b16 v[230:231], v241 offset:21504
 v_rcp_f32 v250, v250
 v_rcp_f32 v251, v251
 v_mul_f32 v180, v250, v180
 v_mul_f32 v181, v251, v181
 s_waitcnt lgkmcnt(4)
 v_mfma_f32_32x32x16_bf16 v[144:159], v[208:211], a[32:35], v[144:159]
 ds_read_b64_tr_b16 v[232:233], v240 offset:22528
 ds_read_b64_tr_b16 v[234:235], v240 offset:23552
 buffer_load_dwordx4 v247, s[16:19], s36 offen offset:1024 lds
 v_cvt_pk_bf16_f32 v114, v180, v181
 v_mul_f32 v250, v182, v182
 v_mul_f32 v251, v183, v183
 v_mfma_f32_32x32x16_bf16 v[160:175], v[212:215], a[32:35], v[160:175]
 ds_read_b64_tr_b16 v[236:237], v241 offset:22528
 ds_read_b64_tr_b16 v[238:239], v241 offset:23552
 v_fma_f32 v250, v250, v248, v249
 v_fma_f32 v251, v251, v248, v249
 v_mul_f32 v250, v250, v182
 v_mul_f32 v251, v251, v183
 v_mfma_f32_32x32x16_bf16 v[144:159], v[216:219], a[36:39], v[144:159]
 ds_read_b64_tr_b16 v[208:209], v240 offset:24576
 ds_read_b64_tr_b16 v[210:211], v240 offset:25600
 v_exp_f32 v250, v250
 v_exp_f32 v251, v251
 v_add_f32 v250, 1.0, v250
 v_add_f32 v251, 1.0, v251
 v_mfma_f32_32x32x16_bf16 v[160:175], v[220:223], a[36:39], v[160:175]
 ds_read_b64_tr_b16 v[212:213], v241 offset:24576
 ds_read_b64_tr_b16 v[214:215], v241 offset:25600
 v_rcp_f32 v250, v250
 v_rcp_f32 v251, v251
 v_mul_f32 v182, v250, v182
 v_mul_f32 v183, v251, v183
 s_waitcnt lgkmcnt(4)
 v_mfma_f32_32x32x16_bf16 v[144:159], v[224:227], a[40:43], v[144:159]
 ds_read_b64_tr_b16 v[216:217], v240 offset:26624
 ds_read_b64_tr_b16 v[218:219], v240 offset:27648
 s_add_u32 m0, s30, 98304
 s_add_u32 s36, s43, s34
 buffer_load_dwordx4 v246, s[16:19], s36 offen lds
 v_cvt_pk_bf16_f32 v115, v182, v183
 v_mul_f32 v250, v184, v184
 v_mul_f32 v251, v185, v185
 v_mfma_f32_32x32x16_bf16 v[160:175], v[228:231], a[40:43], v[160:175]
 ds_read_b64_tr_b16 v[220:221], v241 offset:26624
 ds_read_b64_tr_b16 v[222:223], v241 offset:27648
 v_fma_f32 v250, v250, v248, v249
 v_fma_f32 v251, v251, v248, v249
 v_mul_f32 v250, v250, v184
 v_mfma_f32_32x32x16_bf16 v[144:159], v[232:235], a[44:47], v[144:159]
 ds_read_b64_tr_b16 v[224:225], v240 offset:28672
 ds_read_b64_tr_b16 v[226:227], v240 offset:29696
 v_mul_f32 v251, v251, v185
 v_exp_f32 v250, v250
 v_exp_f32 v251, v251
 v_add_f32 v250, 1.0, v250
 v_mfma_f32_32x32x16_bf16 v[160:175], v[236:239], a[44:47], v[160:175]
 ds_read_b64_tr_b16 v[228:229], v241 offset:28672
 ds_read_b64_tr_b16 v[230:231], v241 offset:29696
 v_add_f32 v251, 1.0, v251
 v_rcp_f32 v250, v250
 v_rcp_f32 v251, v251
 v_mul_f32 v184, v250, v184
 v_mul_f32 v185, v251, v185
 s_waitcnt lgkmcnt(4)
 v_mfma_f32_32x32x16_bf16 v[144:159], v[208:211], a[48:51], v[144:159]
 ds_read_b64_tr_b16 v[232:233], v240 offset:30720
 ds_read_b64_tr_b16 v[234:235], v240 offset:31744
 buffer_load_dwordx4 v247, s[16:19], s36 offen offset:1024 lds
 v_cvt_pk_bf16_f32 v116, v184, v185
 v_mul_f32 v250, v186, v186
 v_mul_f32 v251, v187, v187
 v_mfma_f32_32x32x16_bf16 v[160:175], v[212:215], a[48:51], v[160:175]
 ds_read_b64_tr_b16 v[236:237], v241 offset:30720
 ds_read_b64_tr_b16 v[238:239], v241 offset:31744
 v_fma_f32 v250, v250, v248, v249
 v_fma_f32 v251, v251, v248, v249
 v_mul_f32 v250, v250, v186
 v_mfma_f32_32x32x16_bf16 v[144:159], v[216:219], a[52:55], v[144:159]
 ds_read_b64_tr_b16 v[208:209], v240 offset:32768
 ds_read_b64_tr_b16 v[210:211], v240 offset:33792
 v_mul_f32 v251, v251, v187
 v_exp_f32 v250, v250
 v_exp_f32 v251, v251
 v_add_f32 v250, 1.0, v250
 v_mfma_f32_32x32x16_bf16 v[160:175], v[220:223], a[52:55], v[160:175]
 ds_read_b64_tr_b16 v[212:213], v241 offset:32768
 ds_read_b64_tr_b16 v[214:215], v241 offset:33792
 v_add_f32 v251, 1.0, v251
 v_rcp_f32 v250, v250
 v_rcp_f32 v251, v251
 v_mul_f32 v186, v250, v186
 s_waitcnt lgkmcnt(4)
 v_mfma_f32_32x32x16_bf16 v[144:159], v[224:227], a[56:59], v[144:159]
 ds_read_b64_tr_b16 v[216:217], v240 offset:34816
 ds_read_b64_tr_b16 v[218:219], v240 offset:35840
 s_add_u32 m0, s30, 106496
 s_add_u32 s36, s44, s34
 buffer_load_dwordx4 v246, s[16:19], s36 offen lds
 v_mul_f32 v187, v251, v187
 v_cvt_pk_bf16_f32 v117, v186, v187
 v_mul_f32 v250, v188, v188
 v_mfma_f32_32x32x16_bf16 v[160:175], v[228:231], a[56:59], v[160:175]
 ds_read_b64_tr_b16 v[220:221], v241 offset:34816
 ds_read_b64_tr_b16 v[222:223], v241 offset:35840
 s_waitcnt vmcnt(9)
 s_barrier
 v_mfma_f32_32x32x16_bf16 v[144:159], v[232:235], a[60:63], v[144:159]
 ds_read_b64_tr_b16 v[224:225], v240 offset:36864
 ds_read_b64_tr_b16 v[226:227], v240 offset:37888
 v_mul_f32 v251, v189, v189
 v_fma_f32 v250, v250, v248, v249
 v_fma_f32 v251, v251, v248, v249
 v_mfma_f32_32x32x16_bf16 v[160:175], v[236:239], a[60:63], v[160:175]
 ds_read_b64_tr_b16 v[228:229], v241 offset:36864
 ds_read_b64_tr_b16 v[230:231], v241 offset:37888
 v_mul_f32 v250, v250, v188
 v_mul_f32 v251, v251, v189
 v_exp_f32 v250, v250
 v_exp_f32 v251, v251
 v_add_f32 v250, 1.0, v250
 s_waitcnt lgkmcnt(4)
 v_mfma_f32_32x32x16_bf16 v[144:159], v[208:211], a[64:67], v[144:159]
 ds_read_b64_tr_b16 v[232:233], v240 offset:38912
 ds_read_b64_tr_b16 v[234:235], v240 offset:39936
 buffer_load_dwordx4 v247, s[16:19], s36 offen offset:1024 lds
 v_add_f32 v251, 1.0, v251
 v_rcp_f32 v250, v250
 v_rcp_f32 v251, v251
 v_mul_f32 v188, v250, v188
 v_mfma_f32_32x32x16_bf16 v[160:175], v[212:215], a[64:67], v[160:175]
 ds_read_b64_tr_b16 v[236:237], v241 offset:38912
 ds_read_b64_tr_b16 v[238:239], v241 offset:39936
 v_mul_f32 v189, v251, v189
 v_cvt_pk_bf16_f32 v118, v188, v189
 v_mul_f32 v250, v190, v190
 v_mfma_f32_32x32x16_bf16 v[144:159], v[216:219], a[68:71], v[144:159]
 ds_read_b64_tr_b16 v[208:209], v240 offset:40960
 ds_read_b64_tr_b16 v[210:211], v240 offset:41984
 v_mul_f32 v251, v191, v191
 v_fma_f32 v250, v250, v248, v249
 v_fma_f32 v251, v251, v248, v249
 v_mfma_f32_32x32x16_bf16 v[160:175], v[220:223], a[68:71], v[160:175]
 ds_read_b64_tr_b16 v[212:213], v241 offset:40960
 ds_read_b64_tr_b16 v[214:215], v241 offset:41984
 v_mul_f32 v250, v250, v190
 v_mul_f32 v251, v251, v191
 v_exp_f32 v250, v250
 s_waitcnt lgkmcnt(4)
 v_mfma_f32_32x32x16_bf16 v[144:159], v[224:227], a[72:75], v[144:159]
 ds_read_b64_tr_b16 v[216:217], v240 offset:43008
 ds_read_b64_tr_b16 v[218:219], v240 offset:44032
 s_add_u32 m0, s30, 114688
 s_add_u32 s36, s45, s34
 buffer_load_dwordx4 v246, s[16:19], s36 offen lds
 v_exp_f32 v251, v251
 v_add_f32 v250, 1.0, v250
 v_add_f32 v251, 1.0, v251
 v_rcp_f32 v250, v250
 v_mfma_f32_32x32x16_bf16 v[160:175], v[228:231], a[72:75], v[160:175]
 ds_read_b64_tr_b16 v[220:221], v241 offset:43008
 ds_read_b64_tr_b16 v[222:223], v241 offset:44032
 v_rcp_f32 v251, v251
 v_mul_f32 v190, v250, v190
 v_mul_f32 v191, v251, v191
 v_cvt_pk_bf16_f32 v119, v190, v191
 v_mfma_f32_32x32x16_bf16 v[144:159], v[232:235], a[76:79], v[144:159]
 ds_read_b64_tr_b16 v[224:225], v240 offset:45056
 ds_read_b64_tr_b16 v[226:227], v240 offset:46080
 v_mul_f32 v250, v192, v192
 v_mul_f32 v251, v193, v193
 v_fma_f32 v250, v250, v248, v249
 v_fma_f32 v251, v251, v248, v249
 v_mfma_f32_32x32x16_bf16 v[160:175], v[236:239], a[76:79], v[160:175]
 ds_read_b64_tr_b16 v[228:229], v241 offset:45056
 ds_read_b64_tr_b16 v[230:231], v241 offset:46080
 v_mul_f32 v250, v250, v192
 v_mul_f32 v251, v251, v193
 v_exp_f32 v250, v250
 s_waitcnt lgkmcnt(4)
 v_mfma_f32_32x32x16_bf16 v[144:159], v[208:211], a[80:83], v[144:159]
 ds_read_b64_tr_b16 v[232:233], v240 offset:47104
 ds_read_b64_tr_b16 v[234:235], v240 offset:48128
 buffer_load_dwordx4 v247, s[16:19], s36 offen offset:1024 lds
 v_exp_f32 v251, v251
 v_add_f32 v250, 1.0, v250
 v_add_f32 v251, 1.0, v251
 v_rcp_f32 v250, v250
 v_mfma_f32_32x32x16_bf16 v[160:175], v[212:215], a[80:83], v[160:175]
 ds_read_b64_tr_b16 v[236:237], v241 offset:47104
 ds_read_b64_tr_b16 v[238:239], v241 offset:48128
 v_rcp_f32 v251, v251
 v_mul_f32 v192, v250, v192
 v_mul_f32 v193, v251, v193
 v_cvt_pk_bf16_f32 v120, v192, v193
 v_mfma_f32_32x32x16_bf16 v[144:159], v[216:219], a[84:87], v[144:159]
 ds_read_b64_tr_b16 v[208:209], v242 offset:0
 ds_read_b64_tr_b16 v[210:211], v242 offset:1024
 v_mul_f32 v250, v194, v194
 v_mul_f32 v251, v195, v195
 v_fma_f32 v250, v250, v248, v249
 v_mfma_f32_32x32x16_bf16 v[160:175], v[220:223], a[84:87], v[160:175]
 ds_read_b64_tr_b16 v[212:213], v243 offset:0
 ds_read_b64_tr_b16 v[214:215], v243 offset:1024
 v_fma_f32 v251, v251, v248, v249
 v_mul_f32 v250, v250, v194
 v_mul_f32 v251, v251, v195
 s_waitcnt lgkmcnt(4)
 v_mfma_f32_32x32x16_bf16 v[144:159], v[224:227], a[88:91], v[144:159]
 ds_read_b64_tr_b16 v[216:217], v242 offset:2048
 ds_read_b64_tr_b16 v[218:219], v242 offset:3072
 s_add_u32 m0, s30, 122880
 s_add_u32 s36, s46, s34
 buffer_load_dwordx4 v246, s[16:19], s36 offen lds
 v_exp_f32 v250, v250
 v_exp_f32 v251, v251
 v_add_f32 v250, 1.0, v250
 v_add_f32 v251, 1.0, v251
 v_rcp_f32 v250, v250
 v_mfma_f32_32x32x16_bf16 v[160:175], v[228:231], a[88:91], v[160:175]
 ds_read_b64_tr_b16 v[220:221], v243 offset:2048
 ds_read_b64_tr_b16 v[222:223], v243 offset:3072
 v_rcp_f32 v251, v251
 v_mul_f32 v194, v250, v194
 v_mul_f32 v195, v251, v195
 v_cvt_pk_bf16_f32 v121, v194, v195
 v_mfma_f32_32x32x16_bf16 v[144:159], v[232:235], a[92:95], v[144:159]
 ds_read_b64_tr_b16 v[224:225], v242 offset:4096
 ds_read_b64_tr_b16 v[226:227], v242 offset:5120
 v_mul_f32 v250, v196, v196
 v_mul_f32 v251, v197, v197
 v_fma_f32 v250, v250, v248, v249
 v_mfma_f32_32x32x16_bf16 v[160:175], v[236:239], a[92:95], v[160:175]
 ds_read_b64_tr_b16 v[228:229], v243 offset:4096
 ds_read_b64_tr_b16 v[230:231], v243 offset:5120
 v_fma_f32 v251, v251, v248, v249
 v_mul_f32 v250, v250, v196
 v_mul_f32 v251, v251, v197
 s_waitcnt lgkmcnt(4)
 v_mfma_f32_32x32x16_bf16 v[144:159], v[208:211], a[96:99], v[144:159]
 ds_read_b64_tr_b16 v[232:233], v242 offset:6144
 ds_read_b64_tr_b16 v[234:235], v242 offset:7168
 buffer_load_dwordx4 v247, s[16:19], s36 offen offset:1024 lds
 v_exp_f32 v250, v250
 v_exp_f32 v251, v251
 v_add_f32 v250, 1.0, v250
 v_add_f32 v251, 1.0, v251
 v_mfma_f32_32x32x16_bf16 v[160:175], v[212:215], a[96:99], v[160:175]
 ds_read_b64_tr_b16 v[236:237], v243 offset:6144
 ds_read_b64_tr_b16 v[238:239], v243 offset:7168
 v_rcp_f32 v250, v250
 v_rcp_f32 v251, v251
 v_mul_f32 v196, v250, v196
 v_mul_f32 v197, v251, v197
 v_mfma_f32_32x32x16_bf16 v[144:159], v[216:219], a[100:103], v[144:159]
 ds_read_b64_tr_b16 v[208:209], v242 offset:8192
 ds_read_b64_tr_b16 v[210:211], v242 offset:9216
 v_cvt_pk_bf16_f32 v122, v196, v197
 v_mul_f32 v250, v198, v198
 v_mul_f32 v251, v199, v199
 v_mfma_f32_32x32x16_bf16 v[160:175], v[220:223], a[100:103], v[160:175]
 ds_read_b64_tr_b16 v[212:213], v243 offset:8192
 ds_read_b64_tr_b16 v[214:215], v243 offset:9216
 v_fma_f32 v250, v250, v248, v249
 v_fma_f32 v251, v251, v248, v249
 v_mul_f32 v250, v250, v198
 v_mul_f32 v251, v251, v199
 s_waitcnt lgkmcnt(4)
 v_mfma_f32_32x32x16_bf16 v[144:159], v[224:227], a[104:107], v[144:159]
 ds_read_b64_tr_b16 v[216:217], v242 offset:10240
 ds_read_b64_tr_b16 v[218:219], v242 offset:11264
 s_add_u32 m0, s30, 131072
 s_add_u32 s36, s47, s34
 buffer_load_dwordx4 v246, s[16:19], s36 offen lds
 v_exp_f32 v250, v250
 v_exp_f32 v251, v251
 v_add_f32 v250, 1.0, v250
 v_add_f32 v251, 1.0, v251
 v_mfma_f32_32x32x16_bf16 v[160:175], v[228:231], a[104:107], v[160:175]
 ds_read_b64_tr_b16 v[220:221], v243 offset:10240
 ds_read_b64_tr_b16 v[222:223], v243 offset:11264
 v_rcp_f32 v250, v250
 v_rcp_f32 v251, v251
 v_mul_f32 v198, v250, v198
 v_mul_f32 v199, v251, v199
 v_mfma_f32_32x32x16_bf16 v[144:159], v[232:235], a[108:111], v[144:159]
 ds_read_b64_tr_b16 v[224:225], v242 offset:12288
 ds_read_b64_tr_b16 v[226:227], v242 offset:13312
 v_cvt_pk_bf16_f32 v123, v198, v199
 v_mul_f32 v250, v200, v200
 v_mul_f32 v251, v201, v201
 v_mfma_f32_32x32x16_bf16 v[160:175], v[236:239], a[108:111], v[160:175]
 ds_read_b64_tr_b16 v[228:229], v243 offset:12288
 ds_read_b64_tr_b16 v[230:231], v243 offset:13312
 v_fma_f32 v250, v250, v248, v249
 v_fma_f32 v251, v251, v248, v249
 v_mul_f32 v250, v250, v200
 s_waitcnt lgkmcnt(4)
 v_mfma_f32_32x32x16_bf16 v[144:159], v[208:211], a[112:115], v[144:159]
 ds_read_b64_tr_b16 v[232:233], v242 offset:14336
 ds_read_b64_tr_b16 v[234:235], v242 offset:15360
 buffer_load_dwordx4 v247, s[16:19], s36 offen offset:1024 lds
 v_mul_f32 v251, v251, v201
 v_exp_f32 v250, v250
 v_exp_f32 v251, v251
 v_add_f32 v250, 1.0, v250
 v_mfma_f32_32x32x16_bf16 v[160:175], v[212:215], a[112:115], v[160:175]
 ds_read_b64_tr_b16 v[236:237], v243 offset:14336
 ds_read_b64_tr_b16 v[238:239], v243 offset:15360
 v_add_f32 v251, 1.0, v251
 v_rcp_f32 v250, v250
 v_rcp_f32 v251, v251
 v_mul_f32 v200, v250, v200
 v_mul_f32 v201, v251, v201
 v_mfma_f32_32x32x16_bf16 v[144:159], v[216:219], a[116:119], v[144:159]
 ds_read_b64_tr_b16 v[208:209], v242 offset:16384
 ds_read_b64_tr_b16 v[210:211], v242 offset:17408
 v_cvt_pk_bf16_f32 v124, v200, v201
 v_mul_f32 v250, v202, v202
 v_mul_f32 v251, v203, v203
 v_mfma_f32_32x32x16_bf16 v[160:175], v[220:223], a[116:119], v[160:175]
 ds_read_b64_tr_b16 v[212:213], v243 offset:16384
 ds_read_b64_tr_b16 v[214:215], v243 offset:17408
 v_fma_f32 v250, v250, v248, v249
 v_fma_f32 v251, v251, v248, v249
 v_mul_f32 v250, v250, v202
 s_waitcnt lgkmcnt(4)
 v_mfma_f32_32x32x16_bf16 v[144:159], v[224:227], a[120:123], v[144:159]
 ds_read_b64_tr_b16 v[216:217], v242 offset:18432
 ds_read_b64_tr_b16 v[218:219], v242 offset:19456
 s_add_u32 m0, s30, 139264
 s_add_u32 s36, s48, s34
 buffer_load_dwordx4 v246, s[16:19], s36 offen lds
 v_mul_f32 v251, v251, v203
 v_exp_f32 v250, v250
 v_exp_f32 v251, v251
 v_add_f32 v250, 1.0, v250
 v_mfma_f32_32x32x16_bf16 v[160:175], v[228:231], a[120:123], v[160:175]
 ds_read_b64_tr_b16 v[220:221], v243 offset:18432
 ds_read_b64_tr_b16 v[222:223], v243 offset:19456
 v_add_f32 v251, 1.0, v251
 v_rcp_f32 v250, v250
 v_rcp_f32 v251, v251
 v_mul_f32 v202, v250, v202
 v_mfma_f32_32x32x16_bf16 v[144:159], v[232:235], a[124:127], v[144:159]
 ds_read_b64_tr_b16 v[224:225], v242 offset:20480
 ds_read_b64_tr_b16 v[226:227], v242 offset:21504
 v_mul_f32 v203, v251, v203
 v_cvt_pk_bf16_f32 v125, v202, v203
 v_mul_f32 v250, v204, v204
 v_mfma_f32_32x32x16_bf16 v[160:175], v[236:239], a[124:127], v[160:175]
 ds_read_b64_tr_b16 v[228:229], v243 offset:20480
 ds_read_b64_tr_b16 v[230:231], v243 offset:21504
 v_mul_f32 v251, v205, v205
 v_fma_f32 v250, v250, v248, v249
 v_fma_f32 v251, v251, v248, v249
 s_waitcnt lgkmcnt(4)
 v_mfma_f32_32x32x16_bf16 v[144:159], v[208:211], a[128:131], v[144:159]
 ds_read_b64_tr_b16 v[232:233], v242 offset:22528
 ds_read_b64_tr_b16 v[234:235], v242 offset:23552
 buffer_load_dwordx4 v247, s[16:19], s36 offen offset:1024 lds
 v_mul_f32 v250, v250, v204
 v_mul_f32 v251, v251, v205
 v_exp_f32 v250, v250
 v_exp_f32 v251, v251
 v_add_f32 v250, 1.0, v250
 v_mfma_f32_32x32x16_bf16 v[160:175], v[212:215], a[128:131], v[160:175]
 ds_read_b64_tr_b16 v[236:237], v243 offset:22528
 ds_read_b64_tr_b16 v[238:239], v243 offset:23552
 s_waitcnt vmcnt(8)
 s_barrier
 v_mfma_f32_32x32x16_bf16 v[144:159], v[216:219], a[132:135], v[144:159]
 ds_read_b64_tr_b16 v[208:209], v242 offset:24576
 ds_read_b64_tr_b16 v[210:211], v242 offset:25600
 v_add_f32 v251, 1.0, v251
 v_rcp_f32 v250, v250
 v_rcp_f32 v251, v251
 v_mul_f32 v204, v250, v204
 v_mfma_f32_32x32x16_bf16 v[160:175], v[220:223], a[132:135], v[160:175]
 ds_read_b64_tr_b16 v[212:213], v243 offset:24576
 ds_read_b64_tr_b16 v[214:215], v243 offset:25600
 v_mul_f32 v205, v251, v205
 v_cvt_pk_bf16_f32 v126, v204, v205
 v_mul_f32 v250, v206, v206
 s_waitcnt lgkmcnt(4)
 v_mfma_f32_32x32x16_bf16 v[144:159], v[224:227], a[136:139], v[144:159]
 ds_read_b64_tr_b16 v[216:217], v242 offset:26624
 ds_read_b64_tr_b16 v[218:219], v242 offset:27648
 s_add_u32 m0, s30, 0
 s_add_u32 s34, s34, 128
 s_cmp_ge_u32 s34, 1152
 s_cselect_b32 s3, 1152, 0
 s_sub_u32 s34, s34, s3
 s_add_u32 s36, s40, s34
 buffer_load_dwordx4 v246, s[16:19], s36 offen lds
 v_mul_f32 v251, v207, v207
 v_fma_f32 v250, v250, v248, v249
 v_fma_f32 v251, v251, v248, v249
 v_mfma_f32_32x32x16_bf16 v[160:175], v[228:231], a[136:139], v[160:175]
 ds_read_b64_tr_b16 v[220:221], v243 offset:26624
 ds_read_b64_tr_b16 v[222:223], v243 offset:27648
 v_mul_f32 v250, v250, v206
 v_mul_f32 v251, v251, v207
 v_exp_f32 v250, v250
 v_mfma_f32_32x32x16_bf16 v[144:159], v[232:235], a[140:143], v[144:159]
 ds_read_b64_tr_b16 v[224:225], v242 offset:28672
 ds_read_b64_tr_b16 v[226:227], v242 offset:29696
 v_exp_f32 v251, v251
 v_add_f32 v250, 1.0, v250
 v_add_f32 v251, 1.0, v251
 v_rcp_f32 v250, v250
 v_mfma_f32_32x32x16_bf16 v[160:175], v[236:239], a[140:143], v[160:175]
 ds_read_b64_tr_b16 v[228:229], v243 offset:28672
 ds_read_b64_tr_b16 v[230:231], v243 offset:29696
 v_rcp_f32 v251, v251
 v_mul_f32 v206, v250, v206
 v_mul_f32 v207, v251, v207
 v_cvt_pk_bf16_f32 v127, v206, v207
 s_waitcnt lgkmcnt(4)
 v_mfma_f32_32x32x16_bf16 v[176:191], v[208:211], v[0:3], 0
 ds_read_b64_tr_b16 v[232:233], v242 offset:30720
 ds_read_b64_tr_b16 v[234:235], v242 offset:31744
 buffer_load_dwordx4 v247, s[16:19], s36 offen offset:1024 lds
 v_mfma_f32_32x32x16_bf16 v[192:207], v[212:215], v[0:3], 0
 ds_read_b64_tr_b16 v[236:237], v243 offset:30720
 ds_read_b64_tr_b16 v[238:239], v243 offset:31744
 v_mfma_f32_32x32x16_bf16 v[176:191], v[216:219], v[4:7], v[176:191]
 ds_read_b64_tr_b16 v[208:209], v242 offset:32768
 ds_read_b64_tr_b16 v[210:211], v242 offset:33792
 v_mfma_f32_32x32x16_bf16 v[192:207], v[220:223], v[4:7], v[192:207]
 ds_read_b64_tr_b16 v[212:213], v243 offset:32768
 ds_read_b64_tr_b16 v[214:215], v243 offset:33792
 s_waitcnt lgkmcnt(4)
 v_mfma_f32_32x32x16_bf16 v[176:191], v[224:227], v[8:11], v[176:191]
 ds_read_b64_tr_b16 v[216:217], v242 offset:34816
 ds_read_b64_tr_b16 v[218:219], v242 offset:35840
 s_add_u32 m0, s30, 8192
 s_add_u32 s36, s41, s34
 buffer_load_dwordx4 v246, s[16:19], s36 offen lds
 v_mul_f32 v250, v144, v144
 v_mul_f32 v251, v145, v145
 v_fma_f32 v250, v250, v248, v249
 v_fma_f32 v251, v251, v248, v249
 v_mfma_f32_32x32x16_bf16 v[192:207], v[228:231], v[8:11], v[192:207]
 ds_read_b64_tr_b16 v[220:221], v243 offset:34816
 ds_read_b64_tr_b16 v[222:223], v243 offset:35840
 v_mul_f32 v250, v250, v144
 v_mul_f32 v251, v251, v145
 v_exp_f32 v250, v250
 v_exp_f32 v251, v251
 v_add_f32 v250, 1.0, v250
 v_mfma_f32_32x32x16_bf16 v[176:191], v[232:235], v[12:15], v[176:191]
 ds_read_b64_tr_b16 v[224:225], v242 offset:36864
 ds_read_b64_tr_b16 v[226:227], v242 offset:37888
 v_add_f32 v251, 1.0, v251
 v_rcp_f32 v250, v250
 v_rcp_f32 v251, v251
 v_mul_f32 v144, v250, v144
 v_mul_f32 v145, v251, v145
 v_mfma_f32_32x32x16_bf16 v[192:207], v[236:239], v[12:15], v[192:207]
 ds_read_b64_tr_b16 v[228:229], v243 offset:36864
 ds_read_b64_tr_b16 v[230:231], v243 offset:37888
 v_cvt_pk_bf16_f32 v128, v144, v145
 v_mul_f32 v250, v146, v146
 v_mul_f32 v251, v147, v147
 v_fma_f32 v250, v250, v248, v249
 s_waitcnt lgkmcnt(4)
 v_mfma_f32_32x32x16_bf16 v[176:191], v[208:211], v[16:19], v[176:191]
 ds_read_b64_tr_b16 v[232:233], v242 offset:38912
 ds_read_b64_tr_b16 v[234:235], v242 offset:39936
 buffer_load_dwordx4 v247, s[16:19], s36 offen offset:1024 lds
 v_fma_f32 v251, v251, v248, v249
 v_mul_f32 v250, v250, v146
 v_mul_f32 v251, v251, v147
 v_mfma_f32_32x32x16_bf16 v[192:207], v[212:215], v[16:19], v[192:207]
 ds_read_b64_tr_b16 v[236:237], v243 offset:38912
 ds_read_b64_tr_b16 v[238:239], v243 offset:39936
 v_exp_f32 v250, v250
 v_exp_f32 v251, v251
 v_add_f32 v250, 1.0, v250
 v_add_f32 v251, 1.0, v251
 v_rcp_f32 v250, v250
 v_mfma_f32_32x32x16_bf16 v[176:191], v[216:219], v[20:23], v[176:191]
 ds_read_b64_tr_b16 v[208:209], v242 offset:40960
 ds_read_b64_tr_b16 v[210:211], v242 offset:41984
 v_rcp_f32 v251, v251
 v_mul_f32 v146, v250, v146
 v_mul_f32 v147, v251, v147
 v_cvt_pk_bf16_f32 v129, v146, v147
 v_mul_f32 v250, v148, v148
 v_mfma_f32_32x32x16_bf16 v[192:207], v[220:223], v[20:23], v[192:207]
 ds_read_b64_tr_b16 v[212:213], v243 offset:40960
 ds_read_b64_tr_b16 v[214:215], v243 offset:41984
 v_mul_f32 v251, v149, v149
 v_fma_f32 v250, v250, v248, v249
 v_fma_f32 v251, v251, v248, v249
 v_mul_f32 v250, v250, v148
 s_waitcnt lgkmcnt(4)
 v_mfma_f32_32x32x16_bf16 v[176:191], v[224:227], v[24:27], v[176:191]
 ds_read_b64_tr_b16 v[216:217], v242 offset:43008
 ds_read_b64_tr_b16 v[218:219], v242 offset:44032
 s_add_u32 m0, s30, 16384
 s_add_u32 s36, s42, s34
 buffer_load_dwordx4 v246, s[16:19], s36 offen lds
 v_mul_f32 v251, v251, v149
 v_exp_f32 v250, v250
 v_exp_f32 v251, v251
 v_add_f32 v250, 1.0, v250
 v_add_f32 v251, 1.0, v251
 v_mfma_f32_32x32x16_bf16 v[192:207], v[228:231], v[24:27], v[192:207]
 ds_read_b64_tr_b16 v[220:221], v243 offset:43008
 ds_read_b64_tr_b16 v[222:223], v243 offset:44032
 v_rcp_f32 v250, v250
 v_rcp_f32 v251, v251
 v_mul_f32 v148, v250, v148
 v_mul_f32 v149, v251, v149
 v_mfma_f32_32x32x16_bf16 v[176:191], v[232:235], v[28:31], v[176:191]
 ds_read_b64_tr_b16 v[224:225], v242 offset:45056
 ds_read_b64_tr_b16 v[226:227], v242 offset:46080
 v_cvt_pk_bf16_f32 v130, v148, v149
 v_mul_f32 v250, v150, v150
 v_mul_f32 v251, v151, v151
 v_fma_f32 v250, v250, v248, v249
 v_mfma_f32_32x32x16_bf16 v[192:207], v[236:239], v[28:31], v[192:207]
 ds_read_b64_tr_b16 v[228:229], v243 offset:45056
 ds_read_b64_tr_b16 v[230:231], v243 offset:46080
 v_fma_f32 v251, v251, v248, v249
 v_mul_f32 v250, v250, v150
 v_mul_f32 v251, v251, v151
 v_exp_f32 v250, v250
 s_waitcnt lgkmcnt(4)
 v_mfma_f32_32x32x16_bf16 v[176:191], v[208:211], v[32:35], v[176:191]
 ds_read_b64_tr_b16 v[232:233], v242 offset:47104
 ds_read_b64_tr_b16 v[234:235], v242 offset:48128
 buffer_load_dwordx4 v247, s[16:19], s36 offen offset:1024 lds
 v_exp_f32 v251, v251
 v_add_f32 v250, 1.0, v250
 v_add_f32 v251, 1.0, v251
 v_rcp_f32 v250, v250
 v_rcp_f32 v251, v251
 v_mul_f32 v150, v250, v150
 v_mfma_f32_32x32x16_bf16 v[192:207], v[212:215], v[32:35], v[192:207]
 ds_read_b64_tr_b16 v[236:237], v243 offset:47104
 ds_read_b64_tr_b16 v[238:239], v243 offset:48128
 v_mul_f32 v151, v251, v151
 v_cvt_pk_bf16_f32 v131, v150, v151
 v_mul_f32 v250, v152, v152
 v_mfma_f32_32x32x16_bf16 v[176:191], v[216:219], v[36:39], v[176:191]
 ds_read_b64_tr_b16 v[208:209], v244 offset:0
 ds_read_b64_tr_b16 v[210:211], v244 offset:1024
 v_mul_f32 v251, v153, v153
 v_fma_f32 v250, v250, v248, v249
 v_fma_f32 v251, v251, v248, v249
 v_mul_f32 v250, v250, v152
 v_mfma_f32_32x32x16_bf16 v[192:207], v[220:223], v[36:39], v[192:207]
 ds_read_b64_tr_b16 v[212:213], v245 offset:0
 ds_read_b64_tr_b16 v[214:215], v245 offset:1024
 v_mul_f32 v251, v251, v153
 v_exp_f32 v250, v250
 v_exp_f32 v251, v251
 v_add_f32 v250, 1.0, v250
 v_add_f32 v251, 1.0, v251
 s_waitcnt lgkmcnt(4)
 v_mfma_f32_32x32x16_bf16 v[176:191], v[224:227], v[40:43], v[176:191]
 ds_read_b64_tr_b16 v[216:217], v244 offset:2048
 ds_read_b64_tr_b16 v[218:219], v244 offset:3072
 s_add_u32 m0, s30, 24576
 s_add_u32 s36, s43, s34
 buffer_load_dwordx4 v246, s[16:19], s36 offen lds
 v_rcp_f32 v250, v250
 v_rcp_f32 v251, v251
 v_mul_f32 v152, v250, v152
 v_mul_f32 v153, v251, v153
 v_cvt_pk_bf16_f32 v132, v152, v153
 v_mfma_f32_32x32x16_bf16 v[192:207], v[228:231], v[40:43], v[192:207]
 ds_read_b64_tr_b16 v[220:221], v245 offset:2048
 ds_read_b64_tr_b16 v[222:223], v245 offset:3072
 v_mul_f32 v250, v154, v154
 v_mul_f32 v251, v155, v155
 v_fma_f32 v250, v250, v248, v249
 v_fma_f32 v251, v251, v248, v249
 v_mfma_f32_32x32x16_bf16 v[176:191], v[232:235], v[44:47], v[176:191]
 ds_read_b64_tr_b16 v[224:225], v244 offset:4096
 ds_read_b64_tr_b16 v[226:227], v244 offset:5120
 v_mul_f32 v250, v250, v154
 v_mul_f32 v251, v251, v155
 v_exp_f32 v250, v250
 v_mfma_f32_32x32x16_bf16 v[192:207], v[236:239], v[44:47], v[192:207]
 ds_read_b64_tr_b16 v[228:229], v245 offset:4096
 ds_read_b64_tr_b16 v[230:231], v245 offset:5120
 v_exp_f32 v251, v251
 v_add_f32 v250, 1.0, v250
 v_add_f32 v251, 1.0, v251
 v_rcp_f32 v250, v250
 v_rcp_f32 v251, v251
 v_mul_f32 v154, v250, v154
 s_waitcnt lgkmcnt(4)
 v_mfma_f32_32x32x16_bf16 v[176:191], v[208:211], v[48:51], v[176:191]
 ds_read_b64_tr_b16 v[232:233], v244 offset:6144
 ds_read_b64_tr_b16 v[234:235], v244 offset:7168
 buffer_load_dwordx4 v247, s[16:19], s36 offen offset:1024 lds
 v_mul_f32 v155, v251, v155
 v_cvt_pk_bf16_f32 v133, v154, v155
 v_mul_f32 v250, v156, v156
 v_mul_f32 v251, v157, v157
 v_mfma_f32_32x32x16_bf16 v[192:207], v[212:215], v[48:51], v[192:207]
 ds_read_b64_tr_b16 v[236:237], v245 offset:6144
 ds_read_b64_tr_b16 v[238:239], v245 offset:7168
 v_fma_f32 v250, v250, v248, v249
 v_fma_f32 v251, v251, v248, v249
 v_mul_f32 v250, v250, v156
 v_mul_f32 v251, v251, v157
 v_mfma_f32_32x32x16_bf16 v[176:191], v[216:219], v[52:55], v[176:191]
 ds_read_b64_tr_b16 v[208:209], v244 offset:8192
 ds_read_b64_tr_b16 v[210:211], v244 offset:9216
 v_exp_f32 v250, v250
 v_exp_f32 v251, v251
 v_add_f32 v250, 1.0, v250
 v_add_f32 v251, 1.0, v251
 v_mfma_f32_32x32x16_bf16 v[192:207], v[220:223], v[52:55], v[192:207]
 ds_read_b64_tr_b16 v[212:213], v245 offset:8192
 ds_read_b64_tr_b16 v[214:215], v245 offset:9216
 v_rcp_f32 v250, v250
 v_rcp_f32 v251, v251
 v_mul_f32 v156, v250, v156
 v_mul_f32 v157, v251, v157
 v_cvt_pk_bf16_f32 v134, v156, v157
 s_waitcnt lgkmcnt(4)
 v_mfma_f32_32x32x16_bf16 v[176:191], v[224:227], v[56:59], v[176:191]
 ds_read_b64_tr_b16 v[216:217], v244 offset:10240
 ds_read_b64_tr_b16 v[218:219], v244 offset:11264
 s_add_u32 m0, s30, 32768
 s_add_u32 s36, s44, s34
 buffer_load_dwordx4 v246, s[16:19], s36 offen lds
 v_mul_f32 v250, v158, v158
 v_mul_f32 v251, v159, v159
 v_fma_f32 v250, v250, v248, v249
 v_fma_f32 v251, v251, v248, v249
 v_mfma_f32_32x32x16_bf16 v[192:207], v[228:231], v[56:59], v[192:207]
 ds_read_b64_tr_b16 v[220:221], v245 offset:10240
 ds_read_b64_tr_b16 v[222:223], v245 offset:11264
 s_waitcnt vmcnt(9)
 s_barrier
 v_mfma_f32_32x32x16_bf16 v[176:191], v[232:235], v[60:63], v[176:191]
 ds_read_b64_tr_b16 v[224:225], v244 offset:12288
 ds_read_b64_tr_b16 v[226:227], v244 offset:13312
 v_mul_f32 v250, v250, v158
 v_mul_f32 v251, v251, v159
 v_exp_f32 v250, v250
 v_exp_f32 v251, v251
 v_add_f32 v250, 1.0, v250
 v_mfma_f32_32x32x16_bf16 v[192:207], v[236:239], v[60:63], v[192:207]
 ds_read_b64_tr_b16 v[228:229], v245 offset:12288
 ds_read_b64_tr_b16 v[230:231], v245 offset:13312
 v_add_f32 v251, 1.0, v251
 v_rcp_f32 v250, v250
 v_rcp_f32 v251, v251
 v_mul_f32 v158, v250, v158
 v_mul_f32 v159, v251, v159
 s_waitcnt lgkmcnt(4)
 v_mfma_f32_32x32x16_bf16 v[176:191], v[208:211], v[64:67], v[176:191]
 ds_read_b64_tr_b16 v[232:233], v244 offset:14336
 ds_read_b64_tr_b16 v[234:235], v244 offset:15360
 buffer_load_dwordx4 v247, s[16:19], s36 offen offset:1024 lds
 v_cvt_pk_bf16_f32 v135, v158, v159
 v_mul_f32 v250, v160, v160
 v_mul_f32 v251, v161, v161
 v_mfma_f32_32x32x16_bf16 v[192:207], v[212:215], v[64:67], v[192:207]
 ds_read_b64_tr_b16 v[236:237], v245 offset:14336
 ds_read_b64_tr_b16 v[238:239], v245 offset:15360
 v_fma_f32 v250, v250, v248, v249
 v_fma_f32 v251, v251, v248, v249
 v_mul_f32 v250, v250, v160
 v_mul_f32 v251, v251, v161
 v_mfma_f32_32x32x16_bf16 v[176:191], v[216:219], v[68:71], v[176:191]
 ds_read_b64_tr_b16 v[208:209], v244 offset:16384
 ds_read_b64_tr_b16 v[210:211], v244 offset:17408
 v_exp_f32 v250, v250
 v_exp_f32 v251, v251
 v_add_f32 v250, 1.0, v250
 v_add_f32 v251, 1.0, v251
 v_rcp_f32 v250, v250
 v_mfma_f32_32x32x16_bf16 v[192:207], v[220:223], v[68:71], v[192:207]
 ds_read_b64_tr_b16 v[212:213], v245 offset:16384
 ds_read_b64_tr_b16 v[214:215], v245 offset:17408
 v_rcp_f32 v251, v251
 v_mul_f32 v160, v250, v160
 v_mul_f32 v161, v251, v161
 v_cvt_pk_bf16_f32 v136, v160, v161
 v_mul_f32 v250, v162, v162
 s_waitcnt lgkmcnt(4)
 v_mfma_f32_32x32x16_bf16 v[176:191], v[224:227], v[72:75], v[176:191]
 ds_read_b64_tr_b16 v[216:217], v244 offset:18432
 ds_read_b64_tr_b16 v[218:219], v244 offset:19456
 s_add_u32 m0, s30, 40960
 s_add_u32 s36, s45, s34
 buffer_load_dwordx4 v246, s[16:19], s36 offen lds
 v_mul_f32 v251, v163, v163
 v_fma_f32 v250, v250, v248, v249
 v_fma_f32 v251, v251, v248, v249
 v_mul_f32 v250, v250, v162
 v_mfma_f32_32x32x16_bf16 v[192:207], v[228:231], v[72:75], v[192:207]
 ds_read_b64_tr_b16 v[220:221], v245 offset:18432
 ds_read_b64_tr_b16 v[222:223], v245 offset:19456
 v_mul_f32 v251, v251, v163
 v_exp_f32 v250, v250
 v_exp_f32 v251, v251
 v_add_f32 v250, 1.0, v250
 v_mfma_f32_32x32x16_bf16 v[176:191], v[232:235], v[76:79], v[176:191]
 ds_read_b64_tr_b16 v[224:225], v244 offset:20480
 ds_read_b64_tr_b16 v[226:227], v244 offset:21504
 v_add_f32 v251, 1.0, v251
 v_rcp_f32 v250, v250
 v_rcp_f32 v251, v251
 v_mul_f32 v162, v250, v162
 v_mul_f32 v163, v251, v163
 v_mfma_f32_32x32x16_bf16 v[192:207], v[236:239], v[76:79], v[192:207]
 ds_read_b64_tr_b16 v[228:229], v245 offset:20480
 ds_read_b64_tr_b16 v[230:231], v245 offset:21504
 v_cvt_pk_bf16_f32 v137, v162, v163
 v_mul_f32 v250, v164, v164
 v_mul_f32 v251, v165, v165
 v_fma_f32 v250, v250, v248, v249
 s_waitcnt lgkmcnt(4)
 v_mfma_f32_32x32x16_bf16 v[176:191], v[208:211], v[80:83], v[176:191]
 ds_read_b64_tr_b16 v[232:233], v244 offset:22528
 ds_read_b64_tr_b16 v[234:235], v244 offset:23552
 buffer_load_dwordx4 v247, s[16:19], s36 offen offset:1024 lds
 v_fma_f32 v251, v251, v248, v249
 v_mul_f32 v250, v250, v164
 v_mul_f32 v251, v251, v165
 v_exp_f32 v250, v250
 v_mfma_f32_32x32x16_bf16 v[192:207], v[212:215], v[80:83], v[192:207]
 ds_read_b64_tr_b16 v[236:237], v245 offset:22528
 ds_read_b64_tr_b16 v[238:239], v245 offset:23552
 v_exp_f32 v251, v251
 v_add_f32 v250, 1.0, v250
 v_add_f32 v251, 1.0, v251
 v_rcp_f32 v250, v250
 v_mfma_f32_32x32x16_bf16 v[176:191], v[216:219], v[84:87], v[176:191]
 ds_read_b64_tr_b16 v[208:209], v244 offset:24576
 ds_read_b64_tr_b16 v[210:211], v244 offset:25600
 v_rcp_f32 v251, v251
 v_mul_f32 v164, v250, v164
 v_mul_f32 v165, v251, v165
 v_cvt_pk_bf16_f32 v138, v164, v165
 v_mul_f32 v250, v166, v166
 v_mfma_f32_32x32x16_bf16 v[192:207], v[220:223], v[84:87], v[192:207]
 ds_read_b64_tr_b16 v[212:213], v245 offset:24576
 ds_read_b64_tr_b16 v[214:215], v245 offset:25600
 v_mul_f32 v251, v167, v167
 v_fma_f32 v250, v250, v248, v249
 v_fma_f32 v251, v251, v248, v249
 v_mul_f32 v250, v250, v166
 s_waitcnt lgkmcnt(4)
 v_mfma_f32_32x32x16_bf16 v[176:191], v[224:227], v[88:91], v[176:191]
 ds_read_b64_tr_b16 v[216:217], v244 offset:26624
 ds_read_b64_tr_b16 v[218:219], v244 offset:27648
 s_add_u32 m0, s30, 49152
 s_add_u32 s36, s46, s34
 buffer_load_dwordx4 v246, s[16:19], s36 offen lds
 v_mul_f32 v251, v251, v167
 v_exp_f32 v250, v250
 v_exp_f32 v251, v251
 v_add_f32 v250, 1.0, v250
 v_add_f32 v251, 1.0, v251
 v_mfma_f32_32x32x16_bf16 v[192:207], v[228:231], v[88:91], v[192:207]
 ds_read_b64_tr_b16 v[220:221], v245 offset:26624
 ds_read_b64_tr_b16 v[222:223], v245 offset:27648
 v_rcp_f32 v250, v250
 v_rcp_f32 v251, v251
 v_mul_f32 v166, v250, v166
 v_mul_f32 v167, v251, v167
 v_cvt_pk_bf16_f32 v139, v166, v167
 v_mfma_f32_32x32x16_bf16 v[176:191], v[232:235], v[92:95], v[176:191]
 ds_read_b64_tr_b16 v[224:225], v244 offset:28672
 ds_read_b64_tr_b16 v[226:227], v244 offset:29696
 v_mul_f32 v250, v168, v168
 v_mul_f32 v251, v169, v169
 v_fma_f32 v250, v250, v248, v249
 v_mfma_f32_32x32x16_bf16 v[192:207], v[236:239], v[92:95], v[192:207]
 ds_read_b64_tr_b16 v[228:229], v245 offset:28672
 ds_read_b64_tr_b16 v[230:231], v245 offset:29696
 v_fma_f32 v251, v251, v248, v249
 v_mul_f32 v250, v250, v168
 v_mul_f32 v251, v251, v169
 v_exp_f32 v250, v250
 s_waitcnt lgkmcnt(4)
 v_mfma_f32_32x32x16_bf16 v[176:191], v[208:211], v[96:99], v[176:191]
 ds_read_b64_tr_b16 v[232:233], v244 offset:30720
 ds_read_b64_tr_b16 v[234:235], v244 offset:31744
 buffer_load_dwordx4 v247, s[16:19], s36 offen offset:1024 lds
 v_exp_f32 v251, v251
 v_add_f32 v250, 1.0, v250
 v_add_f32 v251, 1.0, v251
 v_rcp_f32 v250, v250
 v_rcp_f32 v251, v251
 v_mul_f32 v168, v250, v168
 v_mfma_f32_32x32x16_bf16 v[192:207], v[212:215], v[96:99], v[192:207]
 ds_read_b64_tr_b16 v[236:237], v245 offset:30720
 ds_read_b64_tr_b16 v[238:239], v245 offset:31744
 v_mul_f32 v169, v251, v169
 v_cvt_pk_bf16_f32 v140, v168, v169
 v_mul_f32 v250, v170, v170
 v_mul_f32 v251, v171, v171
 v_mfma_f32_32x32x16_bf16 v[176:191], v[216:219], v[100:103], v[176:191]
 ds_read_b64_tr_b16 v[208:209], v244 offset:32768
 ds_read_b64_tr_b16 v[210:211], v244 offset:33792
 v_fma_f32 v250, v250, v248, v249
 v_fma_f32 v251, v251, v248, v249
 v_mul_f32 v250, v250, v170
 v_mfma_f32_32x32x16_bf16 v[192:207], v[220:223], v[100:103], v[192:207]
 ds_read_b64_tr_b16 v[212:213], v245 offset:32768
 ds_read_b64_tr_b16 v[214:215], v245 offset:33792
 v_mul_f32 v251, v251, v171
 v_exp_f32 v250, v250
 v_exp_f32 v251, v251
 v_add_f32 v250, 1.0, v250
 v_add_f32 v251, 1.0, v251
 s_waitcnt lgkmcnt(4)
 v_mfma_f32_32x32x16_bf16 v[176:191], v[224:227], v[104:107], v[176:191]
 ds_read_b64_tr_b16 v[216:217], v244 offset:34816
 ds_read_b64_tr_b16 v[218:219], v244 offset:35840
 s_add_u32 m0, s30, 57344
 s_add_u32 s36, s47, s34
 buffer_load_dwordx4 v246, s[16:19], s36 offen lds
 v_rcp_f32 v250, v250
 v_rcp_f32 v251, v251
 v_mul_f32 v170, v250, v170
 v_mul_f32 v171, v251, v171
 v_cvt_pk_bf16_f32 v141, v170, v171
 v_mfma_f32_32x32x16_bf16 v[192:207], v[228:231], v[104:107], v[192:207]
 ds_read_b64_tr_b16 v[220:221], v245 offset:34816
 ds_read_b64_tr_b16 v[222:223], v245 offset:35840
 v_mul_f32 v250, v172, v172
 v_mul_f32 v251, v173, v173
 v_fma_f32 v250, v250, v248, v249
 v_fma_f32 v251, v251, v248, v249
 v_mfma_f32_32x32x16_bf16 v[176:191], v[232:235], v[108:111], v[176:191]
 ds_read_b64_tr_b16 v[224:225], v244 offset:36864
 ds_read_b64_tr_b16 v[226:227], v244 offset:37888
 v_mul_f32 v250, v250, v172
 v_mul_f32 v251, v251, v173
 v_exp_f32 v250, v250
 v_exp_f32 v251, v251
 v_add_f32 v250, 1.0, v250
 v_mfma_f32_32x32x16_bf16 v[192:207], v[236:239], v[108:111], v[192:207]
 ds_read_b64_tr_b16 v[228:229], v245 offset:36864
 ds_read_b64_tr_b16 v[230:231], v245 offset:37888
 v_add_f32 v251, 1.0, v251
 v_rcp_f32 v250, v250
 v_rcp_f32 v251, v251
 v_mul_f32 v172, v250, v172
 s_waitcnt lgkmcnt(4)
 v_mfma_f32_32x32x16_bf16 v[176:191], v[208:211], v[112:115], v[176:191]
 ds_read_b64_tr_b16 v[232:233], v244 offset:38912
 ds_read_b64_tr_b16 v[234:235], v244 offset:39936
 buffer_load_dwordx4 v247, s[16:19], s36 offen offset:1024 lds
 v_mul_f32 v173, v251, v173
 v_cvt_pk_bf16_f32 v142, v172, v173
 v_mul_f32 v250, v174, v174
 v_mul_f32 v251, v175, v175
 v_mfma_f32_32x32x16_bf16 v[192:207], v[212:215], v[112:115], v[192:207]
 ds_read_b64_tr_b16 v[236:237], v245 offset:38912
 ds_read_b64_tr_b16 v[238:239], v245 offset:39936
 v_fma_f32 v250, v250, v248, v249
 v_fma_f32 v251, v251, v248, v249
 v_mul_f32 v250, v250, v174
 v_mul_f32 v251, v251, v175
 v_mfma_f32_32x32x16_bf16 v[176:191], v[216:219], v[116:119], v[176:191]
 ds_read_b64_tr_b16 v[208:209], v244 offset:40960
 ds_read_b64_tr_b16 v[210:211], v244 offset:41984
 v_exp_f32 v250, v250
 v_exp_f32 v251, v251
 v_add_f32 v250, 1.0, v250
 v_add_f32 v251, 1.0, v251
 v_rcp_f32 v250, v250
 v_mfma_f32_32x32x16_bf16 v[192:207], v[220:223], v[116:119], v[192:207]
 ds_read_b64_tr_b16 v[212:213], v245 offset:40960
 ds_read_b64_tr_b16 v[214:215], v245 offset:41984
 v_rcp_f32 v251, v251
 v_mul_f32 v174, v250, v174
 v_mul_f32 v175, v251, v175
 v_cvt_pk_bf16_f32 v143, v174, v175
 s_waitcnt lgkmcnt(4)
 v_mfma_f32_32x32x16_bf16 v[176:191], v[224:227], v[120:123], v[176:191]
 ds_read_b64_tr_b16 v[216:217], v244 offset:43008
 ds_read_b64_tr_b16 v[218:219], v244 offset:44032
 s_add_u32 m0, s30, 65536
 s_add_u32 s36, s48, s34
 buffer_load_dwordx4 v246, s[16:19], s36 offen lds
 v_mfma_f32_32x32x16_bf16 v[192:207], v[228:231], v[120:123], v[192:207]
 ds_read_b64_tr_b16 v[220:221], v245 offset:43008
 ds_read_b64_tr_b16 v[222:223], v245 offset:44032
 v_mfma_f32_32x32x16_bf16 v[176:191], v[232:235], v[124:127], v[176:191]
 ds_read_b64_tr_b16 v[224:225], v244 offset:45056
 ds_read_b64_tr_b16 v[226:227], v244 offset:46080
 v_mfma_f32_32x32x16_bf16 v[192:207], v[236:239], v[124:127], v[192:207]
 ds_read_b64_tr_b16 v[228:229], v245 offset:45056
 ds_read_b64_tr_b16 v[230:231], v245 offset:46080
 s_waitcnt lgkmcnt(4)
 v_mfma_f32_32x32x16_bf16 v[176:191], v[208:211], v[128:131], v[176:191]
 ds_read_b64_tr_b16 v[232:233], v244 offset:47104
 ds_read_b64_tr_b16 v[234:235], v244 offset:48128
 buffer_load_dwordx4 v247, s[16:19], s36 offen offset:1024 lds
 v_mfma_f32_32x32x16_bf16 v[192:207], v[212:215], v[128:131], v[192:207]
 ds_read_b64_tr_b16 v[236:237], v245 offset:47104
 ds_read_b64_tr_b16 v[238:239], v245 offset:48128
 s_waitcnt vmcnt(8)
 s_barrier
 v_mfma_f32_32x32x16_bf16 v[176:191], v[216:219], v[132:135], v[176:191]
 ds_read_b64_tr_b16 v[208:209], v240 offset:0
 ds_read_b64_tr_b16 v[210:211], v240 offset:1024
 v_mfma_f32_32x32x16_bf16 v[192:207], v[220:223], v[132:135], v[192:207]
 ds_read_b64_tr_b16 v[212:213], v241 offset:0
 ds_read_b64_tr_b16 v[214:215], v241 offset:1024
 s_waitcnt lgkmcnt(4)
 v_mfma_f32_32x32x16_bf16 v[176:191], v[224:227], v[136:139], v[176:191]
 ds_read_b64_tr_b16 v[216:217], v240 offset:2048
 ds_read_b64_tr_b16 v[218:219], v240 offset:3072
 s_add_u32 m0, s30, 73728
 s_add_u32 s34, s34, 128
 s_cmp_ge_u32 s34, 1152
 s_cselect_b32 s3, 1152, 0
 s_sub_u32 s34, s34, s3
 s_add_u32 s36, s40, s34
 buffer_load_dwordx4 v246, s[16:19], s36 offen lds
 v_mfma_f32_32x32x16_bf16 v[192:207], v[228:231], v[136:139], v[192:207]
 ds_read_b64_tr_b16 v[220:221], v241 offset:2048
 ds_read_b64_tr_b16 v[222:223], v241 offset:3072
 v_mfma_f32_32x32x16_bf16 v[176:191], v[232:235], v[140:143], v[176:191]
 ds_read_b64_tr_b16 v[224:225], v240 offset:4096
 ds_read_b64_tr_b16 v[226:227], v240 offset:5120
 v_mfma_f32_32x32x16_bf16 v[192:207], v[236:239], v[140:143], v[192:207]
 ds_read_b64_tr_b16 v[228:229], v241 offset:4096
 ds_read_b64_tr_b16 v[230:231], v241 offset:5120
L3_g2:
 s_waitcnt lgkmcnt(4)
 v_mfma_f32_32x32x16_bf16 v[144:159], v[208:211], v[0:3], 0
 ds_read_b64_tr_b16 v[232:233], v240 offset:6144
 ds_read_b64_tr_b16 v[234:235], v240 offset:7168
 buffer_load_dwordx4 v247, s[16:19], s36 offen offset:1024 lds
 v_mfma_f32_32x32x16_bf16 v[160:175], v[212:215], v[0:3], 0
 ds_read_b64_tr_b16 v[236:237], v241 offset:6144
 ds_read_b64_tr_b16 v[238:239], v241 offset:7168
 v_mfma_f32_32x32x16_bf16 v[144:159], v[216:219], v[4:7], v[144:159]
 ds_read_b64_tr_b16 v[208:209], v240 offset:8192
 ds_read_b64_tr_b16 v[210:211], v240 offset:9216
 v_mfma_f32_32x32x16_bf16 v[160:175], v[220:223], v[4:7], v[160:175]
 ds_read_b64_tr_b16 v[212:213], v241 offset:8192
 ds_read_b64_tr_b16 v[214:215], v241 offset:9216
 s_waitcnt lgkmcnt(4)
 v_mfma_f32_32x32x16_bf16 v[144:159], v[224:227], v[8:11], v[144:159]
 ds_read_b64_tr_b16 v[216:217], v240 offset:10240
 ds_read_b64_tr_b16 v[218:219], v240 offset:11264
 s_add_u32 m0, s30, 81920
 s_add_u32 s36, s41, s34
 buffer_load_dwordx4 v246, s[16:19], s36 offen lds
 v_mul_f32 v176, v253, v176
 v_mfma_f32_32x32x16_bf16 v[160:175], v[228:231], v[8:11], v[160:175]
 ds_read_b64_tr_b16 v[220:221], v241 offset:10240
 ds_read_b64_tr_b16 v[222:223], v241 offset:11264
 v_mul_f32 v177, v253, v177
 v_mfma_f32_32x32x16_bf16 v[144:159], v[232:235], v[12:15], v[144:159]
 ds_read_b64_tr_b16 v[224:225], v240 offset:12288
 ds_read_b64_tr_b16 v[226:227], v240 offset:13312
 v_mul_f32 v178, v253, v178
 v_mfma_f32_32x32x16_bf16 v[160:175], v[236:239], v[12:15], v[160:175]
 ds_read_b64_tr_b16 v[228:229], v241 offset:12288
 ds_read_b64_tr_b16 v[230:231], v241 offset:13312
 v_mul_f32 v179, v253, v179
 s_waitcnt lgkmcnt(4)
 v_mfma_f32_32x32x16_bf16 v[144:159], v[208:211], v[16:19], v[144:159]
 ds_read_b64_tr_b16 v[232:233], v240 offset:14336
 ds_read_b64_tr_b16 v[234:235], v240 offset:15360
 buffer_load_dwordx4 v247, s[16:19], s36 offen offset:1024 lds
 v_mul_f32 v180, v253, v180
 v_mfma_f32_32x32x16_bf16 v[160:175], v[212:215], v[16:19], v[160:175]
 ds_read_b64_tr_b16 v[236:237], v241 offset:14336
 ds_read_b64_tr_b16 v[238:239], v241 offset:15360
 v_mul_f32 v181, v253, v181
 v_mfma_f32_32x32x16_bf16 v[144:159], v[216:219], v[20:23], v[144:159]
 ds_read_b64_tr_b16 v[208:209], v240 offset:16384
 ds_read_b64_tr_b16 v[210:211], v240 offset:17408
 v_mul_f32 v182, v253, v182
 v_mfma_f32_32x32x16_bf16 v[160:175], v[220:223], v[20:23], v[160:175]
 ds_read_b64_tr_b16 v[212:213], v241 offset:16384
 ds_read_b64_tr_b16 v[214:215], v241 offset:17408
 v_mul_f32 v183, v253, v183
 s_waitcnt lgkmcnt(4)
 v_mfma_f32_32x32x16_bf16 v[144:159], v[224:227], v[24:27], v[144:159]
 ds_read_b64_tr_b16 v[216:217], v240 offset:18432
 ds_read_b64_tr_b16 v[218:219], v240 offset:19456
 s_add_u32 m0, s30, 90112
 s_add_u32 s36, s42, s34
 buffer_load_dwordx4 v246, s[16:19], s36 offen lds
 v_cvt_pk_bf16_f32 v176, v176, v177
 v_mfma_f32_32x32x16_bf16 v[160:175], v[228:231], v[24:27], v[160:175]
 ds_read_b64_tr_b16 v[220:221], v241 offset:18432
 ds_read_b64_tr_b16 v[222:223], v241 offset:19456
 v_cvt_pk_bf16_f32 v177, v178, v179
 v_mfma_f32_32x32x16_bf16 v[144:159], v[232:235], v[28:31], v[144:159]
 ds_read_b64_tr_b16 v[224:225], v240 offset:20480
 ds_read_b64_tr_b16 v[226:227], v240 offset:21504
 v_cvt_pk_bf16_f32 v178, v180, v181
 v_mfma_f32_32x32x16_bf16 v[160:175], v[236:239], v[28:31], v[160:175]
 ds_read_b64_tr_b16 v[228:229], v241 offset:20480
 ds_read_b64_tr_b16 v[230:231], v241 offset:21504
 v_cvt_pk_bf16_f32 v179, v182, v183
 s_waitcnt lgkmcnt(4)
 v_mfma_f32_32x32x16_bf16 v[144:159], v[208:211], v[32:35], v[144:159]
 ds_read_b64_tr_b16 v[232:233], v240 offset:22528
 ds_read_b64_tr_b16 v[234:235], v240 offset:23552
 buffer_load_dwordx4 v247, s[16:19], s36 offen offset:1024 lds
 buffer_store_dwordx4 v[176:179], v252, s[8:11], s35 offen offset:0 sc1
 v_mfma_f32_32x32x16_bf16 v[160:175], v[212:215], v[32:35], v[160:175]
 ds_read_b64_tr_b16 v[236:237], v241 offset:22528
 ds_read_b64_tr_b16 v[238:239], v241 offset:23552
 v_mul_f32 v184, v253, v184
 v_mfma_f32_32x32x16_bf16 v[144:159], v[216:219], v[36:39], v[144:159]
 ds_read_b64_tr_b16 v[208:209], v240 offset:24576
 ds_read_b64_tr_b16 v[210:211], v240 offset:25600
 v_mul_f32 v185, v253, v185
 v_mfma_f32_32x32x16_bf16 v[160:175], v[220:223], v[36:39], v[160:175]
 ds_read_b64_tr_b16 v[212:213], v241 offset:24576
 ds_read_b64_tr_b16 v[214:215], v241 offset:25600
 v_mul_f32 v186, v253, v186
 s_waitcnt lgkmcnt(4)
 v_mfma_f32_32x32x16_bf16 v[144:159], v[224:227], v[40:43], v[144:159]
 ds_read_b64_tr_b16 v[216:217], v240 offset:26624
 ds_read_b64_tr_b16 v[218:219], v240 offset:27648
 s_add_u32 m0, s30, 98304
 s_add_u32 s36, s43, s34
 buffer_load_dwordx4 v246, s[16:19], s36 offen lds
 v_mul_f32 v187, v253, v187
 v_mfma_f32_32x32x16_bf16 v[160:175], v[228:231], v[40:43], v[160:175]
 ds_read_b64_tr_b16 v[220:221], v241 offset:26624
 ds_read_b64_tr_b16 v[222:223], v241 offset:27648
 v_mul_f32 v188, v253, v188
 v_mfma_f32_32x32x16_bf16 v[144:159], v[232:235], v[44:47], v[144:159]
 ds_read_b64_tr_b16 v[224:225], v240 offset:28672
 ds_read_b64_tr_b16 v[226:227], v240 offset:29696
 v_mul_f32 v189, v253, v189
 v_mfma_f32_32x32x16_bf16 v[160:175], v[236:239], v[44:47], v[160:175]
 ds_read_b64_tr_b16 v[228:229], v241 offset:28672
 ds_read_b64_tr_b16 v[230:231], v241 offset:29696
 v_mul_f32 v190, v253, v190
 s_waitcnt lgkmcnt(4)
 v_mfma_f32_32x32x16_bf16 v[144:159], v[208:211], v[48:51], v[144:159]
 ds_read_b64_tr_b16 v[232:233], v240 offset:30720
 ds_read_b64_tr_b16 v[234:235], v240 offset:31744
 buffer_load_dwordx4 v247, s[16:19], s36 offen offset:1024 lds
 v_mul_f32 v191, v253, v191
 v_mfma_f32_32x32x16_bf16 v[160:175], v[212:215], v[48:51], v[160:175]
 ds_read_b64_tr_b16 v[236:237], v241 offset:30720
 ds_read_b64_tr_b16 v[238:239], v241 offset:31744
 v_cvt_pk_bf16_f32 v184, v184, v185
 v_mfma_f32_32x32x16_bf16 v[144:159], v[216:219], v[52:55], v[144:159]
 ds_read_b64_tr_b16 v[208:209], v240 offset:32768
 ds_read_b64_tr_b16 v[210:211], v240 offset:33792
 v_cvt_pk_bf16_f32 v185, v186, v187
 v_mfma_f32_32x32x16_bf16 v[160:175], v[220:223], v[52:55], v[160:175]
 ds_read_b64_tr_b16 v[212:213], v241 offset:32768
 ds_read_b64_tr_b16 v[214:215], v241 offset:33792
 v_cvt_pk_bf16_f32 v186, v188, v189
 s_waitcnt lgkmcnt(4)
 v_mfma_f32_32x32x16_bf16 v[144:159], v[224:227], v[56:59], v[144:159]
 ds_read_b64_tr_b16 v[216:217], v240 offset:34816
 ds_read_b64_tr_b16 v[218:219], v240 offset:35840
 s_add_u32 m0, s30, 106496
 s_add_u32 s36, s44, s34
 buffer_load_dwordx4 v246, s[16:19], s36 offen lds
 v_cvt_pk_bf16_f32 v187, v190, v191
 v_mfma_f32_32x32x16_bf16 v[160:175], v[228:231], v[56:59], v[160:175]
 ds_read_b64_tr_b16 v[220:221], v241 offset:34816
 ds_read_b64_tr_b16 v[222:223], v241 offset:35840
 s_waitcnt vmcnt(10)
 s_barrier
 v_mfma_f32_32x32x16_bf16 v[144:159], v[232:235], v[60:63], v[144:159]
 ds_read_b64_tr_b16 v[224:225], v240 offset:36864
 ds_read_b64_tr_b16 v[226:227], v240 offset:37888
 buffer_store_dwordx4 v[184:187], v252, s[8:11], s35 offen offset:1024 sc1
 v_mfma_f32_32x32x16_bf16 v[160:175], v[236:239], v[60:63], v[160:175]
 ds_read_b64_tr_b16 v[228:229], v241 offset:36864
 ds_read_b64_tr_b16 v[230:231], v241 offset:37888
 v_mul_f32 v192, v253, v192
 s_waitcnt lgkmcnt(4)
 v_mfma_f32_32x32x16_bf16 v[144:159], v[208:211], v[64:67], v[144:159]
 ds_read_b64_tr_b16 v[232:233], v240 offset:38912
 ds_read_b64_tr_b16 v[234:235], v240 offset:39936
 buffer_load_dwordx4 v247, s[16:19], s36 offen offset:1024 lds
 v_mfma_f32_32x32x16_bf16 v[160:175], v[212:215], v[64:67], v[160:175]
 ds_read_b64_tr_b16 v[236:237], v241 offset:38912
 ds_read_b64_tr_b16 v[238:239], v241 offset:39936
 v_mul_f32 v193, v253, v193
 v_mfma_f32_32x32x16_bf16 v[144:159], v[216:219], v[68:71], v[144:159]
 ds_read_b64_tr_b16 v[208:209], v240 offset:40960
 ds_read_b64_tr_b16 v[210:211], v240 offset:41984
 v_mul_f32 v194, v253, v194
 v_mfma_f32_32x32x16_bf16 v[160:175], v[220:223], v[68:71], v[160:175]
 ds_read_b64_tr_b16 v[212:213], v241 offset:40960
 ds_read_b64_tr_b16 v[214:215], v241 offset:41984
 v_mul_f32 v195, v253, v195
 s_waitcnt lgkmcnt(4)
 v_mfma_f32_32x32x16_bf16 v[144:159], v[224:227], v[72:75], v[144:159]
 ds_read_b64_tr_b16 v[216:217], v240 offset:43008
 ds_read_b64_tr_b16 v[218:219], v240 offset:44032
 s_add_u32 m0, s30, 114688
 s_add_u32 s36, s45, s34
 buffer_load_dwordx4 v246, s[16:19], s36 offen lds
 v_mul_f32 v196, v253, v196
 v_mfma_f32_32x32x16_bf16 v[160:175], v[228:231], v[72:75], v[160:175]
 ds_read_b64_tr_b16 v[220:221], v241 offset:43008
 ds_read_b64_tr_b16 v[222:223], v241 offset:44032
 v_mul_f32 v197, v253, v197
 v_mfma_f32_32x32x16_bf16 v[144:159], v[232:235], v[76:79], v[144:159]
 ds_read_b64_tr_b16 v[224:225], v240 offset:45056
 ds_read_b64_tr_b16 v[226:227], v240 offset:46080
 v_mul_f32 v198, v253, v198
 v_mfma_f32_32x32x16_bf16 v[160:175], v[236:239], v[76:79], v[160:175]
 ds_read_b64_tr_b16 v[228:229], v241 offset:45056
 ds_read_b64_tr_b16 v[230:231], v241 offset:46080
 v_mul_f32 v199, v253, v199
 s_waitcnt lgkmcnt(4)
 v_mfma_f32_32x32x16_bf16 v[144:159], v[208:211], v[80:83], v[144:159]
 ds_read_b64_tr_b16 v[232:233], v240 offset:47104
 ds_read_b64_tr_b16 v[234:235], v240 offset:48128
 buffer_load_dwordx4 v247, s[16:19], s36 offen offset:1024 lds
 v_cvt_pk_bf16_f32 v192, v192, v193
 v_mfma_f32_32x32x16_bf16 v[160:175], v[212:215], v[80:83], v[160:175]
 ds_read_b64_tr_b16 v[236:237], v241 offset:47104
 ds_read_b64_tr_b16 v[238:239], v241 offset:48128
 v_cvt_pk_bf16_f32 v193, v194, v195
 v_mfma_f32_32x32x16_bf16 v[144:159], v[216:219], v[84:87], v[144:159]
 ds_read_b64_tr_b16 v[208:209], v242 offset:0
 ds_read_b64_tr_b16 v[210:211], v242 offset:1024
 v_cvt_pk_bf16_f32 v194, v196, v197
 v_mfma_f32_32x32x16_bf16 v[160:175], v[220:223], v[84:87], v[160:175]
 ds_read_b64_tr_b16 v[212:213], v243 offset:0
 ds_read_b64_tr_b16 v[214:215], v243 offset:1024
 v_cvt_pk_bf16_f32 v195, v198, v199
 s_waitcnt lgkmcnt(4)
 v_mfma_f32_32x32x16_bf16 v[144:159], v[224:227], v[88:91], v[144:159]
 ds_read_b64_tr_b16 v[216:217], v242 offset:2048
 ds_read_b64_tr_b16 v[218:219], v242 offset:3072
 s_add_u32 m0, s30, 122880
 s_add_u32 s36, s46, s34
 buffer_load_dwordx4 v246, s[16:19], s36 offen lds
 buffer_store_dwordx4 v[192:195], v252, s[8:11], s35 offen offset:2048 sc1
 v_mfma_f32_32x32x16_bf16 v[160:175], v[228:231], v[88:91], v[160:175]
 ds_read_b64_tr_b16 v[220:221], v243 offset:2048
 ds_read_b64_tr_b16 v[222:223], v243 offset:3072
 v_mul_f32 v200, v253, v200
 v_mfma_f32_32x32x16_bf16 v[144:159], v[232:235], v[92:95], v[144:159]
 ds_read_b64_tr_b16 v[224:225], v242 offset:4096
 ds_read_b64_tr_b16 v[226:227], v242 offset:5120
 v_mul_f32 v201, v253, v201
 v_mfma_f32_32x32x16_bf16 v[160:175], v[236:239], v[92:95], v[160:175]
 ds_read_b64_tr_b16 v[228:229], v243 offset:4096
 ds_read_b64_tr_b16 v[230:231], v243 offset:5120
 v_mul_f32 v202, v253, v202
 s_waitcnt lgkmcnt(4)
 v_mfma_f32_32x32x16_bf16 v[144:159], v[208:211], v[96:99], v[144:159]
 ds_read_b64_tr_b16 v[232:233], v242 offset:6144
 ds_read_b64_tr_b16 v[234:235], v242 offset:7168
 buffer_load_dwordx4 v247, s[16:19], s36 offen offset:1024 lds
 v_mul_f32 v203, v253, v203
 v_mfma_f32_32x32x16_bf16 v[160:175], v[212:215], v[96:99], v[160:175]
 ds_read_b64_tr_b16 v[236:237], v243 offset:6144
 ds_read_b64_tr_b16 v[238:239], v243 offset:7168
 v_mul_f32 v204, v253, v204
 v_mfma_f32_32x32x16_bf16 v[144:159], v[216:219], v[100:103], v[144:159]
 ds_read_b64_tr_b16 v[208:209], v242 offset:8192
 ds_read_b64_tr_b16 v[210:211], v242 offset:9216
 v_mul_f32 v205, v253, v205
 v_mfma_f32_32x32x16_bf16 v[160:175], v[220:223], v[100:103], v[160:175]
 ds_read_b64_tr_b16 v[212:213], v243 offset:8192
 ds_read_b64_tr_b16 v[214:215], v243 offset:9216
 v_mul_f32 v206, v253, v206
 s_waitcnt lgkmcnt(4)
 v_mfma_f32_32x32x16_bf16 v[144:159], v[224:227], v[104:107], v[144:159]
 ds_read_b64_tr_b16 v[216:217], v242 offset:10240
 ds_read_b64_tr_b16 v[218:219], v242 offset:11264
 s_add_u32 m0, s30, 131072
 s_add_u32 s36, s47, s34
 buffer_load_dwordx4 v246, s[16:19], s36 offen lds
 v_mul_f32 v207, v253, v207
 v_mfma_f32_32x32x16_bf16 v[160:175], v[228:231], v[104:107], v[160:175]
 ds_read_b64_tr_b16 v[220:221], v243 offset:10240
 ds_read_b64_tr_b16 v[222:223], v243 offset:11264
 v_cvt_pk_bf16_f32 v200, v200, v201
 v_mfma_f32_32x32x16_bf16 v[144:159], v[232:235], v[108:111], v[144:159]
 ds_read_b64_tr_b16 v[224:225], v242 offset:12288
 ds_read_b64_tr_b16 v[226:227], v242 offset:13312
 v_cvt_pk_bf16_f32 v201, v202, v203
 v_mfma_f32_32x32x16_bf16 v[160:175], v[236:239], v[108:111], v[160:175]
 ds_read_b64_tr_b16 v[228:229], v243 offset:12288
 ds_read_b64_tr_b16 v[230:231], v243 offset:13312
 v_cvt_pk_bf16_f32 v202, v204, v205
 s_waitcnt lgkmcnt(4)
 v_mfma_f32_32x32x16_bf16 v[144:159], v[208:211], v[112:115], v[144:159]
 ds_read_b64_tr_b16 v[232:233], v242 offset:14336
 ds_read_b64_tr_b16 v[234:235], v242 offset:15360
 buffer_load_dwordx4 v247, s[16:19], s36 offen offset:1024 lds
 v_cvt_pk_bf16_f32 v203, v206, v207
 v_mfma_f32_32x32x16_bf16 v[160:175], v[212:215], v[112:115], v[160:175]
 ds_read_b64_tr_b16 v[236:237], v243 offset:14336
 ds_read_b64_tr_b16 v[238:239], v243 offset:15360
 buffer_store_dwordx4 v[200:203], v252, s[8:11], s35 offen offset:3072 sc1
 v_mfma_f32_32x32x16_bf16 v[144:159], v[216:219], v[116:119], v[144:159]
 ds_read_b64_tr_b16 v[208:209], v242 offset:16384
 ds_read_b64_tr_b16 v[210:211], v242 offset:17408
 s_add_u32 s35, s35, 4096
 s_cmp_ge_u32 s35, s50
 s_cselect_b32 s3, 36864, 0
 s_sub_u32 s35, s35, s3
 v_mfma_f32_32x32x16_bf16 v[160:175], v[220:223], v[116:119], v[160:175]
 ds_read_b64_tr_b16 v[212:213], v243 offset:16384
 ds_read_b64_tr_b16 v[214:215], v243 offset:17408
 s_waitcnt lgkmcnt(4)
 v_mfma_f32_32x32x16_bf16 v[144:159], v[224:227], v[120:123], v[144:159]
 ds_read_b64_tr_b16 v[216:217], v242 offset:18432
 ds_read_b64_tr_b16 v[218:219], v242 offset:19456
 s_add_u32 m0, s30, 139264
 s_add_u32 s36, s48, s34
 buffer_load_dwordx4 v246, s[16:19], s36 offen lds
 v_mfma_f32_32x32x16_bf16 v[160:175], v[228:231], v[120:123], v[160:175]
 ds_read_b64_tr_b16 v[220:221], v243 offset:18432
 ds_read_b64_tr_b16 v[222:223], v243 offset:19456
 v_mfma_f32_32x32x16_bf16 v[144:159], v[232:235], v[124:127], v[144:159]
 ds_read_b64_tr_b16 v[224:225], v242 offset:20480
 ds_read_b64_tr_b16 v[226:227], v242 offset:21504
 v_mfma_f32_32x32x16_bf16 v[160:175], v[236:239], v[124:127], v[160:175]
 ds_read_b64_tr_b16 v[228:229], v243 offset:20480
 ds_read_b64_tr_b16 v[230:231], v243 offset:21504
 s_waitcnt lgkmcnt(4)
 v_mfma_f32_32x32x16_bf16 v[144:159], v[208:211], v[128:131], v[144:159]
 ds_read_b64_tr_b16 v[232:233], v242 offset:22528
 ds_read_b64_tr_b16 v[234:235], v242 offset:23552
 buffer_load_dwordx4 v247, s[16:19], s36 offen offset:1024 lds
 v_mfma_f32_32x32x16_bf16 v[160:175], v[212:215], v[128:131], v[160:175]
 ds_read_b64_tr_b16 v[236:237], v243 offset:22528
 ds_read_b64_tr_b16 v[238:239], v243 offset:23552
 s_cmp_eq_u32 s37, 1
 s_cselect_b32 s18, 0, s18
 s_waitcnt vmcnt(10)
 s_barrier
 v_mfma_f32_32x32x16_bf16 v[144:159], v[216:219], v[132:135], v[144:159]
 ds_read_b64_tr_b16 v[208:209], v242 offset:24576
 ds_read_b64_tr_b16 v[210:211], v242 offset:25600
 v_mfma_f32_32x32x16_bf16 v[160:175], v[220:223], v[132:135], v[160:175]
 ds_read_b64_tr_b16 v[212:213], v243 offset:24576
 ds_read_b64_tr_b16 v[214:215], v243 offset:25600
 s_waitcnt lgkmcnt(4)
 v_mfma_f32_32x32x16_bf16 v[144:159], v[224:227], v[136:139], v[144:159]
 ds_read_b64_tr_b16 v[216:217], v242 offset:26624
 ds_read_b64_tr_b16 v[218:219], v242 offset:27648
 s_add_u32 m0, s30, 0
 s_add_u32 s34, s34, 128
 s_cmp_ge_u32 s34, 1152
 s_cselect_b32 s3, 1152, 0
 s_sub_u32 s34, s34, s3
 s_add_u32 s36, s40, s34
 buffer_load_dwordx4 v246, s[16:19], s36 offen lds
 v_mfma_f32_32x32x16_bf16 v[160:175], v[228:231], v[136:139], v[160:175]
 ds_read_b64_tr_b16 v[220:221], v243 offset:26624
 ds_read_b64_tr_b16 v[222:223], v243 offset:27648
 v_mfma_f32_32x32x16_bf16 v[144:159], v[232:235], v[140:143], v[144:159]
 ds_read_b64_tr_b16 v[224:225], v242 offset:28672
 ds_read_b64_tr_b16 v[226:227], v242 offset:29696
 v_mfma_f32_32x32x16_bf16 v[160:175], v[236:239], v[140:143], v[160:175]
 ds_read_b64_tr_b16 v[228:229], v243 offset:28672
 ds_read_b64_tr_b16 v[230:231], v243 offset:29696
 s_waitcnt lgkmcnt(4)
 v_mfma_f32_32x32x16_bf16 v[176:191], v[208:211], v[0:3], 0
 ds_read_b64_tr_b16 v[232:233], v242 offset:30720
 ds_read_b64_tr_b16 v[234:235], v242 offset:31744
 buffer_load_dwordx4 v247, s[16:19], s36 offen offset:1024 lds
 v_mfma_f32_32x32x16_bf16 v[192:207], v[212:215], v[0:3], 0
 ds_read_b64_tr_b16 v[236:237], v243 offset:30720
 ds_read_b64_tr_b16 v[238:239], v243 offset:31744
 v_mfma_f32_32x32x16_bf16 v[176:191], v[216:219], v[4:7], v[176:191]
 ds_read_b64_tr_b16 v[208:209], v242 offset:32768
 ds_read_b64_tr_b16 v[210:211], v242 offset:33792
 v_mfma_f32_32x32x16_bf16 v[192:207], v[220:223], v[4:7], v[192:207]
 ds_read_b64_tr_b16 v[212:213], v243 offset:32768
 ds_read_b64_tr_b16 v[214:215], v243 offset:33792
 s_waitcnt lgkmcnt(4)
 v_mfma_f32_32x32x16_bf16 v[176:191], v[224:227], v[8:11], v[176:191]
 ds_read_b64_tr_b16 v[216:217], v242 offset:34816
 ds_read_b64_tr_b16 v[218:219], v242 offset:35840
 s_add_u32 m0, s30, 8192
 s_add_u32 s36, s41, s34
 buffer_load_dwordx4 v246, s[16:19], s36 offen lds
 v_mul_f32 v144, v253, v144
 v_mfma_f32_32x32x16_bf16 v[192:207], v[228:231], v[8:11], v[192:207]
 ds_read_b64_tr_b16 v[220:221], v243 offset:34816
 ds_read_b64_tr_b16 v[222:223], v243 offset:35840
 v_mul_f32 v145, v253, v145
 v_mfma_f32_32x32x16_bf16 v[176:191], v[232:235], v[12:15], v[176:191]
 ds_read_b64_tr_b16 v[224:225], v242 offset:36864
 ds_read_b64_tr_b16 v[226:227], v242 offset:37888
 v_mul_f32 v146, v253, v146
 v_mfma_f32_32x32x16_bf16 v[192:207], v[236:239], v[12:15], v[192:207]
 ds_read_b64_tr_b16 v[228:229], v243 offset:36864
 ds_read_b64_tr_b16 v[230:231], v243 offset:37888
 v_mul_f32 v147, v253, v147
 s_waitcnt lgkmcnt(4)
 v_mfma_f32_32x32x16_bf16 v[176:191], v[208:211], v[16:19], v[176:191]
 ds_read_b64_tr_b16 v[232:233], v242 offset:38912
 ds_read_b64_tr_b16 v[234:235], v242 offset:39936
 buffer_load_dwordx4 v247, s[16:19], s36 offen offset:1024 lds
 v_mul_f32 v148, v253, v148
 v_mfma_f32_32x32x16_bf16 v[192:207], v[212:215], v[16:19], v[192:207]
 ds_read_b64_tr_b16 v[236:237], v243 offset:38912
 ds_read_b64_tr_b16 v[238:239], v243 offset:39936
 v_mul_f32 v149, v253, v149
 v_mfma_f32_32x32x16_bf16 v[176:191], v[216:219], v[20:23], v[176:191]
 ds_read_b64_tr_b16 v[208:209], v242 offset:40960
 ds_read_b64_tr_b16 v[210:211], v242 offset:41984
 v_mul_f32 v150, v253, v150
 v_mfma_f32_32x32x16_bf16 v[192:207], v[220:223], v[20:23], v[192:207]
 ds_read_b64_tr_b16 v[212:213], v243 offset:40960
 ds_read_b64_tr_b16 v[214:215], v243 offset:41984
 v_mul_f32 v151, v253, v151
 s_waitcnt lgkmcnt(4)
 v_mfma_f32_32x32x16_bf16 v[176:191], v[224:227], v[24:27], v[176:191]
 ds_read_b64_tr_b16 v[216:217], v242 offset:43008
 ds_read_b64_tr_b16 v[218:219], v242 offset:44032
 s_add_u32 m0, s30, 16384
 s_add_u32 s36, s42, s34
 buffer_load_dwordx4 v246, s[16:19], s36 offen lds
 v_cvt_pk_bf16_f32 v144, v144, v145
 v_mfma_f32_32x32x16_bf16 v[192:207], v[228:231], v[24:27], v[192:207]
 ds_read_b64_tr_b16 v[220:221], v243 offset:43008
 ds_read_b64_tr_b16 v[222:223], v243 offset:44032
 v_cvt_pk_bf16_f32 v145, v146, v147
 v_mfma_f32_32x32x16_bf16 v[176:191], v[232:235], v[28:31], v[176:191]
 ds_read_b64_tr_b16 v[224:225], v242 offset:45056
 ds_read_b64_tr_b16 v[226:227], v242 offset:46080
 v_cvt_pk_bf16_f32 v146, v148, v149
 v_mfma_f32_32x32x16_bf16 v[192:207], v[236:239], v[28:31], v[192:207]
 ds_read_b64_tr_b16 v[228:229], v243 offset:45056
 ds_read_b64_tr_b16 v[230:231], v243 offset:46080
 v_cvt_pk_bf16_f32 v147, v150, v151
 s_waitcnt lgkmcnt(4)
 v_mfma_f32_32x32x16_bf16 v[176:191], v[208:211], v[32:35], v[176:191]
 ds_read_b64_tr_b16 v[232:233], v242 offset:47104
 ds_read_b64_tr_b16 v[234:235], v242 offset:48128
 buffer_load_dwordx4 v247, s[16:19], s36 offen offset:1024 lds
 buffer_store_dwordx4 v[144:147], v252, s[8:11], s35 offen offset:0 sc1
 v_mfma_f32_32x32x16_bf16 v[192:207], v[212:215], v[32:35], v[192:207]
 ds_read_b64_tr_b16 v[236:237], v243 offset:47104
 ds_read_b64_tr_b16 v[238:239], v243 offset:48128
 v_mul_f32 v152, v253, v152
 v_mfma_f32_32x32x16_bf16 v[176:191], v[216:219], v[36:39], v[176:191]
 ds_read_b64_tr_b16 v[208:209], v244 offset:0
 ds_read_b64_tr_b16 v[210:211], v244 offset:1024
 v_mul_f32 v153, v253, v153
 v_mfma_f32_32x32x16_bf16 v[192:207], v[220:223], v[36:39], v[192:207]
 ds_read_b64_tr_b16 v[212:213], v245 offset:0
 ds_read_b64_tr_b16 v[214:215], v245 offset:1024
 v_mul_f32 v154, v253, v154
 s_waitcnt lgkmcnt(4)
 v_mfma_f32_32x32x16_bf16 v[176:191], v[224:227], v[40:43], v[176:191]
 ds_read_b64_tr_b16 v[216:217], v244 offset:2048
 ds_read_b64_tr_b16 v[218:219], v244 offset:3072
 s_add_u32 m0, s30, 24576
 s_add_u32 s36, s43, s34
 buffer_load_dwordx4 v246, s[16:19], s36 offen lds
 v_mul_f32 v155, v253, v155
 v_mfma_f32_32x32x16_bf16 v[192:207], v[228:231], v[40:43], v[192:207]
 ds_read_b64_tr_b16 v[220:221], v245 offset:2048
 ds_read_b64_tr_b16 v[222:223], v245 offset:3072
 v_mul_f32 v156, v253, v156
 v_mfma_f32_32x32x16_bf16 v[176:191], v[232:235], v[44:47], v[176:191]
 ds_read_b64_tr_b16 v[224:225], v244 offset:4096
 ds_read_b64_tr_b16 v[226:227], v244 offset:5120
 v_mul_f32 v157, v253, v157
 v_mfma_f32_32x32x16_bf16 v[192:207], v[236:239], v[44:47], v[192:207]
 ds_read_b64_tr_b16 v[228:229], v245 offset:4096
 ds_read_b64_tr_b16 v[230:231], v245 offset:5120
 v_mul_f32 v158, v253, v158
 s_waitcnt lgkmcnt(4)
 v_mfma_f32_32x32x16_bf16 v[176:191], v[208:211], v[48:51], v[176:191]
 ds_read_b64_tr_b16 v[232:233], v244 offset:6144
 ds_read_b64_tr_b16 v[234:235], v244 offset:7168
 buffer_load_dwordx4 v247, s[16:19], s36 offen offset:1024 lds
 v_mul_f32 v159, v253, v159
 v_mfma_f32_32x32x16_bf16 v[192:207], v[212:215], v[48:51], v[192:207]
 ds_read_b64_tr_b16 v[236:237], v245 offset:6144
 ds_read_b64_tr_b16 v[238:239], v245 offset:7168
 v_cvt_pk_bf16_f32 v152, v152, v153
 v_mfma_f32_32x32x16_bf16 v[176:191], v[216:219], v[52:55], v[176:191]
 ds_read_b64_tr_b16 v[208:209], v244 offset:8192
 ds_read_b64_tr_b16 v[210:211], v244 offset:9216
 v_cvt_pk_bf16_f32 v153, v154, v155
 v_mfma_f32_32x32x16_bf16 v[192:207], v[220:223], v[52:55], v[192:207]
 ds_read_b64_tr_b16 v[212:213], v245 offset:8192
 ds_read_b64_tr_b16 v[214:215], v245 offset:9216
 v_cvt_pk_bf16_f32 v154, v156, v157
 s_waitcnt lgkmcnt(4)
 v_mfma_f32_32x32x16_bf16 v[176:191], v[224:227], v[56:59], v[176:191]
 ds_read_b64_tr_b16 v[216:217], v244 offset:10240
 ds_read_b64_tr_b16 v[218:219], v244 offset:11264
 s_add_u32 m0, s30, 32768
 s_add_u32 s36, s44, s34
 buffer_load_dwordx4 v246, s[16:19], s36 offen lds
 v_cvt_pk_bf16_f32 v155, v158, v159
 v_mfma_f32_32x32x16_bf16 v[192:207], v[228:231], v[56:59], v[192:207]
 ds_read_b64_tr_b16 v[220:221], v245 offset:10240
 ds_read_b64_tr_b16 v[222:223], v245 offset:11264
 s_waitcnt vmcnt(10)
 s_barrier
 v_mfma_f32_32x32x16_bf16 v[176:191], v[232:235], v[60:63], v[176:191]
 ds_read_b64_tr_b16 v[224:225], v244 offset:12288
 ds_read_b64_tr_b16 v[226:227], v244 offset:13312
 buffer_store_dwordx4 v[152:155], v252, s[8:11], s35 offen offset:1024 sc1
 v_mfma_f32_32x32x16_bf16 v[192:207], v[236:239], v[60:63], v[192:207]
 ds_read_b64_tr_b16 v[228:229], v245 offset:12288
 ds_read_b64_tr_b16 v[230:231], v245 offset:13312
 v_mul_f32 v160, v253, v160
 s_waitcnt lgkmcnt(4)
 v_mfma_f32_32x32x16_bf16 v[176:191], v[208:211], v[64:67], v[176:191]
 ds_read_b64_tr_b16 v[232:233], v244 offset:14336
 ds_read_b64_tr_b16 v[234:235], v244 offset:15360
 buffer_load_dwordx4 v247, s[16:19], s36 offen offset:1024 lds
 v_mfma_f32_32x32x16_bf16 v[192:207], v[212:215], v[64:67], v[192:207]
 ds_read_b64_tr_b16 v[236:237], v245 offset:14336
 ds_read_b64_tr_b16 v[238:239], v245 offset:15360
 v_mul_f32 v161, v253, v161
 v_mfma_f32_32x32x16_bf16 v[176:191], v[216:219], v[68:71], v[176:191]
 ds_read_b64_tr_b16 v[208:209], v244 offset:16384
 ds_read_b64_tr_b16 v[210:211], v244 offset:17408
 v_mul_f32 v162, v253, v162
 v_mfma_f32_32x32x16_bf16 v[192:207], v[220:223], v[68:71], v[192:207]
 ds_read_b64_tr_b16 v[212:213], v245 offset:16384
 ds_read_b64_tr_b16 v[214:215], v245 offset:17408
 v_mul_f32 v163, v253, v163
 s_waitcnt lgkmcnt(4)
 v_mfma_f32_32x32x16_bf16 v[176:191], v[224:227], v[72:75], v[176:191]
 ds_read_b64_tr_b16 v[216:217], v244 offset:18432
 ds_read_b64_tr_b16 v[218:219], v244 offset:19456
 s_add_u32 m0, s30, 40960
 s_add_u32 s36, s45, s34
 buffer_load_dwordx4 v246, s[16:19], s36 offen lds
 v_mul_f32 v164, v253, v164
 v_mfma_f32_32x32x16_bf16 v[192:207], v[228:231], v[72:75], v[192:207]
 ds_read_b64_tr_b16 v[220:221], v245 offset:18432
 ds_read_b64_tr_b16 v[222:223], v245 offset:19456
 v_mul_f32 v165, v253, v165
 v_mfma_f32_32x32x16_bf16 v[176:191], v[232:235], v[76:79], v[176:191]
 ds_read_b64_tr_b16 v[224:225], v244 offset:20480
 ds_read_b64_tr_b16 v[226:227], v244 offset:21504
 v_mul_f32 v166, v253, v166
 v_mfma_f32_32x32x16_bf16 v[192:207], v[236:239], v[76:79], v[192:207]
 ds_read_b64_tr_b16 v[228:229], v245 offset:20480
 ds_read_b64_tr_b16 v[230:231], v245 offset:21504
 v_mul_f32 v167, v253, v167
 s_waitcnt lgkmcnt(4)
 v_mfma_f32_32x32x16_bf16 v[176:191], v[208:211], v[80:83], v[176:191]
 ds_read_b64_tr_b16 v[232:233], v244 offset:22528
 ds_read_b64_tr_b16 v[234:235], v244 offset:23552
 buffer_load_dwordx4 v247, s[16:19], s36 offen offset:1024 lds
 v_cvt_pk_bf16_f32 v160, v160, v161
 v_mfma_f32_32x32x16_bf16 v[192:207], v[212:215], v[80:83], v[192:207]
 ds_read_b64_tr_b16 v[236:237], v245 offset:22528
 ds_read_b64_tr_b16 v[238:239], v245 offset:23552
 v_cvt_pk_bf16_f32 v161, v162, v163
 v_mfma_f32_32x32x16_bf16 v[176:191], v[216:219], v[84:87], v[176:191]
 ds_read_b64_tr_b16 v[208:209], v244 offset:24576
 ds_read_b64_tr_b16 v[210:211], v244 offset:25600
 v_cvt_pk_bf16_f32 v162, v164, v165
 v_mfma_f32_32x32x16_bf16 v[192:207], v[220:223], v[84:87], v[192:207]
 ds_read_b64_tr_b16 v[212:213], v245 offset:24576
 ds_read_b64_tr_b16 v[214:215], v245 offset:25600
 v_cvt_pk_bf16_f32 v163, v166, v167
 s_waitcnt lgkmcnt(4)
 v_mfma_f32_32x32x16_bf16 v[176:191], v[224:227], v[88:91], v[176:191]
 ds_read_b64_tr_b16 v[216:217], v244 offset:26624
 ds_read_b64_tr_b16 v[218:219], v244 offset:27648
 s_add_u32 m0, s30, 49152
 s_add_u32 s36, s46, s34
 buffer_load_dwordx4 v246, s[16:19], s36 offen lds
 buffer_store_dwordx4 v[160:163], v252, s[8:11], s35 offen offset:2048 sc1
 v_mfma_f32_32x32x16_bf16 v[192:207], v[228:231], v[88:91], v[192:207]
 ds_read_b64_tr_b16 v[220:221], v245 offset:26624
 ds_read_b64_tr_b16 v[222:223], v245 offset:27648
 v_mul_f32 v168, v253, v168
 v_mfma_f32_32x32x16_bf16 v[176:191], v[232:235], v[92:95], v[176:191]
 ds_read_b64_tr_b16 v[224:225], v244 offset:28672
 ds_read_b64_tr_b16 v[226:227], v244 offset:29696
 v_mul_f32 v169, v253, v169
 v_mfma_f32_32x32x16_bf16 v[192:207], v[236:239], v[92:95], v[192:207]
 ds_read_b64_tr_b16 v[228:229], v245 offset:28672
 ds_read_b64_tr_b16 v[230:231], v245 offset:29696
 v_mul_f32 v170, v253, v170
 s_waitcnt lgkmcnt(4)
 v_mfma_f32_32x32x16_bf16 v[176:191], v[208:211], v[96:99], v[176:191]
 ds_read_b64_tr_b16 v[232:233], v244 offset:30720
 ds_read_b64_tr_b16 v[234:235], v244 offset:31744
 buffer_load_dwordx4 v247, s[16:19], s36 offen offset:1024 lds
 v_mul_f32 v171, v253, v171
 v_mfma_f32_32x32x16_bf16 v[192:207], v[212:215], v[96:99], v[192:207]
 ds_read_b64_tr_b16 v[236:237], v245 offset:30720
 ds_read_b64_tr_b16 v[238:239], v245 offset:31744
 v_mul_f32 v172, v253, v172
 v_mfma_f32_32x32x16_bf16 v[176:191], v[216:219], v[100:103], v[176:191]
 ds_read_b64_tr_b16 v[208:209], v244 offset:32768
 ds_read_b64_tr_b16 v[210:211], v244 offset:33792
 v_mul_f32 v173, v253, v173
 v_mfma_f32_32x32x16_bf16 v[192:207], v[220:223], v[100:103], v[192:207]
 ds_read_b64_tr_b16 v[212:213], v245 offset:32768
 ds_read_b64_tr_b16 v[214:215], v245 offset:33792
 v_mul_f32 v174, v253, v174
 s_waitcnt lgkmcnt(4)
 v_mfma_f32_32x32x16_bf16 v[176:191], v[224:227], v[104:107], v[176:191]
 ds_read_b64_tr_b16 v[216:217], v244 offset:34816
 ds_read_b64_tr_b16 v[218:219], v244 offset:35840
 s_add_u32 m0, s30, 57344
 s_add_u32 s36, s47, s34
 buffer_load_dwordx4 v246, s[16:19], s36 offen lds
 v_mul_f32 v175, v253, v175
 v_mfma_f32_32x32x16_bf16 v[192:207], v[228:231], v[104:107], v[192:207]
 ds_read_b64_tr_b16 v[220:221], v245 offset:34816
 ds_read_b64_tr_b16 v[222:223], v245 offset:35840
 v_cvt_pk_bf16_f32 v168, v168, v169
 v_mfma_f32_32x32x16_bf16 v[176:191], v[232:235], v[108:111], v[176:191]
 ds_read_b64_tr_b16 v[224:225], v244 offset:36864
 ds_read_b64_tr_b16 v[226:227], v244 offset:37888
 v_cvt_pk_bf16_f32 v169, v170, v171
 v_mfma_f32_32x32x16_bf16 v[192:207], v[236:239], v[108:111], v[192:207]
 ds_read_b64_tr_b16 v[228:229], v245 offset:36864
 ds_read_b64_tr_b16 v[230:231], v245 offset:37888
 v_cvt_pk_bf16_f32 v170, v172, v173
 s_waitcnt lgkmcnt(4)
 v_mfma_f32_32x32x16_bf16 v[176:191], v[208:211], v[112:115], v[176:191]
 ds_read_b64_tr_b16 v[232:233], v244 offset:38912
 ds_read_b64_tr_b16 v[234:235], v244 offset:39936
 buffer_load_dwordx4 v247, s[16:19], s36 offen offset:1024 lds
 v_cvt_pk_bf16_f32 v171, v174, v175
 v_mfma_f32_32x32x16_bf16 v[192:207], v[212:215], v[112:115], v[192:207]
 ds_read_b64_tr_b16 v[236:237], v245 offset:38912
 ds_read_b64_tr_b16 v[238:239], v245 offset:39936
 buffer_store_dwordx4 v[168:171], v252, s[8:11], s35 offen offset:3072 sc1
 v_mfma_f32_32x32x16_bf16 v[176:191], v[216:219], v[116:119], v[176:191]
 ds_read_b64_tr_b16 v[208:209], v244 offset:40960
 ds_read_b64_tr_b16 v[210:211], v244 offset:41984
 s_add_u32 s35, s35, 4096
 s_cmp_ge_u32 s35, s50
 s_cselect_b32 s3, 36864, 0
 s_sub_u32 s35, s35, s3
 v_mfma_f32_32x32x16_bf16 v[192:207], v[220:223], v[116:119], v[192:207]
 ds_read_b64_tr_b16 v[212:213], v245 offset:40960
 ds_read_b64_tr_b16 v[214:215], v245 offset:41984
 s_waitcnt lgkmcnt(4)
 v_mfma_f32_32x32x16_bf16 v[176:191], v[224:227], v[120:123], v[176:191]
 ds_read_b64_tr_b16 v[216:217], v244 offset:43008
 ds_read_b64_tr_b16 v[218:219], v244 offset:44032
 s_add_u32 m0, s30, 65536
 s_add_u32 s36, s48, s34
 buffer_load_dwordx4 v246, s[16:19], s36 offen lds
 v_mfma_f32_32x32x16_bf16 v[192:207], v[228:231], v[120:123], v[192:207]
 ds_read_b64_tr_b16 v[220:221], v245 offset:43008
 ds_read_b64_tr_b16 v[222:223], v245 offset:44032
 v_mfma_f32_32x32x16_bf16 v[176:191], v[232:235], v[124:127], v[176:191]
 ds_read_b64_tr_b16 v[224:225], v244 offset:45056
 ds_read_b64_tr_b16 v[226:227], v244 offset:46080
 v_mfma_f32_32x32x16_bf16 v[192:207], v[236:239], v[124:127], v[192:207]
 ds_read_b64_tr_b16 v[228:229], v245 offset:45056
 ds_read_b64_tr_b16 v[230:231], v245 offset:46080
 s_waitcnt lgkmcnt(4)
 v_mfma_f32_32x32x16_bf16 v[176:191], v[208:211], v[128:131], v[176:191]
 ds_read_b64_tr_b16 v[232:233], v244 offset:47104
 ds_read_b64_tr_b16 v[234:235], v244 offset:48128
 buffer_load_dwordx4 v247, s[16:19], s36 offen offset:1024 lds
 v_mfma_f32_32x32x16_bf16 v[192:207], v[212:215], v[128:131], v[192:207]
 ds_read_b64_tr_b16 v[236:237], v245 offset:47104
 ds_read_b64_tr_b16 v[238:239], v245 offset:48128
 s_waitcnt vmcnt(10)
 s_barrier
 v_mfma_f32_32x32x16_bf16 v[176:191], v[216:219], v[132:135], v[176:191]
 ds_read_b64_tr_b16 v[208:209], v240 offset:0
 ds_read_b64_tr_b16 v[210:211], v240 offset:1024
 v_mfma_f32_32x32x16_bf16 v[192:207], v[220:223], v[132:135], v[192:207]
 ds_read_b64_tr_b16 v[212:213], v241 offset:0
 ds_read_b64_tr_b16 v[214:215], v241 offset:1024
 s_waitcnt lgkmcnt(4)
 v_mfma_f32_32x32x16_bf16 v[176:191], v[224:227], v[136:139], v[176:191]
 ds_read_b64_tr_b16 v[216:217], v240 offset:2048
 ds_read_b64_tr_b16 v[218:219], v240 offset:3072
 s_add_u32 m0, s30, 73728
 s_add_u32 s34, s34, 128
 s_cmp_ge_u32 s34, 1152
 s_cselect_b32 s3, 1152, 0
 s_sub_u32 s34, s34, s3
 s_add_u32 s36, s40, s34
 buffer_load_dwordx4 v246, s[16:19], s36 offen lds
 v_mfma_f32_32x32x16_bf16 v[192:207], v[228:231], v[136:139], v[192:207]
 ds_read_b64_tr_b16 v[220:221], v241 offset:2048
 ds_read_b64_tr_b16 v[222:223], v241 offset:3072
 v_mfma_f32_32x32x16_bf16 v[176:191], v[232:235], v[140:143], v[176:191]
 ds_read_b64_tr_b16 v[224:225], v240 offset:4096
 ds_read_b64_tr_b16 v[226:227], v240 offset:5120
 v_mfma_f32_32x32x16_bf16 v[192:207], v[236:239], v[140:143], v[192:207]
 ds_read_b64_tr_b16 v[228:229], v241 offset:4096
 ds_read_b64_tr_b16 v[230:231], v241 offset:5120
 s_sub_u32 s37, s37, 1
 s_cmp_lg_u32 s37, 0
 s_cbranch_scc1 L3_g2
 s_nop 7
 v_mul_f32 v176, v253, v176
 v_mul_f32 v177, v253, v177
 v_mul_f32 v178, v253, v178
 v_mul_f32 v179, v253, v179
 v_mul_f32 v180, v253, v180
 v_mul_f32 v181, v253, v181
 v_mul_f32 v182, v253, v182
 v_mul_f32 v183, v253, v183
 v_cvt_pk_bf16_f32 v176, v176, v177
 v_cvt_pk_bf16_f32 v177, v178, v179
 v_cvt_pk_bf16_f32 v178, v180, v181
 v_cvt_pk_bf16_f32 v179, v182, v183
 buffer_store_dwordx4 v[176:179], v252, s[8:11], s35 offen offset:0 sc1
 v_mul_f32 v184, v253, v184
 v_mul_f32 v185, v253, v185
 v_mul_f32 v186, v253, v186
 v_mul_f32 v187, v253, v187
 v_mul_f32 v188, v253, v188
 v_mul_f32 v189, v253, v189
 v_mul_f32 v190, v253, v190
 v_mul_f32 v191, v253, v191
 v_cvt_pk_bf16_f32 v184, v184, v185
 v_cvt_pk_bf16_f32 v185, v186, v187
 v_cvt_pk_bf16_f32 v186, v188, v189
 v_cvt_pk_bf16_f32 v187, v190, v191
 buffer_store_dwordx4 v[184:187], v252, s[8:11], s35 offen offset:1024 sc1
 v_mul_f32 v192, v253, v192
 v_mul_f32 v193, v253, v193
 v_mul_f32 v194, v253, v194
 v_mul_f32 v195, v253, v195
 v_mul_f32 v196, v253, v196
 v_mul_f32 v197, v253, v197
 v_mul_f32 v198, v253, v198
 v_mul_f32 v199, v253, v199
 v_cvt_pk_bf16_f32 v192, v192, v193
 v_cvt_pk_bf16_f32 v193, v194, v195
 v_cvt_pk_bf16_f32 v194, v196, v197
 v_cvt_pk_bf16_f32 v195, v198, v199
 buffer_store_dwordx4 v[192:195], v252, s[8:11], s35 offen offset:2048 sc1
 v_mul_f32 v200, v253, v200
 v_mul_f32 v201, v253, v201
 v_mul_f32 v202, v253, v202
 v_mul_f32 v203, v253, v203
 v_mul_f32 v204, v253, v204
 v_mul_f32 v205, v253, v205
 v_mul_f32 v206, v253, v206
 v_mul_f32 v207, v253, v207
 v_cvt_pk_bf16_f32 v200, v200, v201
 v_cvt_pk_bf16_f32 v201, v202, v203
 v_cvt_pk_bf16_f32 v202, v204, v205
 v_cvt_pk_bf16_f32 v203, v206, v207
 buffer_store_dwordx4 v[200:203], v252, s[8:11], s35 offen offset:3072 sc1
 s_add_u32 s35, s35, 4096
 s_cmp_ge_u32 s35, s50
 s_cselect_b32 s3, 36864, 0
 s_sub_u32 s35, s35, s3
 s_mov_b32 s57, s25
 s_waitcnt lgkmcnt(0)
 s_mul_i32 s3, s57, 128
 s_add_u32 s3, s3, 19132928
 v_lshl_add_u32 v2, v255, 7, s3
 v_mov_b32 v1, 0
 s_waitcnt vmcnt(0)
 s_barrier
 s_cmp_lg_u32 s29, 0
 s_cbranch_scc1 L_arr_m
 v_mov_b32 v1, 1
 s_mov_b64 exec, 1
 buffer_atomic_add v1, v2, s[8:11], 0 offen sc1
 s_mov_b64 exec, -1
L_arr_m:
 s_and_b32 s24, s2, 7
 s_bfe_u32 s25, s2, 0x40003
 s_lshl_b32 s3, s24, 7
 s_add_u32 s3, s3, 19134976
 v_mov_b32 v4, s3
 s_lshl_b32 s3, s24, 8
 s_add_u32 s3, s3, 19132928
 v_mov_b32 v5, s3
 s_add_u32 s3, s3, 128
 v_writelane_b32 v5, s3, 0
 v_lshlrev_b32 v7, 4, v255
 s_mul_i32 s26, s24, 294912
 s_mul_i32 s27, s25, 18432
 s_add_u32 s26, s26, s27
 s_lshl_b32 s27, s29, 10
 s_add_u32 s26, s26, s27
 s_cmp_lg_u32 s29, 0
 s_cbranch_scc1 L3_pollb_ok
 s_mov_b32 s38, 0x100000
L3_pollb:
 buffer_load_dword v6, v4, s[8:11], 0 offen sc1
 s_sub_u32 s38, s38, 1
 s_cbranch_scc1 L3_pollb_ok
 s_waitcnt vmcnt(0)
 v_cmp_ne_u32 vcc, 32, v6
 s_cmp_lg_u64 vcc, 0
 s_cbranch_scc1 L3_pollb
L3_pollb_ok:
 s_waitcnt vmcnt(0)
 s_barrier
 s_add_u32 s3, s26, 16622080
 buffer_load_dwordx4 v[8:11], v7, s[8:11], s3 offen sc1
 s_add_u32 s3, s3, 4096
 buffer_load_dwordx4 v[8:11], v7, s[8:11], s3 offen sc1
 s_add_u32 s3, s3, 4096
 buffer_load_dwordx4 v[8:11], v7, s[8:11], s3 offen sc1
 s_add_u32 s3, s3, 4096
 buffer_load_dwordx4 v[8:11], v7, s[8:11], s3 offen sc1
 s_add_u32 s3, s3, 2048
 buffer_load_dwordx4 v[8:11], v7, s[8:11], s3 offen sc1
 s_add_u32 s3, s3, 2048
 s_cmp_lg_u32 s29, 0
 s_cbranch_scc1 L3_polln_ok
 s_mov_b32 s38, 0x100000
L3_polln:
 buffer_load_dword v6, v5, s[8:11], 0 offen sc1
 s_sub_u32 s38, s38, 1
 s_cbranch_scc1 L3_polln_ok
 s_waitcnt vmcnt(0)
 v_cmp_ne_u32 vcc, 8, v6
 s_cmp_lg_u64 vcc, 0
 s_cbranch_scc1 L3_polln
L3_polln_ok:
 s_waitcnt vmcnt(0)
 s_barrier
 s_add_u32 s3, s26, 19165696
 buffer_load_dwordx4 v[8:11], v7, s[8:11], s3 offen sc1
 s_add_u32 s3, s3, 4096
 buffer_load_dwordx4 v[8:11], v7, s[8:11], s3 offen sc1
 s_add_u32 s3, s3, 4096
 buffer_load_dwordx4 v[8:11], v7, s[8:11], s3 offen sc1
 s_add_u32 s3, s3, 4096
 buffer_load_dwordx4 v[8:11], v7, s[8:11], s3 offen sc1
 s_add_u32 s3, s3, 2048
 buffer_load_dwordx4 v[8:11], v7, s[8:11], s3 offen sc1
 s_add_u32 s3, s3, 2048
 s_add_u32 s3, s26, 21524992
 buffer_load_dwordx4 v[8:11], v7, s[8:11], s3 offen sc1
 s_add_u32 s3, s3, 4096
 buffer_load_dwordx4 v[8:11], v7, s[8:11], s3 offen sc1
 s_add_u32 s3, s3, 4096
 buffer_load_dwordx4 v[8:11], v7, s[8:11], s3 offen sc1
 s_add_u32 s3, s3, 4096
 buffer_load_dwordx4 v[8:11], v7, s[8:11], s3 offen sc1
 s_add_u32 s3, s3, 2048
 buffer_load_dwordx4 v[8:11], v7, s[8:11], s3 offen sc1
 s_add_u32 s3, s3, 2048
 s_add_u32 s3, s26, 23884288
 buffer_load_dwordx4 v[8:11], v7, s[8:11], s3 offen sc1
 s_add_u32 s3, s3, 4096
 buffer_load_dwordx4 v[8:11], v7, s[8:11], s3 offen sc1
 s_add_u32 s3, s3, 4096
 buffer_load_dwordx4 v[8:11], v7, s[8:11], s3 offen sc1
 s_add_u32 s3, s3, 4096
 buffer_load_dwordx4 v[8:11], v7, s[8:11], s3 offen sc1
 s_add_u32 s3, s3, 2048
 buffer_load_dwordx4 v[8:11], v7, s[8:11], s3 offen sc1
 s_add_u32 s3, s3, 2048
 s_add_u32 s3, s26, 26243584
 buffer_load_dwordx4 v[8:11], v7, s[8:11], s3 offen sc1
 s_add_u32 s3, s3, 4096
 buffer_load_dwordx4 v[8:11], v7, s[8:11], s3 offen sc1
 s_add_u32 s3, s3, 4096
 buffer_load_dwordx4 v[8:11], v7, s[8:11], s3 offen sc1
 s_add_u32 s3, s3, 4096
 buffer_load_dwordx4 v[8:11], v7, s[8:11], s3 offen sc1
 s_add_u32 s3, s3, 2048
 buffer_load_dwordx4 v[8:11], v7, s[8:11], s3 offen sc1
 s_add_u32 s3, s3, 2048
 s_add_u32 s3, s26, 28602880
 buffer_load_dwordx4 v[8:11], v7, s[8:11], s3 offen sc1
 s_add_u32 s3, s3, 4096
 buffer_load_dwordx4 v[8:11], v7, s[8:11], s3 offen sc1
 s_add_u32 s3, s3, 4096
 buffer_load_dwordx4 v[8:11], v7, s[8:11], s3 offen sc1
 s_add_u32 s3, s3, 4096
 buffer_load_dwordx4 v[8:11], v7, s[8:11], s3 offen sc1
 s_add_u32 s3, s3, 2048
 buffer_load_dwordx4 v[8:11], v7, s[8:11], s3 offen sc1
 s_add_u32 s3, s3, 2048
 s_add_u32 s3, s26, 30962176
 buffer_load_dwordx4 v[8:11], v7, s[8:11], s3 offen sc1
 s_add_u32 s3, s3, 4096
 buffer_load_dwordx4 v[8:11], v7, s[8:11], s3 offen sc1
 s_add_u32 s3, s3, 4096
 buffer_load_dwordx4 v[8:11], v7, s[8:11], s3 offen sc1
 s_add_u32 s3, s3, 4096
 buffer_load_dwordx4 v[8:11], v7, s[8:11], s3 offen sc1
 s_add_u32 s3, s3, 2048
 buffer_load_dwordx4 v[8:11], v7, s[8:11], s3 offen sc1
 s_add_u32 s3, s3, 2048
 s_add_u32 s3, s26, 33321472
 buffer_load_dwordx4 v[8:11], v7, s[8:11], s3 offen sc1
 s_add_u32 s3, s3, 4096
 buffer_load_dwordx4 v[8:11], v7, s[8:11], s3 offen sc1
 s_add_u32 s3, s3, 4096
 buffer_load_dwordx4 v[8:11], v7, s[8:11], s3 offen sc1
 s_add_u32 s3, s3, 4096
 buffer_load_dwordx4 v[8:11], v7, s[8:11], s3 offen sc1
 s_add_u32 s3, s3, 2048
 buffer_load_dwordx4 v[8:11], v7, s[8:11], s3 offen sc1
 s_add_u32 s3, s3, 2048
 s_add_u32 s3, s26, 35680768
 buffer_load_dwordx4 v[8:11], v7, s[8:11], s3 offen sc1
 s_add_u32 s3, s3, 4096
 buffer_load_dwordx4 v[8:11], v7, s[8:11], s3 offen sc1
 s_add_u32 s3, s3, 4096
 buffer_load_dwordx4 v[8:11], v7, s[8:11], s3 offen sc1
 s_add_u32 s3, s3, 4096
 buffer_load_dwordx4 v[8:11], v7, s[8:11], s3 offen sc1
 s_add_u32 s3, s3, 2048
 buffer_load_dwordx4 v[8:11], v7, s[8:11], s3 offen sc1
 s_add_u32 s3, s3, 2048
 s_endpgm
L3_att:
 s_sub_u32 s3, s25, 16
 s_lshl_b32 s35, s24, 2
 s_and_b32 s28, s3, 3
 s_add_u32 s35, s35, s28
 s_lshr_b32 s3, s3, 2
 s_lshl_b32 s3, s3, 2
 s_add_u32 s3, s3, s29
 s_lshl_b32 s36, s3, 2
 s_mul_i32 s26, s36, 36864
 s_add_u32 s26, s26, 0
 s_lshr_b32 s3, s35, 1
 s_mul_i32 s3, s3, 9
 s_and_b32 s27, s35, 1
 s_mul_i32 s28, s27, 5
 s_add_u32 s28, s28, s3
 s_add_u32 s3, s3, 4
 v_and_b32 v6, 31, v255
 v_lshrrev_b32 v7, 5, v255
 v_xor_b32 v0, s28, v7
 v_and_b32 v0, 1, v0
 v_add_u32 v0, s28, v0
 v_lshrrev_b32 v1, 2, v0
 v_lshlrev_b32 v1, 1, v1
 v_and_b32 v208, 1, v0
 v_add_lshl_u32 v1, v1, v208, 6
 v_bfe_u32 v208, v0, 1, 1
 v_add_lshl_u32 v1, v1, v208, 3
 v_add_u32 v0, 2, v0
 v_lshrrev_b32 v2, 2, v0
 v_lshlrev_b32 v2, 1, v2
 v_and_b32 v208, 1, v0
 v_add_lshl_u32 v2, v2, v208, 6
 v_bfe_u32 v208, v0, 1, 1
 v_add_lshl_u32 v2, v2, v208, 3
 v_mov_b32 v0, s3
 v_lshrrev_b32 v3, 2, v0
 v_lshlrev_b32 v3, 1, v3
 v_and_b32 v208, 1, v0
 v_add_lshl_u32 v3, v3, v208, 6
 v_bfe_u32 v208, v0, 1, 1
 v_add_lshl_u32 v3, v3, v208, 3
 s_lshl_b32 s27, s27, 2
 v_lshl_add_u32 v1, v6, 4, v1
 v_lshl_add_u32 v2, v6, 4, v2
 v_lshl_add_u32 v3, v6, 4, v3
 v_add_u32 v3, s27, v3
 s_mul_i32 s3, s35, 18
 v_add_u32 v0, s3, v6
 v_mov_b32 v4, 576
 v_cmp_gt_u32 vcc, 18, v6
 v_cmp_gt_u32 s[42:43], 19, v6
 v_mul_u32_u24 v7, 9344, v7
 v_cndmask_b32 v0, v4, v0, vcc
 v_lshl_add_u32 v0, v0, 4, v7
 v_add_u32 v0, 36864, v0
 v_mov_b32 v7, 0x40000000
 v_cndmask_b32 v4, v7, v0, s[42:43]
 v_add_u32 v5, 18688, v4
 v_cmp_gt_u32 s[40:41], 32, v255
 s_mov_b32 s33, 0
 s_mov_b32 s34, 0x42400000
 s_mov_b32 s30, 2359296
 s_waitcnt lgkmcnt(0)
 s_mov_b32 s8, s6
 s_and_b32 s9, s7, 0xffff
 s_mov_b32 s10, 0x2447200
 s_mov_b32 s11, 0x20000
 v_and_b32 v0, 15, v255
 s_lshl_b32 s3, s24, 7
 s_add_u32 s3, s3, 19137024
 v_lshl_add_u32 v0, v0, 10, s3
 s_cmp_lg_u32 s29, 0
 s_cbranch_scc1 L3_pollq_ok
 s_mov_b32 s38, 0x100000
L3_pollq:
 buffer_load_dword v7, v0, s[8:11], 0 offen sc1
 s_sub_u32 s38, s38, 1
 s_cbranch_scc1 L3_pollq_ok
 s_waitcnt vmcnt(0)
 v_cmp_ne_u32 vcc, 7, v7
 s_cmp_lg_u64 vcc, 0
 s_cbranch_scc1 L3_pollq
L3_pollq_ok:
 s_waitcnt vmcnt(0)
 s_barrier
 buffer_load_dwordx2 v[8:9], v1, s[8:11], s26 offen sc1
 buffer_load_dwordx2 v[10:11], v2, s[8:11], s26 offen sc1
 buffer_load_dword v12, v3, s[8:11], s26 offen sc1
 s_add_u32 s26, s26, 36864
 buffer_load_dwordx2 v[14:15], v1, s[8:11], s26 offen sc1
 buffer_load_dwordx2 v[16:17], v2, s[8:11], s26 offen sc1
 buffer_load_dword v18, v3, s[8:11], s26 offen sc1
 s_add_u32 s26, s26, 36864
 buffer_load_dwordx2 v[20:21], v1, s[8:11], s26 offen sc1
 buffer_load_dwordx2 v[22:23], v2, s[8:11], s26 offen sc1
 buffer_load_dword v24, v3, s[8:11], s26 offen sc1
 s_add_u32 s26, s26, 36864
 buffer_load_dwordx2 v[26:27], v1, s[8:11], s26 offen sc1
 buffer_load_dwordx2 v[28:29], v2, s[8:11], s26 offen sc1
 buffer_load_dword v30, v3, s[8:11], s26 offen sc1
 buffer_load_dwordx2 v[136:137], v1, s[8:11], s30 offen sc1
 buffer_load_dwordx2 v[138:139], v2, s[8:11], s30 offen sc1
 buffer_load_dword v140, v3, s[8:11], s30 offen sc1
 buffer_load_dwordx4 v[144:147], v4, s[8:11], s30 offen sc1
 buffer_load_dwordx4 v[148:151], v5, s[8:11], s30 offen sc1
 s_add_u32 s30, s30, 74240
 s_lshl_b32 s44, s24, 1
 s_and_b32 s3, s25, 1
 s_add_u32 s44, s44, s3
 s_bfe_u32 s45, s25, 0x30001
 s_lshl_b32 s46, s29, 11
 s_lshl_b32 s47, s45, 7
 s_movk_i32 s48, 1152
 s_mul_i32 s49, s29, 18
 s_movk_i32 s58, 1024
 s_add_u32 s59, s46, 73728
 v_lshrrev_b32 v218, 3, v255
 v_add_u32 v218, s49, v218
 v_mul_lo_u32 v216, v218, s48
 v_bfe_u32 v218, v255, 4, 1
 v_lshlrev_b32 v218, 2, v218
 v_and_b32 v217, 7, v255
 v_xor_b32 v218, v218, v217
 v_lshl_add_u32 v216, v218, 4, v216
 s_lshl_b32 s3, s48, 3
 s_sub_u32 s3, s3, 1024
 v_add_u32 v217, s3, v216
 v_lshrrev_b32 v220, 5, v255
 v_bfe_u32 v221, v255, 4, 1
 v_lshl_add_u32 v220, v220, 2, v221
 s_lshl_b32 s3, s29, 3
 v_add_u32 v220, s3, v220
 v_mul_u32_u24 v220, 18, v220
 v_bfe_u32 v222, v255, 3, 1
 v_add3_u32 v220, v220, v222, 16
 v_mul_u32_u24 v220, 1152, v220
 v_lshlrev_b32 v221, 2, v221
 v_and_b32 v222, 7, v255
 v_xor_b32 v221, v221, v222
 v_lshl_add_u32 v218, v221, 4, v220
 v_add_u32 v219, 40448, v218
 s_mov_b32 s12, s60
 s_and_b32 s13, s61, 0xffff
 s_mov_b32 s14, 0xa2000
 s_mov_b32 s15, 0x20000
 v_mov_b32 v141, 0x3f803f80
 v_mov_b32 v157, 0x3f803f80
 v_mov_b32 v173, 0x3f803f80
 v_mov_b32 v189, 0x3f803f80
 v_mov_b32 v13, 0
 v_mov_b32 v200, 0xff800000
 v_mov_b32 v19, 0
 v_mov_b32 v201, 0xff800000
 v_mov_b32 v25, 0
 v_mov_b32 v202, 0xff800000
 v_mov_b32 v31, 0
 v_mov_b32 v203, 0xff800000
 s_waitcnt vmcnt(2)
 v_cndmask_b32 v12, 0, v12, s[40:41]
 v_cndmask_b32 v18, 0, v18, s[40:41]
 v_cndmask_b32 v24, 0, v24, s[40:41]
 v_cndmask_b32 v30, 0, v30, s[40:41]
 s_nop 1
 v_mfma_f32_32x32x16_bf16 v[72:87], v[136:139], v[8:11], 0
 v_mfma_f32_32x32x8_bf16 v[72:87], v[140:141], v[12:13], v[72:87]
 v_mfma_f32_32x32x16_bf16 v[88:103], v[136:139], v[14:17], 0
 v_mfma_f32_32x32x8_bf16 v[88:103], v[140:141], v[18:19], v[88:103]
 v_mfma_f32_32x32x16_bf16 v[104:119], v[136:139], v[20:23], 0
 v_mfma_f32_32x32x8_bf16 v[104:119], v[140:141], v[24:25], v[104:119]
 v_mfma_f32_32x32x16_bf16 v[120:135], v[136:139], v[26:29], 0
 v_mfma_f32_32x32x8_bf16 v[120:135], v[140:141], v[30:31], v[120:135]
 buffer_load_dwordx2 v[152:153], v1, s[8:11], s30 offen sc1
 buffer_load_dwordx2 v[154:155], v2, s[8:11], s30 offen sc1
 buffer_load_dword v156, v3, s[8:11], s30 offen sc1
 buffer_load_dwordx4 v[160:163], v4, s[8:11], s30 offen sc1
 buffer_load_dwordx4 v[164:167], v5, s[8:11], s30 offen sc1
 s_add_u32 s30, s30, 74240
 buffer_load_dwordx2 v[168:169], v1, s[8:11], s30 offen sc1
 buffer_load_dwordx2 v[170:171], v2, s[8:11], s30 offen sc1
 buffer_load_dword v172, v3, s[8:11], s30 offen sc1
 buffer_load_dwordx4 v[176:179], v4, s[8:11], s30 offen sc1
 buffer_load_dwordx4 v[180:183], v5, s[8:11], s30 offen sc1
 s_add_u32 s30, s30, 74240
 v_max3_f32 v200, v72, v73, v200
 v_max3_f32 v200, v74, v75, v200
 v_max3_f32 v200, v76, v77, v200
 v_max3_f32 v200, v78, v79, v200
 v_max3_f32 v200, v80, v81, v200
 v_max3_f32 v200, v82, v83, v200
 v_max3_f32 v200, v84, v85, v200
 v_max3_f32 v200, v86, v87, v200
 v_max3_f32 v201, v88, v89, v201
 v_max3_f32 v201, v90, v91, v201
 v_max3_f32 v201, v92, v93, v201
 v_max3_f32 v201, v94, v95, v201
 v_max3_f32 v201, v96, v97, v201
 v_max3_f32 v201, v98, v99, v201
 v_max3_f32 v201, v100, v101, v201
 v_max3_f32 v201, v102, v103, v201
 v_max3_f32 v202, v104, v105, v202
 v_max3_f32 v202, v106, v107, v202
 v_max3_f32 v202, v108, v109, v202
 v_max3_f32 v202, v110, v111, v202
 v_max3_f32 v202, v112, v113, v202
 v_max3_f32 v202, v114, v115, v202
 v_max3_f32 v202, v116, v117, v202
 v_max3_f32 v202, v118, v119, v202
 v_max3_f32 v203, v120, v121, v203
 v_max3_f32 v203, v122, v123, v203
 v_max3_f32 v203, v124, v125, v203
 v_max3_f32 v203, v126, v127, v203
 v_max3_f32 v203, v128, v129, v203
 v_max3_f32 v203, v130, v131, v203
 v_max3_f32 v203, v132, v133, v203
 v_max3_f32 v203, v134, v135, v203
L3_shift:
 v_mov_b32 v208, v200
 v_mov_b32 v209, v201
 v_mov_b32 v210, v202
 v_mov_b32 v211, v203
 v_mov_b32 v68, 0
 v_mov_b32 v196, 0
 v_mov_b32 v69, 0
 v_mov_b32 v197, 0
 v_mov_b32 v70, 0
 v_mov_b32 v198, 0
 v_mov_b32 v71, 0
 v_mov_b32 v199, 0
 v_permlane32_swap_b32 v208, v200
 v_permlane32_swap_b32 v209, v201
 v_permlane32_swap_b32 v210, v202
 v_permlane32_swap_b32 v211, v203
 v_max_f32 v200, v200, v208
 v_add_f32 v200, s34, v200
 v_cvt_pk_bf16_f32 v208, -v200, 0
 v_lshlrev_b32 v208, 16, v208
 v_sub_f32 v208, -v200, v208
 v_cvt_pk_bf16_f32 v212, -v200, v208
 v_and_b32 v213, 0xffff0000, v212
 v_sub_f32 v208, v208, v213
 v_cvt_pk_bf16_f32 v208, v208, 0
 v_cndmask_b32 v13, v208, v212, s[40:41]
 v_max_f32 v201, v201, v209
 v_add_f32 v201, s34, v201
 v_cvt_pk_bf16_f32 v209, -v201, 0
 v_lshlrev_b32 v209, 16, v209
 v_sub_f32 v209, -v201, v209
 v_cvt_pk_bf16_f32 v212, -v201, v209
 v_and_b32 v213, 0xffff0000, v212
 v_sub_f32 v209, v209, v213
 v_cvt_pk_bf16_f32 v209, v209, 0
 v_cndmask_b32 v19, v209, v212, s[40:41]
 v_mfma_f32_32x32x16_bf16 v[32:47], v[136:139], v[8:11], 0
 v_mfma_f32_32x32x8_bf16 v[32:47], v[140:141], v[12:13], v[32:47]
 v_max_f32 v202, v202, v210
 v_add_f32 v202, s34, v202
 v_cvt_pk_bf16_f32 v210, -v202, 0
 v_lshlrev_b32 v210, 16, v210
 v_sub_f32 v210, -v202, v210
 v_cvt_pk_bf16_f32 v212, -v202, v210
 v_and_b32 v213, 0xffff0000, v212
 v_sub_f32 v210, v210, v213
 v_cvt_pk_bf16_f32 v210, v210, 0
 v_cndmask_b32 v25, v210, v212, s[40:41]
 v_max_f32 v203, v203, v211
 v_add_f32 v203, s34, v203
 v_cvt_pk_bf16_f32 v211, -v203, 0
 v_lshlrev_b32 v211, 16, v211
 v_sub_f32 v211, -v203, v211
 v_cvt_pk_bf16_f32 v212, -v203, v211
 v_and_b32 v213, 0xffff0000, v212
 v_sub_f32 v211, v211, v213
 v_cvt_pk_bf16_f32 v211, v211, 0
 v_cndmask_b32 v31, v211, v212, s[40:41]
 s_mov_b32 s32, 16
 s_waitcnt vmcnt(10)
 v_mov_b32 v72, 0
 v_mov_b32 v73, 0
 v_mov_b32 v74, 0
 v_mov_b32 v75, 0
 v_mov_b32 v76, 0
 v_mov_b32 v77, 0
 v_mov_b32 v78, 0
 v_mov_b32 v79, 0
 v_mov_b32 v80, 0
 v_mov_b32 v81, 0
 v_mov_b32 v82, 0
 v_mov_b32 v83, 0
 v_mov_b32 v84, 0
 v_mov_b32 v85, 0
 v_mov_b32 v86, 0
 v_mov_b32 v87, 0
 v_mov_b32 v88, 0
 v_mov_b32 v89, 0
 v_mov_b32 v90, 0
 v_mov_b32 v91, 0
 v_mov_b32 v92, 0
 v_mov_b32 v93, 0
 v_mov_b32 v94, 0
 v_mov_b32 v95, 0
 v_mov_b32 v96, 0
 v_mov_b32 v97, 0
 v_mov_b32 v98, 0
 v_mov_b32 v99, 0
 v_mov_b32 v100, 0
 v_mov_b32 v101, 0
 v_mov_b32 v102, 0
 v_mov_b32 v103, 0
 v_mov_b32 v104, 0
 v_mov_b32 v105, 0
 v_mov_b32 v106, 0
 v_mov_b32 v107, 0
 v_mov_b32 v108, 0
 v_mov_b32 v109, 0
 v_mov_b32 v110, 0
 v_mov_b32 v111, 0
 v_mov_b32 v112, 0
 v_mov_b32 v113, 0
 v_mov_b32 v114, 0
 v_mov_b32 v115, 0
 v_mov_b32 v116, 0
 v_mov_b32 v117, 0
 v_mov_b32 v118, 0
 v_mov_b32 v119, 0
 v_mov_b32 v120, 0
 v_mov_b32 v121, 0
 v_mov_b32 v122, 0
 v_mov_b32 v123, 0
 v_mov_b32 v124, 0
 v_mov_b32 v125, 0
 v_mov_b32 v126, 0
 v_mov_b32 v127, 0
 v_mov_b32 v128, 0
 v_mov_b32 v129, 0
 v_mov_b32 v130, 0
 v_mov_b32 v131, 0
 v_mov_b32 v132, 0
 v_mov_b32 v133, 0
 v_mov_b32 v134, 0
 v_mov_b32 v135, 0
 s_cmp_eq_u32 s33, 1
 s_cbranch_scc1 L3_main
 s_mov_b32 s32, 8
.p2align 6
L3_main0:
 v_mfma_f32_32x32x16_bf16 v[48:63], v[136:139], v[14:17], 0
 s_mov_b32 m0, s46
 s_add_u32 s46, s46, 8192
 buffer_load_dwordx4 v216, s[12:15], s47 offen lds
 v_exp_f32 v32, v32
 v_exp_f32 v33, v33
 v_exp_f32 v34, v34
 v_exp_f32 v35, v35
 v_cvt_pk_bf16_f32 v64, v32, v33
 v_cvt_pk_bf16_f32 v65, v34, v35
 v_mfma_f32_32x32x8_bf16 v[48:63], v[140:141], v[18:19], v[48:63]
 v_exp_f32 v36, v36
 v_exp_f32 v37, v37
 v_exp_f32 v38, v38
 v_exp_f32 v39, v39
 v_cvt_pk_bf16_f32 v66, v36, v37
 v_cvt_pk_bf16_f32 v67, v38, v39
 v_mfma_f32_32x32x16_bf16 v[120:135], v[196:199], v[68:71], v[120:135]
 v_exp_f32 v40, v40
 v_exp_f32 v41, v41
 v_exp_f32 v42, v42
 v_exp_f32 v43, v43
 v_cvt_pk_bf16_f32 v68, v40, v41
 v_cvt_pk_bf16_f32 v69, v42, v43
 v_mfma_f32_32x32x16_bf16 v[72:87], v[144:147], v[64:67], v[72:87]
 v_exp_f32 v44, v44
 v_exp_f32 v45, v45
 v_exp_f32 v46, v46
 v_exp_f32 v47, v47
 v_cvt_pk_bf16_f32 v70, v44, v45
 v_cvt_pk_bf16_f32 v71, v46, v47
 v_mfma_f32_32x32x16_bf16 v[32:47], v[136:139], v[20:23], 0
 buffer_load_dwordx2 v[184:185], v1, s[8:11], s30 offen sc1
 v_exp_f32 v48, v48
 v_exp_f32 v49, v49
 v_exp_f32 v50, v50
 v_exp_f32 v51, v51
 v_cvt_pk_bf16_f32 v64, v48, v49
 v_cvt_pk_bf16_f32 v65, v50, v51
 v_mfma_f32_32x32x8_bf16 v[32:47], v[140:141], v[24:25], v[32:47]
 buffer_load_dwordx2 v[186:187], v2, s[8:11], s30 offen sc1
 v_exp_f32 v52, v52
 v_exp_f32 v53, v53
 v_exp_f32 v54, v54
 v_exp_f32 v55, v55
 v_cvt_pk_bf16_f32 v66, v52, v53
 v_cvt_pk_bf16_f32 v67, v54, v55
 v_mfma_f32_32x32x16_bf16 v[72:87], v[148:151], v[68:71], v[72:87]
 buffer_load_dword v188, v3, s[8:11], s30 offen sc1
 v_exp_f32 v56, v56
 v_exp_f32 v57, v57
 v_exp_f32 v58, v58
 v_exp_f32 v59, v59
 v_cvt_pk_bf16_f32 v68, v56, v57
 v_cvt_pk_bf16_f32 v69, v58, v59
 v_mfma_f32_32x32x16_bf16 v[88:103], v[144:147], v[64:67], v[88:103]
 v_exp_f32 v60, v60
 v_exp_f32 v61, v61
 v_exp_f32 v62, v62
 v_exp_f32 v63, v63
 v_cvt_pk_bf16_f32 v70, v60, v61
 v_cvt_pk_bf16_f32 v71, v62, v63
 v_mfma_f32_32x32x16_bf16 v[48:63], v[136:139], v[26:29], 0
 buffer_load_dwordx4 v[192:195], v4, s[8:11], s30 offen sc1
 v_exp_f32 v32, v32
 v_exp_f32 v33, v33
 v_exp_f32 v34, v34
 v_exp_f32 v35, v35
 v_cvt_pk_bf16_f32 v64, v32, v33
 v_cvt_pk_bf16_f32 v65, v34, v35
 v_mfma_f32_32x32x8_bf16 v[48:63], v[140:141], v[30:31], v[48:63]
 v_exp_f32 v36, v36
 v_exp_f32 v37, v37
 v_exp_f32 v38, v38
 v_exp_f32 v39, v39
 v_cvt_pk_bf16_f32 v66, v36, v37
 v_cvt_pk_bf16_f32 v67, v38, v39
 v_mfma_f32_32x32x16_bf16 v[88:103], v[148:151], v[68:71], v[88:103]
 buffer_load_dwordx4 v[196:199], v5, s[8:11], s30 offen sc1
 s_add_u32 s30, s30, 74240
 v_exp_f32 v40, v40
 v_exp_f32 v41, v41
 v_exp_f32 v42, v42
 v_exp_f32 v43, v43
 v_cvt_pk_bf16_f32 v68, v40, v41
 v_cvt_pk_bf16_f32 v69, v42, v43
 v_mfma_f32_32x32x16_bf16 v[104:119], v[144:147], v[64:67], v[104:119]
 v_exp_f32 v44, v44
 v_exp_f32 v45, v45
 v_exp_f32 v46, v46
 v_exp_f32 v47, v47
 v_cvt_pk_bf16_f32 v70, v44, v45
 v_cvt_pk_bf16_f32 v71, v46, v47
 s_waitcnt vmcnt(11)
 v_mfma_f32_32x32x16_bf16 v[32:47], v[152:155], v[8:11], 0
 v_exp_f32 v48, v48
 v_exp_f32 v49, v49
 v_exp_f32 v50, v50
 v_exp_f32 v51, v51
 v_cvt_pk_bf16_f32 v64, v48, v49
 v_cvt_pk_bf16_f32 v65, v50, v51
 v_mfma_f32_32x32x8_bf16 v[32:47], v[156:157], v[12:13], v[32:47]
 v_exp_f32 v52, v52
 v_exp_f32 v53, v53
 v_exp_f32 v54, v54
 v_exp_f32 v55, v55
 v_cvt_pk_bf16_f32 v66, v52, v53
 v_cvt_pk_bf16_f32 v67, v54, v55
 v_mfma_f32_32x32x16_bf16 v[104:119], v[148:151], v[68:71], v[104:119]
 v_exp_f32 v56, v56
 v_exp_f32 v57, v57
 v_exp_f32 v58, v58
 v_exp_f32 v59, v59
 v_cvt_pk_bf16_f32 v68, v56, v57
 v_cvt_pk_bf16_f32 v69, v58, v59
 v_mfma_f32_32x32x16_bf16 v[120:135], v[144:147], v[64:67], v[120:135]
 v_exp_f32 v60, v60
 v_exp_f32 v61, v61
 v_exp_f32 v62, v62
 v_exp_f32 v63, v63
 v_cvt_pk_bf16_f32 v70, v60, v61
 v_cvt_pk_bf16_f32 v71, v62, v63
 v_mfma_f32_32x32x16_bf16 v[48:63], v[152:155], v[14:17], 0
 buffer_load_dwordx4 v217, s[12:15], s47 offen offset:1024 lds
 s_add_u32 s47, s47, 82944
 v_exp_f32 v32, v32
 v_exp_f32 v33, v33
 v_exp_f32 v34, v34
 v_exp_f32 v35, v35
 v_cvt_pk_bf16_f32 v64, v32, v33
 v_cvt_pk_bf16_f32 v65, v34, v35
 v_mfma_f32_32x32x8_bf16 v[48:63], v[156:157], v[18:19], v[48:63]
 v_exp_f32 v36, v36
 v_exp_f32 v37, v37
 v_exp_f32 v38, v38
 v_exp_f32 v39, v39
 v_cvt_pk_bf16_f32 v66, v36, v37
 v_cvt_pk_bf16_f32 v67, v38, v39
 v_mfma_f32_32x32x16_bf16 v[120:135], v[148:151], v[68:71], v[120:135]
 v_exp_f32 v40, v40
 v_exp_f32 v41, v41
 v_exp_f32 v42, v42
 v_exp_f32 v43, v43
 v_cvt_pk_bf16_f32 v68, v40, v41
 v_cvt_pk_bf16_f32 v69, v42, v43
 v_mfma_f32_32x32x16_bf16 v[72:87], v[160:163], v[64:67], v[72:87]
 v_exp_f32 v44, v44
 v_exp_f32 v45, v45
 v_exp_f32 v46, v46
 v_exp_f32 v47, v47
 v_cvt_pk_bf16_f32 v70, v44, v45
 v_cvt_pk_bf16_f32 v71, v46, v47
 v_mfma_f32_32x32x16_bf16 v[32:47], v[152:155], v[20:23], 0
 buffer_load_dwordx2 v[136:137], v1, s[8:11], s30 offen sc1
 v_exp_f32 v48, v48
 v_exp_f32 v49, v49
 v_exp_f32 v50, v50
 v_exp_f32 v51, v51
 v_cvt_pk_bf16_f32 v64, v48, v49
 v_cvt_pk_bf16_f32 v65, v50, v51
 v_mfma_f32_32x32x8_bf16 v[32:47], v[156:157], v[24:25], v[32:47]
 buffer_load_dwordx2 v[138:139], v2, s[8:11], s30 offen sc1
 v_exp_f32 v52, v52
 v_exp_f32 v53, v53
 v_exp_f32 v54, v54
 v_exp_f32 v55, v55
 v_cvt_pk_bf16_f32 v66, v52, v53
 v_cvt_pk_bf16_f32 v67, v54, v55
 v_mfma_f32_32x32x16_bf16 v[72:87], v[164:167], v[68:71], v[72:87]
 buffer_load_dword v140, v3, s[8:11], s30 offen sc1
 v_exp_f32 v56, v56
 v_exp_f32 v57, v57
 v_exp_f32 v58, v58
 v_exp_f32 v59, v59
 v_cvt_pk_bf16_f32 v68, v56, v57
 v_cvt_pk_bf16_f32 v69, v58, v59
 v_mfma_f32_32x32x16_bf16 v[88:103], v[160:163], v[64:67], v[88:103]
 v_exp_f32 v60, v60
 v_exp_f32 v61, v61
 v_exp_f32 v62, v62
 v_exp_f32 v63, v63
 v_cvt_pk_bf16_f32 v70, v60, v61
 v_cvt_pk_bf16_f32 v71, v62, v63
 v_mfma_f32_32x32x16_bf16 v[48:63], v[152:155], v[26:29], 0
 buffer_load_dwordx4 v[144:147], v4, s[8:11], s30 offen sc1
 v_exp_f32 v32, v32
 v_exp_f32 v33, v33
 v_exp_f32 v34, v34
 v_exp_f32 v35, v35
 v_cvt_pk_bf16_f32 v64, v32, v33
 v_cvt_pk_bf16_f32 v65, v34, v35
 v_mfma_f32_32x32x8_bf16 v[48:63], v[156:157], v[30:31], v[48:63]
 v_exp_f32 v36, v36
 v_exp_f32 v37, v37
 v_exp_f32 v38, v38
 v_exp_f32 v39, v39
 v_cvt_pk_bf16_f32 v66, v36, v37
 v_cvt_pk_bf16_f32 v67, v38, v39
 v_mfma_f32_32x32x16_bf16 v[88:103], v[164:167], v[68:71], v[88:103]
 buffer_load_dwordx4 v[148:151], v5, s[8:11], s30 offen sc1
 s_add_u32 s30, s30, 74240
 v_exp_f32 v40, v40
 v_exp_f32 v41, v41
 v_exp_f32 v42, v42
 v_exp_f32 v43, v43
 v_cvt_pk_bf16_f32 v68, v40, v41
 v_cvt_pk_bf16_f32 v69, v42, v43
 v_mfma_f32_32x32x16_bf16 v[104:119], v[160:163], v[64:67], v[104:119]
 v_exp_f32 v44, v44
 v_exp_f32 v45, v45
 v_exp_f32 v46, v46
 v_exp_f32 v47, v47
 v_cvt_pk_bf16_f32 v70, v44, v45
 v_cvt_pk_bf16_f32 v71, v46, v47
 s_waitcnt vmcnt(12)
 v_mfma_f32_32x32x16_bf16 v[32:47], v[168:171], v[8:11], 0
 v_exp_f32 v48, v48
 v_exp_f32 v49, v49
 v_exp_f32 v50, v50
 v_exp_f32 v51, v51
 v_cvt_pk_bf16_f32 v64, v48, v49
 v_cvt_pk_bf16_f32 v65, v50, v51
 v_mfma_f32_32x32x8_bf16 v[32:47], v[172:173], v[12:13], v[32:47]
 v_exp_f32 v52, v52
 v_exp_f32 v53, v53
 v_exp_f32 v54, v54
 v_exp_f32 v55, v55
 v_cvt_pk_bf16_f32 v66, v52, v53
 v_cvt_pk_bf16_f32 v67, v54, v55
 v_mfma_f32_32x32x16_bf16 v[104:119], v[164:167], v[68:71], v[104:119]
 v_exp_f32 v56, v56
 v_exp_f32 v57, v57
 v_exp_f32 v58, v58
 v_exp_f32 v59, v59
 v_cvt_pk_bf16_f32 v68, v56, v57
 v_cvt_pk_bf16_f32 v69, v58, v59
 v_mfma_f32_32x32x16_bf16 v[120:135], v[160:163], v[64:67], v[120:135]
 v_exp_f32 v60, v60
 v_exp_f32 v61, v61
 v_exp_f32 v62, v62
 v_exp_f32 v63, v63
 v_cvt_pk_bf16_f32 v70, v60, v61
 v_cvt_pk_bf16_f32 v71, v62, v63
 v_mfma_f32_32x32x16_bf16 v[48:63], v[168:171], v[14:17], 0
 s_mov_b32 m0, s59
 s_add_u32 s59, s59, 8192
 buffer_load_dwordx4 v216, s[12:15], s58 offen lds
 v_exp_f32 v32, v32
 v_exp_f32 v33, v33
 v_exp_f32 v34, v34
 v_exp_f32 v35, v35
 v_cvt_pk_bf16_f32 v64, v32, v33
 v_cvt_pk_bf16_f32 v65, v34, v35
 v_mfma_f32_32x32x8_bf16 v[48:63], v[172:173], v[18:19], v[48:63]
 v_exp_f32 v36, v36
 v_exp_f32 v37, v37
 v_exp_f32 v38, v38
 v_exp_f32 v39, v39
 v_cvt_pk_bf16_f32 v66, v36, v37
 v_cvt_pk_bf16_f32 v67, v38, v39
 v_mfma_f32_32x32x16_bf16 v[120:135], v[164:167], v[68:71], v[120:135]
 v_exp_f32 v40, v40
 v_exp_f32 v41, v41
 v_exp_f32 v42, v42
 v_exp_f32 v43, v43
 v_cvt_pk_bf16_f32 v68, v40, v41
 v_cvt_pk_bf16_f32 v69, v42, v43
 v_mfma_f32_32x32x16_bf16 v[72:87], v[176:179], v[64:67], v[72:87]
 v_exp_f32 v44, v44
 v_exp_f32 v45, v45
 v_exp_f32 v46, v46
 v_exp_f32 v47, v47
 v_cvt_pk_bf16_f32 v70, v44, v45
 v_cvt_pk_bf16_f32 v71, v46, v47
 v_mfma_f32_32x32x16_bf16 v[32:47], v[168:171], v[20:23], 0
 buffer_load_dwordx2 v[152:153], v1, s[8:11], s30 offen sc1
 v_exp_f32 v48, v48
 v_exp_f32 v49, v49
 v_exp_f32 v50, v50
 v_exp_f32 v51, v51
 v_cvt_pk_bf16_f32 v64, v48, v49
 v_cvt_pk_bf16_f32 v65, v50, v51
 v_mfma_f32_32x32x8_bf16 v[32:47], v[172:173], v[24:25], v[32:47]
 buffer_load_dwordx2 v[154:155], v2, s[8:11], s30 offen sc1
 v_exp_f32 v52, v52
 v_exp_f32 v53, v53
 v_exp_f32 v54, v54
 v_exp_f32 v55, v55
 v_cvt_pk_bf16_f32 v66, v52, v53
 v_cvt_pk_bf16_f32 v67, v54, v55
 v_mfma_f32_32x32x16_bf16 v[72:87], v[180:183], v[68:71], v[72:87]
 buffer_load_dword v156, v3, s[8:11], s30 offen sc1
 v_exp_f32 v56, v56
 v_exp_f32 v57, v57
 v_exp_f32 v58, v58
 v_exp_f32 v59, v59
 v_cvt_pk_bf16_f32 v68, v56, v57
 v_cvt_pk_bf16_f32 v69, v58, v59
 v_mfma_f32_32x32x16_bf16 v[88:103], v[176:179], v[64:67], v[88:103]
 v_exp_f32 v60, v60
 v_exp_f32 v61, v61
 v_exp_f32 v62, v62
 v_exp_f32 v63, v63
 v_cvt_pk_bf16_f32 v70, v60, v61
 v_cvt_pk_bf16_f32 v71, v62, v63
 v_mfma_f32_32x32x16_bf16 v[48:63], v[168:171], v[26:29], 0
 buffer_load_dwordx4 v[160:163], v4, s[8:11], s30 offen sc1
 v_exp_f32 v32, v32
 v_exp_f32 v33, v33
 v_exp_f32 v34, v34
 v_exp_f32 v35, v35
 v_cvt_pk_bf16_f32 v64, v32, v33
 v_cvt_pk_bf16_f32 v65, v34, v35
 v_mfma_f32_32x32x8_bf16 v[48:63], v[172:173], v[30:31], v[48:63]
 v_exp_f32 v36, v36
 v_exp_f32 v37, v37
 v_exp_f32 v38, v38
 v_exp_f32 v39, v39
 v_cvt_pk_bf16_f32 v66, v36, v37
 v_cvt_pk_bf16_f32 v67, v38, v39
 v_mfma_f32_32x32x16_bf16 v[88:103], v[180:183], v[68:71], v[88:103]
 buffer_load_dwordx4 v[164:167], v5, s[8:11], s30 offen sc1
 s_add_u32 s30, s30, 74240
 v_exp_f32 v40, v40
 v_exp_f32 v41, v41
 v_exp_f32 v42, v42
 v_exp_f32 v43, v43
 v_cvt_pk_bf16_f32 v68, v40, v41
 v_cvt_pk_bf16_f32 v69, v42, v43
 v_mfma_f32_32x32x16_bf16 v[104:119], v[176:179], v[64:67], v[104:119]
 v_exp_f32 v44, v44
 v_exp_f32 v45, v45
 v_exp_f32 v46, v46
 v_exp_f32 v47, v47
 v_cvt_pk_bf16_f32 v70, v44, v45
 v_cvt_pk_bf16_f32 v71, v46, v47
 s_waitcnt vmcnt(12)
 v_mfma_f32_32x32x16_bf16 v[32:47], v[184:187], v[8:11], 0
 v_exp_f32 v48, v48
 v_exp_f32 v49, v49
 v_exp_f32 v50, v50
 v_exp_f32 v51, v51
 v_cvt_pk_bf16_f32 v64, v48, v49
 v_cvt_pk_bf16_f32 v65, v50, v51
 v_mfma_f32_32x32x8_bf16 v[32:47], v[188:189], v[12:13], v[32:47]
 v_exp_f32 v52, v52
 v_exp_f32 v53, v53
 v_exp_f32 v54, v54
 v_exp_f32 v55, v55
 v_cvt_pk_bf16_f32 v66, v52, v53
 v_cvt_pk_bf16_f32 v67, v54, v55
 v_mfma_f32_32x32x16_bf16 v[104:119], v[180:183], v[68:71], v[104:119]
 v_exp_f32 v56, v56
 v_exp_f32 v57, v57
 v_exp_f32 v58, v58
 v_exp_f32 v59, v59
 v_cvt_pk_bf16_f32 v68, v56, v57
 v_cvt_pk_bf16_f32 v69, v58, v59
 v_mfma_f32_32x32x16_bf16 v[120:135], v[176:179], v[64:67], v[120:135]
 v_exp_f32 v60, v60
 v_exp_f32 v61, v61
 v_exp_f32 v62, v62
 v_exp_f32 v63, v63
 v_cvt_pk_bf16_f32 v70, v60, v61
 v_cvt_pk_bf16_f32 v71, v62, v63
 v_mfma_f32_32x32x16_bf16 v[48:63], v[184:187], v[14:17], 0
 buffer_load_dwordx4 v217, s[12:15], s58 offen offset:1024 lds
 s_add_u32 s58, s58, 82944
 v_exp_f32 v32, v32
 v_exp_f32 v33, v33
 v_exp_f32 v34, v34
 v_exp_f32 v35, v35
 v_cvt_pk_bf16_f32 v64, v32, v33
 v_cvt_pk_bf16_f32 v65, v34, v35
 v_mfma_f32_32x32x8_bf16 v[48:63], v[188:189], v[18:19], v[48:63]
 v_exp_f32 v36, v36
 v_exp_f32 v37, v37
 v_exp_f32 v38, v38
 v_exp_f32 v39, v39
 v_cvt_pk_bf16_f32 v66, v36, v37
 v_cvt_pk_bf16_f32 v67, v38, v39
 v_mfma_f32_32x32x16_bf16 v[120:135], v[180:183], v[68:71], v[120:135]
 v_exp_f32 v40, v40
 v_exp_f32 v41, v41
 v_exp_f32 v42, v42
 v_exp_f32 v43, v43
 v_cvt_pk_bf16_f32 v68, v40, v41
 v_cvt_pk_bf16_f32 v69, v42, v43
 v_mfma_f32_32x32x16_bf16 v[72:87], v[192:195], v[64:67], v[72:87]
 v_exp_f32 v44, v44
 v_exp_f32 v45, v45
 v_exp_f32 v46, v46
 v_exp_f32 v47, v47
 v_cvt_pk_bf16_f32 v70, v44, v45
 v_cvt_pk_bf16_f32 v71, v46, v47
 v_mfma_f32_32x32x16_bf16 v[32:47], v[184:187], v[20:23], 0
 buffer_load_dwordx2 v[168:169], v1, s[8:11], s30 offen sc1
 v_exp_f32 v48, v48
 v_exp_f32 v49, v49
 v_exp_f32 v50, v50
 v_exp_f32 v51, v51
 v_cvt_pk_bf16_f32 v64, v48, v49
 v_cvt_pk_bf16_f32 v65, v50, v51
 v_mfma_f32_32x32x8_bf16 v[32:47], v[188:189], v[24:25], v[32:47]
 buffer_load_dwordx2 v[170:171], v2, s[8:11], s30 offen sc1
 v_exp_f32 v52, v52
 v_exp_f32 v53, v53
 v_exp_f32 v54, v54
 v_exp_f32 v55, v55
 v_cvt_pk_bf16_f32 v66, v52, v53
 v_cvt_pk_bf16_f32 v67, v54, v55
 v_mfma_f32_32x32x16_bf16 v[72:87], v[196:199], v[68:71], v[72:87]
 buffer_load_dword v172, v3, s[8:11], s30 offen sc1
 v_exp_f32 v56, v56
 v_exp_f32 v57, v57
 v_exp_f32 v58, v58
 v_exp_f32 v59, v59
 v_cvt_pk_bf16_f32 v68, v56, v57
 v_cvt_pk_bf16_f32 v69, v58, v59
 v_mfma_f32_32x32x16_bf16 v[88:103], v[192:195], v[64:67], v[88:103]
 v_exp_f32 v60, v60
 v_exp_f32 v61, v61
 v_exp_f32 v62, v62
 v_exp_f32 v63, v63
 v_cvt_pk_bf16_f32 v70, v60, v61
 v_cvt_pk_bf16_f32 v71, v62, v63
 v_mfma_f32_32x32x16_bf16 v[48:63], v[184:187], v[26:29], 0
 buffer_load_dwordx4 v[176:179], v4, s[8:11], s30 offen sc1
 v_exp_f32 v32, v32
 v_exp_f32 v33, v33
 v_exp_f32 v34, v34
 v_exp_f32 v35, v35
 v_cvt_pk_bf16_f32 v64, v32, v33
 v_cvt_pk_bf16_f32 v65, v34, v35
 v_mfma_f32_32x32x8_bf16 v[48:63], v[188:189], v[30:31], v[48:63]
 v_exp_f32 v36, v36
 v_exp_f32 v37, v37
 v_exp_f32 v38, v38
 v_exp_f32 v39, v39
 v_cvt_pk_bf16_f32 v66, v36, v37
 v_cvt_pk_bf16_f32 v67, v38, v39
 v_mfma_f32_32x32x16_bf16 v[88:103], v[196:199], v[68:71], v[88:103]
 buffer_load_dwordx4 v[180:183], v5, s[8:11], s30 offen sc1
 s_add_u32 s30, s30, 74240
 v_exp_f32 v40, v40
 v_exp_f32 v41, v41
 v_exp_f32 v42, v42
 v_exp_f32 v43, v43
 v_cvt_pk_bf16_f32 v68, v40, v41
 v_cvt_pk_bf16_f32 v69, v42, v43
 v_mfma_f32_32x32x16_bf16 v[104:119], v[192:195], v[64:67], v[104:119]
 v_exp_f32 v44, v44
 v_exp_f32 v45, v45
 v_exp_f32 v46, v46
 v_exp_f32 v47, v47
 v_cvt_pk_bf16_f32 v70, v44, v45
 v_cvt_pk_bf16_f32 v71, v46, v47
 s_waitcnt vmcnt(12)
 v_mfma_f32_32x32x16_bf16 v[32:47], v[136:139], v[8:11], 0
 v_exp_f32 v48, v48
 v_exp_f32 v49, v49
 v_exp_f32 v50, v50
 v_exp_f32 v51, v51
 v_cvt_pk_bf16_f32 v64, v48, v49
 v_cvt_pk_bf16_f32 v65, v50, v51
 v_mfma_f32_32x32x8_bf16 v[32:47], v[140:141], v[12:13], v[32:47]
 v_exp_f32 v52, v52
 v_exp_f32 v53, v53
 v_exp_f32 v54, v54
 v_exp_f32 v55, v55
 v_cvt_pk_bf16_f32 v66, v52, v53
 v_cvt_pk_bf16_f32 v67, v54, v55
 v_mfma_f32_32x32x16_bf16 v[104:119], v[196:199], v[68:71], v[104:119]
 v_exp_f32 v56, v56
 v_exp_f32 v57, v57
 v_exp_f32 v58, v58
 v_exp_f32 v59, v59
 v_cvt_pk_bf16_f32 v68, v56, v57
 v_cvt_pk_bf16_f32 v69, v58, v59
 v_mfma_f32_32x32x16_bf16 v[120:135], v[192:195], v[64:67], v[120:135]
 v_exp_f32 v60, v60
 v_exp_f32 v61, v61
 v_exp_f32 v62, v62
 v_exp_f32 v63, v63
 v_cvt_pk_bf16_f32 v70, v60, v61
 v_cvt_pk_bf16_f32 v71, v62, v63
 s_sub_u32 s32, s32, 1
 s_cmp_lg_u32 s32, 0
 s_cbranch_scc1 L3_main0
 s_mov_b32 s32, 8
.p2align 6
L3_main:
 v_mfma_f32_32x32x16_bf16 v[48:63], v[136:139], v[14:17], 0
 v_exp_f32 v32, v32
 v_exp_f32 v33, v33
 v_exp_f32 v34, v34
 v_exp_f32 v35, v35
 v_cvt_pk_bf16_f32 v64, v32, v33
 v_cvt_pk_bf16_f32 v65, v34, v35
 v_mfma_f32_32x32x8_bf16 v[48:63], v[140:141], v[18:19], v[48:63]
 v_exp_f32 v36, v36
 v_exp_f32 v37, v37
 v_exp_f32 v38, v38
 v_exp_f32 v39, v39
 v_cvt_pk_bf16_f32 v66, v36, v37
 v_cvt_pk_bf16_f32 v67, v38, v39
 v_mfma_f32_32x32x16_bf16 v[120:135], v[196:199], v[68:71], v[120:135]
 v_exp_f32 v40, v40
 v_exp_f32 v41, v41
 v_exp_f32 v42, v42
 v_exp_f32 v43, v43
 v_cvt_pk_bf16_f32 v68, v40, v41
 v_cvt_pk_bf16_f32 v69, v42, v43
 v_mfma_f32_32x32x16_bf16 v[72:87], v[144:147], v[64:67], v[72:87]
 v_exp_f32 v44, v44
 v_exp_f32 v45, v45
 v_exp_f32 v46, v46
 v_exp_f32 v47, v47
 v_cvt_pk_bf16_f32 v70, v44, v45
 v_cvt_pk_bf16_f32 v71, v46, v47
 v_mfma_f32_32x32x16_bf16 v[32:47], v[136:139], v[20:23], 0
 buffer_load_dwordx2 v[184:185], v1, s[8:11], s30 offen sc1
 v_exp_f32 v48, v48
 v_exp_f32 v49, v49
 v_exp_f32 v50, v50
 v_exp_f32 v51, v51
 v_cvt_pk_bf16_f32 v64, v48, v49
 v_cvt_pk_bf16_f32 v65, v50, v51
 v_mfma_f32_32x32x8_bf16 v[32:47], v[140:141], v[24:25], v[32:47]
 buffer_load_dwordx2 v[186:187], v2, s[8:11], s30 offen sc1
 v_exp_f32 v52, v52
 v_exp_f32 v53, v53
 v_exp_f32 v54, v54
 v_exp_f32 v55, v55
 v_cvt_pk_bf16_f32 v66, v52, v53
 v_cvt_pk_bf16_f32 v67, v54, v55
 v_mfma_f32_32x32x16_bf16 v[72:87], v[148:151], v[68:71], v[72:87]
 buffer_load_dword v188, v3, s[8:11], s30 offen sc1
 v_exp_f32 v56, v56
 v_exp_f32 v57, v57
 v_exp_f32 v58, v58
 v_exp_f32 v59, v59
 v_cvt_pk_bf16_f32 v68, v56, v57
 v_cvt_pk_bf16_f32 v69, v58, v59
 v_mfma_f32_32x32x16_bf16 v[88:103], v[144:147], v[64:67], v[88:103]
 v_exp_f32 v60, v60
 v_exp_f32 v61, v61
 v_exp_f32 v62, v62
 v_exp_f32 v63, v63
 v_cvt_pk_bf16_f32 v70, v60, v61
 v_cvt_pk_bf16_f32 v71, v62, v63
 v_mfma_f32_32x32x16_bf16 v[48:63], v[136:139], v[26:29], 0
 buffer_load_dwordx4 v[192:195], v4, s[8:11], s30 offen sc1
 v_exp_f32 v32, v32
 v_exp_f32 v33, v33
 v_exp_f32 v34, v34
 v_exp_f32 v35, v35
 v_cvt_pk_bf16_f32 v64, v32, v33
 v_cvt_pk_bf16_f32 v65, v34, v35
 v_mfma_f32_32x32x8_bf16 v[48:63], v[140:141], v[30:31], v[48:63]
 v_exp_f32 v36, v36
 v_exp_f32 v37, v37
 v_exp_f32 v38, v38
 v_exp_f32 v39, v39
 v_cvt_pk_bf16_f32 v66, v36, v37
 v_cvt_pk_bf16_f32 v67, v38, v39
 v_mfma_f32_32x32x16_bf16 v[88:103], v[148:151], v[68:71], v[88:103]
 buffer_load_dwordx4 v[196:199], v5, s[8:11], s30 offen sc1
 s_add_u32 s30, s30, 74240
 v_exp_f32 v40, v40
 v_exp_f32 v41, v41
 v_exp_f32 v42, v42
 v_exp_f32 v43, v43
 v_cvt_pk_bf16_f32 v68, v40, v41
 v_cvt_pk_bf16_f32 v69, v42, v43
 v_mfma_f32_32x32x16_bf16 v[104:119], v[144:147], v[64:67], v[104:119]
 v_exp_f32 v44, v44
 v_exp_f32 v45, v45
 v_exp_f32 v46, v46
 v_exp_f32 v47, v47
 v_cvt_pk_bf16_f32 v70, v44, v45
 v_cvt_pk_bf16_f32 v71, v46, v47
 s_waitcnt vmcnt(10)
 v_mfma_f32_32x32x16_bf16 v[32:47], v[152:155], v[8:11], 0
 v_exp_f32 v48, v48
 v_exp_f32 v49, v49
 v_exp_f32 v50, v50
 v_exp_f32 v51, v51
 v_cvt_pk_bf16_f32 v64, v48, v49
 v_cvt_pk_bf16_f32 v65, v50, v51
 v_mfma_f32_32x32x8_bf16 v[32:47], v[156:157], v[12:13], v[32:47]
 v_exp_f32 v52, v52
 v_exp_f32 v53, v53
 v_exp_f32 v54, v54
 v_exp_f32 v55, v55
 v_cvt_pk_bf16_f32 v66, v52, v53
 v_cvt_pk_bf16_f32 v67, v54, v55
 v_mfma_f32_32x32x16_bf16 v[104:119], v[148:151], v[68:71], v[104:119]
 v_exp_f32 v56, v56
 v_exp_f32 v57, v57
 v_exp_f32 v58, v58
 v_exp_f32 v59, v59
 v_cvt_pk_bf16_f32 v68, v56, v57
 v_cvt_pk_bf16_f32 v69, v58, v59
 v_mfma_f32_32x32x16_bf16 v[120:135], v[144:147], v[64:67], v[120:135]
 v_exp_f32 v60, v60
 v_exp_f32 v61, v61
 v_exp_f32 v62, v62
 v_exp_f32 v63, v63
 v_cvt_pk_bf16_f32 v70, v60, v61
 v_cvt_pk_bf16_f32 v71, v62, v63
 v_mfma_f32_32x32x16_bf16 v[48:63], v[152:155], v[14:17], 0
 v_exp_f32 v32, v32
 v_exp_f32 v33, v33
 v_exp_f32 v34, v34
 v_exp_f32 v35, v35
 v_cvt_pk_bf16_f32 v64, v32, v33
 v_cvt_pk_bf16_f32 v65, v34, v35
 v_mfma_f32_32x32x8_bf16 v[48:63], v[156:157], v[18:19], v[48:63]
 v_exp_f32 v36, v36
 v_exp_f32 v37, v37
 v_exp_f32 v38, v38
 v_exp_f32 v39, v39
 v_cvt_pk_bf16_f32 v66, v36, v37
 v_cvt_pk_bf16_f32 v67, v38, v39
 v_mfma_f32_32x32x16_bf16 v[120:135], v[148:151], v[68:71], v[120:135]
 v_exp_f32 v40, v40
 v_exp_f32 v41, v41
 v_exp_f32 v42, v42
 v_exp_f32 v43, v43
 v_cvt_pk_bf16_f32 v68, v40, v41
 v_cvt_pk_bf16_f32 v69, v42, v43
 v_mfma_f32_32x32x16_bf16 v[72:87], v[160:163], v[64:67], v[72:87]
 v_exp_f32 v44, v44
 v_exp_f32 v45, v45
 v_exp_f32 v46, v46
 v_exp_f32 v47, v47
 v_cvt_pk_bf16_f32 v70, v44, v45
 v_cvt_pk_bf16_f32 v71, v46, v47
 v_mfma_f32_32x32x16_bf16 v[32:47], v[152:155], v[20:23], 0
 buffer_load_dwordx2 v[136:137], v1, s[8:11], s30 offen sc1
 v_exp_f32 v48, v48
 v_exp_f32 v49, v49
 v_exp_f32 v50, v50
 v_exp_f32 v51, v51
 v_cvt_pk_bf16_f32 v64, v48, v49
 v_cvt_pk_bf16_f32 v65, v50, v51
 v_mfma_f32_32x32x8_bf16 v[32:47], v[156:157], v[24:25], v[32:47]
 buffer_load_dwordx2 v[138:139], v2, s[8:11], s30 offen sc1
 v_exp_f32 v52, v52
 v_exp_f32 v53, v53
 v_exp_f32 v54, v54
 v_exp_f32 v55, v55
 v_cvt_pk_bf16_f32 v66, v52, v53
 v_cvt_pk_bf16_f32 v67, v54, v55
 v_mfma_f32_32x32x16_bf16 v[72:87], v[164:167], v[68:71], v[72:87]
 buffer_load_dword v140, v3, s[8:11], s30 offen sc1
 v_exp_f32 v56, v56
 v_exp_f32 v57, v57
 v_exp_f32 v58, v58
 v_exp_f32 v59, v59
 v_cvt_pk_bf16_f32 v68, v56, v57
 v_cvt_pk_bf16_f32 v69, v58, v59
 v_mfma_f32_32x32x16_bf16 v[88:103], v[160:163], v[64:67], v[88:103]
 v_exp_f32 v60, v60
 v_exp_f32 v61, v61
 v_exp_f32 v62, v62
 v_exp_f32 v63, v63
 v_cvt_pk_bf16_f32 v70, v60, v61
 v_cvt_pk_bf16_f32 v71, v62, v63
 v_mfma_f32_32x32x16_bf16 v[48:63], v[152:155], v[26:29], 0
 buffer_load_dwordx4 v[144:147], v4, s[8:11], s30 offen sc1
 v_exp_f32 v32, v32
 v_exp_f32 v33, v33
 v_exp_f32 v34, v34
 v_exp_f32 v35, v35
 v_cvt_pk_bf16_f32 v64, v32, v33
 v_cvt_pk_bf16_f32 v65, v34, v35
 v_mfma_f32_32x32x8_bf16 v[48:63], v[156:157], v[30:31], v[48:63]
 v_exp_f32 v36, v36
 v_exp_f32 v37, v37
 v_exp_f32 v38, v38
 v_exp_f32 v39, v39
 v_cvt_pk_bf16_f32 v66, v36, v37
 v_cvt_pk_bf16_f32 v67, v38, v39
 v_mfma_f32_32x32x16_bf16 v[88:103], v[164:167], v[68:71], v[88:103]
 buffer_load_dwordx4 v[148:151], v5, s[8:11], s30 offen sc1
 s_add_u32 s30, s30, 74240
 v_exp_f32 v40, v40
 v_exp_f32 v41, v41
 v_exp_f32 v42, v42
 v_exp_f32 v43, v43
 v_cvt_pk_bf16_f32 v68, v40, v41
 v_cvt_pk_bf16_f32 v69, v42, v43
 v_mfma_f32_32x32x16_bf16 v[104:119], v[160:163], v[64:67], v[104:119]
 v_exp_f32 v44, v44
 v_exp_f32 v45, v45
 v_exp_f32 v46, v46
 v_exp_f32 v47, v47
 v_cvt_pk_bf16_f32 v70, v44, v45
 v_cvt_pk_bf16_f32 v71, v46, v47
 s_waitcnt vmcnt(10)
 v_mfma_f32_32x32x16_bf16 v[32:47], v[168:171], v[8:11], 0
 v_exp_f32 v48, v48
 v_exp_f32 v49, v49
 v_exp_f32 v50, v50
 v_exp_f32 v51, v51
 v_cvt_pk_bf16_f32 v64, v48, v49
 v_cvt_pk_bf16_f32 v65, v50, v51
 v_mfma_f32_32x32x8_bf16 v[32:47], v[172:173], v[12:13], v[32:47]
 v_exp_f32 v52, v52
 v_exp_f32 v53, v53
 v_exp_f32 v54, v54
 v_exp_f32 v55, v55
 v_cvt_pk_bf16_f32 v66, v52, v53
 v_cvt_pk_bf16_f32 v67, v54, v55
 v_mfma_f32_32x32x16_bf16 v[104:119], v[164:167], v[68:71], v[104:119]
 v_exp_f32 v56, v56
 v_exp_f32 v57, v57
 v_exp_f32 v58, v58
 v_exp_f32 v59, v59
 v_cvt_pk_bf16_f32 v68, v56, v57
 v_cvt_pk_bf16_f32 v69, v58, v59
 v_mfma_f32_32x32x16_bf16 v[120:135], v[160:163], v[64:67], v[120:135]
 v_exp_f32 v60, v60
 v_exp_f32 v61, v61
 v_exp_f32 v62, v62
 v_exp_f32 v63, v63
 v_cvt_pk_bf16_f32 v70, v60, v61
 v_cvt_pk_bf16_f32 v71, v62, v63
 v_mfma_f32_32x32x16_bf16 v[48:63], v[168:171], v[14:17], 0
 v_exp_f32 v32, v32
 v_exp_f32 v33, v33
 v_exp_f32 v34, v34
 v_exp_f32 v35, v35
 v_cvt_pk_bf16_f32 v64, v32, v33
 v_cvt_pk_bf16_f32 v65, v34, v35
 v_mfma_f32_32x32x8_bf16 v[48:63], v[172:173], v[18:19], v[48:63]
 v_exp_f32 v36, v36
 v_exp_f32 v37, v37
 v_exp_f32 v38, v38
 v_exp_f32 v39, v39
 v_cvt_pk_bf16_f32 v66, v36, v37
 v_cvt_pk_bf16_f32 v67, v38, v39
 v_mfma_f32_32x32x16_bf16 v[120:135], v[164:167], v[68:71], v[120:135]
 v_exp_f32 v40, v40
 v_exp_f32 v41, v41
 v_exp_f32 v42, v42
 v_exp_f32 v43, v43
 v_cvt_pk_bf16_f32 v68, v40, v41
 v_cvt_pk_bf16_f32 v69, v42, v43
 v_mfma_f32_32x32x16_bf16 v[72:87], v[176:179], v[64:67], v[72:87]
 v_exp_f32 v44, v44
 v_exp_f32 v45, v45
 v_exp_f32 v46, v46
 v_exp_f32 v47, v47
 v_cvt_pk_bf16_f32 v70, v44, v45
 v_cvt_pk_bf16_f32 v71, v46, v47
 v_mfma_f32_32x32x16_bf16 v[32:47], v[168:171], v[20:23], 0
 buffer_load_dwordx2 v[152:153], v1, s[8:11], s30 offen sc1
 v_exp_f32 v48, v48
 v_exp_f32 v49, v49
 v_exp_f32 v50, v50
 v_exp_f32 v51, v51
 v_cvt_pk_bf16_f32 v64, v48, v49
 v_cvt_pk_bf16_f32 v65, v50, v51
 v_mfma_f32_32x32x8_bf16 v[32:47], v[172:173], v[24:25], v[32:47]
 buffer_load_dwordx2 v[154:155], v2, s[8:11], s30 offen sc1
 v_exp_f32 v52, v52
 v_exp_f32 v53, v53
 v_exp_f32 v54, v54
 v_exp_f32 v55, v55
 v_cvt_pk_bf16_f32 v66, v52, v53
 v_cvt_pk_bf16_f32 v67, v54, v55
 v_mfma_f32_32x32x16_bf16 v[72:87], v[180:183], v[68:71], v[72:87]
 buffer_load_dword v156, v3, s[8:11], s30 offen sc1
 v_exp_f32 v56, v56
 v_exp_f32 v57, v57
 v_exp_f32 v58, v58
 v_exp_f32 v59, v59
 v_cvt_pk_bf16_f32 v68, v56, v57
 v_cvt_pk_bf16_f32 v69, v58, v59
 v_mfma_f32_32x32x16_bf16 v[88:103], v[176:179], v[64:67], v[88:103]
 v_exp_f32 v60, v60
 v_exp_f32 v61, v61
 v_exp_f32 v62, v62
 v_exp_f32 v63, v63
 v_cvt_pk_bf16_f32 v70, v60, v61
 v_cvt_pk_bf16_f32 v71, v62, v63
 v_mfma_f32_32x32x16_bf16 v[48:63], v[168:171], v[26:29], 0
 buffer_load_dwordx4 v[160:163], v4, s[8:11], s30 offen sc1
 v_exp_f32 v32, v32
 v_exp_f32 v33, v33
 v_exp_f32 v34, v34
 v_exp_f32 v35, v35
 v_cvt_pk_bf16_f32 v64, v32, v33
 v_cvt_pk_bf16_f32 v65, v34, v35
 v_mfma_f32_32x32x8_bf16 v[48:63], v[172:173], v[30:31], v[48:63]
 v_exp_f32 v36, v36
 v_exp_f32 v37, v37
 v_exp_f32 v38, v38
 v_exp_f32 v39, v39
 v_cvt_pk_bf16_f32 v66, v36, v37
 v_cvt_pk_bf16_f32 v67, v38, v39
 v_mfma_f32_32x32x16_bf16 v[88:103], v[180:183], v[68:71], v[88:103]
 buffer_load_dwordx4 v[164:167], v5, s[8:11], s30 offen sc1
 s_add_u32 s30, s30, 74240
 v_exp_f32 v40, v40
 v_exp_f32 v41, v41
 v_exp_f32 v42, v42
 v_exp_f32 v43, v43
 v_cvt_pk_bf16_f32 v68, v40, v41
 v_cvt_pk_bf16_f32 v69, v42, v43
 v_mfma_f32_32x32x16_bf16 v[104:119], v[176:179], v[64:67], v[104:119]
 v_exp_f32 v44, v44
 v_exp_f32 v45, v45
 v_exp_f32 v46, v46
 v_exp_f32 v47, v47
 v_cvt_pk_bf16_f32 v70, v44, v45
 v_cvt_pk_bf16_f32 v71, v46, v47
 s_waitcnt vmcnt(10)
 v_mfma_f32_32x32x16_bf16 v[32:47], v[184:187], v[8:11], 0
 v_exp_f32 v48, v48
 v_exp_f32 v49, v49
 v_exp_f32 v50, v50
 v_exp_f32 v51, v51
 v_cvt_pk_bf16_f32 v64, v48, v49
 v_cvt_pk_bf16_f32 v65, v50, v51
 v_mfma_f32_32x32x8_bf16 v[32:47], v[188:189], v[12:13], v[32:47]
 v_exp_f32 v52, v52
 v_exp_f32 v53, v53
 v_exp_f32 v54, v54
 v_exp_f32 v55, v55
 v_cvt_pk_bf16_f32 v66, v52, v53
 v_cvt_pk_bf16_f32 v67, v54, v55
 v_mfma_f32_32x32x16_bf16 v[104:119], v[180:183], v[68:71], v[104:119]
 v_exp_f32 v56, v56
 v_exp_f32 v57, v57
 v_exp_f32 v58, v58
 v_exp_f32 v59, v59
 v_cvt_pk_bf16_f32 v68, v56, v57
 v_cvt_pk_bf16_f32 v69, v58, v59
 v_mfma_f32_32x32x16_bf16 v[120:135], v[176:179], v[64:67], v[120:135]
 v_exp_f32 v60, v60
 v_exp_f32 v61, v61
 v_exp_f32 v62, v62
 v_exp_f32 v63, v63
 v_cvt_pk_bf16_f32 v70, v60, v61
 v_cvt_pk_bf16_f32 v71, v62, v63
 v_mfma_f32_32x32x16_bf16 v[48:63], v[184:187], v[14:17], 0
 v_exp_f32 v32, v32
 v_exp_f32 v33, v33
 v_exp_f32 v34, v34
 v_exp_f32 v35, v35
 v_cvt_pk_bf16_f32 v64, v32, v33
 v_cvt_pk_bf16_f32 v65, v34, v35
 v_mfma_f32_32x32x8_bf16 v[48:63], v[188:189], v[18:19], v[48:63]
 v_exp_f32 v36, v36
 v_exp_f32 v37, v37
 v_exp_f32 v38, v38
 v_exp_f32 v39, v39
 v_cvt_pk_bf16_f32 v66, v36, v37
 v_cvt_pk_bf16_f32 v67, v38, v39
 v_mfma_f32_32x32x16_bf16 v[120:135], v[180:183], v[68:71], v[120:135]
 v_exp_f32 v40, v40
 v_exp_f32 v41, v41
 v_exp_f32 v42, v42
 v_exp_f32 v43, v43
 v_cvt_pk_bf16_f32 v68, v40, v41
 v_cvt_pk_bf16_f32 v69, v42, v43
 v_mfma_f32_32x32x16_bf16 v[72:87], v[192:195], v[64:67], v[72:87]
 v_exp_f32 v44, v44
 v_exp_f32 v45, v45
 v_exp_f32 v46, v46
 v_exp_f32 v47, v47
 v_cvt_pk_bf16_f32 v70, v44, v45
 v_cvt_pk_bf16_f32 v71, v46, v47
 v_mfma_f32_32x32x16_bf16 v[32:47], v[184:187], v[20:23], 0
 buffer_load_dwordx2 v[168:169], v1, s[8:11], s30 offen sc1
 v_exp_f32 v48, v48
 v_exp_f32 v49, v49
 v_exp_f32 v50, v50
 v_exp_f32 v51, v51
 v_cvt_pk_bf16_f32 v64, v48, v49
 v_cvt_pk_bf16_f32 v65, v50, v51
 v_mfma_f32_32x32x8_bf16 v[32:47], v[188:189], v[24:25], v[32:47]
 buffer_load_dwordx2 v[170:171], v2, s[8:11], s30 offen sc1
 v_exp_f32 v52, v52
 v_exp_f32 v53, v53
 v_exp_f32 v54, v54
 v_exp_f32 v55, v55
 v_cvt_pk_bf16_f32 v66, v52, v53
 v_cvt_pk_bf16_f32 v67, v54, v55
 v_mfma_f32_32x32x16_bf16 v[72:87], v[196:199], v[68:71], v[72:87]
 buffer_load_dword v172, v3, s[8:11], s30 offen sc1
 v_exp_f32 v56, v56
 v_exp_f32 v57, v57
 v_exp_f32 v58, v58
 v_exp_f32 v59, v59
 v_cvt_pk_bf16_f32 v68, v56, v57
 v_cvt_pk_bf16_f32 v69, v58, v59
 v_mfma_f32_32x32x16_bf16 v[88:103], v[192:195], v[64:67], v[88:103]
 v_exp_f32 v60, v60
 v_exp_f32 v61, v61
 v_exp_f32 v62, v62
 v_exp_f32 v63, v63
 v_cvt_pk_bf16_f32 v70, v60, v61
 v_cvt_pk_bf16_f32 v71, v62, v63
 v_mfma_f32_32x32x16_bf16 v[48:63], v[184:187], v[26:29], 0
 buffer_load_dwordx4 v[176:179], v4, s[8:11], s30 offen sc1
 v_exp_f32 v32, v32
 v_exp_f32 v33, v33
 v_exp_f32 v34, v34
 v_exp_f32 v35, v35
 v_cvt_pk_bf16_f32 v64, v32, v33
 v_cvt_pk_bf16_f32 v65, v34, v35
 v_mfma_f32_32x32x8_bf16 v[48:63], v[188:189], v[30:31], v[48:63]
 v_exp_f32 v36, v36
 v_exp_f32 v37, v37
 v_exp_f32 v38, v38
 v_exp_f32 v39, v39
 v_cvt_pk_bf16_f32 v66, v36, v37
 v_cvt_pk_bf16_f32 v67, v38, v39
 v_mfma_f32_32x32x16_bf16 v[88:103], v[196:199], v[68:71], v[88:103]
 buffer_load_dwordx4 v[180:183], v5, s[8:11], s30 offen sc1
 s_add_u32 s30, s30, 74240
 v_exp_f32 v40, v40
 v_exp_f32 v41, v41
 v_exp_f32 v42, v42
 v_exp_f32 v43, v43
 v_cvt_pk_bf16_f32 v68, v40, v41
 v_cvt_pk_bf16_f32 v69, v42, v43
 v_mfma_f32_32x32x16_bf16 v[104:119], v[192:195], v[64:67], v[104:119]
 v_exp_f32 v44, v44
 v_exp_f32 v45, v45
 v_exp_f32 v46, v46
 v_exp_f32 v47, v47
 v_cvt_pk_bf16_f32 v70, v44, v45
 v_cvt_pk_bf16_f32 v71, v46, v47
 s_waitcnt vmcnt(10)
 v_mfma_f32_32x32x16_bf16 v[32:47], v[136:139], v[8:11], 0
 v_exp_f32 v48, v48
 v_exp_f32 v49, v49
 v_exp_f32 v50, v50
 v_exp_f32 v51, v51
 v_cvt_pk_bf16_f32 v64, v48, v49
 v_cvt_pk_bf16_f32 v65, v50, v51
 v_mfma_f32_32x32x8_bf16 v[32:47], v[140:141], v[12:13], v[32:47]
 v_exp_f32 v52, v52
 v_exp_f32 v53, v53
 v_exp_f32 v54, v54
 v_exp_f32 v55, v55
 v_cvt_pk_bf16_f32 v66, v52, v53
 v_cvt_pk_bf16_f32 v67, v54, v55
 v_mfma_f32_32x32x16_bf16 v[104:119], v[196:199], v[68:71], v[104:119]
 v_exp_f32 v56, v56
 v_exp_f32 v57, v57
 v_exp_f32 v58, v58
 v_exp_f32 v59, v59
 v_cvt_pk_bf16_f32 v68, v56, v57
 v_cvt_pk_bf16_f32 v69, v58, v59
 v_mfma_f32_32x32x16_bf16 v[120:135], v[192:195], v[64:67], v[120:135]
 v_exp_f32 v60, v60
 v_exp_f32 v61, v61
 v_exp_f32 v62, v62
 v_exp_f32 v63, v63
 v_cvt_pk_bf16_f32 v70, v60, v61
 v_cvt_pk_bf16_f32 v71, v62, v63
 s_sub_u32 s32, s32, 1
 s_cmp_lg_u32 s32, 0
 s_cbranch_scc1 L3_main
 v_mfma_f32_32x32x16_bf16 v[120:135], v[196:199], v[68:71], v[120:135]
 s_mov_b32 s3, 0x57800000
 s_mov_b64 s[42:43], 0
 s_mul_i32 s26, s36, 36864
 s_add_u32 s26, s26, 16622080
 s_lshl_b32 s4, s35, 10
 s_add_u32 s27, s26, s4
 s_lshl_b32 s4, s35, 7
 s_add_u32 s26, s26, s4
 s_add_u32 s26, s26, 32768
 v_mov_b32 v208, v82
 v_mov_b32 v200, v82
 v_mov_b32 v209, v98
 v_mov_b32 v201, v98
 v_mov_b32 v210, v114
 v_mov_b32 v202, v114
 v_mov_b32 v211, v130
 v_mov_b32 v203, v130
 s_nop 0
 v_permlane32_swap_b32 v208, v200
 v_permlane32_swap_b32 v209, v201
 v_permlane32_swap_b32 v210, v202
 v_permlane32_swap_b32 v211, v203
 v_cmp_nge_f32 vcc, s3, v208
 s_or_b64 s[42:43], s[42:43], vcc
 v_cmp_nge_f32 vcc, s3, v209
 s_or_b64 s[42:43], s[42:43], vcc
 v_cmp_nge_f32 vcc, s3, v210
 s_or_b64 s[42:43], s[42:43], vcc
 v_cmp_nge_f32 vcc, s3, v211
 s_or_b64 s[42:43], s[42:43], vcc
 s_cmp_eq_u64 s[42:43], 0
 s_cbranch_scc0 L3_redo
L3_fin:
 v_lshlrev_b32 v6, 4, v255
 v_and_b32 v7, 31, v255
 v_lshlrev_b32 v7, 2, v7
 v_lshrrev_b32 v0, 5, v255
 v_mul_u32_u24 v0, 36864, v0
 v_add_u32 v7, v7, v0
 v_rcp_f32 v208, v208
 v_rcp_f32 v209, v209
 v_rcp_f32 v210, v210
 v_rcp_f32 v211, v211
 v_mul_f32 v72, v208, v72
 v_mul_f32 v73, v208, v73
 v_mul_f32 v74, v208, v74
 v_mul_f32 v75, v208, v75
 v_mul_f32 v76, v208, v76
 v_mul_f32 v77, v208, v77
 v_mul_f32 v78, v208, v78
 v_mul_f32 v79, v208, v79
 v_mul_f32 v80, v208, v80
 v_mul_f32 v81, v208, v81
 v_cvt_pk_bf16_f32 v72, v72, v73
 v_cvt_pk_bf16_f32 v73, v74, v75
 v_cvt_pk_bf16_f32 v74, v76, v77
 v_cvt_pk_bf16_f32 v75, v78, v79
 v_cvt_pk_bf16_f32 v76, v80, v81
 buffer_store_dwordx4 v[72:75], v6, s[8:11], s27 offen sc1
 s_add_u32 s27, s27, 36864
 v_mul_f32 v88, v209, v88
 v_mul_f32 v89, v209, v89
 v_mul_f32 v90, v209, v90
 v_mul_f32 v91, v209, v91
 v_mul_f32 v92, v209, v92
 v_mul_f32 v93, v209, v93
 v_mul_f32 v94, v209, v94
 v_mul_f32 v95, v209, v95
 v_mul_f32 v96, v209, v96
 v_mul_f32 v97, v209, v97
 v_cvt_pk_bf16_f32 v88, v88, v89
 v_cvt_pk_bf16_f32 v89, v90, v91
 v_cvt_pk_bf16_f32 v90, v92, v93
 v_cvt_pk_bf16_f32 v91, v94, v95
 v_cvt_pk_bf16_f32 v92, v96, v97
 buffer_store_dwordx4 v[88:91], v6, s[8:11], s27 offen sc1
 s_add_u32 s27, s27, 36864
 v_permlane32_swap_b32 v76, v92
 buffer_store_dword v76, v7, s[8:11], s26 offen sc1
 s_add_u32 s26, s26, 73728
 v_mul_f32 v104, v210, v104
 v_mul_f32 v105, v210, v105
 v_mul_f32 v106, v210, v106
 v_mul_f32 v107, v210, v107
 v_mul_f32 v108, v210, v108
 v_mul_f32 v109, v210, v109
 v_mul_f32 v110, v210, v110
 v_mul_f32 v111, v210, v111
 v_mul_f32 v112, v210, v112
 v_mul_f32 v113, v210, v113
 v_cvt_pk_bf16_f32 v104, v104, v105
 v_cvt_pk_bf16_f32 v105, v106, v107
 v_cvt_pk_bf16_f32 v106, v108, v109
 v_cvt_pk_bf16_f32 v107, v110, v111
 v_cvt_pk_bf16_f32 v108, v112, v113
 buffer_store_dwordx4 v[104:107], v6, s[8:11], s27 offen sc1
 s_add_u32 s27, s27, 36864
 v_mul_f32 v120, v211, v120
 v_mul_f32 v121, v211, v121
 v_mul_f32 v122, v211, v122
 v_mul_f32 v123, v211, v123
 v_mul_f32 v124, v211, v124
 v_mul_f32 v125, v211, v125
 v_mul_f32 v126, v211, v126
 v_mul_f32 v127, v211, v127
 v_mul_f32 v128, v211, v128
 v_mul_f32 v129, v211, v129
 v_cvt_pk_bf16_f32 v120, v120, v121
 v_cvt_pk_bf16_f32 v121, v122, v123
 v_cvt_pk_bf16_f32 v122, v124, v125
 v_cvt_pk_bf16_f32 v123, v126, v127
 v_cvt_pk_bf16_f32 v124, v128, v129
 buffer_store_dwordx4 v[120:123], v6, s[8:11], s27 offen sc1
 s_add_u32 s27, s27, 36864
 v_permlane32_swap_b32 v108, v124
 buffer_store_dword v108, v7, s[8:11], s26 offen sc1
 s_add_u32 s26, s26, 73728
 s_lshr_b32 s57, s36, 4
 s_load_dwordx2 s[20:21], s[0:1], 64
 s_mul_i32 s3, s57, 256
 s_add_u32 s3, s3, 19134976
 v_lshl_add_u32 v2, v255, 7, s3
 v_mov_b32 v1, 0
 s_waitcnt vmcnt(0)
 s_barrier
 s_cmp_lg_u32 s29, 0
 s_cbranch_scc1 L_arr_a
 v_mov_b32 v1, 1
 s_mov_b64 exec, 3
 buffer_atomic_add v1, v2, s[8:11], 0 offen sc1
 s_mov_b64 exec, -1
L_arr_a:
 s_waitcnt lgkmcnt(0)
 s_lshl_b32 s23, s45, 7
 s_mov_b32 m0, s46
 s_movk_i32 s58, 1024
 buffer_load_dwordx4 v218, s[12:15], s23 offen lds
 buffer_load_dwordx4 v219, s[12:15], s23 offen offset:1024 lds
 s_mov_b32 m0, s59
 s_lshl_b32 s24, s44, 2
 buffer_load_dwordx4 v218, s[12:15], s58 offen lds
 buffer_load_dwordx4 v219, s[12:15], s58 offen offset:1024 lds
 s_add_u32 s24, s24, s29
 s_mul_i32 s31, s24, 36864
 s_lshl_b32 s32, s45, 12
 s_add_u32 s32, s32, s31
 s_and_b32 s22, s45, 1
 s_lshl_b32 s3, s22, 11
 s_lshl_b32 s4, s45, 12
 s_sub_u32 s3, s3, s4
 s_add_u32 s3, s3, 32768
 s_lshr_b32 s25, s45, 1
 s_cmp_eq_u32 s25, s29
 s_cselect_b32 s3, s3, 0x40000000
 s_add_u32 s31, s31, 16622080
 v_mov_b32 v95, v255
 v_lshlrev_b32 v88, 4, v255
 v_add_u32 v89, s3, v88
 s_add_u32 s3, s32, 11903488
 buffer_load_dwordx4 v[96:99], v88, s[8:11], s3 offen offset:0 sc1
 buffer_load_dwordx4 v[100:103], v88, s[8:11], s3 offen offset:1024 sc1
 buffer_load_dwordx4 v[104:107], v88, s[8:11], s3 offen offset:2048 sc1
 buffer_load_dwordx4 v[108:111], v88, s[8:11], s3 offen offset:3072 sc1
 buffer_load_dwordx4 a[144:147], v89, s[8:11], s3 offen offset:0 sc1
 buffer_load_dwordx4 a[148:151], v89, s[8:11], s3 offen offset:1024 sc1
 s_add_u32 s3, s32, 14262784
 buffer_load_dwordx4 v[112:115], v88, s[8:11], s3 offen offset:0 sc1
 buffer_load_dwordx4 v[116:119], v88, s[8:11], s3 offen offset:1024 sc1
 buffer_load_dwordx4 v[120:123], v88, s[8:11], s3 offen offset:2048 sc1
 buffer_load_dwordx4 v[124:127], v88, s[8:11], s3 offen offset:3072 sc1
 buffer_load_dwordx4 a[152:155], v89, s[8:11], s3 offen offset:0 sc1
 buffer_load_dwordx4 a[156:159], v89, s[8:11], s3 offen offset:1024 sc1
 v_bfe_u32 v90, v95, 2, 2
 v_lshrrev_b32 v91, 5, v95
 v_lshl_add_u32 v91, v91, 2, v90
 v_lshlrev_b32 v72, 7, v91
 v_lshrrev_b32 v90, 1, v90
 v_lshl_add_u32 v72, v90, 6, v72
 v_bfe_u32 v90, v95, 4, 1
 v_lshl_add_u32 v72, v90, 5, v72
 v_and_b32 v90, 3, v95
 v_lshl_add_u32 v72, v90, 3, v72
 v_xor_b32 v73, 64, v72
 v_add_u32 v74, 49152, v72
 v_add_u32 v75, 49152, v73
 v_add_u32 v76, 98304, v72
 v_add_u32 v77, 98304, v73
 v_and_b32 v90, 31, v95
 v_lshrrev_b32 v91, 5, v95
 v_lshlrev_b32 v94, 2, v90
 v_lshl_add_u32 v94, v91, 9, v94
 v_lshlrev_b32 v91, 2, v91
 v_sub_u32 v90, v90, v91
 v_mov_b32 v91, 0x3f80
 v_mov_b32 v92, 1.0
 v_cmp_eq_u32 vcc, 0, v90
 v_cmp_eq_u32 s[34:35], 1, v90
 s_nop 0
 v_cndmask_b32 v80, 0, v91, vcc
 v_cndmask_b32 v80, v80, v92, s[34:35]
 v_cmp_eq_u32 vcc, 2, v90
 v_cmp_eq_u32 s[34:35], 3, v90
 s_nop 0
 v_cndmask_b32 v81, 0, v91, vcc
 v_cndmask_b32 v81, v81, v92, s[34:35]
 v_cmp_eq_u32 vcc, 8, v90
 v_cmp_eq_u32 s[34:35], 9, v90
 s_nop 0
 v_cndmask_b32 v82, 0, v91, vcc
 v_cndmask_b32 v82, v82, v92, s[34:35]
 v_cmp_eq_u32 vcc, 10, v90
 v_cmp_eq_u32 s[34:35], 11, v90
 s_nop 0
 v_cndmask_b32 v83, 0, v91, vcc
 v_cndmask_b32 v83, v83, v92, s[34:35]
 v_cmp_eq_u32 vcc, 16, v90
 v_cmp_eq_u32 s[34:35], 17, v90
 s_nop 0
 v_cndmask_b32 v84, 0, v91, vcc
 v_cndmask_b32 v84, v84, v92, s[34:35]
 v_cmp_eq_u32 vcc, 18, v90
 v_cmp_eq_u32 s[34:35], 19, v90
 s_nop 0
 v_cndmask_b32 v85, 0, v91, vcc
 v_cndmask_b32 v85, v85, v92, s[34:35]
 v_cmp_eq_u32 vcc, 24, v90
 v_cmp_eq_u32 s[34:35], 25, v90
 s_nop 0
 v_cndmask_b32 v86, 0, v91, vcc
 v_cndmask_b32 v86, v86, v92, s[34:35]
 v_cmp_eq_u32 vcc, 26, v90
 v_cmp_eq_u32 s[34:35], 27, v90
 s_nop 0
 v_cndmask_b32 v87, 0, v91, vcc
 v_cndmask_b32 v87, v87, v92, s[34:35]
 s_lshr_b32 s4, s44, 1
 s_lshl_b32 s4, s4, 7
 s_add_u32 s4, s4, 19134976
 v_mov_b32 v90, s4
 s_lshl_b32 s4, s44, 7
 s_add_u32 s4, s4, 19132928
 v_mov_b32 v91, s4
 s_mov_b32 s16, s20
 s_and_b32 s17, s21, 0xffff
 s_mov_b32 s18, 0x240000
 s_mov_b32 s19, 0x20000
 s_cmp_lg_u32 s29, 0
 s_cbranch_scc1 L3_polla_ok
 s_mov_b32 s38, 0x100000
L3_polla:
 buffer_load_dword v92, v90, s[8:11], 0 offen sc1
 s_sub_u32 s38, s38, 1
 s_cbranch_scc1 L3_polla_ok
 s_waitcnt vmcnt(0)
 v_cmp_ne_u32 vcc, 32, v92
 s_cmp_lg_u64 vcc, 0
 s_cbranch_scc1 L3_polla
L3_polla_ok:
 s_waitcnt vmcnt(0)
 s_barrier
 s_add_u32 s3, s31, 0
 buffer_load_dwordx4 a[0:3], v88, s[8:11], s3 offen offset:0 sc1
 buffer_load_dwordx4 a[4:7], v88, s[8:11], s3 offen offset:1024 sc1
 buffer_load_dwordx4 a[8:11], v88, s[8:11], s3 offen offset:2048 sc1
 buffer_load_dwordx4 a[12:15], v88, s[8:11], s3 offen offset:3072 sc1
 s_add_u32 s3, s31, 4096
 buffer_load_dwordx4 a[16:19], v88, s[8:11], s3 offen offset:0 sc1
 buffer_load_dwordx4 a[20:23], v88, s[8:11], s3 offen offset:1024 sc1
 buffer_load_dwordx4 a[24:27], v88, s[8:11], s3 offen offset:2048 sc1
 buffer_load_dwordx4 a[28:31], v88, s[8:11], s3 offen offset:3072 sc1
 s_add_u32 s3, s31, 8192
 buffer_load_dwordx4 a[32:35], v88, s[8:11], s3 offen offset:0 sc1
 buffer_load_dwordx4 a[36:39], v88, s[8:11], s3 offen offset:1024 sc1
 buffer_load_dwordx4 a[40:43], v88, s[8:11], s3 offen offset:2048 sc1
 buffer_load_dwordx4 a[44:47], v88, s[8:11], s3 offen offset:3072 sc1
 ds_read_b64_tr_b16 v[48:49], v72 offset:0
 ds_read_b64_tr_b16 v[50:51], v72 offset:1024
 ds_read_b64_tr_b16 v[52:53], v73 offset:0
 ds_read_b64_tr_b16 v[54:55], v73 offset:1024
 ds_read_b64_tr_b16 v[56:57], v72 offset:2048
 ds_read_b64_tr_b16 v[58:59], v72 offset:3072
 ds_read_b64_tr_b16 v[60:61], v73 offset:2048
 ds_read_b64_tr_b16 v[62:63], v73 offset:3072
 v_mfma_f32_32x32x16_bf16 v[0:15], v[80:83], v[96:99], 0
 v_mfma_f32_32x32x16_bf16 v[16:31], v[80:83], v[104:107], 0
 v_mfma_f32_32x32x16_bf16 v[0:15], v[84:87], v[100:103], v[0:15]
 v_mfma_f32_32x32x16_bf16 v[16:31], v[84:87], v[108:111], v[16:31]
 v_mfma_f32_32x32x16_bf16 v[0:15], v[80:83], v[112:115], v[0:15]
 v_mfma_f32_32x32x16_bf16 v[16:31], v[80:83], v[120:123], v[16:31]
 v_mfma_f32_32x32x16_bf16 v[0:15], v[84:87], v[116:119], v[0:15]
 v_mfma_f32_32x32x16_bf16 v[16:31], v[84:87], v[124:127], v[16:31]
 v_mfma_f32_32x32x16_bf16 v[32:47], v[80:83], a[144:147], 0
 v_mfma_f32_32x32x16_bf16 v[32:47], v[84:87], a[148:151], v[32:47]
 v_mfma_f32_32x32x16_bf16 v[32:47], v[80:83], a[152:155], v[32:47]
 v_mfma_f32_32x32x16_bf16 v[32:47], v[84:87], a[156:159], v[32:47]
 s_waitcnt vmcnt(8)
 s_waitcnt lgkmcnt(4)
 v_mfma_f32_32x32x16_bf16 v[0:15], v[48:51], a[0:3], v[0:15]
 ds_read_b64_tr_b16 v[64:65], v72 offset:4096
 ds_read_b64_tr_b16 v[66:67], v72 offset:5120
 s_add_u32 s3, s31, 12288
 buffer_load_dwordx4 a[48:51], v88, s[8:11], s3 offen offset:0 sc1
 v_mfma_f32_32x32x16_bf16 v[16:31], v[52:55], a[0:3], v[16:31]
 ds_read_b64_tr_b16 v[68:69], v73 offset:4096
 ds_read_b64_tr_b16 v[70:71], v73 offset:5120
 s_waitcnt lgkmcnt(4)
 v_mfma_f32_32x32x16_bf16 v[0:15], v[56:59], a[4:7], v[0:15]
 ds_read_b64_tr_b16 v[48:49], v72 offset:6144
 ds_read_b64_tr_b16 v[50:51], v72 offset:7168
 buffer_load_dwordx4 a[52:55], v88, s[8:11], s3 offen offset:1024 sc1
 v_mfma_f32_32x32x16_bf16 v[16:31], v[60:63], a[4:7], v[16:31]
 ds_read_b64_tr_b16 v[52:53], v73 offset:6144
 ds_read_b64_tr_b16 v[54:55], v73 offset:7168
 s_waitcnt lgkmcnt(4)
 v_mfma_f32_32x32x16_bf16 v[0:15], v[64:67], a[8:11], v[0:15]
 ds_read_b64_tr_b16 v[56:57], v72 offset:8192
 ds_read_b64_tr_b16 v[58:59], v72 offset:9216
 buffer_load_dwordx4 a[56:59], v88, s[8:11], s3 offen offset:2048 sc1
 v_mfma_f32_32x32x16_bf16 v[16:31], v[68:71], a[8:11], v[16:31]
 ds_read_b64_tr_b16 v[60:61], v73 offset:8192
 ds_read_b64_tr_b16 v[62:63], v73 offset:9216
 s_waitcnt lgkmcnt(4)
 v_mfma_f32_32x32x16_bf16 v[0:15], v[48:51], a[12:15], v[0:15]
 ds_read_b64_tr_b16 v[64:65], v72 offset:10240
 ds_read_b64_tr_b16 v[66:67], v72 offset:11264
 buffer_load_dwordx4 a[60:63], v88, s[8:11], s3 offen offset:3072 sc1
 v_mfma_f32_32x32x16_bf16 v[16:31], v[52:55], a[12:15], v[16:31]
 ds_read_b64_tr_b16 v[68:69], v73 offset:10240
 ds_read_b64_tr_b16 v[70:71], v73 offset:11264
 s_waitcnt vmcnt(8)
 s_waitcnt lgkmcnt(4)
 v_mfma_f32_32x32x16_bf16 v[0:15], v[56:59], a[16:19], v[0:15]
 ds_read_b64_tr_b16 v[48:49], v72 offset:12288
 ds_read_b64_tr_b16 v[50:51], v72 offset:13312
 s_add_u32 s3, s31, 16384
 buffer_load_dwordx4 a[64:67], v88, s[8:11], s3 offen offset:0 sc1
 v_mfma_f32_32x32x16_bf16 v[16:31], v[60:63], a[16:19], v[16:31]
 ds_read_b64_tr_b16 v[52:53], v73 offset:12288
 ds_read_b64_tr_b16 v[54:55], v73 offset:13312
 s_waitcnt lgkmcnt(4)
 v_mfma_f32_32x32x16_bf16 v[0:15], v[64:67], a[20:23], v[0:15]
 ds_read_b64_tr_b16 v[56:57], v72 offset:14336
 ds_read_b64_tr_b16 v[58:59], v72 offset:15360
 buffer_load_dwordx4 a[68:71], v88, s[8:11], s3 offen offset:1024 sc1
 v_mfma_f32_32x32x16_bf16 v[16:31], v[68:71], a[20:23], v[16:31]
 ds_read_b64_tr_b16 v[60:61], v73 offset:14336
 ds_read_b64_tr_b16 v[62:63], v73 offset:15360
 s_waitcnt lgkmcnt(4)
 v_mfma_f32_32x32x16_bf16 v[0:15], v[48:51], a[24:27], v[0:15]
 ds_read_b64_tr_b16 v[64:65], v72 offset:16384
 ds_read_b64_tr_b16 v[66:67], v72 offset:17408
 buffer_load_dwordx4 a[72:75], v88, s[8:11], s3 offen offset:2048 sc1
 v_mfma_f32_32x32x16_bf16 v[16:31], v[52:55], a[24:27], v[16:31]
 ds_read_b64_tr_b16 v[68:69], v73 offset:16384
 ds_read_b64_tr_b16 v[70:71], v73 offset:17408
 s_waitcnt lgkmcnt(4)
 v_mfma_f32_32x32x16_bf16 v[0:15], v[56:59], a[28:31], v[0:15]
 ds_read_b64_tr_b16 v[48:49], v72 offset:18432
 ds_read_b64_tr_b16 v[50:51], v72 offset:19456
 buffer_load_dwordx4 a[76:79], v88, s[8:11], s3 offen offset:3072 sc1
 v_mfma_f32_32x32x16_bf16 v[16:31], v[60:63], a[28:31], v[16:31]
 ds_read_b64_tr_b16 v[52:53], v73 offset:18432
 ds_read_b64_tr_b16 v[54:55], v73 offset:19456
 s_waitcnt vmcnt(8)
 s_waitcnt lgkmcnt(4)
 v_mfma_f32_32x32x16_bf16 v[0:15], v[64:67], a[32:35], v[0:15]
 ds_read_b64_tr_b16 v[56:57], v72 offset:20480
 ds_read_b64_tr_b16 v[58:59], v72 offset:21504
 s_add_u32 s3, s31, 20480
 buffer_load_dwordx4 a[80:83], v88, s[8:11], s3 offen offset:0 sc1
 v_mfma_f32_32x32x16_bf16 v[16:31], v[68:71], a[32:35], v[16:31]
 ds_read_b64_tr_b16 v[60:61], v73 offset:20480
 ds_read_b64_tr_b16 v[62:63], v73 offset:21504
 buffer_load_dwordx4 a[84:87], v88, s[8:11], s3 offen offset:1024 sc1
 s_waitcnt lgkmcnt(4)
 v_mfma_f32_32x32x16_bf16 v[0:15], v[48:51], a[36:39], v[0:15]
 ds_read_b64_tr_b16 v[64:65], v72 offset:22528
 ds_read_b64_tr_b16 v[66:67], v72 offset:23552
 v_mfma_f32_32x32x16_bf16 v[16:31], v[52:55], a[36:39], v[16:31]
 ds_read_b64_tr_b16 v[68:69], v73 offset:22528
 ds_read_b64_tr_b16 v[70:71], v73 offset:23552
 s_waitcnt lgkmcnt(4)
 v_mfma_f32_32x32x16_bf16 v[0:15], v[56:59], a[40:43], v[0:15]
 ds_read_b64_tr_b16 v[48:49], v72 offset:24576
 ds_read_b64_tr_b16 v[50:51], v72 offset:25600
 buffer_load_dwordx4 a[88:91], v88, s[8:11], s3 offen offset:2048 sc1
 v_mfma_f32_32x32x16_bf16 v[16:31], v[60:63], a[40:43], v[16:31]
 ds_read_b64_tr_b16 v[52:53], v73 offset:24576
 ds_read_b64_tr_b16 v[54:55], v73 offset:25600
 s_waitcnt lgkmcnt(4)
 v_mfma_f32_32x32x16_bf16 v[0:15], v[64:67], a[44:47], v[0:15]
 ds_read_b64_tr_b16 v[56:57], v72 offset:26624
 ds_read_b64_tr_b16 v[58:59], v72 offset:27648
 buffer_load_dwordx4 a[92:95], v88, s[8:11], s3 offen offset:3072 sc1
 v_mfma_f32_32x32x16_bf16 v[16:31], v[68:71], a[44:47], v[16:31]
 ds_read_b64_tr_b16 v[60:61], v73 offset:26624
 ds_read_b64_tr_b16 v[62:63], v73 offset:27648
 s_waitcnt vmcnt(8)
 s_waitcnt lgkmcnt(4)
 v_mfma_f32_32x32x16_bf16 v[0:15], v[48:51], a[48:51], v[0:15]
 ds_read_b64_tr_b16 v[64:65], v72 offset:28672
 ds_read_b64_tr_b16 v[66:67], v72 offset:29696
 s_add_u32 s3, s31, 24576
 buffer_load_dwordx4 a[96:99], v88, s[8:11], s3 offen offset:0 sc1
 v_mfma_f32_32x32x16_bf16 v[16:31], v[52:55], a[48:51], v[16:31]
 ds_read_b64_tr_b16 v[68:69], v73 offset:28672
 ds_read_b64_tr_b16 v[70:71], v73 offset:29696
 s_waitcnt lgkmcnt(4)
 v_mfma_f32_32x32x16_bf16 v[0:15], v[56:59], a[52:55], v[0:15]
 ds_read_b64_tr_b16 v[48:49], v72 offset:30720
 ds_read_b64_tr_b16 v[50:51], v72 offset:31744
 buffer_load_dwordx4 a[100:103], v88, s[8:11], s3 offen offset:1024 sc1
 v_mfma_f32_32x32x16_bf16 v[16:31], v[60:63], a[52:55], v[16:31]
 ds_read_b64_tr_b16 v[52:53], v73 offset:30720
 ds_read_b64_tr_b16 v[54:55], v73 offset:31744
 s_waitcnt lgkmcnt(4)
 v_mfma_f32_32x32x16_bf16 v[0:15], v[64:67], a[56:59], v[0:15]
 ds_read_b64_tr_b16 v[56:57], v72 offset:32768
 ds_read_b64_tr_b16 v[58:59], v72 offset:33792
 buffer_load_dwordx4 a[104:107], v88, s[8:11], s3 offen offset:2048 sc1
 v_mfma_f32_32x32x16_bf16 v[16:31], v[68:71], a[56:59], v[16:31]
 ds_read_b64_tr_b16 v[60:61], v73 offset:32768
 ds_read_b64_tr_b16 v[62:63], v73 offset:33792
 s_waitcnt lgkmcnt(4)
 v_mfma_f32_32x32x16_bf16 v[0:15], v[48:51], a[60:63], v[0:15]
 ds_read_b64_tr_b16 v[64:65], v72 offset:34816
 ds_read_b64_tr_b16 v[66:67], v72 offset:35840
 buffer_load_dwordx4 a[108:111], v88, s[8:11], s3 offen offset:3072 sc1
 v_mfma_f32_32x32x16_bf16 v[16:31], v[52:55], a[60:63], v[16:31]
 ds_read_b64_tr_b16 v[68:69], v73 offset:34816
 ds_read_b64_tr_b16 v[70:71], v73 offset:35840
 s_waitcnt vmcnt(8)
 s_waitcnt lgkmcnt(4)
 v_mfma_f32_32x32x16_bf16 v[0:15], v[56:59], a[64:67], v[0:15]
 ds_read_b64_tr_b16 v[48:49], v72 offset:36864
 ds_read_b64_tr_b16 v[50:51], v72 offset:37888
 s_add_u32 s3, s31, 28672
 buffer_load_dwordx4 a[112:115], v88, s[8:11], s3 offen offset:0 sc1
 v_mfma_f32_32x32x16_bf16 v[16:31], v[60:63], a[64:67], v[16:31]
 ds_read_b64_tr_b16 v[52:53], v73 offset:36864
 ds_read_b64_tr_b16 v[54:55], v73 offset:37888
 s_waitcnt lgkmcnt(4)
 v_mfma_f32_32x32x16_bf16 v[0:15], v[64:67], a[68:71], v[0:15]
 ds_read_b64_tr_b16 v[56:57], v72 offset:38912
 ds_read_b64_tr_b16 v[58:59], v72 offset:39936
 buffer_load_dwordx4 a[116:119], v88, s[8:11], s3 offen offset:1024 sc1
 v_mfma_f32_32x32x16_bf16 v[16:31], v[68:71], a[68:71], v[16:31]
 ds_read_b64_tr_b16 v[60:61], v73 offset:38912
 ds_read_b64_tr_b16 v[62:63], v73 offset:39936
 s_waitcnt lgkmcnt(4)
 v_mfma_f32_32x32x16_bf16 v[0:15], v[48:51], a[72:75], v[0:15]
 ds_read_b64_tr_b16 v[64:65], v72 offset:40960
 ds_read_b64_tr_b16 v[66:67], v72 offset:41984
 buffer_load_dwordx4 a[120:123], v88, s[8:11], s3 offen offset:2048 sc1
 v_mfma_f32_32x32x16_bf16 v[16:31], v[52:55], a[72:75], v[16:31]
 ds_read_b64_tr_b16 v[68:69], v73 offset:40960
 ds_read_b64_tr_b16 v[70:71], v73 offset:41984
 s_waitcnt lgkmcnt(4)
 v_mfma_f32_32x32x16_bf16 v[0:15], v[56:59], a[76:79], v[0:15]
 ds_read_b64_tr_b16 v[48:49], v72 offset:43008
 ds_read_b64_tr_b16 v[50:51], v72 offset:44032
 buffer_load_dwordx4 a[124:127], v88, s[8:11], s3 offen offset:3072 sc1
 v_mfma_f32_32x32x16_bf16 v[16:31], v[60:63], a[76:79], v[16:31]
 ds_read_b64_tr_b16 v[52:53], v73 offset:43008
 ds_read_b64_tr_b16 v[54:55], v73 offset:44032
 s_waitcnt vmcnt(8)
 s_waitcnt lgkmcnt(4)
 v_mfma_f32_32x32x16_bf16 v[0:15], v[64:67], a[80:83], v[0:15]
 ds_read_b64_tr_b16 v[56:57], v72 offset:45056
 ds_read_b64_tr_b16 v[58:59], v72 offset:46080
 s_add_u32 s3, s31, 32768
 buffer_load_dword a128, v94, s[8:11], s3 offen offset:0 sc1
 buffer_load_dword a129, v94, s[8:11], s3 offen offset:128 sc1
 buffer_load_dword a130, v94, s[8:11], s3 offen offset:256 sc1
 v_mfma_f32_32x32x16_bf16 v[16:31], v[68:71], a[80:83], v[16:31]
 ds_read_b64_tr_b16 v[60:61], v73 offset:45056
 ds_read_b64_tr_b16 v[62:63], v73 offset:46080
 buffer_load_dword a131, v94, s[8:11], s3 offen offset:384 sc1
 buffer_load_dword a132, v94, s[8:11], s3 offen offset:1024 sc1
 s_waitcnt lgkmcnt(4)
 v_mfma_f32_32x32x16_bf16 v[0:15], v[48:51], a[84:87], v[0:15]
 ds_read_b64_tr_b16 v[64:65], v72 offset:47104
 ds_read_b64_tr_b16 v[66:67], v72 offset:48128
 buffer_load_dword a133, v94, s[8:11], s3 offen offset:1152 sc1
 buffer_load_dword a134, v94, s[8:11], s3 offen offset:1280 sc1
 v_mfma_f32_32x32x16_bf16 v[16:31], v[52:55], a[84:87], v[16:31]
 ds_read_b64_tr_b16 v[68:69], v73 offset:47104
 ds_read_b64_tr_b16 v[70:71], v73 offset:48128
 s_waitcnt lgkmcnt(4)
 v_mfma_f32_32x32x16_bf16 v[0:15], v[56:59], a[88:91], v[0:15]
 ds_read_b64_tr_b16 v[48:49], v74 offset:0
 ds_read_b64_tr_b16 v[50:51], v74 offset:1024
 buffer_load_dword a135, v94, s[8:11], s3 offen offset:1408 sc1
 buffer_load_dword a136, v94, s[8:11], s3 offen offset:2048 sc1
 buffer_load_dword a137, v94, s[8:11], s3 offen offset:2176 sc1
 v_mfma_f32_32x32x16_bf16 v[16:31], v[60:63], a[88:91], v[16:31]
 ds_read_b64_tr_b16 v[52:53], v75 offset:0
 ds_read_b64_tr_b16 v[54:55], v75 offset:1024
 buffer_load_dword a138, v94, s[8:11], s3 offen offset:2304 sc1
 buffer_load_dword a139, v94, s[8:11], s3 offen offset:2432 sc1
 s_waitcnt lgkmcnt(4)
 v_mfma_f32_32x32x16_bf16 v[0:15], v[64:67], a[92:95], v[0:15]
 ds_read_b64_tr_b16 v[56:57], v74 offset:2048
 ds_read_b64_tr_b16 v[58:59], v74 offset:3072
 buffer_load_dword a140, v94, s[8:11], s3 offen offset:3072 sc1
 buffer_load_dword a141, v94, s[8:11], s3 offen offset:3200 sc1
 v_mfma_f32_32x32x16_bf16 v[16:31], v[68:71], a[92:95], v[16:31]
 ds_read_b64_tr_b16 v[60:61], v75 offset:2048
 ds_read_b64_tr_b16 v[62:63], v75 offset:3072
 buffer_load_dword a142, v94, s[8:11], s3 offen offset:3328 sc1
 buffer_load_dword a143, v94, s[8:11], s3 offen offset:3456 sc1
 s_waitcnt vmcnt(20)
 s_waitcnt lgkmcnt(4)
 v_mfma_f32_32x32x16_bf16 v[0:15], v[48:51], a[96:99], v[0:15]
 ds_read_b64_tr_b16 v[64:65], v74 offset:4096
 ds_read_b64_tr_b16 v[66:67], v74 offset:5120
 v_mfma_f32_32x32x16_bf16 v[16:31], v[52:55], a[96:99], v[16:31]
 ds_read_b64_tr_b16 v[68:69], v75 offset:4096
 ds_read_b64_tr_b16 v[70:71], v75 offset:5120
 s_waitcnt lgkmcnt(4)
 v_mfma_f32_32x32x16_bf16 v[0:15], v[56:59], a[100:103], v[0:15]
 ds_read_b64_tr_b16 v[48:49], v74 offset:6144
 ds_read_b64_tr_b16 v[50:51], v74 offset:7168
 v_mfma_f32_32x32x16_bf16 v[16:31], v[60:63], a[100:103], v[16:31]
 ds_read_b64_tr_b16 v[52:53], v75 offset:6144
 ds_read_b64_tr_b16 v[54:55], v75 offset:7168
 s_waitcnt lgkmcnt(4)
 v_mfma_f32_32x32x16_bf16 v[0:15], v[64:67], a[104:107], v[0:15]
 ds_read_b64_tr_b16 v[56:57], v74 offset:8192
 ds_read_b64_tr_b16 v[58:59], v74 offset:9216
 v_mfma_f32_32x32x16_bf16 v[16:31], v[68:71], a[104:107], v[16:31]
 ds_read_b64_tr_b16 v[60:61], v75 offset:8192
 ds_read_b64_tr_b16 v[62:63], v75 offset:9216
 s_waitcnt lgkmcnt(4)
 v_mfma_f32_32x32x16_bf16 v[0:15], v[48:51], a[108:111], v[0:15]
 ds_read_b64_tr_b16 v[64:65], v74 offset:10240
 ds_read_b64_tr_b16 v[66:67], v74 offset:11264
 v_mfma_f32_32x32x16_bf16 v[16:31], v[52:55], a[108:111], v[16:31]
 ds_read_b64_tr_b16 v[68:69], v75 offset:10240
 ds_read_b64_tr_b16 v[70:71], v75 offset:11264
 s_waitcnt vmcnt(16)
 s_waitcnt lgkmcnt(4)
 v_mfma_f32_32x32x16_bf16 v[0:15], v[56:59], a[112:115], v[0:15]
 ds_read_b64_tr_b16 v[48:49], v74 offset:12288
 ds_read_b64_tr_b16 v[50:51], v74 offset:13312
 v_mfma_f32_32x32x16_bf16 v[16:31], v[60:63], a[112:115], v[16:31]
 ds_read_b64_tr_b16 v[52:53], v75 offset:12288
 ds_read_b64_tr_b16 v[54:55], v75 offset:13312
 s_waitcnt lgkmcnt(4)
 v_mfma_f32_32x32x16_bf16 v[0:15], v[64:67], a[116:119], v[0:15]
 ds_read_b64_tr_b16 v[56:57], v74 offset:14336
 ds_read_b64_tr_b16 v[58:59], v74 offset:15360
 v_mfma_f32_32x32x16_bf16 v[16:31], v[68:71], a[116:119], v[16:31]
 ds_read_b64_tr_b16 v[60:61], v75 offset:14336
 ds_read_b64_tr_b16 v[62:63], v75 offset:15360
 s_waitcnt lgkmcnt(4)
 v_mfma_f32_32x32x16_bf16 v[0:15], v[48:51], a[120:123], v[0:15]
 ds_read_b64_tr_b16 v[64:65], v74 offset:16384
 ds_read_b64_tr_b16 v[66:67], v74 offset:17408
 v_mfma_f32_32x32x16_bf16 v[16:31], v[52:55], a[120:123], v[16:31]
 ds_read_b64_tr_b16 v[68:69], v75 offset:16384
 ds_read_b64_tr_b16 v[70:71], v75 offset:17408
 s_waitcnt lgkmcnt(4)
 v_mfma_f32_32x32x16_bf16 v[0:15], v[56:59], a[124:127], v[0:15]
 ds_read_b64_tr_b16 v[48:49], v74 offset:18432
 ds_read_b64_tr_b16 v[50:51], v74 offset:19456
 v_mfma_f32_32x32x16_bf16 v[16:31], v[60:63], a[124:127], v[16:31]
 ds_read_b64_tr_b16 v[52:53], v75 offset:18432
 ds_read_b64_tr_b16 v[54:55], v75 offset:19456
 s_waitcnt vmcnt(0)
 s_waitcnt lgkmcnt(4)
 v_mfma_f32_32x32x16_bf16 v[0:15], v[64:67], a[128:131], v[0:15]
 ds_read_b64_tr_b16 v[56:57], v74 offset:20480
 ds_read_b64_tr_b16 v[58:59], v74 offset:21504
 v_mfma_f32_32x32x16_bf16 v[16:31], v[68:71], a[128:131], v[16:31]
 ds_read_b64_tr_b16 v[60:61], v75 offset:20480
 ds_read_b64_tr_b16 v[62:63], v75 offset:21504
 s_waitcnt lgkmcnt(4)
 v_mfma_f32_32x32x16_bf16 v[0:15], v[48:51], a[132:135], v[0:15]
 ds_read_b64_tr_b16 v[64:65], v74 offset:22528
 ds_read_b64_tr_b16 v[66:67], v74 offset:23552
 v_mfma_f32_32x32x16_bf16 v[16:31], v[52:55], a[132:135], v[16:31]
 ds_read_b64_tr_b16 v[68:69], v75 offset:22528
 ds_read_b64_tr_b16 v[70:71], v75 offset:23552
 s_waitcnt lgkmcnt(4)
 v_mfma_f32_32x32x16_bf16 v[0:15], v[56:59], a[136:139], v[0:15]
 v_mfma_f32_32x32x16_bf16 v[16:31], v[60:63], a[136:139], v[16:31]
 s_waitcnt lgkmcnt(0)
 v_mfma_f32_32x32x16_bf16 v[0:15], v[64:67], a[140:143], v[0:15]
 v_mfma_f32_32x32x16_bf16 v[16:31], v[68:71], a[140:143], v[16:31]
 s_cmp_lg_u32 s29, 0
 s_cbranch_scc1 L3_pollm_ok
 s_mov_b32 s38, 0x100000
L3_pollm:
 buffer_load_dword v92, v91, s[8:11], 0 offen sc1
 s_sub_u32 s38, s38, 1
 s_cbranch_scc1 L3_pollm_ok
 s_waitcnt vmcnt(0)
 v_cmp_ne_u32 vcc, 8, v92
 s_cmp_lg_u64 vcc, 0
 s_cbranch_scc1 L3_pollm
L3_pollm_ok:
 s_waitcnt vmcnt(0)
 s_barrier
 s_add_u32 s3, s32, 19165696
 buffer_load_dwordx4 v[128:131], v88, s[8:11], s3 offen offset:0 sc1
 buffer_load_dwordx4 v[132:135], v88, s[8:11], s3 offen offset:1024 sc1
 buffer_load_dwordx4 v[136:139], v88, s[8:11], s3 offen offset:2048 sc1
 buffer_load_dwordx4 v[140:143], v88, s[8:11], s3 offen offset:3072 sc1
 buffer_load_dwordx4 a[160:163], v89, s[8:11], s3 offen offset:0 sc1
 buffer_load_dwordx4 a[164:167], v89, s[8:11], s3 offen offset:1024 sc1
 s_add_u32 s3, s32, 21524992
 buffer_load_dwordx4 v[144:147], v88, s[8:11], s3 offen offset:0 sc1
 buffer_load_dwordx4 v[148:151], v88, s[8:11], s3 offen offset:1024 sc1
 buffer_load_dwordx4 v[152:155], v88, s[8:11], s3 offen offset:2048 sc1
 buffer_load_dwordx4 v[156:159], v88, s[8:11], s3 offen offset:3072 sc1
 buffer_load_dwordx4 a[168:171], v89, s[8:11], s3 offen offset:0 sc1
 buffer_load_dwordx4 a[172:175], v89, s[8:11], s3 offen offset:1024 sc1
 s_add_u32 s3, s32, 23884288
 buffer_load_dwordx4 v[160:163], v88, s[8:11], s3 offen offset:0 sc1
 buffer_load_dwordx4 v[164:167], v88, s[8:11], s3 offen offset:1024 sc1
 buffer_load_dwordx4 v[168:171], v88, s[8:11], s3 offen offset:2048 sc1
 buffer_load_dwordx4 v[172:175], v88, s[8:11], s3 offen offset:3072 sc1
 buffer_load_dwordx4 a[176:179], v89, s[8:11], s3 offen offset:0 sc1
 buffer_load_dwordx4 a[180:183], v89, s[8:11], s3 offen offset:1024 sc1
 s_cmp_lg_u32 s25, s29
 s_cbranch_scc1 L3_nox
 s_lshl_b32 s4, s22, 6
 v_xor_b32 v74, s4, v74
 v_xor_b32 v76, s4, v76
 ds_read_b64_tr_b16 v[48:49], v74 offset:24576
 ds_read_b64_tr_b16 v[50:51], v74 offset:25600
 ds_read_b64_tr_b16 v[56:57], v74 offset:26624
 ds_read_b64_tr_b16 v[58:59], v74 offset:27648
 s_waitcnt lgkmcnt(2)
 v_mfma_f32_32x32x16_bf16 v[32:47], v[48:51], a[0:3], v[32:47]
 ds_read_b64_tr_b16 v[64:65], v74 offset:28672
 ds_read_b64_tr_b16 v[66:67], v74 offset:29696
 s_waitcnt lgkmcnt(2)
 v_mfma_f32_32x32x16_bf16 v[32:47], v[56:59], a[4:7], v[32:47]
 ds_read_b64_tr_b16 v[48:49], v74 offset:30720
 ds_read_b64_tr_b16 v[50:51], v74 offset:31744
 s_waitcnt lgkmcnt(2)
 v_mfma_f32_32x32x16_bf16 v[32:47], v[64:67], a[8:11], v[32:47]
 ds_read_b64_tr_b16 v[56:57], v74 offset:32768
 ds_read_b64_tr_b16 v[58:59], v74 offset:33792
 s_waitcnt lgkmcnt(2)
 v_mfma_f32_32x32x16_bf16 v[32:47], v[48:51], a[12:15], v[32:47]
 ds_read_b64_tr_b16 v[64:65], v74 offset:34816
 ds_read_b64_tr_b16 v[66:67], v74 offset:35840
 s_waitcnt lgkmcnt(2)
 v_mfma_f32_32x32x16_bf16 v[32:47], v[56:59], a[16:19], v[32:47]
 ds_read_b64_tr_b16 v[48:49], v74 offset:36864
 ds_read_b64_tr_b16 v[50:51], v74 offset:37888
 s_waitcnt lgkmcnt(2)
 v_mfma_f32_32x32x16_bf16 v[32:47], v[64:67], a[20:23], v[32:47]
 ds_read_b64_tr_b16 v[56:57], v74 offset:38912
 ds_read_b64_tr_b16 v[58:59], v74 offset:39936
 s_waitcnt lgkmcnt(2)
 v_mfma_f32_32x32x16_bf16 v[32:47], v[48:51], a[24:27], v[32:47]
 ds_read_b64_tr_b16 v[64:65], v74 offset:40960
 ds_read_b64_tr_b16 v[66:67], v74 offset:41984
 s_waitcnt lgkmcnt(2)
 v_mfma_f32_32x32x16_bf16 v[32:47], v[56:59], a[28:31], v[32:47]
 ds_read_b64_tr_b16 v[48:49], v74 offset:43008
 ds_read_b64_tr_b16 v[50:51], v74 offset:44032
 s_waitcnt lgkmcnt(2)
 v_mfma_f32_32x32x16_bf16 v[32:47], v[64:67], a[32:35], v[32:47]
 ds_read_b64_tr_b16 v[56:57], v74 offset:45056
 ds_read_b64_tr_b16 v[58:59], v74 offset:46080
 s_waitcnt lgkmcnt(2)
 v_mfma_f32_32x32x16_bf16 v[32:47], v[48:51], a[36:39], v[32:47]
 ds_read_b64_tr_b16 v[64:65], v74 offset:47104
 ds_read_b64_tr_b16 v[66:67], v74 offset:48128
 s_waitcnt lgkmcnt(2)
 v_mfma_f32_32x32x16_bf16 v[32:47], v[56:59], a[40:43], v[32:47]
 ds_read_b64_tr_b16 v[48:49], v76 offset:0
 ds_read_b64_tr_b16 v[50:51], v76 offset:1024
 s_waitcnt lgkmcnt(2)
 v_mfma_f32_32x32x16_bf16 v[32:47], v[64:67], a[44:47], v[32:47]
 ds_read_b64_tr_b16 v[56:57], v76 offset:2048
 ds_read_b64_tr_b16 v[58:59], v76 offset:3072
 s_waitcnt lgkmcnt(2)
 v_mfma_f32_32x32x16_bf16 v[32:47], v[48:51], a[48:51], v[32:47]
 ds_read_b64_tr_b16 v[64:65], v76 offset:4096
 ds_read_b64_tr_b16 v[66:67], v76 offset:5120
 s_waitcnt lgkmcnt(2)
 v_mfma_f32_32x32x16_bf16 v[32:47], v[56:59], a[52:55], v[32:47]
 ds_read_b64_tr_b16 v[48:49], v76 offset:6144
 ds_read_b64_tr_b16 v[50:51], v76 offset:7168
 s_waitcnt lgkmcnt(2)
 v_mfma_f32_32x32x16_bf16 v[32:47], v[64:67], a[56:59], v[32:47]
 ds_read_b64_tr_b16 v[56:57], v76 offset:8192
 ds_read_b64_tr_b16 v[58:59], v76 offset:9216
 s_waitcnt lgkmcnt(2)
 v_mfma_f32_32x32x16_bf16 v[32:47], v[48:51], a[60:63], v[32:47]
 ds_read_b64_tr_b16 v[64:65], v76 offset:10240
 ds_read_b64_tr_b16 v[66:67], v76 offset:11264
 s_waitcnt lgkmcnt(2)
 v_mfma_f32_32x32x16_bf16 v[32:47], v[56:59], a[64:67], v[32:47]
 ds_read_b64_tr_b16 v[48:49], v76 offset:12288
 ds_read_b64_tr_b16 v[50:51], v76 offset:13312
 s_waitcnt lgkmcnt(2)
 v_mfma_f32_32x32x16_bf16 v[32:47], v[64:67], a[68:71], v[32:47]
 ds_read_b64_tr_b16 v[56:57], v76 offset:14336
 ds_read_b64_tr_b16 v[58:59], v76 offset:15360
 s_waitcnt lgkmcnt(2)
 v_mfma_f32_32x32x16_bf16 v[32:47], v[48:51], a[72:75], v[32:47]
 ds_read_b64_tr_b16 v[64:65], v76 offset:16384
 ds_read_b64_tr_b16 v[66:67], v76 offset:17408
 s_waitcnt lgkmcnt(2)
 v_mfma_f32_32x32x16_bf16 v[32:47], v[56:59], a[76:79], v[32:47]
 ds_read_b64_tr_b16 v[48:49], v76 offset:18432
 ds_read_b64_tr_b16 v[50:51], v76 offset:19456
 s_waitcnt lgkmcnt(2)
 v_mfma_f32_32x32x16_bf16 v[32:47], v[64:67], a[80:83], v[32:47]
 ds_read_b64_tr_b16 v[56:57], v76 offset:20480
 ds_read_b64_tr_b16 v[58:59], v76 offset:21504
 s_waitcnt lgkmcnt(2)
 v_mfma_f32_32x32x16_bf16 v[32:47], v[48:51], a[84:87], v[32:47]
 ds_read_b64_tr_b16 v[64:65], v76 offset:22528
 ds_read_b64_tr_b16 v[66:67], v76 offset:23552
 s_waitcnt lgkmcnt(2)
 v_mfma_f32_32x32x16_bf16 v[32:47], v[56:59], a[88:91], v[32:47]
 ds_read_b64_tr_b16 v[48:49], v76 offset:24576
 ds_read_b64_tr_b16 v[50:51], v76 offset:25600
 s_waitcnt lgkmcnt(2)
 v_mfma_f32_32x32x16_bf16 v[32:47], v[64:67], a[92:95], v[32:47]
 ds_read_b64_tr_b16 v[56:57], v76 offset:26624
 ds_read_b64_tr_b16 v[58:59], v76 offset:27648
 s_waitcnt lgkmcnt(2)
 v_mfma_f32_32x32x16_bf16 v[32:47], v[48:51], a[96:99], v[32:47]
 ds_read_b64_tr_b16 v[64:65], v76 offset:28672
 ds_read_b64_tr_b16 v[66:67], v76 offset:29696
 s_waitcnt lgkmcnt(2)
 v_mfma_f32_32x32x16_bf16 v[32:47], v[56:59], a[100:103], v[32:47]
 ds_read_b64_tr_b16 v[48:49], v76 offset:30720
 ds_read_b64_tr_b16 v[50:51], v76 offset:31744
 s_waitcnt lgkmcnt(2)
 v_mfma_f32_32x32x16_bf16 v[32:47], v[64:67], a[104:107], v[32:47]
 ds_read_b64_tr_b16 v[56:57], v76 offset:32768
 ds_read_b64_tr_b16 v[58:59], v76 offset:33792
 s_waitcnt lgkmcnt(2)
 v_mfma_f32_32x32x16_bf16 v[32:47], v[48:51], a[108:111], v[32:47]
 ds_read_b64_tr_b16 v[64:65], v76 offset:34816
 ds_read_b64_tr_b16 v[66:67], v76 offset:35840
 s_waitcnt lgkmcnt(2)
 v_mfma_f32_32x32x16_bf16 v[32:47], v[56:59], a[112:115], v[32:47]
 ds_read_b64_tr_b16 v[48:49], v76 offset:36864
 ds_read_b64_tr_b16 v[50:51], v76 offset:37888
 s_waitcnt lgkmcnt(2)
 v_mfma_f32_32x32x16_bf16 v[32:47], v[64:67], a[116:119], v[32:47]
 ds_read_b64_tr_b16 v[56:57], v76 offset:38912
 ds_read_b64_tr_b16 v[58:59], v76 offset:39936
 s_waitcnt lgkmcnt(2)
 v_mfma_f32_32x32x16_bf16 v[32:47], v[48:51], a[120:123], v[32:47]
 ds_read_b64_tr_b16 v[64:65], v76 offset:40960
 ds_read_b64_tr_b16 v[66:67], v76 offset:41984
 s_waitcnt lgkmcnt(2)
 v_mfma_f32_32x32x16_bf16 v[32:47], v[56:59], a[124:127], v[32:47]
 ds_read_b64_tr_b16 v[48:49], v76 offset:43008
 ds_read_b64_tr_b16 v[50:51], v76 offset:44032
 s_waitcnt lgkmcnt(2)
 v_mfma_f32_32x32x16_bf16 v[32:47], v[64:67], a[128:131], v[32:47]
 ds_read_b64_tr_b16 v[56:57], v76 offset:45056
 ds_read_b64_tr_b16 v[58:59], v76 offset:46080
 s_waitcnt lgkmcnt(2)
 v_mfma_f32_32x32x16_bf16 v[32:47], v[48:51], a[132:135], v[32:47]
 ds_read_b64_tr_b16 v[64:65], v76 offset:47104
 ds_read_b64_tr_b16 v[66:67], v76 offset:48128
 s_waitcnt lgkmcnt(2)
 v_mfma_f32_32x32x16_bf16 v[32:47], v[56:59], a[136:139], v[32:47]
 s_waitcnt lgkmcnt(0)
 v_mfma_f32_32x32x16_bf16 v[32:47], v[64:67], a[140:143], v[32:47]
L3_nox:
 s_mul_i32 s4, s24, 36864
 s_lshl_b32 s5, s22, 6
 s_add_u32 s5, s5, 1024
 s_cmp_eq_u32 s25, s29
 s_cselect_b32 s5, s5, 0x40000000
 s_add_u32 s5, s5, s4
 s_add_u32 s4, s4, s23
 v_and_b32 v90, 31, v95
 v_mul_u32_u24 v90, 1152, v90
 v_lshrrev_b32 v91, 5, v95
 v_lshl_add_u32 v90, v91, 4, v90
 s_add_u32 s3, s32, 26243584
 buffer_load_dwordx4 v[176:179], v88, s[8:11], s3 offen offset:0 sc1
 buffer_load_dwordx4 v[180:183], v88, s[8:11], s3 offen offset:1024 sc1
 buffer_load_dwordx4 v[184:187], v88, s[8:11], s3 offen offset:2048 sc1
 buffer_load_dwordx4 v[188:191], v88, s[8:11], s3 offen offset:3072 sc1
 buffer_load_dwordx4 a[184:187], v89, s[8:11], s3 offen offset:0 sc1
 buffer_load_dwordx4 a[188:191], v89, s[8:11], s3 offen offset:1024 sc1
 s_waitcnt vmcnt(18)
 v_mfma_f32_32x32x16_bf16 v[0:15], v[80:83], v[128:131], v[0:15]
 v_mfma_f32_32x32x16_bf16 v[16:31], v[80:83], v[136:139], v[16:31]
 v_mfma_f32_32x32x16_bf16 v[0:15], v[84:87], v[132:135], v[0:15]
 v_mfma_f32_32x32x16_bf16 v[16:31], v[84:87], v[140:143], v[16:31]
 v_mfma_f32_32x32x16_bf16 v[32:47], v[80:83], a[160:163], v[32:47]
 v_mfma_f32_32x32x16_bf16 v[32:47], v[84:87], a[164:167], v[32:47]
 s_add_u32 s3, s32, 28602880
 buffer_load_dwordx4 v[192:195], v88, s[8:11], s3 offen offset:0 sc1
 buffer_load_dwordx4 v[196:199], v88, s[8:11], s3 offen offset:1024 sc1
 buffer_load_dwordx4 v[200:203], v88, s[8:11], s3 offen offset:2048 sc1
 buffer_load_dwordx4 v[204:207], v88, s[8:11], s3 offen offset:3072 sc1
 buffer_load_dwordx4 a[192:195], v89, s[8:11], s3 offen offset:0 sc1
 buffer_load_dwordx4 a[196:199], v89, s[8:11], s3 offen offset:1024 sc1
 s_waitcnt vmcnt(18)
 v_mfma_f32_32x32x16_bf16 v[0:15], v[80:83], v[144:147], v[0:15]
 v_mfma_f32_32x32x16_bf16 v[16:31], v[80:83], v[152:155], v[16:31]
 v_mfma_f32_32x32x16_bf16 v[0:15], v[84:87], v[148:151], v[0:15]
 v_mfma_f32_32x32x16_bf16 v[16:31], v[84:87], v[156:159], v[16:31]
 v_mfma_f32_32x32x16_bf16 v[32:47], v[80:83], a[168:171], v[32:47]
 v_mfma_f32_32x32x16_bf16 v[32:47], v[84:87], a[172:175], v[32:47]
 s_add_u32 s3, s32, 30962176
 buffer_load_dwordx4 v[208:211], v88, s[8:11], s3 offen offset:0 sc1
 buffer_load_dwordx4 v[212:215], v88, s[8:11], s3 offen offset:1024 sc1
 buffer_load_dwordx4 v[216:219], v88, s[8:11], s3 offen offset:2048 sc1
 buffer_load_dwordx4 v[220:223], v88, s[8:11], s3 offen offset:3072 sc1
 buffer_load_dwordx4 a[200:203], v89, s[8:11], s3 offen offset:0 sc1
 buffer_load_dwordx4 a[204:207], v89, s[8:11], s3 offen offset:1024 sc1
 s_waitcnt vmcnt(18)
 v_mfma_f32_32x32x16_bf16 v[0:15], v[80:83], v[160:163], v[0:15]
 v_mfma_f32_32x32x16_bf16 v[16:31], v[80:83], v[168:171], v[16:31]
 v_mfma_f32_32x32x16_bf16 v[0:15], v[84:87], v[164:167], v[0:15]
 v_mfma_f32_32x32x16_bf16 v[16:31], v[84:87], v[172:175], v[16:31]
 v_mfma_f32_32x32x16_bf16 v[32:47], v[80:83], a[176:179], v[32:47]
 v_mfma_f32_32x32x16_bf16 v[32:47], v[84:87], a[180:183], v[32:47]
 s_add_u32 s3, s32, 33321472
 buffer_load_dwordx4 v[224:227], v88, s[8:11], s3 offen offset:0 sc1
 buffer_load_dwordx4 v[228:231], v88, s[8:11], s3 offen offset:1024 sc1
 buffer_load_dwordx4 v[232:235], v88, s[8:11], s3 offen offset:2048 sc1
 buffer_load_dwordx4 v[236:239], v88, s[8:11], s3 offen offset:3072 sc1
 buffer_load_dwordx4 a[208:211], v89, s[8:11], s3 offen offset:0 sc1
 buffer_load_dwordx4 a[212:215], v89, s[8:11], s3 offen offset:1024 sc1
 s_waitcnt vmcnt(18)
 v_mfma_f32_32x32x16_bf16 v[0:15], v[80:83], v[176:179], v[0:15]
 v_mfma_f32_32x32x16_bf16 v[16:31], v[80:83], v[184:187], v[16:31]
 v_mfma_f32_32x32x16_bf16 v[0:15], v[84:87], v[180:183], v[0:15]
 v_mfma_f32_32x32x16_bf16 v[16:31], v[84:87], v[188:191], v[16:31]
 v_mfma_f32_32x32x16_bf16 v[32:47], v[80:83], a[184:187], v[32:47]
 v_mfma_f32_32x32x16_bf16 v[32:47], v[84:87], a[188:191], v[32:47]
 s_add_u32 s3, s32, 35680768
 buffer_load_dwordx4 v[240:243], v88, s[8:11], s3 offen offset:0 sc1
 buffer_load_dwordx4 v[244:247], v88, s[8:11], s3 offen offset:1024 sc1
 buffer_load_dwordx4 v[248:251], v88, s[8:11], s3 offen offset:2048 sc1
 buffer_load_dwordx4 v[252:255], v88, s[8:11], s3 offen offset:3072 sc1
 buffer_load_dwordx4 a[216:219], v89, s[8:11], s3 offen offset:0 sc1
 buffer_load_dwordx4 a[220:223], v89, s[8:11], s3 offen offset:1024 sc1
 s_waitcnt vmcnt(18)
 v_mfma_f32_32x32x16_bf16 v[0:15], v[80:83], v[192:195], v[0:15]
 v_mfma_f32_32x32x16_bf16 v[16:31], v[80:83], v[200:203], v[16:31]
 v_mfma_f32_32x32x16_bf16 v[0:15], v[84:87], v[196:199], v[0:15]
 v_mfma_f32_32x32x16_bf16 v[16:31], v[84:87], v[204:207], v[16:31]
 v_mfma_f32_32x32x16_bf16 v[32:47], v[80:83], a[192:195], v[32:47]
 v_mfma_f32_32x32x16_bf16 v[32:47], v[84:87], a[196:199], v[32:47]
 s_waitcnt vmcnt(12)
 v_mfma_f32_32x32x16_bf16 v[0:15], v[80:83], v[208:211], v[0:15]
 v_mfma_f32_32x32x16_bf16 v[16:31], v[80:83], v[216:219], v[16:31]
 v_mfma_f32_32x32x16_bf16 v[0:15], v[84:87], v[212:215], v[0:15]
 v_mfma_f32_32x32x16_bf16 v[16:31], v[84:87], v[220:223], v[16:31]
 v_mfma_f32_32x32x16_bf16 v[32:47], v[80:83], a[200:203], v[32:47]
 v_mfma_f32_32x32x16_bf16 v[32:47], v[84:87], a[204:207], v[32:47]
 s_waitcnt vmcnt(6)
 v_mfma_f32_32x32x16_bf16 v[0:15], v[80:83], v[224:227], v[0:15]
 v_mfma_f32_32x32x16_bf16 v[16:31], v[80:83], v[232:235], v[16:31]
 v_mfma_f32_32x32x16_bf16 v[0:15], v[84:87], v[228:231], v[0:15]
 v_mfma_f32_32x32x16_bf16 v[16:31], v[84:87], v[236:239], v[16:31]
 v_mfma_f32_32x32x16_bf16 v[32:47], v[80:83], a[208:211], v[32:47]
 v_mfma_f32_32x32x16_bf16 v[32:47], v[84:87], a[212:215], v[32:47]
 s_waitcnt vmcnt(0)
 v_mfma_f32_32x32x16_bf16 v[0:15], v[80:83], v[240:243], v[0:15]
 v_mfma_f32_32x32x16_bf16 v[16:31], v[80:83], v[248:251], v[16:31]
 v_mfma_f32_32x32x16_bf16 v[0:15], v[84:87], v[244:247], v[0:15]
 v_mfma_f32_32x32x16_bf16 v[16:31], v[84:87], v[252:255], v[16:31]
 v_mfma_f32_32x32x16_bf16 v[32:47], v[80:83], a[216:219], v[32:47]
 v_mfma_f32_32x32x16_bf16 v[32:47], v[84:87], a[220:223], v[32:47]
 s_nop 9
 v_cvt_pk_bf16_f32 v0, v0, v1
 v_cvt_pk_bf16_f32 v1, v2, v3
 v_cvt_pk_bf16_f32 v2, v4, v5
 v_cvt_pk_bf16_f32 v3, v6, v7
 s_nop 1
 v_permlane32_swap_b32 v0, v2
 v_permlane32_swap_b32 v1, v3
 buffer_store_dwordx4 v[0:3], v90, s[16:19], s4 offen offset:0
 v_cvt_pk_bf16_f32 v8, v8, v9
 v_cvt_pk_bf16_f32 v9, v10, v11
 v_cvt_pk_bf16_f32 v10, v12, v13
 v_cvt_pk_bf16_f32 v11, v14, v15
 s_nop 1
 v_permlane32_swap_b32 v8, v10
 v_permlane32_swap_b32 v9, v11
 buffer_store_dwordx4 v[8:11], v90, s[16:19], s4 offen offset:32
 v_cvt_pk_bf16_f32 v16, v16, v17
 v_cvt_pk_bf16_f32 v17, v18, v19
 v_cvt_pk_bf16_f32 v18, v20, v21
 v_cvt_pk_bf16_f32 v19, v22, v23
 s_nop 1
 v_permlane32_swap_b32 v16, v18
 v_permlane32_swap_b32 v17, v19
 buffer_store_dwordx4 v[16:19], v90, s[16:19], s4 offen offset:64
 v_cvt_pk_bf16_f32 v24, v24, v25
 v_cvt_pk_bf16_f32 v25, v26, v27
 v_cvt_pk_bf16_f32 v26, v28, v29
 v_cvt_pk_bf16_f32 v27, v30, v31
 s_nop 1
 v_permlane32_swap_b32 v24, v26
 v_permlane32_swap_b32 v25, v27
 buffer_store_dwordx4 v[24:27], v90, s[16:19], s4 offen offset:96
 v_cvt_pk_bf16_f32 v32, v32, v33
 v_cvt_pk_bf16_f32 v33, v34, v35
 v_cvt_pk_bf16_f32 v34, v36, v37
 v_cvt_pk_bf16_f32 v35, v38, v39
 s_nop 1
 v_permlane32_swap_b32 v32, v34
 v_permlane32_swap_b32 v33, v35
 buffer_store_dwordx4 v[32:35], v90, s[16:19], s5 offen offset:0
 v_cvt_pk_bf16_f32 v40, v40, v41
 v_cvt_pk_bf16_f32 v41, v42, v43
 v_cvt_pk_bf16_f32 v42, v44, v45
 v_cvt_pk_bf16_f32 v43, v46, v47
 s_nop 1
 v_permlane32_swap_b32 v40, v42
 v_permlane32_swap_b32 v41, v43
 buffer_store_dwordx4 v[40:43], v90, s[16:19], s5 offen offset:32
L3_end:
 s_endpgm
L3_redo:
 s_cmp_eq_u32 s33, 1
 s_cbranch_scc1 L3_fin
 s_mov_b32 s33, 1
 s_mov_b32 s34, 0
 s_mov_b32 s30, 2359296
 s_mov_b32 s37, 2359296
 s_mov_b32 s32, 64
 s_waitcnt vmcnt(0)
 v_mov_b32 v13, 0
 v_mov_b32 v200, 0xff800000
 v_mov_b32 v19, 0
 v_mov_b32 v201, 0xff800000
 v_mov_b32 v25, 0
 v_mov_b32 v202, 0xff800000
 v_mov_b32 v31, 0
 v_mov_b32 v203, 0xff800000
 buffer_load_dwordx2 v[136:137], v1, s[8:11], s30 offen sc1
 buffer_load_dwordx2 v[138:139], v2, s[8:11], s30 offen sc1
 buffer_load_dword v140, v3, s[8:11], s30 offen sc1
 buffer_load_dwordx4 v[144:147], v4, s[8:11], s30 offen sc1
 buffer_load_dwordx4 v[148:151], v5, s[8:11], s30 offen sc1
 s_add_u32 s30, s30, 74240
 buffer_load_dwordx2 v[152:153], v1, s[8:11], s30 offen sc1
 buffer_load_dwordx2 v[154:155], v2, s[8:11], s30 offen sc1
 buffer_load_dword v156, v3, s[8:11], s30 offen sc1
 buffer_load_dwordx4 v[160:163], v4, s[8:11], s30 offen sc1
 buffer_load_dwordx4 v[164:167], v5, s[8:11], s30 offen sc1
 s_add_u32 s30, s30, 74240
 buffer_load_dwordx2 v[168:169], v1, s[8:11], s30 offen sc1
 buffer_load_dwordx2 v[170:171], v2, s[8:11], s30 offen sc1
 buffer_load_dword v172, v3, s[8:11], s30 offen sc1
 buffer_load_dwordx4 v[176:179], v4, s[8:11], s30 offen sc1
 buffer_load_dwordx4 v[180:183], v5, s[8:11], s30 offen sc1
 s_add_u32 s30, s30, 74240
L3_maxl:
 buffer_load_dwordx2 v[184:185], v1, s[8:11], s37 offen sc1
 buffer_load_dwordx2 v[186:187], v2, s[8:11], s37 offen sc1
 buffer_load_dword v188, v3, s[8:11], s37 offen sc1
 s_add_u32 s37, s37, 74240
 s_waitcnt vmcnt(0)
 v_mfma_f32_32x32x16_bf16 v[72:87], v[184:187], v[8:11], 0
 v_mfma_f32_32x32x8_bf16 v[72:87], v[188:189], v[12:13], v[72:87]
 v_mfma_f32_32x32x16_bf16 v[88:103], v[184:187], v[14:17], 0
 v_mfma_f32_32x32x8_bf16 v[88:103], v[188:189], v[18:19], v[88:103]
 v_mfma_f32_32x32x16_bf16 v[104:119], v[184:187], v[20:23], 0
 v_mfma_f32_32x32x8_bf16 v[104:119], v[188:189], v[24:25], v[104:119]
 v_mfma_f32_32x32x16_bf16 v[120:135], v[184:187], v[26:29], 0
 v_mfma_f32_32x32x8_bf16 v[120:135], v[188:189], v[30:31], v[120:135]
 s_nop 5
 v_max3_f32 v200, v72, v73, v200
 v_max3_f32 v200, v74, v75, v200
 v_max3_f32 v200, v76, v77, v200
 v_max3_f32 v200, v78, v79, v200
 v_max3_f32 v200, v80, v81, v200
 v_max3_f32 v200, v82, v83, v200
 v_max3_f32 v200, v84, v85, v200
 v_max3_f32 v200, v86, v87, v200
 v_max3_f32 v201, v88, v89, v201
 v_max3_f32 v201, v90, v91, v201
 v_max3_f32 v201, v92, v93, v201
 v_max3_f32 v201, v94, v95, v201
 v_max3_f32 v201, v96, v97, v201
 v_max3_f32 v201, v98, v99, v201
 v_max3_f32 v201, v100, v101, v201
 v_max3_f32 v201, v102, v103, v201
 v_max3_f32 v202, v104, v105, v202
 v_max3_f32 v202, v106, v107, v202
 v_max3_f32 v202, v108, v109, v202
 v_max3_f32 v202, v110, v111, v202
 v_max3_f32 v202, v112, v113, v202
 v_max3_f32 v202, v114, v115, v202
 v_max3_f32 v202, v116, v117, v202
 v_max3_f32 v202, v118, v119, v202
 v_max3_f32 v203, v120, v121, v203
 v_max3_f32 v203, v122, v123, v203
 v_max3_f32 v203, v124, v125, v203
 v_max3_f32 v203, v126, v127, v203
 v_max3_f32 v203, v128, v129, v203
 v_max3_f32 v203, v130, v131, v203
 v_max3_f32 v203, v132, v133, v203
 v_max3_f32 v203, v134, v135, v203
 s_sub_u32 s32, s32, 1
 s_cmp_lg_u32 s32, 0
 s_cbranch_scc1 L3_maxl
 s_branch L3_shift
.p2align 8
L_text_end:
.fill 18432, 4, 0xbf810000
.section .rodata,"a"
.p2align 6
.amdhsa_kernel parallel_sum__softmax_full_mha__mixer_s_mlp__prompt_kernel
  .amdhsa_next_free_vgpr 480
  .amdhsa_next_free_sgpr 102
  .amdhsa_accum_offset 256
  .amdhsa_group_segment_fixed_size 0
  .amdhsa_kernarg_size 88
  .amdhsa_user_sgpr_count 2
  .amdhsa_user_sgpr_kernarg_segment_ptr 1
  .amdhsa_system_sgpr_workgroup_id_x 1
.end_amdhsa_kernel
```
